```python
import torch

def _softmax(x, axis=-1):
    return torch.softmax(x, dim=axis)
def _gelu(x):
    return torch.nn.functional.gelu(x, approximate="tanh")
def _silu(x):
    return torch.nn.functional.silu(x)
def _sigmoid(x):
    return torch.sigmoid(x)
def _layernorm(x, axis=-1, eps=1e-5):
    m = x.mean(dim=axis, keepdim=True)
    v = x.var(dim=axis, keepdim=True, unbiased=False)
    return (x - m) / torch.sqrt(v + eps)
def _scatter_add(tgt, idx, src, axis=0):
    return tgt.clone().index_add_(axis, idx, src)
def _segment_sum(src, seg, n):
    out = torch.zeros((n,) + src.shape[1:], dtype=src.dtype)
    return out.index_add_(0, seg, src)
def _pad(x, pw):
    flat = tuple(v for pair in reversed(pw) for v in pair)
    return torch.nn.functional.pad(x, flat)

kernel_name = 'recurrent_scan__gqa_block_cached__mixer_token_mlp__decode'

def setup_inputs():

    _w = (lambda a: (lambda t: t.to(torch.bfloat16) if t.is_floating_point() else t)(torch.as_tensor(a)))
    def _A_setup():
        B, Sq, D = 4, 1, 576
        Hq, Hkv, Sk, Dh = 32, 16, 8192, 128
        assert Hq % Hkv == 0, (Hq, Hkv)
        return {
            "x": _w((lambda *s: torch.randn(*s, dtype=torch.bfloat16) * 0.05)(B, Sq, D)),
            "k_cache": _w((lambda *s: torch.randn(*s, dtype=torch.bfloat16) * 1.6)(B, Hkv, Sk, Dh)),
            "v_cache": _w((lambda *s: torch.randn(*s, dtype=torch.bfloat16) * 1.6)(B, Hkv, Sk, Dh)),
            "wq": _w((lambda *s: torch.randn(*s, dtype=torch.bfloat16) * 1.6)(D, Hq * Dh) * (D ** -0.5)),
            "wo": _w((lambda *s: torch.randn(*s, dtype=torch.bfloat16) * 1.6)(Hq * Dh, D) * ((Hq * Dh) ** -0.5)),
        }
    _A_in = _A_setup()

    def _B_setup():
        B, S, D, F = 4, 1, 576, 4608
        return {
            "x": _w((lambda *s: torch.randn(*s, dtype=torch.bfloat16) * 0.05)(B, S, D)),
            "w1": _w((lambda *s: torch.randn(*s, dtype=torch.bfloat16) * 0.2)(S, F) * (S ** -0.5)),
            "b1": _w((lambda *s: torch.randn(*s, dtype=torch.bfloat16) * 0.2)(F) * 0.02),
            "w2": _w((lambda *s: torch.randn(*s, dtype=torch.bfloat16) * 0.2)(F, S) * (F ** -0.5)),
            "b2": _w((lambda *s: torch.randn(*s, dtype=torch.bfloat16) * 0.2)(S) * 0.02),
        }
    _B_in = _B_setup()

    return {
        "A_x": _A_in["x"],
        "A_k_cache": _A_in["k_cache"],
        "A_v_cache": _A_in["v_cache"],
        "A_wq": _A_in["wq"],
        "A_wo": _A_in["wo"],
        "B_x": _B_in["x"],
        "B_w1": _B_in["w1"],
        "B_b1": _B_in["b1"],
        "B_w2": _B_in["w2"],
        "B_b2": _B_in["b2"],
    }

def reference(A_x, A_k_cache, A_v_cache, A_wq, A_wo, B_x, B_w1, B_b1, B_w2, B_b2):
    def _A_ref(x, k_cache, v_cache, wq, wo):
        B, Sq, D = x.shape
        Hq, Dh = 32, 128
        Hkv = k_cache.shape[1]
        rep = Hq // Hkv
        q = (lambda x, *d: x.permute(*d))((x @ wq).reshape(B, Sq, Hq, Dh), 0, 2, 1, 3)
        k = (lambda x, n, axis: torch.repeat_interleave(x, n, dim=axis))(k_cache, rep, axis=1)
        v = (lambda x, n, axis: torch.repeat_interleave(x, n, dim=axis))(v_cache, rep, axis=1)
        scores = torch.einsum("bhqd,bhkd->bhqk", q, k) * (Dh ** -0.5)
        p = _softmax(scores, axis=-1)
        o = torch.einsum("bhqk,bhkd->bhqd", p, v)
        return (lambda x, *d: x.permute(*d))(o, 0, 2, 1, 3).reshape(B, Sq, Hq * Dh) @ wo

    def _B_ref(x, w1, b1, w2, b2):
        B, S, D = x.shape
        h = _layernorm(x, axis=-1)
        u = torch.einsum("bsd,sf->bdf", h, w1) + b1
        u = _gelu(u)
        y = torch.einsum("bdf,fs->bds", u, w2) + b2
        return (lambda x, *d: x.permute(*d))(y, 0, 2, 1)

    x = A_x
    xn = _layernorm(x, axis=-1)
    s = _A_ref(xn, A_k_cache, A_v_cache, A_wq, A_wo)
    g = _silu(_B_ref(xn, B_w1, B_b1, B_w2, B_b2))
    return x + s * g
```

```asm
; @launch grid=(256,1,1) block=(512,1,1) lds=155648
.amdgcn_target "amdgcn-amd-amdhsa--gfx950"
.text
.globl recurrent_scan__gqa_block_cached__mixer_token_mlp__decode_kernel
.p2align 8
.type recurrent_scan__gqa_block_cached__mixer_token_mlp__decode_kernel,@function
recurrent_scan__gqa_block_cached__mixer_token_mlp__decode_kernel:
  s_cmp_ge_u32 s2, 256
  s_cbranch_scc1 K1_END
  s_load_dwordx16 s[36:51], s[0:1], 0
  s_load_dwordx8 s[52:59], s[0:1], 64
  s_load_dwordx2 s[60:61], s[0:1], 96
  s_getreg_b32 s100, hwreg(HW_REG_XCC_ID, 0, 4)
  s_and_b32 s100, s100, 7
  s_bfe_u32 s83, s2, 65542
  s_lshl_b32 s62, s100, 1
  s_or_b32 s62, s62, s83
  s_mov_b32 s85, 0x05040100
  s_mov_b32 s86, 0x07060302
  s_mov_b32 s87, 0xffff0000
  s_mov_b32 s88, 0x3db504f3
  s_mov_b32 s89, 0x3fb8aa3b
  v_and_b32 v1, 63, v0
  v_lshrrev_b32 v5, 6, v0
  s_nop 0
  v_readfirstlane_b32 s82, v5
  v_lshlrev_b32 v2, 4, v1
  v_lshl_add_u32 v2, v5, 12, v2
  v_mul_u32_u24 v6, 18, v1
  v_lshrrev_b32 v7, 5, v0
  v_mul_u32_u24 v7, 294912, v7
  v_and_b32 v40, 31, v0
  v_lshl_add_u32 v7, v40, 4, v7
  s_waitcnt lgkmcnt(0)
  s_cmp_eq_u32 s82, 7
  s_cbranch_scc1 K1_TK
  s_and_b32 s83, s82, 3
  s_mul_i32 s83, s83, 1152
  s_add_u32 s20, s36, s83
  s_addc_u32 s21, s37, 0
  s_mov_b32 s22, 1152
  s_mov_b32 s23, 0x20000
  buffer_load_ushort v16, v6, s[20:23], 0 offen offset:0
  buffer_load_ushort v17, v6, s[20:23], 0 offen offset:2
  buffer_load_ushort v18, v6, s[20:23], 0 offen offset:4
  buffer_load_ushort v19, v6, s[20:23], 0 offen offset:6
  buffer_load_ushort v20, v6, s[20:23], 0 offen offset:8
  buffer_load_ushort v21, v6, s[20:23], 0 offen offset:10
  buffer_load_ushort v22, v6, s[20:23], 0 offen offset:12
  buffer_load_ushort v23, v6, s[20:23], 0 offen offset:14
  buffer_load_ushort v24, v6, s[20:23], 0 offen offset:16
  v_add_u32 v6, s83, v6
  s_lshl_b32 s83, s62, 9
  s_sub_u32 s84, 4718592, s83
  s_add_u32 s12, s42, s83
  s_addc_u32 s13, s43, 0
  s_mov_b32 s14, s84
  s_mov_b32 s15, 0x20000
  s_bitcmp1_b32 s2, 7
  s_cbranch_scc1 K1_GB
  s_mov_b32 s96, 0
  buffer_load_dwordx4 v[48:51], v7, s[12:15], s96 offen
  s_mov_b32 s96, 8192
  buffer_load_dwordx4 v[52:55], v7, s[12:15], s96 offen
  s_mov_b32 s96, 16384
  buffer_load_dwordx4 v[56:59], v7, s[12:15], s96 offen
  s_mov_b32 s96, 24576
  buffer_load_dwordx4 v[60:63], v7, s[12:15], s96 offen
  s_mov_b32 s96, 32768
  buffer_load_dwordx4 v[64:67], v7, s[12:15], s96 offen
  s_mov_b32 s96, 40960
  buffer_load_dwordx4 v[68:71], v7, s[12:15], s96 offen
  s_mov_b32 s96, 49152
  buffer_load_dwordx4 v[72:75], v7, s[12:15], s96 offen
  s_mov_b32 s96, 57344
  buffer_load_dwordx4 v[76:79], v7, s[12:15], s96 offen
  s_mov_b32 s96, 65536
  buffer_load_dwordx4 v[80:83], v7, s[12:15], s96 offen
  s_mov_b32 s96, 73728
  buffer_load_dwordx4 v[84:87], v7, s[12:15], s96 offen
  s_mov_b32 s96, 81920
  buffer_load_dwordx4 v[88:91], v7, s[12:15], s96 offen
  s_mov_b32 s96, 90112
  buffer_load_dwordx4 v[92:95], v7, s[12:15], s96 offen
  s_mov_b32 s96, 98304
  buffer_load_dwordx4 v[96:99], v7, s[12:15], s96 offen
  s_mov_b32 s96, 106496
  buffer_load_dwordx4 v[100:103], v7, s[12:15], s96 offen
  s_mov_b32 s96, 114688
  buffer_load_dwordx4 v[104:107], v7, s[12:15], s96 offen
  s_mov_b32 s96, 122880
  buffer_load_dwordx4 v[108:111], v7, s[12:15], s96 offen
  s_mov_b32 s96, 131072
  buffer_load_dwordx4 v[112:115], v7, s[12:15], s96 offen
  s_mov_b32 s96, 139264
  buffer_load_dwordx4 v[116:119], v7, s[12:15], s96 offen
  s_mov_b32 s96, 147456
  buffer_load_dwordx4 v[120:123], v7, s[12:15], s96 offen
  s_mov_b32 s96, 155648
  buffer_load_dwordx4 v[124:127], v7, s[12:15], s96 offen
  s_mov_b32 s96, 163840
  buffer_load_dwordx4 v[128:131], v7, s[12:15], s96 offen
  s_mov_b32 s96, 172032
  buffer_load_dwordx4 v[132:135], v7, s[12:15], s96 offen
  s_mov_b32 s96, 180224
  buffer_load_dwordx4 v[136:139], v7, s[12:15], s96 offen
  s_mov_b32 s96, 188416
  buffer_load_dwordx4 v[140:143], v7, s[12:15], s96 offen
  s_mov_b32 s96, 196608
  buffer_load_dwordx4 v[144:147], v7, s[12:15], s96 offen
  s_waitcnt vmcnt(25)
  v_lshlrev_b32 v16, 16, v16
  v_lshlrev_b32 v17, 16, v17
  v_lshlrev_b32 v18, 16, v18
  v_lshlrev_b32 v19, 16, v19
  v_lshlrev_b32 v20, 16, v20
  v_lshlrev_b32 v21, 16, v21
  v_lshlrev_b32 v22, 16, v22
  v_lshlrev_b32 v23, 16, v23
  v_lshlrev_b32 v24, 16, v24
  v_add_f32 v34, v16, v17
  v_add_f32 v34, v34, v18
  v_add_f32 v34, v34, v19
  v_add_f32 v34, v34, v20
  v_add_f32 v34, v34, v21
  v_add_f32 v34, v34, v22
  v_add_f32 v34, v34, v23
  v_add_f32 v34, v34, v24
  s_nop 1
  v_add_f32_dpp v34, v34, v34 row_ror:8 row_mask:0xf bank_mask:0xf
  s_nop 1
  v_add_f32_dpp v34, v34, v34 row_ror:4 row_mask:0xf bank_mask:0xf
  s_nop 1
  v_add_f32_dpp v34, v34, v34 row_ror:2 row_mask:0xf bank_mask:0xf
  s_nop 1
  v_add_f32_dpp v34, v34, v34 row_ror:1 row_mask:0xf bank_mask:0xf
  v_mov_b32 v35, v34
  s_nop 1
  v_permlane16_swap_b32 v34, v35
  v_add_f32 v34, v34, v35
  v_mov_b32 v35, v34
  s_nop 1
  v_permlane32_swap_b32 v34, v35
  v_add_f32 v34, v34, v35
  v_mul_f32 v36, 0x3ae38e39, v34
  v_sub_f32 v25, v16, v36
  v_sub_f32 v26, v17, v36
  v_sub_f32 v27, v18, v36
  v_sub_f32 v28, v19, v36
  v_sub_f32 v29, v20, v36
  v_sub_f32 v30, v21, v36
  v_sub_f32 v31, v22, v36
  v_sub_f32 v32, v23, v36
  v_sub_f32 v33, v24, v36
  v_mul_f32 v37, v25, v25
  v_fmac_f32 v37, v26, v26
  v_fmac_f32 v37, v27, v27
  v_fmac_f32 v37, v28, v28
  v_fmac_f32 v37, v29, v29
  v_fmac_f32 v37, v30, v30
  v_fmac_f32 v37, v31, v31
  v_fmac_f32 v37, v32, v32
  v_fmac_f32 v37, v33, v33
  s_nop 1
  v_add_f32_dpp v37, v37, v37 row_ror:8 row_mask:0xf bank_mask:0xf
  s_nop 1
  v_add_f32_dpp v37, v37, v37 row_ror:4 row_mask:0xf bank_mask:0xf
  s_nop 1
  v_add_f32_dpp v37, v37, v37 row_ror:2 row_mask:0xf bank_mask:0xf
  s_nop 1
  v_add_f32_dpp v37, v37, v37 row_ror:1 row_mask:0xf bank_mask:0xf
  v_mov_b32 v35, v37
  s_nop 1
  v_permlane16_swap_b32 v37, v35
  v_add_f32 v37, v37, v35
  v_mov_b32 v35, v37
  s_nop 1
  v_permlane32_swap_b32 v37, v35
  v_add_f32 v37, v37, v35
  v_mul_f32 v37, 0x3ae38e39, v37
  v_cvt_pk_bf16_f32 v35, v36, v37
  v_lshlrev_b32 v36, 16, v35
  v_and_b32 v37, s87, v35
  v_add_f32 v37, 0x3727c5ac, v37
  v_cvt_pk_bf16_f32 v37, v37, v37
  v_and_b32 v37, s87, v37
  v_sqrt_f32 v38, v37
  s_nop 0
  v_cvt_pk_bf16_f32 v38, v38, v38
  v_and_b32 v38, s87, v38
  v_rcp_f32 v39, v38
  v_sub_f32 v25, v16, v36
  v_sub_f32 v26, v17, v36
  v_sub_f32 v27, v18, v36
  v_sub_f32 v28, v19, v36
  v_sub_f32 v29, v20, v36
  v_sub_f32 v30, v21, v36
  v_sub_f32 v31, v22, v36
  v_sub_f32 v32, v23, v36
  v_sub_f32 v33, v24, v36
  v_cvt_pk_bf16_f32 v35, v25, v26
  v_lshlrev_b32 v25, 16, v35
  v_and_b32 v26, s87, v35
  v_cvt_pk_bf16_f32 v35, v27, v28
  v_lshlrev_b32 v27, 16, v35
  v_and_b32 v28, s87, v35
  v_cvt_pk_bf16_f32 v35, v29, v30
  v_lshlrev_b32 v29, 16, v35
  v_and_b32 v30, s87, v35
  v_cvt_pk_bf16_f32 v35, v31, v32
  v_lshlrev_b32 v31, 16, v35
  v_and_b32 v32, s87, v35
  v_cvt_pk_bf16_f32 v33, v33, v33
  v_and_b32 v33, s87, v33
  v_mul_f32 v34, v25, v39
  v_fma_f32 v35, -v34, v38, v25
  v_fma_f32 v25, v35, v39, v34
  v_mul_f32 v34, v26, v39
  v_fma_f32 v35, -v34, v38, v26
  v_fma_f32 v26, v35, v39, v34
  v_mul_f32 v34, v27, v39
  v_fma_f32 v35, -v34, v38, v27
  v_fma_f32 v27, v35, v39, v34
  v_mul_f32 v34, v28, v39
  v_fma_f32 v35, -v34, v38, v28
  v_fma_f32 v28, v35, v39, v34
  v_mul_f32 v34, v29, v39
  v_fma_f32 v35, -v34, v38, v29
  v_fma_f32 v29, v35, v39, v34
  v_mul_f32 v34, v30, v39
  v_fma_f32 v35, -v34, v38, v30
  v_fma_f32 v30, v35, v39, v34
  v_mul_f32 v34, v31, v39
  v_fma_f32 v35, -v34, v38, v31
  v_fma_f32 v31, v35, v39, v34
  v_mul_f32 v34, v32, v39
  v_fma_f32 v35, -v34, v38, v32
  v_fma_f32 v32, v35, v39, v34
  v_mul_f32 v34, v33, v39
  v_fma_f32 v35, -v34, v38, v33
  v_fma_f32 v33, v35, v39, v34
  v_cvt_pk_bf16_f32 v35, v25, v26
  v_lshlrev_b32 v25, 16, v35
  v_and_b32 v26, s87, v35
  v_cvt_pk_bf16_f32 v35, v27, v28
  v_lshlrev_b32 v27, 16, v35
  v_and_b32 v28, s87, v35
  v_cvt_pk_bf16_f32 v35, v29, v30
  v_lshlrev_b32 v29, 16, v35
  v_and_b32 v30, s87, v35
  v_cvt_pk_bf16_f32 v35, v31, v32
  v_lshlrev_b32 v31, 16, v35
  v_and_b32 v32, s87, v35
  v_cvt_pk_bf16_f32 v33, v33, v33
  v_and_b32 v33, s87, v33
  ds_write_b16_d16_hi v6, v25 offset:0
  ds_write_b16_d16_hi v6, v26 offset:2
  ds_write_b16_d16_hi v6, v27 offset:4
  ds_write_b16_d16_hi v6, v28 offset:6
  ds_write_b16_d16_hi v6, v29 offset:8
  ds_write_b16_d16_hi v6, v30 offset:10
  ds_write_b16_d16_hi v6, v31 offset:12
  ds_write_b16_d16_hi v6, v32 offset:14
  ds_write_b16_d16_hi v6, v33 offset:16
  s_mov_b32 s96, 204800
  buffer_load_dwordx4 v[148:151], v7, s[12:15], s96 offen
  s_mov_b32 s96, 212992
  buffer_load_dwordx4 v[152:155], v7, s[12:15], s96 offen
  s_mov_b32 s96, 221184
  buffer_load_dwordx4 v[156:159], v7, s[12:15], s96 offen
  s_mov_b32 s96, 229376
  buffer_load_dwordx4 v[160:163], v7, s[12:15], s96 offen
  s_mov_b32 s96, 237568
  buffer_load_dwordx4 v[164:167], v7, s[12:15], s96 offen
  s_mov_b32 s96, 245760
  buffer_load_dwordx4 v[168:171], v7, s[12:15], s96 offen
  s_mov_b32 s96, 253952
  buffer_load_dwordx4 v[172:175], v7, s[12:15], s96 offen
  s_mov_b32 s96, 262144
  buffer_load_dwordx4 v[176:179], v7, s[12:15], s96 offen
  s_mov_b32 s96, 270336
  buffer_load_dwordx4 v[180:183], v7, s[12:15], s96 offen
  s_mov_b32 s96, 278528
  buffer_load_dwordx4 v[184:187], v7, s[12:15], s96 offen
  s_mov_b32 s96, 286720
  buffer_load_dwordx4 v[188:191], v7, s[12:15], s96 offen
  s_waitcnt lgkmcnt(0)
  s_barrier
  v_mov_b32 v41, 0
  ds_read_b32 v40, v41 offset:9408
  s_waitcnt lgkmcnt(0)
  v_readfirstlane_b32 s101, v40
  s_mov_b32 s91, s62
  s_nop 1
  s_lshr_b32 s62, s101, 4
  s_and_b32 s62, s62, 15
  s_and_b32 s63, s101, 3
  s_bfe_u32 s80, s101, 131074
  s_lshl_b32 s81, s62, 2
  s_or_b32 s81, s81, s63
  s_lshl_b32 s90, s80, 6
  s_or_b32 s90, s90, s81
  s_lshl_b32 s83, s90, 19
  s_add_u32 s4, s38, s83
  s_addc_u32 s5, s39, 0
  s_mov_b32 s6, 524288
  s_mov_b32 s7, 0x20000
  s_add_u32 s8, s40, s83
  s_addc_u32 s9, s41, 0
  s_mov_b32 s10, 524288
  s_mov_b32 s11, 0x20000
  s_mul_i32 s83, s90, 5120
  s_add_u32 s28, s60, s83
  s_addc_u32 s29, s61, 0
  s_mov_b32 s30, 5120
  s_mov_b32 s31, 0x20000
  s_cmp_eq_u32 s91, s62
  s_cbranch_scc1 K1_GOA
  s_waitcnt vmcnt(0)
K1_RQ2A:
  s_nop 4
  s_lshl_b32 s83, s62, 9
  s_sub_u32 s84, 4718592, s83
  s_add_u32 s12, s42, s83
  s_addc_u32 s13, s43, 0
  s_mov_b32 s14, s84
  s_mov_b32 s15, 0x20000
  s_mov_b32 s96, 0
  buffer_load_dwordx4 v[48:51], v7, s[12:15], s96 offen
  s_mov_b32 s96, 8192
  buffer_load_dwordx4 v[52:55], v7, s[12:15], s96 offen
  s_mov_b32 s96, 16384
  buffer_load_dwordx4 v[56:59], v7, s[12:15], s96 offen
  s_mov_b32 s96, 24576
  buffer_load_dwordx4 v[60:63], v7, s[12:15], s96 offen
  s_mov_b32 s96, 32768
  buffer_load_dwordx4 v[64:67], v7, s[12:15], s96 offen
  s_mov_b32 s96, 40960
  buffer_load_dwordx4 v[68:71], v7, s[12:15], s96 offen
  s_mov_b32 s96, 49152
  buffer_load_dwordx4 v[72:75], v7, s[12:15], s96 offen
  s_mov_b32 s96, 57344
  buffer_load_dwordx4 v[76:79], v7, s[12:15], s96 offen
  s_mov_b32 s96, 65536
  buffer_load_dwordx4 v[80:83], v7, s[12:15], s96 offen
  s_mov_b32 s96, 73728
  buffer_load_dwordx4 v[84:87], v7, s[12:15], s96 offen
  s_mov_b32 s96, 81920
  buffer_load_dwordx4 v[88:91], v7, s[12:15], s96 offen
  s_mov_b32 s96, 90112
  buffer_load_dwordx4 v[92:95], v7, s[12:15], s96 offen
  s_mov_b32 s96, 98304
  buffer_load_dwordx4 v[96:99], v7, s[12:15], s96 offen
  s_mov_b32 s96, 106496
  buffer_load_dwordx4 v[100:103], v7, s[12:15], s96 offen
  s_mov_b32 s96, 114688
  buffer_load_dwordx4 v[104:107], v7, s[12:15], s96 offen
  s_mov_b32 s96, 122880
  buffer_load_dwordx4 v[108:111], v7, s[12:15], s96 offen
  s_mov_b32 s96, 131072
  buffer_load_dwordx4 v[112:115], v7, s[12:15], s96 offen
  s_mov_b32 s96, 139264
  buffer_load_dwordx4 v[116:119], v7, s[12:15], s96 offen
  s_mov_b32 s96, 147456
  buffer_load_dwordx4 v[120:123], v7, s[12:15], s96 offen
  s_mov_b32 s96, 155648
  buffer_load_dwordx4 v[124:127], v7, s[12:15], s96 offen
  s_mov_b32 s96, 163840
  buffer_load_dwordx4 v[128:131], v7, s[12:15], s96 offen
  s_mov_b32 s96, 172032
  buffer_load_dwordx4 v[132:135], v7, s[12:15], s96 offen
  s_mov_b32 s96, 180224
  buffer_load_dwordx4 v[136:139], v7, s[12:15], s96 offen
  s_mov_b32 s96, 188416
  buffer_load_dwordx4 v[140:143], v7, s[12:15], s96 offen
  s_mov_b32 s96, 196608
  buffer_load_dwordx4 v[144:147], v7, s[12:15], s96 offen
  s_mov_b32 s96, 204800
  buffer_load_dwordx4 v[148:151], v7, s[12:15], s96 offen
  s_mov_b32 s96, 212992
  buffer_load_dwordx4 v[152:155], v7, s[12:15], s96 offen
  s_mov_b32 s96, 221184
  buffer_load_dwordx4 v[156:159], v7, s[12:15], s96 offen
  s_mov_b32 s96, 229376
  buffer_load_dwordx4 v[160:163], v7, s[12:15], s96 offen
  s_mov_b32 s96, 237568
  buffer_load_dwordx4 v[164:167], v7, s[12:15], s96 offen
  s_mov_b32 s96, 245760
  buffer_load_dwordx4 v[168:171], v7, s[12:15], s96 offen
  s_mov_b32 s96, 253952
  buffer_load_dwordx4 v[172:175], v7, s[12:15], s96 offen
  s_mov_b32 s96, 262144
  buffer_load_dwordx4 v[176:179], v7, s[12:15], s96 offen
  s_mov_b32 s96, 270336
  buffer_load_dwordx4 v[180:183], v7, s[12:15], s96 offen
  s_mov_b32 s96, 278528
  buffer_load_dwordx4 v[184:187], v7, s[12:15], s96 offen
  s_mov_b32 s96, 286720
  buffer_load_dwordx4 v[188:191], v7, s[12:15], s96 offen
K1_GOA:
  s_nop 4
  s_mov_b32 s83, 0
  buffer_load_dwordx4 v[192:195], v2, s[4:7], s83 offen offset:0 nt
  s_mov_b32 s83, 0
  buffer_load_dwordx4 v[196:199], v2, s[4:7], s83 offen offset:1024 nt
  s_mov_b32 s83, 0
  buffer_load_dwordx4 v[200:203], v2, s[4:7], s83 offen offset:2048 nt
  s_mov_b32 s83, 0
  buffer_load_dwordx4 v[204:207], v2, s[4:7], s83 offen offset:3072 nt
  s_mov_b32 s83, 0
  buffer_load_dwordx4 v[208:211], v2, s[8:11], s83 offen offset:0 nt
  s_mov_b32 s83, 0
  buffer_load_dwordx4 v[212:215], v2, s[8:11], s83 offen offset:1024 nt
  s_mov_b32 s83, 0
  buffer_load_dwordx4 v[216:219], v2, s[8:11], s83 offen offset:2048 nt
  s_mov_b32 s83, 0
  buffer_load_dwordx4 v[220:223], v2, s[8:11], s83 offen offset:3072 nt
  s_mul_i32 s83, s62, 294912
  s_add_u32 s16, s44, s83
  s_addc_u32 s17, s45, 0
  s_mov_b32 s18, 294912
  s_mov_b32 s19, 0x20000
  s_mov_b32 s24, s48
  s_mov_b32 s25, s49
  s_mov_b32 s26, 9216
  s_mov_b32 s27, 0x20000
  s_mov_b32 s32, s50
  s_mov_b32 s33, s51
  s_mov_b32 s34, 9216
  s_mov_b32 s35, 0x20000
  s_mov_b32 s92, s52
  s_mov_b32 s93, s53
  s_mov_b32 s94, 9216
  s_mov_b32 s95, 0x20000
  v_lshrrev_b32 v5, 5, v0
  v_mul_u32_u24 v5, 72, v5
  s_mul_i32 s83, s80, 1152
  v_add_u32 v5, s83, v5
  ds_read_b64 v[16:17], v5 offset:0
  ds_read_b64 v[18:19], v5 offset:8
  ds_read_b64 v[20:21], v5 offset:16
  ds_read_b64 v[22:23], v5 offset:24
  ds_read_b64 v[24:25], v5 offset:32
  ds_read_b64 v[26:27], v5 offset:40
  ds_read_b64 v[28:29], v5 offset:48
  ds_read_b64 v[30:31], v5 offset:56
  ds_read_b64 v[32:33], v5 offset:64
  s_waitcnt lgkmcnt(0)
  s_waitcnt vmcnt(42)
  v_perm_b32 v42, v52, v48, s85
  v_perm_b32 v43, v52, v48, s86
  v_perm_b32 v44, v53, v49, s85
  v_perm_b32 v45, v53, v49, s86
  v_dot2_f32_bf16 v34, v42, v16, 0
  v_dot2_f32_bf16 v35, v43, v16, 0
  v_dot2_f32_bf16 v36, v44, v16, 0
  v_dot2_f32_bf16 v37, v45, v16, 0
  v_perm_b32 v42, v54, v50, s85
  v_perm_b32 v43, v54, v50, s86
  v_perm_b32 v44, v55, v51, s85
  v_perm_b32 v45, v55, v51, s86
  v_dot2_f32_bf16 v38, v42, v16, 0
  v_dot2_f32_bf16 v39, v43, v16, 0
  v_dot2_f32_bf16 v40, v44, v16, 0
  v_dot2_f32_bf16 v41, v45, v16, 0
  s_waitcnt vmcnt(40)
  v_perm_b32 v42, v60, v56, s85
  v_perm_b32 v43, v60, v56, s86
  v_perm_b32 v44, v61, v57, s85
  v_perm_b32 v45, v61, v57, s86
  v_dot2_f32_bf16 v34, v42, v17, v34
  v_dot2_f32_bf16 v35, v43, v17, v35
  v_dot2_f32_bf16 v36, v44, v17, v36
  v_dot2_f32_bf16 v37, v45, v17, v37
  v_perm_b32 v42, v62, v58, s85
  v_perm_b32 v43, v62, v58, s86
  v_perm_b32 v44, v63, v59, s85
  v_perm_b32 v45, v63, v59, s86
  v_dot2_f32_bf16 v38, v42, v17, v38
  v_dot2_f32_bf16 v39, v43, v17, v39
  v_dot2_f32_bf16 v40, v44, v17, v40
  v_dot2_f32_bf16 v41, v45, v17, v41
  s_waitcnt vmcnt(38)
  v_perm_b32 v42, v68, v64, s85
  v_perm_b32 v43, v68, v64, s86
  v_perm_b32 v44, v69, v65, s85
  v_perm_b32 v45, v69, v65, s86
  v_dot2_f32_bf16 v34, v42, v18, v34
  v_dot2_f32_bf16 v35, v43, v18, v35
  v_dot2_f32_bf16 v36, v44, v18, v36
  v_dot2_f32_bf16 v37, v45, v18, v37
  v_perm_b32 v42, v70, v66, s85
  v_perm_b32 v43, v70, v66, s86
  v_perm_b32 v44, v71, v67, s85
  v_perm_b32 v45, v71, v67, s86
  v_dot2_f32_bf16 v38, v42, v18, v38
  v_dot2_f32_bf16 v39, v43, v18, v39
  v_dot2_f32_bf16 v40, v44, v18, v40
  v_dot2_f32_bf16 v41, v45, v18, v41
  s_waitcnt vmcnt(36)
  v_perm_b32 v42, v76, v72, s85
  v_perm_b32 v43, v76, v72, s86
  v_perm_b32 v44, v77, v73, s85
  v_perm_b32 v45, v77, v73, s86
  v_dot2_f32_bf16 v34, v42, v19, v34
  v_dot2_f32_bf16 v35, v43, v19, v35
  v_dot2_f32_bf16 v36, v44, v19, v36
  v_dot2_f32_bf16 v37, v45, v19, v37
  v_perm_b32 v42, v78, v74, s85
  v_perm_b32 v43, v78, v74, s86
  v_perm_b32 v44, v79, v75, s85
  v_perm_b32 v45, v79, v75, s86
  v_dot2_f32_bf16 v38, v42, v19, v38
  v_dot2_f32_bf16 v39, v43, v19, v39
  v_dot2_f32_bf16 v40, v44, v19, v40
  v_dot2_f32_bf16 v41, v45, v19, v41
  s_waitcnt vmcnt(34)
  v_perm_b32 v42, v84, v80, s85
  v_perm_b32 v43, v84, v80, s86
  v_perm_b32 v44, v85, v81, s85
  v_perm_b32 v45, v85, v81, s86
  v_dot2_f32_bf16 v34, v42, v20, v34
  v_dot2_f32_bf16 v35, v43, v20, v35
  v_dot2_f32_bf16 v36, v44, v20, v36
  v_dot2_f32_bf16 v37, v45, v20, v37
  v_perm_b32 v42, v86, v82, s85
  v_perm_b32 v43, v86, v82, s86
  v_perm_b32 v44, v87, v83, s85
  v_perm_b32 v45, v87, v83, s86
  v_dot2_f32_bf16 v38, v42, v20, v38
  v_dot2_f32_bf16 v39, v43, v20, v39
  v_dot2_f32_bf16 v40, v44, v20, v40
  v_dot2_f32_bf16 v41, v45, v20, v41
  s_waitcnt vmcnt(32)
  v_perm_b32 v42, v92, v88, s85
  v_perm_b32 v43, v92, v88, s86
  v_perm_b32 v44, v93, v89, s85
  v_perm_b32 v45, v93, v89, s86
  v_dot2_f32_bf16 v34, v42, v21, v34
  v_dot2_f32_bf16 v35, v43, v21, v35
  v_dot2_f32_bf16 v36, v44, v21, v36
  v_dot2_f32_bf16 v37, v45, v21, v37
  v_perm_b32 v42, v94, v90, s85
  v_perm_b32 v43, v94, v90, s86
  v_perm_b32 v44, v95, v91, s85
  v_perm_b32 v45, v95, v91, s86
  v_dot2_f32_bf16 v38, v42, v21, v38
  v_dot2_f32_bf16 v39, v43, v21, v39
  v_dot2_f32_bf16 v40, v44, v21, v40
  v_dot2_f32_bf16 v41, v45, v21, v41
  s_waitcnt vmcnt(30)
  v_perm_b32 v42, v100, v96, s85
  v_perm_b32 v43, v100, v96, s86
  v_perm_b32 v44, v101, v97, s85
  v_perm_b32 v45, v101, v97, s86
  v_dot2_f32_bf16 v34, v42, v22, v34
  v_dot2_f32_bf16 v35, v43, v22, v35
  v_dot2_f32_bf16 v36, v44, v22, v36
  v_dot2_f32_bf16 v37, v45, v22, v37
  v_perm_b32 v42, v102, v98, s85
  v_perm_b32 v43, v102, v98, s86
  v_perm_b32 v44, v103, v99, s85
  v_perm_b32 v45, v103, v99, s86
  v_dot2_f32_bf16 v38, v42, v22, v38
  v_dot2_f32_bf16 v39, v43, v22, v39
  v_dot2_f32_bf16 v40, v44, v22, v40
  v_dot2_f32_bf16 v41, v45, v22, v41
  s_waitcnt vmcnt(28)
  v_perm_b32 v42, v108, v104, s85
  v_perm_b32 v43, v108, v104, s86
  v_perm_b32 v44, v109, v105, s85
  v_perm_b32 v45, v109, v105, s86
  v_dot2_f32_bf16 v34, v42, v23, v34
  v_dot2_f32_bf16 v35, v43, v23, v35
  v_dot2_f32_bf16 v36, v44, v23, v36
  v_dot2_f32_bf16 v37, v45, v23, v37
  v_perm_b32 v42, v110, v106, s85
  v_perm_b32 v43, v110, v106, s86
  v_perm_b32 v44, v111, v107, s85
  v_perm_b32 v45, v111, v107, s86
  v_dot2_f32_bf16 v38, v42, v23, v38
  v_dot2_f32_bf16 v39, v43, v23, v39
  v_dot2_f32_bf16 v40, v44, v23, v40
  v_dot2_f32_bf16 v41, v45, v23, v41
  s_waitcnt vmcnt(26)
  v_perm_b32 v42, v116, v112, s85
  v_perm_b32 v43, v116, v112, s86
  v_perm_b32 v44, v117, v113, s85
  v_perm_b32 v45, v117, v113, s86
  v_dot2_f32_bf16 v34, v42, v24, v34
  v_dot2_f32_bf16 v35, v43, v24, v35
  v_dot2_f32_bf16 v36, v44, v24, v36
  v_dot2_f32_bf16 v37, v45, v24, v37
  v_perm_b32 v42, v118, v114, s85
  v_perm_b32 v43, v118, v114, s86
  v_perm_b32 v44, v119, v115, s85
  v_perm_b32 v45, v119, v115, s86
  v_dot2_f32_bf16 v38, v42, v24, v38
  v_dot2_f32_bf16 v39, v43, v24, v39
  v_dot2_f32_bf16 v40, v44, v24, v40
  v_dot2_f32_bf16 v41, v45, v24, v41
  s_waitcnt vmcnt(24)
  v_perm_b32 v42, v124, v120, s85
  v_perm_b32 v43, v124, v120, s86
  v_perm_b32 v44, v125, v121, s85
  v_perm_b32 v45, v125, v121, s86
  v_dot2_f32_bf16 v34, v42, v25, v34
  v_dot2_f32_bf16 v35, v43, v25, v35
  v_dot2_f32_bf16 v36, v44, v25, v36
  v_dot2_f32_bf16 v37, v45, v25, v37
  v_perm_b32 v42, v126, v122, s85
  v_perm_b32 v43, v126, v122, s86
  v_perm_b32 v44, v127, v123, s85
  v_perm_b32 v45, v127, v123, s86
  v_dot2_f32_bf16 v38, v42, v25, v38
  v_dot2_f32_bf16 v39, v43, v25, v39
  v_dot2_f32_bf16 v40, v44, v25, v40
  v_dot2_f32_bf16 v41, v45, v25, v41
  s_waitcnt vmcnt(22)
  v_perm_b32 v42, v132, v128, s85
  v_perm_b32 v43, v132, v128, s86
  v_perm_b32 v44, v133, v129, s85
  v_perm_b32 v45, v133, v129, s86
  v_dot2_f32_bf16 v34, v42, v26, v34
  v_dot2_f32_bf16 v35, v43, v26, v35
  v_dot2_f32_bf16 v36, v44, v26, v36
  v_dot2_f32_bf16 v37, v45, v26, v37
  v_perm_b32 v42, v134, v130, s85
  v_perm_b32 v43, v134, v130, s86
  v_perm_b32 v44, v135, v131, s85
  v_perm_b32 v45, v135, v131, s86
  v_dot2_f32_bf16 v38, v42, v26, v38
  v_dot2_f32_bf16 v39, v43, v26, v39
  v_dot2_f32_bf16 v40, v44, v26, v40
  v_dot2_f32_bf16 v41, v45, v26, v41
  s_waitcnt vmcnt(20)
  v_perm_b32 v42, v140, v136, s85
  v_perm_b32 v43, v140, v136, s86
  v_perm_b32 v44, v141, v137, s85
  v_perm_b32 v45, v141, v137, s86
  v_dot2_f32_bf16 v34, v42, v27, v34
  v_dot2_f32_bf16 v35, v43, v27, v35
  v_dot2_f32_bf16 v36, v44, v27, v36
  v_dot2_f32_bf16 v37, v45, v27, v37
  v_perm_b32 v42, v142, v138, s85
  v_perm_b32 v43, v142, v138, s86
  v_perm_b32 v44, v143, v139, s85
  v_perm_b32 v45, v143, v139, s86
  v_dot2_f32_bf16 v38, v42, v27, v38
  v_dot2_f32_bf16 v39, v43, v27, v39
  v_dot2_f32_bf16 v40, v44, v27, v40
  v_dot2_f32_bf16 v41, v45, v27, v41
  s_waitcnt vmcnt(18)
  v_perm_b32 v42, v148, v144, s85
  v_perm_b32 v43, v148, v144, s86
  v_perm_b32 v44, v149, v145, s85
  v_perm_b32 v45, v149, v145, s86
  v_dot2_f32_bf16 v34, v42, v28, v34
  v_dot2_f32_bf16 v35, v43, v28, v35
  v_dot2_f32_bf16 v36, v44, v28, v36
  v_dot2_f32_bf16 v37, v45, v28, v37
  v_perm_b32 v42, v150, v146, s85
  v_perm_b32 v43, v150, v146, s86
  v_perm_b32 v44, v151, v147, s85
  v_perm_b32 v45, v151, v147, s86
  v_dot2_f32_bf16 v38, v42, v28, v38
  v_dot2_f32_bf16 v39, v43, v28, v39
  v_dot2_f32_bf16 v40, v44, v28, v40
  v_dot2_f32_bf16 v41, v45, v28, v41
  s_waitcnt vmcnt(16)
  v_perm_b32 v42, v156, v152, s85
  v_perm_b32 v43, v156, v152, s86
  v_perm_b32 v44, v157, v153, s85
  v_perm_b32 v45, v157, v153, s86
  v_dot2_f32_bf16 v34, v42, v29, v34
  v_dot2_f32_bf16 v35, v43, v29, v35
  v_dot2_f32_bf16 v36, v44, v29, v36
  v_dot2_f32_bf16 v37, v45, v29, v37
  v_perm_b32 v42, v158, v154, s85
  v_perm_b32 v43, v158, v154, s86
  v_perm_b32 v44, v159, v155, s85
  v_perm_b32 v45, v159, v155, s86
  v_dot2_f32_bf16 v38, v42, v29, v38
  v_dot2_f32_bf16 v39, v43, v29, v39
  v_dot2_f32_bf16 v40, v44, v29, v40
  v_dot2_f32_bf16 v41, v45, v29, v41
  s_waitcnt vmcnt(14)
  v_perm_b32 v42, v164, v160, s85
  v_perm_b32 v43, v164, v160, s86
  v_perm_b32 v44, v165, v161, s85
  v_perm_b32 v45, v165, v161, s86
  v_dot2_f32_bf16 v34, v42, v30, v34
  v_dot2_f32_bf16 v35, v43, v30, v35
  v_dot2_f32_bf16 v36, v44, v30, v36
  v_dot2_f32_bf16 v37, v45, v30, v37
  v_perm_b32 v42, v166, v162, s85
  v_perm_b32 v43, v166, v162, s86
  v_perm_b32 v44, v167, v163, s85
  v_perm_b32 v45, v167, v163, s86
  v_dot2_f32_bf16 v38, v42, v30, v38
  v_dot2_f32_bf16 v39, v43, v30, v39
  v_dot2_f32_bf16 v40, v44, v30, v40
  v_dot2_f32_bf16 v41, v45, v30, v41
  s_waitcnt vmcnt(12)
  v_perm_b32 v42, v172, v168, s85
  v_perm_b32 v43, v172, v168, s86
  v_perm_b32 v44, v173, v169, s85
  v_perm_b32 v45, v173, v169, s86
  v_dot2_f32_bf16 v34, v42, v31, v34
  v_dot2_f32_bf16 v35, v43, v31, v35
  v_dot2_f32_bf16 v36, v44, v31, v36
  v_dot2_f32_bf16 v37, v45, v31, v37
  v_perm_b32 v42, v174, v170, s85
  v_perm_b32 v43, v174, v170, s86
  v_perm_b32 v44, v175, v171, s85
  v_perm_b32 v45, v175, v171, s86
  v_dot2_f32_bf16 v38, v42, v31, v38
  v_dot2_f32_bf16 v39, v43, v31, v39
  v_dot2_f32_bf16 v40, v44, v31, v40
  v_dot2_f32_bf16 v41, v45, v31, v41
  s_waitcnt vmcnt(10)
  v_perm_b32 v42, v180, v176, s85
  v_perm_b32 v43, v180, v176, s86
  v_perm_b32 v44, v181, v177, s85
  v_perm_b32 v45, v181, v177, s86
  v_dot2_f32_bf16 v34, v42, v32, v34
  v_dot2_f32_bf16 v35, v43, v32, v35
  v_dot2_f32_bf16 v36, v44, v32, v36
  v_dot2_f32_bf16 v37, v45, v32, v37
  v_perm_b32 v42, v182, v178, s85
  v_perm_b32 v43, v182, v178, s86
  v_perm_b32 v44, v183, v179, s85
  v_perm_b32 v45, v183, v179, s86
  v_dot2_f32_bf16 v38, v42, v32, v38
  v_dot2_f32_bf16 v39, v43, v32, v39
  v_dot2_f32_bf16 v40, v44, v32, v40
  v_dot2_f32_bf16 v41, v45, v32, v41
  s_waitcnt vmcnt(8)
  v_perm_b32 v42, v188, v184, s85
  v_perm_b32 v43, v188, v184, s86
  v_perm_b32 v44, v189, v185, s85
  v_perm_b32 v45, v189, v185, s86
  v_dot2_f32_bf16 v34, v42, v33, v34
  v_dot2_f32_bf16 v35, v43, v33, v35
  v_dot2_f32_bf16 v36, v44, v33, v36
  v_dot2_f32_bf16 v37, v45, v33, v37
  v_perm_b32 v42, v190, v186, s85
  v_perm_b32 v43, v190, v186, s86
  v_perm_b32 v44, v191, v187, s85
  v_perm_b32 v45, v191, v187, s86
  v_dot2_f32_bf16 v38, v42, v33, v38
  v_dot2_f32_bf16 v39, v43, v33, v39
  v_dot2_f32_bf16 v40, v44, v33, v40
  v_dot2_f32_bf16 v41, v45, v33, v41
  v_lshlrev_b32 v5, 4, v0
  v_lshlrev_b32 v6, 1, v0
  buffer_load_dwordx4 v[128:131], v5, s[24:27], 0 offen
  s_movk_i32 s83, 8192
  buffer_load_ushort v140, v6, s[24:27], s83 offen
  buffer_load_dwordx4 v[132:135], v5, s[32:35], 0 offen
  s_movk_i32 s83, 8192
  buffer_load_ushort v141, v6, s[32:35], s83 offen
  buffer_load_dwordx4 v[136:139], v5, s[92:95], 0 offen
  s_movk_i32 s83, 8192
  buffer_load_ushort v142, v6, s[92:95], s83 offen
  v_permlane32_swap_b32 v34, v38
  v_permlane32_swap_b32 v35, v39
  v_permlane32_swap_b32 v36, v40
  v_permlane32_swap_b32 v37, v41
  v_add_f32 v34, v34, v38
  v_add_f32 v35, v35, v39
  v_add_f32 v36, v36, v40
  v_add_f32 v37, v37, v41
  v_and_b32 v5, 31, v1
  v_lshlrev_b32 v5, 5, v5
  v_lshrrev_b32 v6, 5, v1
  v_lshl_add_u32 v5, v6, 4, v5
  s_lshl_b32 s83, s82, 10
  s_add_u32 s83, s83, 147456
  v_add_u32 v5, s83, v5
  ds_write_b128 v5, v[34:37]
  s_waitcnt lgkmcnt(0)
  s_barrier
  v_lshlrev_b32 v5, 4, v1
  v_add_u32 v5, 147456, v5
  ds_read_b128 v[48:51], v5 offset:0
  ds_read_b128 v[52:55], v5 offset:1024
  ds_read_b128 v[56:59], v5 offset:2048
  ds_read_b128 v[60:63], v5 offset:3072
  ds_read_b128 v[64:67], v5 offset:4096
  ds_read_b128 v[68:71], v5 offset:5120
  ds_read_b128 v[72:75], v5 offset:6144
  ds_read_b128 v[76:79], v5 offset:7168
  s_waitcnt lgkmcnt(0)
  v_add_f32 v48, v48, v64
  v_add_f32 v49, v49, v65
  v_add_f32 v50, v50, v66
  v_add_f32 v51, v51, v67
  v_add_f32 v52, v52, v68
  v_add_f32 v53, v53, v69
  v_add_f32 v54, v54, v70
  v_add_f32 v55, v55, v71
  v_add_f32 v56, v56, v72
  v_add_f32 v57, v57, v73
  v_add_f32 v58, v58, v74
  v_add_f32 v59, v59, v75
  v_add_f32 v60, v60, v76
  v_add_f32 v61, v61, v77
  v_add_f32 v62, v62, v78
  v_add_f32 v63, v63, v79
  v_add_f32 v48, v48, v56
  v_add_f32 v49, v49, v57
  v_add_f32 v50, v50, v58
  v_add_f32 v51, v51, v59
  v_add_f32 v52, v52, v60
  v_add_f32 v53, v53, v61
  v_add_f32 v54, v54, v62
  v_add_f32 v55, v55, v63
  v_add_f32 v48, v48, v52
  v_add_f32 v49, v49, v53
  v_add_f32 v50, v50, v54
  v_add_f32 v51, v51, v55
  v_cvt_pk_bf16_f32 v48, v48, v49
  v_cvt_pk_bf16_f32 v49, v50, v51
  s_lshl_b32 s83, s82, 9
  v_lshlrev_b32 v5, 3, v1
  v_add_u32 v5, s83, v5
  ds_write_b64 v5, v[48:49] offset:4608
  v_and_b32 v5, 15, v1
  v_lshlrev_b32 v5, 4, v5
  v_add_u32 v5, s83, v5
  s_waitcnt lgkmcnt(0)
  ds_read_b128 v[8:11], v5 offset:4608
  ds_read_b128 v[12:15], v5 offset:4864
  s_mov_b32 s83, 32768
  buffer_load_dwordx4 v[224:227], v2, s[4:7], s83 offen offset:0 nt
  s_mov_b32 s83, 32768
  buffer_load_dwordx4 v[228:231], v2, s[4:7], s83 offen offset:1024 nt
  s_mov_b32 s83, 32768
  buffer_load_dwordx4 v[232:235], v2, s[4:7], s83 offen offset:2048 nt
  s_mov_b32 s83, 32768
  buffer_load_dwordx4 v[236:239], v2, s[4:7], s83 offen offset:3072 nt
  s_mov_b32 s83, 32768
  buffer_load_dwordx4 v[240:243], v2, s[8:11], s83 offen offset:0 nt
  s_mov_b32 s83, 32768
  buffer_load_dwordx4 v[244:247], v2, s[8:11], s83 offen offset:1024 nt
  s_mov_b32 s83, 32768
  buffer_load_dwordx4 v[248:251], v2, s[8:11], s83 offen offset:2048 nt
  s_mov_b32 s83, 32768
  buffer_load_dwordx4 v[252:255], v2, s[8:11], s83 offen offset:3072 nt
  v_mov_b32 v16, 0
  v_mov_b32 v17, 0
  v_mov_b32 v18, 0
  v_mov_b32 v19, 0
  v_mov_b32 v20, 0
  v_mov_b32 v21, 0
  v_mov_b32 v22, 0
  v_mov_b32 v23, 0
  v_mov_b32 v24, 0
  v_mov_b32 v25, 0
  v_mov_b32 v26, 0
  v_mov_b32 v27, 0
  v_mov_b32 v28, 0
  v_mov_b32 v29, 0
  v_mov_b32 v30, 0
  v_mov_b32 v31, 0
  v_mov_b32 v3, 0xf149f2ca
  v_mov_b32 v4, 0
  s_waitcnt lgkmcnt(0)
  s_mul_i32 s83, s82, 36864
  v_lshlrev_b32 v46, 4, v1
  v_add_u32 v46, s83, v46
  v_lshrrev_b32 v5, 3, v1
  v_mul_u32_u24 v5, 4608, v5
  v_and_b32 v6, 7, v1
  v_lshl_add_u32 v5, v6, 4, v5
  s_add_u32 s83, s83, 1024
  v_add_u32 v47, s83, v5
  s_waitcnt vmcnt(18)
  v_dot2_f32_bf16 v32, v192, v8, 0
  v_dot2_f32_bf16 v36, v192, v12, 0
  v_dot2_f32_bf16 v33, v196, v8, 0
  v_dot2_f32_bf16 v37, v196, v12, 0
  v_dot2_f32_bf16 v34, v200, v8, 0
  v_dot2_f32_bf16 v38, v200, v12, 0
  v_dot2_f32_bf16 v35, v204, v8, 0
  v_dot2_f32_bf16 v39, v204, v12, 0
  v_dot2_f32_bf16 v32, v193, v9, v32
  v_dot2_f32_bf16 v36, v193, v13, v36
  v_dot2_f32_bf16 v33, v197, v9, v33
  v_dot2_f32_bf16 v37, v197, v13, v37
  v_dot2_f32_bf16 v34, v201, v9, v34
  v_dot2_f32_bf16 v38, v201, v13, v38
  v_dot2_f32_bf16 v35, v205, v9, v35
  v_dot2_f32_bf16 v39, v205, v13, v39
  v_dot2_f32_bf16 v32, v194, v10, v32
  v_dot2_f32_bf16 v36, v194, v14, v36
  v_dot2_f32_bf16 v33, v198, v10, v33
  v_dot2_f32_bf16 v37, v198, v14, v37
  v_dot2_f32_bf16 v34, v202, v10, v34
  v_dot2_f32_bf16 v38, v202, v14, v38
  v_dot2_f32_bf16 v35, v206, v10, v35
  v_dot2_f32_bf16 v39, v206, v14, v39
  v_dot2_f32_bf16 v32, v195, v11, v32
  v_dot2_f32_bf16 v36, v195, v15, v36
  v_dot2_f32_bf16 v33, v199, v11, v33
  v_dot2_f32_bf16 v37, v199, v15, v37
  v_dot2_f32_bf16 v34, v203, v11, v34
  v_dot2_f32_bf16 v38, v203, v15, v38
  v_dot2_f32_bf16 v35, v207, v11, v35
  v_dot2_f32_bf16 v39, v207, v15, v39
  s_mov_b32 s83, 65536
  buffer_load_dwordx4 v[192:195], v2, s[4:7], s83 offen offset:0 nt
  buffer_load_dwordx4 v[196:199], v2, s[4:7], s83 offen offset:1024 nt
  buffer_load_dwordx4 v[200:203], v2, s[4:7], s83 offen offset:2048 nt
  buffer_load_dwordx4 v[204:207], v2, s[4:7], s83 offen offset:3072 nt
  v_add_f32_dpp v32, v32, v32 row_ror:8 row_mask:0xf bank_mask:0x3
  v_add_f32_dpp v33, v33, v33 row_ror:8 row_mask:0xf bank_mask:0x3
  v_add_f32_dpp v36, v36, v36 row_ror:8 row_mask:0xf bank_mask:0x3
  v_add_f32_dpp v37, v37, v37 row_ror:8 row_mask:0xf bank_mask:0x3
  v_add_f32_dpp v32, v34, v34 row_ror:8 row_mask:0xf bank_mask:0xc
  v_add_f32_dpp v33, v35, v35 row_ror:8 row_mask:0xf bank_mask:0xc
  v_add_f32_dpp v36, v38, v38 row_ror:8 row_mask:0xf bank_mask:0xc
  v_add_f32_dpp v37, v39, v39 row_ror:8 row_mask:0xf bank_mask:0xc
  v_add_f32_dpp v32, v32, v32 row_shl:4 row_mask:0xf bank_mask:0x5
  v_add_f32_dpp v33, v33, v33 row_shl:4 row_mask:0xf bank_mask:0x5
  s_nop 0
  v_add_f32_dpp v32, v36, v36 row_shr:4 row_mask:0xf bank_mask:0xa
  v_add_f32_dpp v33, v37, v37 row_shr:4 row_mask:0xf bank_mask:0xa
  s_nop 0
  v_add_f32_dpp v32, v32, v32 quad_perm:[1,0,3,2] row_mask:0xf bank_mask:0xf
  v_add_f32_dpp v33, v33, v33 quad_perm:[1,0,3,2] row_mask:0xf bank_mask:0xf
  s_nop 0
  v_add_f32_dpp v32, v32, v32 quad_perm:[2,3,0,1] row_mask:0xf bank_mask:0xf
  v_add_f32_dpp v33, v33, v33 quad_perm:[2,3,0,1] row_mask:0xf bank_mask:0xf
  v_cvt_pk_bf16_f32 v34, v32, v33
  v_lshlrev_b32 v32, 16, v34
  v_and_b32 v33, s87, v34
  v_mul_f32 v32, s88, v32
  v_mul_f32 v33, s88, v33
  v_cvt_pk_bf16_f32 v34, v32, v33
  v_lshlrev_b32 v32, 16, v34
  v_and_b32 v33, s87, v34
  v_max_f32 v35, v32, v33
  s_nop 1
  v_max_f32_dpp v35, v35, v35 row_ror:8 row_mask:0xf bank_mask:0xf
  v_mul_f32 v35, s89, v35
  v_max_f32 v35, v35, v3
  v_sub_f32 v36, v3, v35
  v_fma_f32 v32, v32, s89, -v35
  v_fma_f32 v33, v33, s89, -v35
  v_exp_f32 v36, v36
  v_exp_f32 v32, v32
  v_exp_f32 v33, v33
  v_mov_b32 v3, v35
  v_fma_f32 v4, v4, v36, v32
  v_cvt_pk_bf16_f32 v44, v32, v33
  v_add_f32 v4, v4, v33
  v_mul_f32_dpp v16, v36, v16 row_newbcast:0 row_mask:0xf bank_mask:0xf
  v_mul_f32_dpp v17, v36, v17 row_newbcast:0 row_mask:0xf bank_mask:0xf
  v_mul_f32_dpp v18, v36, v18 row_newbcast:0 row_mask:0xf bank_mask:0xf
  v_mul_f32_dpp v19, v36, v19 row_newbcast:0 row_mask:0xf bank_mask:0xf
  v_mul_f32_dpp v20, v36, v20 row_newbcast:0 row_mask:0xf bank_mask:0xf
  v_mul_f32_dpp v21, v36, v21 row_newbcast:0 row_mask:0xf bank_mask:0xf
  v_mul_f32_dpp v22, v36, v22 row_newbcast:0 row_mask:0xf bank_mask:0xf
  v_mul_f32_dpp v23, v36, v23 row_newbcast:0 row_mask:0xf bank_mask:0xf
  v_mul_f32_dpp v24, v36, v24 row_newbcast:4 row_mask:0xf bank_mask:0xf
  v_mul_f32_dpp v25, v36, v25 row_newbcast:4 row_mask:0xf bank_mask:0xf
  v_mul_f32_dpp v26, v36, v26 row_newbcast:4 row_mask:0xf bank_mask:0xf
  v_mul_f32_dpp v27, v36, v27 row_newbcast:4 row_mask:0xf bank_mask:0xf
  v_mul_f32_dpp v28, v36, v28 row_newbcast:4 row_mask:0xf bank_mask:0xf
  v_mul_f32_dpp v29, v36, v29 row_newbcast:4 row_mask:0xf bank_mask:0xf
  v_mul_f32_dpp v30, v36, v30 row_newbcast:4 row_mask:0xf bank_mask:0xf
  v_mul_f32_dpp v31, v36, v31 row_newbcast:4 row_mask:0xf bank_mask:0xf
  s_waitcnt vmcnt(18)
  v_perm_b32 v40, v212, v208, s85
  v_perm_b32 v41, v212, v208, s86
  v_perm_b32 v42, v213, v209, s85
  v_perm_b32 v43, v213, v209, s86
  v_dot2c_f32_bf16_dpp v16, v44, v40 row_newbcast:0 row_mask:0xf bank_mask:0xf
  v_dot2c_f32_bf16_dpp v17, v44, v41 row_newbcast:0 row_mask:0xf bank_mask:0xf
  v_dot2c_f32_bf16_dpp v18, v44, v42 row_newbcast:0 row_mask:0xf bank_mask:0xf
  v_dot2c_f32_bf16_dpp v19, v44, v43 row_newbcast:0 row_mask:0xf bank_mask:0xf
  v_dot2c_f32_bf16_dpp v24, v44, v40 row_newbcast:4 row_mask:0xf bank_mask:0xf
  v_dot2c_f32_bf16_dpp v25, v44, v41 row_newbcast:4 row_mask:0xf bank_mask:0xf
  v_dot2c_f32_bf16_dpp v26, v44, v42 row_newbcast:4 row_mask:0xf bank_mask:0xf
  v_dot2c_f32_bf16_dpp v27, v44, v43 row_newbcast:4 row_mask:0xf bank_mask:0xf
  v_perm_b32 v40, v214, v210, s85
  v_perm_b32 v41, v214, v210, s86
  v_perm_b32 v42, v215, v211, s85
  v_perm_b32 v43, v215, v211, s86
  v_dot2c_f32_bf16_dpp v20, v44, v40 row_newbcast:0 row_mask:0xf bank_mask:0xf
  v_dot2c_f32_bf16_dpp v21, v44, v41 row_newbcast:0 row_mask:0xf bank_mask:0xf
  v_dot2c_f32_bf16_dpp v22, v44, v42 row_newbcast:0 row_mask:0xf bank_mask:0xf
  v_dot2c_f32_bf16_dpp v23, v44, v43 row_newbcast:0 row_mask:0xf bank_mask:0xf
  v_dot2c_f32_bf16_dpp v28, v44, v40 row_newbcast:4 row_mask:0xf bank_mask:0xf
  v_dot2c_f32_bf16_dpp v29, v44, v41 row_newbcast:4 row_mask:0xf bank_mask:0xf
  v_dot2c_f32_bf16_dpp v30, v44, v42 row_newbcast:4 row_mask:0xf bank_mask:0xf
  v_dot2c_f32_bf16_dpp v31, v44, v43 row_newbcast:4 row_mask:0xf bank_mask:0xf
  v_perm_b32 v40, v220, v216, s85
  v_perm_b32 v41, v220, v216, s86
  v_perm_b32 v42, v221, v217, s85
  v_perm_b32 v43, v221, v217, s86
  v_dot2c_f32_bf16_dpp v16, v44, v40 row_newbcast:8 row_mask:0xf bank_mask:0xf
  v_dot2c_f32_bf16_dpp v17, v44, v41 row_newbcast:8 row_mask:0xf bank_mask:0xf
  v_dot2c_f32_bf16_dpp v18, v44, v42 row_newbcast:8 row_mask:0xf bank_mask:0xf
  v_dot2c_f32_bf16_dpp v19, v44, v43 row_newbcast:8 row_mask:0xf bank_mask:0xf
  v_dot2c_f32_bf16_dpp v24, v44, v40 row_newbcast:12 row_mask:0xf bank_mask:0xf
  v_dot2c_f32_bf16_dpp v25, v44, v41 row_newbcast:12 row_mask:0xf bank_mask:0xf
  v_dot2c_f32_bf16_dpp v26, v44, v42 row_newbcast:12 row_mask:0xf bank_mask:0xf
  v_dot2c_f32_bf16_dpp v27, v44, v43 row_newbcast:12 row_mask:0xf bank_mask:0xf
  v_perm_b32 v40, v222, v218, s85
  v_perm_b32 v41, v222, v218, s86
  v_perm_b32 v42, v223, v219, s85
  v_perm_b32 v43, v223, v219, s86
  v_dot2c_f32_bf16_dpp v20, v44, v40 row_newbcast:8 row_mask:0xf bank_mask:0xf
  v_dot2c_f32_bf16_dpp v21, v44, v41 row_newbcast:8 row_mask:0xf bank_mask:0xf
  v_dot2c_f32_bf16_dpp v22, v44, v42 row_newbcast:8 row_mask:0xf bank_mask:0xf
  v_dot2c_f32_bf16_dpp v23, v44, v43 row_newbcast:8 row_mask:0xf bank_mask:0xf
  v_dot2c_f32_bf16_dpp v28, v44, v40 row_newbcast:12 row_mask:0xf bank_mask:0xf
  v_dot2c_f32_bf16_dpp v29, v44, v41 row_newbcast:12 row_mask:0xf bank_mask:0xf
  v_dot2c_f32_bf16_dpp v30, v44, v42 row_newbcast:12 row_mask:0xf bank_mask:0xf
  v_dot2c_f32_bf16_dpp v31, v44, v43 row_newbcast:12 row_mask:0xf bank_mask:0xf
  s_mov_b32 s83, 65536
  buffer_load_dwordx4 v[208:211], v2, s[8:11], s83 offen offset:0 nt
  buffer_load_dwordx4 v[212:215], v2, s[8:11], s83 offen offset:1024 nt
  buffer_load_dwordx4 v[216:219], v2, s[8:11], s83 offen offset:2048 nt
  buffer_load_dwordx4 v[220:223], v2, s[8:11], s83 offen offset:3072 nt
  s_waitcnt vmcnt(12)
  v_dot2_f32_bf16 v32, v224, v8, 0
  v_dot2_f32_bf16 v36, v224, v12, 0
  v_dot2_f32_bf16 v33, v228, v8, 0
  v_dot2_f32_bf16 v37, v228, v12, 0
  v_dot2_f32_bf16 v34, v232, v8, 0
  v_dot2_f32_bf16 v38, v232, v12, 0
  v_dot2_f32_bf16 v35, v236, v8, 0
  v_dot2_f32_bf16 v39, v236, v12, 0
  v_dot2_f32_bf16 v32, v225, v9, v32
  v_dot2_f32_bf16 v36, v225, v13, v36
  v_dot2_f32_bf16 v33, v229, v9, v33
  v_dot2_f32_bf16 v37, v229, v13, v37
  v_dot2_f32_bf16 v34, v233, v9, v34
  v_dot2_f32_bf16 v38, v233, v13, v38
  v_dot2_f32_bf16 v35, v237, v9, v35
  v_dot2_f32_bf16 v39, v237, v13, v39
  v_dot2_f32_bf16 v32, v226, v10, v32
  v_dot2_f32_bf16 v36, v226, v14, v36
  v_dot2_f32_bf16 v33, v230, v10, v33
  v_dot2_f32_bf16 v37, v230, v14, v37
  v_dot2_f32_bf16 v34, v234, v10, v34
  v_dot2_f32_bf16 v38, v234, v14, v38
  v_dot2_f32_bf16 v35, v238, v10, v35
  v_dot2_f32_bf16 v39, v238, v14, v39
  v_dot2_f32_bf16 v32, v227, v11, v32
  v_dot2_f32_bf16 v36, v227, v15, v36
  v_dot2_f32_bf16 v33, v231, v11, v33
  v_dot2_f32_bf16 v37, v231, v15, v37
  v_dot2_f32_bf16 v34, v235, v11, v34
  v_dot2_f32_bf16 v38, v235, v15, v38
  v_dot2_f32_bf16 v35, v239, v11, v35
  v_dot2_f32_bf16 v39, v239, v15, v39
  s_mov_b32 s83, 98304
  buffer_load_dwordx4 v[224:227], v2, s[4:7], s83 offen offset:0 nt
  buffer_load_dwordx4 v[228:231], v2, s[4:7], s83 offen offset:1024 nt
  buffer_load_dwordx4 v[232:235], v2, s[4:7], s83 offen offset:2048 nt
  buffer_load_dwordx4 v[236:239], v2, s[4:7], s83 offen offset:3072 nt
  v_add_f32_dpp v32, v32, v32 row_ror:8 row_mask:0xf bank_mask:0x3
  v_add_f32_dpp v33, v33, v33 row_ror:8 row_mask:0xf bank_mask:0x3
  v_add_f32_dpp v36, v36, v36 row_ror:8 row_mask:0xf bank_mask:0x3
  v_add_f32_dpp v37, v37, v37 row_ror:8 row_mask:0xf bank_mask:0x3
  v_add_f32_dpp v32, v34, v34 row_ror:8 row_mask:0xf bank_mask:0xc
  v_add_f32_dpp v33, v35, v35 row_ror:8 row_mask:0xf bank_mask:0xc
  v_add_f32_dpp v36, v38, v38 row_ror:8 row_mask:0xf bank_mask:0xc
  v_add_f32_dpp v37, v39, v39 row_ror:8 row_mask:0xf bank_mask:0xc
  v_add_f32_dpp v32, v32, v32 row_shl:4 row_mask:0xf bank_mask:0x5
  v_add_f32_dpp v33, v33, v33 row_shl:4 row_mask:0xf bank_mask:0x5
  s_nop 0
  v_add_f32_dpp v32, v36, v36 row_shr:4 row_mask:0xf bank_mask:0xa
  v_add_f32_dpp v33, v37, v37 row_shr:4 row_mask:0xf bank_mask:0xa
  s_nop 0
  v_add_f32_dpp v32, v32, v32 quad_perm:[1,0,3,2] row_mask:0xf bank_mask:0xf
  v_add_f32_dpp v33, v33, v33 quad_perm:[1,0,3,2] row_mask:0xf bank_mask:0xf
  s_nop 0
  v_add_f32_dpp v32, v32, v32 quad_perm:[2,3,0,1] row_mask:0xf bank_mask:0xf
  v_add_f32_dpp v33, v33, v33 quad_perm:[2,3,0,1] row_mask:0xf bank_mask:0xf
  v_cvt_pk_bf16_f32 v34, v32, v33
  v_lshlrev_b32 v32, 16, v34
  v_and_b32 v33, s87, v34
  v_mul_f32 v32, s88, v32
  v_mul_f32 v33, s88, v33
  v_cvt_pk_bf16_f32 v34, v32, v33
  v_lshlrev_b32 v32, 16, v34
  v_and_b32 v33, s87, v34
  v_fma_f32 v32, v32, s89, -v3
  v_fma_f32 v33, v33, s89, -v3
  v_max_f32 v35, v32, v33
  v_cmp_lt_f32 vcc, 0x41000000, v35
  v_exp_f32 v37, v32
  v_exp_f32 v38, v33
  s_cmp_eq_u64 vcc, 0
  s_cbranch_scc1 K1_LZ1A
  v_max_f32_dpp v35, v35, v35 row_ror:8 row_mask:0xf bank_mask:0xf
  v_max_f32 v35, 0, v35
  v_exp_f32 v36, -v35
  v_add_f32 v3, v3, v35
  v_sub_f32 v32, v32, v35
  v_sub_f32 v33, v33, v35
  v_exp_f32 v37, v32
  v_exp_f32 v38, v33
  v_mul_f32 v4, v4, v36
  v_mul_f32_dpp v16, v36, v16 row_newbcast:0 row_mask:0xf bank_mask:0xf
  v_mul_f32_dpp v17, v36, v17 row_newbcast:0 row_mask:0xf bank_mask:0xf
  v_mul_f32_dpp v18, v36, v18 row_newbcast:0 row_mask:0xf bank_mask:0xf
  v_mul_f32_dpp v19, v36, v19 row_newbcast:0 row_mask:0xf bank_mask:0xf
  v_mul_f32_dpp v20, v36, v20 row_newbcast:0 row_mask:0xf bank_mask:0xf
  v_mul_f32_dpp v21, v36, v21 row_newbcast:0 row_mask:0xf bank_mask:0xf
  v_mul_f32_dpp v22, v36, v22 row_newbcast:0 row_mask:0xf bank_mask:0xf
  v_mul_f32_dpp v23, v36, v23 row_newbcast:0 row_mask:0xf bank_mask:0xf
  v_mul_f32_dpp v24, v36, v24 row_newbcast:4 row_mask:0xf bank_mask:0xf
  v_mul_f32_dpp v25, v36, v25 row_newbcast:4 row_mask:0xf bank_mask:0xf
  v_mul_f32_dpp v26, v36, v26 row_newbcast:4 row_mask:0xf bank_mask:0xf
  v_mul_f32_dpp v27, v36, v27 row_newbcast:4 row_mask:0xf bank_mask:0xf
  v_mul_f32_dpp v28, v36, v28 row_newbcast:4 row_mask:0xf bank_mask:0xf
  v_mul_f32_dpp v29, v36, v29 row_newbcast:4 row_mask:0xf bank_mask:0xf
  v_mul_f32_dpp v30, v36, v30 row_newbcast:4 row_mask:0xf bank_mask:0xf
  v_mul_f32_dpp v31, v36, v31 row_newbcast:4 row_mask:0xf bank_mask:0xf
K1_LZ1A:
  s_nop 1
  v_add_f32 v4, v4, v37
  v_cvt_pk_bf16_f32 v44, v37, v38
  v_add_f32 v4, v4, v38
  s_waitcnt vmcnt(12)
  v_perm_b32 v40, v244, v240, s85
  v_perm_b32 v41, v244, v240, s86
  v_perm_b32 v42, v245, v241, s85
  v_perm_b32 v43, v245, v241, s86
  v_dot2c_f32_bf16_dpp v16, v44, v40 row_newbcast:0 row_mask:0xf bank_mask:0xf
  v_dot2c_f32_bf16_dpp v17, v44, v41 row_newbcast:0 row_mask:0xf bank_mask:0xf
  v_dot2c_f32_bf16_dpp v18, v44, v42 row_newbcast:0 row_mask:0xf bank_mask:0xf
  v_dot2c_f32_bf16_dpp v19, v44, v43 row_newbcast:0 row_mask:0xf bank_mask:0xf
  v_dot2c_f32_bf16_dpp v24, v44, v40 row_newbcast:4 row_mask:0xf bank_mask:0xf
  v_dot2c_f32_bf16_dpp v25, v44, v41 row_newbcast:4 row_mask:0xf bank_mask:0xf
  v_dot2c_f32_bf16_dpp v26, v44, v42 row_newbcast:4 row_mask:0xf bank_mask:0xf
  v_dot2c_f32_bf16_dpp v27, v44, v43 row_newbcast:4 row_mask:0xf bank_mask:0xf
  v_perm_b32 v40, v246, v242, s85
  v_perm_b32 v41, v246, v242, s86
  v_perm_b32 v42, v247, v243, s85
  v_perm_b32 v43, v247, v243, s86
  v_dot2c_f32_bf16_dpp v20, v44, v40 row_newbcast:0 row_mask:0xf bank_mask:0xf
  v_dot2c_f32_bf16_dpp v21, v44, v41 row_newbcast:0 row_mask:0xf bank_mask:0xf
  v_dot2c_f32_bf16_dpp v22, v44, v42 row_newbcast:0 row_mask:0xf bank_mask:0xf
  v_dot2c_f32_bf16_dpp v23, v44, v43 row_newbcast:0 row_mask:0xf bank_mask:0xf
  v_dot2c_f32_bf16_dpp v28, v44, v40 row_newbcast:4 row_mask:0xf bank_mask:0xf
  v_dot2c_f32_bf16_dpp v29, v44, v41 row_newbcast:4 row_mask:0xf bank_mask:0xf
  v_dot2c_f32_bf16_dpp v30, v44, v42 row_newbcast:4 row_mask:0xf bank_mask:0xf
  v_dot2c_f32_bf16_dpp v31, v44, v43 row_newbcast:4 row_mask:0xf bank_mask:0xf
  v_perm_b32 v40, v252, v248, s85
  v_perm_b32 v41, v252, v248, s86
  v_perm_b32 v42, v253, v249, s85
  v_perm_b32 v43, v253, v249, s86
  v_dot2c_f32_bf16_dpp v16, v44, v40 row_newbcast:8 row_mask:0xf bank_mask:0xf
  v_dot2c_f32_bf16_dpp v17, v44, v41 row_newbcast:8 row_mask:0xf bank_mask:0xf
  v_dot2c_f32_bf16_dpp v18, v44, v42 row_newbcast:8 row_mask:0xf bank_mask:0xf
  v_dot2c_f32_bf16_dpp v19, v44, v43 row_newbcast:8 row_mask:0xf bank_mask:0xf
  v_dot2c_f32_bf16_dpp v24, v44, v40 row_newbcast:12 row_mask:0xf bank_mask:0xf
  v_dot2c_f32_bf16_dpp v25, v44, v41 row_newbcast:12 row_mask:0xf bank_mask:0xf
  v_dot2c_f32_bf16_dpp v26, v44, v42 row_newbcast:12 row_mask:0xf bank_mask:0xf
  v_dot2c_f32_bf16_dpp v27, v44, v43 row_newbcast:12 row_mask:0xf bank_mask:0xf
  v_perm_b32 v40, v254, v250, s85
  v_perm_b32 v41, v254, v250, s86
  v_perm_b32 v42, v255, v251, s85
  v_perm_b32 v43, v255, v251, s86
  v_dot2c_f32_bf16_dpp v20, v44, v40 row_newbcast:8 row_mask:0xf bank_mask:0xf
  v_dot2c_f32_bf16_dpp v21, v44, v41 row_newbcast:8 row_mask:0xf bank_mask:0xf
  v_dot2c_f32_bf16_dpp v22, v44, v42 row_newbcast:8 row_mask:0xf bank_mask:0xf
  v_dot2c_f32_bf16_dpp v23, v44, v43 row_newbcast:8 row_mask:0xf bank_mask:0xf
  v_dot2c_f32_bf16_dpp v28, v44, v40 row_newbcast:12 row_mask:0xf bank_mask:0xf
  v_dot2c_f32_bf16_dpp v29, v44, v41 row_newbcast:12 row_mask:0xf bank_mask:0xf
  v_dot2c_f32_bf16_dpp v30, v44, v42 row_newbcast:12 row_mask:0xf bank_mask:0xf
  v_dot2c_f32_bf16_dpp v31, v44, v43 row_newbcast:12 row_mask:0xf bank_mask:0xf
  s_mov_b32 s83, 98304
  buffer_load_dwordx4 v[240:243], v2, s[8:11], s83 offen offset:0 nt
  buffer_load_dwordx4 v[244:247], v2, s[8:11], s83 offen offset:1024 nt
  buffer_load_dwordx4 v[248:251], v2, s[8:11], s83 offen offset:2048 nt
  buffer_load_dwordx4 v[252:255], v2, s[8:11], s83 offen offset:3072 nt
  v_mul_u32_u24 v183, 18, v1
  s_mul_i32 s83, s80, 1152
  v_add_u32 v183, s83, v183
  v_mov_b32 v144, 0
  v_mov_b32 v145, 0
  v_mov_b32 v146, 0
  v_mov_b32 v147, 0
  v_mov_b32 v148, 0
  v_mov_b32 v149, 0
  v_mov_b32 v150, 0
  v_mov_b32 v151, 0
  v_mov_b32 v152, 0
  ds_read_u16_d16_hi v144, v183 offset:0
  ds_read_u16_d16_hi v145, v183 offset:2
  ds_read_u16_d16_hi v146, v183 offset:4
  ds_read_u16_d16_hi v147, v183 offset:6
  ds_read_u16_d16_hi v148, v183 offset:8
  ds_read_u16_d16_hi v149, v183 offset:10
  ds_read_u16_d16_hi v150, v183 offset:12
  ds_read_u16_d16_hi v151, v183 offset:14
  ds_read_u16_d16_hi v152, v183 offset:16
  s_waitcnt lgkmcnt(0)
  v_add_f32 v171, v144, v145
  v_add_f32 v171, v171, v146
  v_add_f32 v171, v171, v147
  v_add_f32 v171, v171, v148
  v_add_f32 v171, v171, v149
  v_add_f32 v171, v171, v150
  v_add_f32 v171, v171, v151
  v_add_f32 v171, v171, v152
  s_nop 1
  v_add_f32_dpp v171, v171, v171 row_ror:8 row_mask:0xf bank_mask:0xf
  s_nop 1
  v_add_f32_dpp v171, v171, v171 row_ror:4 row_mask:0xf bank_mask:0xf
  s_nop 1
  v_add_f32_dpp v171, v171, v171 row_ror:2 row_mask:0xf bank_mask:0xf
  s_nop 1
  v_add_f32_dpp v171, v171, v171 row_ror:1 row_mask:0xf bank_mask:0xf
  v_mov_b32 v172, v171
  s_nop 1
  v_permlane16_swap_b32 v171, v172
  v_add_f32 v171, v171, v172
  v_mov_b32 v172, v171
  s_nop 1
  v_permlane32_swap_b32 v171, v172
  v_add_f32 v171, v171, v172
  v_mul_f32 v173, 0x3ae38e39, v171
  v_sub_f32 v153, v144, v173
  v_sub_f32 v154, v145, v173
  v_sub_f32 v155, v146, v173
  v_sub_f32 v156, v147, v173
  v_sub_f32 v157, v148, v173
  v_sub_f32 v158, v149, v173
  v_sub_f32 v159, v150, v173
  v_sub_f32 v160, v151, v173
  v_sub_f32 v161, v152, v173
  v_mul_f32 v174, v153, v153
  v_fmac_f32 v174, v154, v154
  v_fmac_f32 v174, v155, v155
  v_fmac_f32 v174, v156, v156
  v_fmac_f32 v174, v157, v157
  v_fmac_f32 v174, v158, v158
  v_fmac_f32 v174, v159, v159
  v_fmac_f32 v174, v160, v160
  v_fmac_f32 v174, v161, v161
  s_nop 1
  v_add_f32_dpp v174, v174, v174 row_ror:8 row_mask:0xf bank_mask:0xf
  s_nop 1
  v_add_f32_dpp v174, v174, v174 row_ror:4 row_mask:0xf bank_mask:0xf
  s_nop 1
  v_add_f32_dpp v174, v174, v174 row_ror:2 row_mask:0xf bank_mask:0xf
  s_nop 1
  v_add_f32_dpp v174, v174, v174 row_ror:1 row_mask:0xf bank_mask:0xf
  v_mov_b32 v172, v174
  s_nop 1
  v_permlane16_swap_b32 v174, v172
  v_add_f32 v174, v174, v172
  v_mov_b32 v172, v174
  s_nop 1
  v_permlane32_swap_b32 v174, v172
  v_add_f32 v174, v174, v172
  v_mul_f32 v174, 0x3ae38e39, v174
  v_cvt_pk_bf16_f32 v172, v173, v174
  v_lshlrev_b32 v173, 16, v172
  v_and_b32 v174, s87, v172
  v_add_f32 v174, 0x3727c5ac, v174
  v_cvt_pk_bf16_f32 v174, v174, v174
  v_and_b32 v174, s87, v174
  v_sqrt_f32 v175, v174
  s_nop 0
  v_cvt_pk_bf16_f32 v175, v175, v175
  v_and_b32 v175, s87, v175
  v_rcp_f32 v176, v175
  v_sub_f32 v153, v144, v173
  v_sub_f32 v154, v145, v173
  v_sub_f32 v155, v146, v173
  v_sub_f32 v156, v147, v173
  v_sub_f32 v157, v148, v173
  v_sub_f32 v158, v149, v173
  v_sub_f32 v159, v150, v173
  v_sub_f32 v160, v151, v173
  v_sub_f32 v161, v152, v173
  v_cvt_pk_bf16_f32 v172, v153, v154
  v_lshlrev_b32 v153, 16, v172
  v_and_b32 v154, s87, v172
  v_cvt_pk_bf16_f32 v172, v155, v156
  v_lshlrev_b32 v155, 16, v172
  v_and_b32 v156, s87, v172
  v_cvt_pk_bf16_f32 v172, v157, v158
  v_lshlrev_b32 v157, 16, v172
  v_and_b32 v158, s87, v172
  v_cvt_pk_bf16_f32 v172, v159, v160
  v_lshlrev_b32 v159, 16, v172
  v_and_b32 v160, s87, v172
  v_cvt_pk_bf16_f32 v161, v161, v161
  v_and_b32 v161, s87, v161
  v_mul_f32 v171, v153, v176
  v_fma_f32 v172, -v171, v175, v153
  v_fma_f32 v153, v172, v176, v171
  v_mul_f32 v171, v154, v176
  v_fma_f32 v172, -v171, v175, v154
  v_fma_f32 v154, v172, v176, v171
  v_mul_f32 v171, v155, v176
  v_fma_f32 v172, -v171, v175, v155
  v_fma_f32 v155, v172, v176, v171
  v_mul_f32 v171, v156, v176
  v_fma_f32 v172, -v171, v175, v156
  v_fma_f32 v156, v172, v176, v171
  v_mul_f32 v171, v157, v176
  v_fma_f32 v172, -v171, v175, v157
  v_fma_f32 v157, v172, v176, v171
  v_mul_f32 v171, v158, v176
  v_fma_f32 v172, -v171, v175, v158
  v_fma_f32 v158, v172, v176, v171
  v_mul_f32 v171, v159, v176
  v_fma_f32 v172, -v171, v175, v159
  v_fma_f32 v159, v172, v176, v171
  v_mul_f32 v171, v160, v176
  v_fma_f32 v172, -v171, v175, v160
  v_fma_f32 v160, v172, v176, v171
  v_mul_f32 v171, v161, v176
  v_fma_f32 v172, -v171, v175, v161
  v_fma_f32 v161, v172, v176, v171
  v_cvt_pk_bf16_f32 v172, v153, v154
  v_lshlrev_b32 v153, 16, v172
  v_and_b32 v154, s87, v172
  v_cvt_pk_bf16_f32 v172, v155, v156
  v_lshlrev_b32 v155, 16, v172
  v_and_b32 v156, s87, v172
  v_cvt_pk_bf16_f32 v172, v157, v158
  v_lshlrev_b32 v157, 16, v172
  v_and_b32 v158, s87, v172
  v_cvt_pk_bf16_f32 v172, v159, v160
  v_lshlrev_b32 v159, 16, v172
  v_and_b32 v160, s87, v172
  v_cvt_pk_bf16_f32 v161, v161, v161
  v_and_b32 v161, s87, v161
  v_readlane_b32 s64, v153, s81
  v_readlane_b32 s65, v154, s81
  v_readlane_b32 s66, v155, s81
  v_readlane_b32 s67, v156, s81
  v_readlane_b32 s68, v157, s81
  v_readlane_b32 s69, v158, s81
  v_readlane_b32 s70, v159, s81
  v_readlane_b32 s71, v160, s81
  v_readlane_b32 s72, v161, s81
  v_mov_b32 v143, 0x3dd2d3e8
  v_lshlrev_b32 v144, 16, v128
  v_and_b32 v145, s87, v128
  v_lshlrev_b32 v153, 16, v132
  v_and_b32 v154, s87, v132
  v_lshlrev_b32 v146, 16, v129
  v_and_b32 v147, s87, v129
  v_lshlrev_b32 v155, 16, v133
  v_and_b32 v156, s87, v133
  v_lshlrev_b32 v148, 16, v130
  v_and_b32 v149, s87, v130
  v_lshlrev_b32 v157, 16, v134
  v_and_b32 v158, s87, v134
  v_lshlrev_b32 v150, 16, v131
  v_and_b32 v151, s87, v131
  v_lshlrev_b32 v159, 16, v135
  v_and_b32 v160, s87, v135
  v_lshlrev_b32 v152, 16, v140
  v_lshlrev_b32 v161, 16, v141
  v_lshlrev_b32 v142, 16, v142
  v_mul_f32 v171, s64, v144
  v_mul_f32 v172, s64, v145
  v_mul_f32 v173, s64, v146
  v_mul_f32 v174, s64, v147
  v_cvt_pk_bf16_f32 v179, v171, v172
  v_lshlrev_b32 v171, 16, v179
  v_and_b32 v172, s87, v179
  v_cvt_pk_bf16_f32 v180, v173, v174
  v_lshlrev_b32 v173, 16, v180
  v_and_b32 v174, s87, v180
  v_add_f32 v171, v171, v153
  v_add_f32 v172, v172, v154
  v_add_f32 v173, v173, v155
  v_add_f32 v174, v174, v156
  v_cvt_pk_bf16_f32 v179, v171, v172
  v_lshlrev_b32 v171, 16, v179
  v_and_b32 v172, s87, v179
  v_cvt_pk_bf16_f32 v180, v173, v174
  v_lshlrev_b32 v173, 16, v180
  v_and_b32 v174, s87, v180
  v_mul_f32 v175, v171, v171
  v_mul_f32 v176, v172, v172
  v_mul_f32 v177, v173, v173
  v_mul_f32 v178, v174, v174
  v_fmaak_f32 v175, v175, v143, 0x40135761
  v_fmaak_f32 v176, v176, v143, 0x40135761
  v_fmaak_f32 v177, v177, v143, 0x40135761
  v_fmaak_f32 v178, v178, v143, 0x40135761
  v_mul_f32 v175, v175, v171
  v_mul_f32 v176, v176, v172
  v_mul_f32 v177, v177, v173
  v_mul_f32 v178, v178, v174
  v_exp_f32 v175, -v175
  v_exp_f32 v176, -v176
  v_exp_f32 v177, -v177
  v_exp_f32 v178, -v178
  v_add_f32 v175, 1.0, v175
  v_add_f32 v176, 1.0, v176
  v_add_f32 v177, 1.0, v177
  v_add_f32 v178, 1.0, v178
  v_rcp_f32 v175, v175
  v_rcp_f32 v176, v176
  v_rcp_f32 v177, v177
  v_rcp_f32 v178, v178
  v_mul_f32 v171, v171, v175
  v_mul_f32 v172, v172, v176
  v_mul_f32 v173, v173, v177
  v_mul_f32 v174, v174, v178
  v_cvt_pk_bf16_f32 v179, v171, v172
  v_cvt_pk_bf16_f32 v180, v173, v174
  v_dot2_f32_bf16 v162, v179, v136, 0
  v_dot2_f32_bf16 v162, v180, v137, v162
  v_mul_f32 v171, s64, v148
  v_mul_f32 v172, s64, v149
  v_mul_f32 v173, s64, v150
  v_mul_f32 v174, s64, v151
  v_cvt_pk_bf16_f32 v179, v171, v172
  v_lshlrev_b32 v171, 16, v179
  v_and_b32 v172, s87, v179
  v_cvt_pk_bf16_f32 v180, v173, v174
  v_lshlrev_b32 v173, 16, v180
  v_and_b32 v174, s87, v180
  v_add_f32 v171, v171, v157
  v_add_f32 v172, v172, v158
  v_add_f32 v173, v173, v159
  v_add_f32 v174, v174, v160
  v_cvt_pk_bf16_f32 v179, v171, v172
  v_lshlrev_b32 v171, 16, v179
  v_and_b32 v172, s87, v179
  v_cvt_pk_bf16_f32 v180, v173, v174
  v_lshlrev_b32 v173, 16, v180
  v_and_b32 v174, s87, v180
  v_mul_f32 v175, v171, v171
  v_mul_f32 v176, v172, v172
  v_mul_f32 v177, v173, v173
  v_mul_f32 v178, v174, v174
  v_fmaak_f32 v175, v175, v143, 0x40135761
  v_fmaak_f32 v176, v176, v143, 0x40135761
  v_fmaak_f32 v177, v177, v143, 0x40135761
  v_fmaak_f32 v178, v178, v143, 0x40135761
  v_mul_f32 v175, v175, v171
  v_mul_f32 v176, v176, v172
  v_mul_f32 v177, v177, v173
  v_mul_f32 v178, v178, v174
  v_exp_f32 v175, -v175
  v_exp_f32 v176, -v176
  v_exp_f32 v177, -v177
  v_exp_f32 v178, -v178
  v_add_f32 v175, 1.0, v175
  v_add_f32 v176, 1.0, v176
  v_add_f32 v177, 1.0, v177
  v_add_f32 v178, 1.0, v178
  v_rcp_f32 v175, v175
  v_rcp_f32 v176, v176
  v_rcp_f32 v177, v177
  v_rcp_f32 v178, v178
  v_mul_f32 v171, v171, v175
  v_mul_f32 v172, v172, v176
  v_mul_f32 v173, v173, v177
  v_mul_f32 v174, v174, v178
  v_cvt_pk_bf16_f32 v179, v171, v172
  v_cvt_pk_bf16_f32 v180, v173, v174
  v_dot2_f32_bf16 v162, v179, v138, v162
  v_dot2_f32_bf16 v162, v180, v139, v162
  v_mul_f32 v171, s65, v144
  v_mul_f32 v172, s65, v145
  v_mul_f32 v173, s65, v146
  v_mul_f32 v174, s65, v147
  v_cvt_pk_bf16_f32 v179, v171, v172
  v_lshlrev_b32 v171, 16, v179
  v_and_b32 v172, s87, v179
  v_cvt_pk_bf16_f32 v180, v173, v174
  v_lshlrev_b32 v173, 16, v180
  v_and_b32 v174, s87, v180
  v_add_f32 v171, v171, v153
  v_add_f32 v172, v172, v154
  v_add_f32 v173, v173, v155
  v_add_f32 v174, v174, v156
  v_cvt_pk_bf16_f32 v179, v171, v172
  v_lshlrev_b32 v171, 16, v179
  v_and_b32 v172, s87, v179
  v_cvt_pk_bf16_f32 v180, v173, v174
  v_lshlrev_b32 v173, 16, v180
  v_and_b32 v174, s87, v180
  v_mul_f32 v175, v171, v171
  v_mul_f32 v176, v172, v172
  v_mul_f32 v177, v173, v173
  v_mul_f32 v178, v174, v174
  v_fmaak_f32 v175, v175, v143, 0x40135761
  v_fmaak_f32 v176, v176, v143, 0x40135761
  v_fmaak_f32 v177, v177, v143, 0x40135761
  v_fmaak_f32 v178, v178, v143, 0x40135761
  v_mul_f32 v175, v175, v171
  v_mul_f32 v176, v176, v172
  v_mul_f32 v177, v177, v173
  v_mul_f32 v178, v178, v174
  v_exp_f32 v175, -v175
  v_exp_f32 v176, -v176
  v_exp_f32 v177, -v177
  v_exp_f32 v178, -v178
  v_add_f32 v175, 1.0, v175
  v_add_f32 v176, 1.0, v176
  v_add_f32 v177, 1.0, v177
  v_add_f32 v178, 1.0, v178
  v_rcp_f32 v175, v175
  v_rcp_f32 v176, v176
  v_rcp_f32 v177, v177
  v_rcp_f32 v178, v178
  v_mul_f32 v171, v171, v175
  v_mul_f32 v172, v172, v176
  v_mul_f32 v173, v173, v177
  v_mul_f32 v174, v174, v178
  v_cvt_pk_bf16_f32 v179, v171, v172
  v_cvt_pk_bf16_f32 v180, v173, v174
  v_dot2_f32_bf16 v163, v179, v136, 0
  v_dot2_f32_bf16 v163, v180, v137, v163
  v_mul_f32 v171, s65, v148
  v_mul_f32 v172, s65, v149
  v_mul_f32 v173, s65, v150
  v_mul_f32 v174, s65, v151
  v_cvt_pk_bf16_f32 v179, v171, v172
  v_lshlrev_b32 v171, 16, v179
  v_and_b32 v172, s87, v179
  v_cvt_pk_bf16_f32 v180, v173, v174
  v_lshlrev_b32 v173, 16, v180
  v_and_b32 v174, s87, v180
  v_add_f32 v171, v171, v157
  v_add_f32 v172, v172, v158
  v_add_f32 v173, v173, v159
  v_add_f32 v174, v174, v160
  v_cvt_pk_bf16_f32 v179, v171, v172
  v_lshlrev_b32 v171, 16, v179
  v_and_b32 v172, s87, v179
  v_cvt_pk_bf16_f32 v180, v173, v174
  v_lshlrev_b32 v173, 16, v180
  v_and_b32 v174, s87, v180
  v_mul_f32 v175, v171, v171
  v_mul_f32 v176, v172, v172
  v_mul_f32 v177, v173, v173
  v_mul_f32 v178, v174, v174
  v_fmaak_f32 v175, v175, v143, 0x40135761
  v_fmaak_f32 v176, v176, v143, 0x40135761
  v_fmaak_f32 v177, v177, v143, 0x40135761
  v_fmaak_f32 v178, v178, v143, 0x40135761
  v_mul_f32 v175, v175, v171
  v_mul_f32 v176, v176, v172
  v_mul_f32 v177, v177, v173
  v_mul_f32 v178, v178, v174
  v_exp_f32 v175, -v175
  v_exp_f32 v176, -v176
  v_exp_f32 v177, -v177
  v_exp_f32 v178, -v178
  v_add_f32 v175, 1.0, v175
  v_add_f32 v176, 1.0, v176
  v_add_f32 v177, 1.0, v177
  v_add_f32 v178, 1.0, v178
  v_rcp_f32 v175, v175
  v_rcp_f32 v176, v176
  v_rcp_f32 v177, v177
  v_rcp_f32 v178, v178
  v_mul_f32 v171, v171, v175
  v_mul_f32 v172, v172, v176
  v_mul_f32 v173, v173, v177
  v_mul_f32 v174, v174, v178
  v_cvt_pk_bf16_f32 v179, v171, v172
  v_cvt_pk_bf16_f32 v180, v173, v174
  v_dot2_f32_bf16 v163, v179, v138, v163
  v_dot2_f32_bf16 v163, v180, v139, v163
  s_waitcnt vmcnt(12)
  v_dot2_f32_bf16 v32, v192, v8, 0
  v_dot2_f32_bf16 v36, v192, v12, 0
  v_dot2_f32_bf16 v33, v196, v8, 0
  v_dot2_f32_bf16 v37, v196, v12, 0
  v_dot2_f32_bf16 v34, v200, v8, 0
  v_dot2_f32_bf16 v38, v200, v12, 0
  v_dot2_f32_bf16 v35, v204, v8, 0
  v_dot2_f32_bf16 v39, v204, v12, 0
  v_dot2_f32_bf16 v32, v193, v9, v32
  v_dot2_f32_bf16 v36, v193, v13, v36
  v_dot2_f32_bf16 v33, v197, v9, v33
  v_dot2_f32_bf16 v37, v197, v13, v37
  v_dot2_f32_bf16 v34, v201, v9, v34
  v_dot2_f32_bf16 v38, v201, v13, v38
  v_dot2_f32_bf16 v35, v205, v9, v35
  v_dot2_f32_bf16 v39, v205, v13, v39
  v_dot2_f32_bf16 v32, v194, v10, v32
  v_dot2_f32_bf16 v36, v194, v14, v36
  v_dot2_f32_bf16 v33, v198, v10, v33
  v_dot2_f32_bf16 v37, v198, v14, v37
  v_dot2_f32_bf16 v34, v202, v10, v34
  v_dot2_f32_bf16 v38, v202, v14, v38
  v_dot2_f32_bf16 v35, v206, v10, v35
  v_dot2_f32_bf16 v39, v206, v14, v39
  v_dot2_f32_bf16 v32, v195, v11, v32
  v_dot2_f32_bf16 v36, v195, v15, v36
  v_dot2_f32_bf16 v33, v199, v11, v33
  v_dot2_f32_bf16 v37, v199, v15, v37
  v_dot2_f32_bf16 v34, v203, v11, v34
  v_dot2_f32_bf16 v38, v203, v15, v38
  v_dot2_f32_bf16 v35, v207, v11, v35
  v_dot2_f32_bf16 v39, v207, v15, v39
  s_mov_b32 s83, 131072
  buffer_load_dwordx4 v[192:195], v2, s[4:7], s83 offen offset:0 nt
  buffer_load_dwordx4 v[196:199], v2, s[4:7], s83 offen offset:1024 nt
  buffer_load_dwordx4 v[200:203], v2, s[4:7], s83 offen offset:2048 nt
  buffer_load_dwordx4 v[204:207], v2, s[4:7], s83 offen offset:3072 nt
  v_add_f32_dpp v32, v32, v32 row_ror:8 row_mask:0xf bank_mask:0x3
  v_add_f32_dpp v33, v33, v33 row_ror:8 row_mask:0xf bank_mask:0x3
  v_add_f32_dpp v36, v36, v36 row_ror:8 row_mask:0xf bank_mask:0x3
  v_add_f32_dpp v37, v37, v37 row_ror:8 row_mask:0xf bank_mask:0x3
  v_add_f32_dpp v32, v34, v34 row_ror:8 row_mask:0xf bank_mask:0xc
  v_add_f32_dpp v33, v35, v35 row_ror:8 row_mask:0xf bank_mask:0xc
  v_add_f32_dpp v36, v38, v38 row_ror:8 row_mask:0xf bank_mask:0xc
  v_add_f32_dpp v37, v39, v39 row_ror:8 row_mask:0xf bank_mask:0xc
  v_add_f32_dpp v32, v32, v32 row_shl:4 row_mask:0xf bank_mask:0x5
  v_add_f32_dpp v33, v33, v33 row_shl:4 row_mask:0xf bank_mask:0x5
  s_nop 0
  v_add_f32_dpp v32, v36, v36 row_shr:4 row_mask:0xf bank_mask:0xa
  v_add_f32_dpp v33, v37, v37 row_shr:4 row_mask:0xf bank_mask:0xa
  s_nop 0
  v_add_f32_dpp v32, v32, v32 quad_perm:[1,0,3,2] row_mask:0xf bank_mask:0xf
  v_add_f32_dpp v33, v33, v33 quad_perm:[1,0,3,2] row_mask:0xf bank_mask:0xf
  s_nop 0
  v_add_f32_dpp v32, v32, v32 quad_perm:[2,3,0,1] row_mask:0xf bank_mask:0xf
  v_add_f32_dpp v33, v33, v33 quad_perm:[2,3,0,1] row_mask:0xf bank_mask:0xf
  v_cvt_pk_bf16_f32 v34, v32, v33
  v_lshlrev_b32 v32, 16, v34
  v_and_b32 v33, s87, v34
  v_mul_f32 v32, s88, v32
  v_mul_f32 v33, s88, v33
  v_cvt_pk_bf16_f32 v34, v32, v33
  v_lshlrev_b32 v32, 16, v34
  v_and_b32 v33, s87, v34
  v_fma_f32 v32, v32, s89, -v3
  v_fma_f32 v33, v33, s89, -v3
  v_max_f32 v35, v32, v33
  v_cmp_lt_f32 vcc, 0x41000000, v35
  v_exp_f32 v37, v32
  v_exp_f32 v38, v33
  s_cmp_eq_u64 vcc, 0
  s_cbranch_scc1 K1_LZ2A
  v_max_f32_dpp v35, v35, v35 row_ror:8 row_mask:0xf bank_mask:0xf
  v_max_f32 v35, 0, v35
  v_exp_f32 v36, -v35
  v_add_f32 v3, v3, v35
  v_sub_f32 v32, v32, v35
  v_sub_f32 v33, v33, v35
  v_exp_f32 v37, v32
  v_exp_f32 v38, v33
  v_mul_f32 v4, v4, v36
  v_mul_f32_dpp v16, v36, v16 row_newbcast:0 row_mask:0xf bank_mask:0xf
  v_mul_f32_dpp v17, v36, v17 row_newbcast:0 row_mask:0xf bank_mask:0xf
  v_mul_f32_dpp v18, v36, v18 row_newbcast:0 row_mask:0xf bank_mask:0xf
  v_mul_f32_dpp v19, v36, v19 row_newbcast:0 row_mask:0xf bank_mask:0xf
  v_mul_f32_dpp v20, v36, v20 row_newbcast:0 row_mask:0xf bank_mask:0xf
  v_mul_f32_dpp v21, v36, v21 row_newbcast:0 row_mask:0xf bank_mask:0xf
  v_mul_f32_dpp v22, v36, v22 row_newbcast:0 row_mask:0xf bank_mask:0xf
  v_mul_f32_dpp v23, v36, v23 row_newbcast:0 row_mask:0xf bank_mask:0xf
  v_mul_f32_dpp v24, v36, v24 row_newbcast:4 row_mask:0xf bank_mask:0xf
  v_mul_f32_dpp v25, v36, v25 row_newbcast:4 row_mask:0xf bank_mask:0xf
  v_mul_f32_dpp v26, v36, v26 row_newbcast:4 row_mask:0xf bank_mask:0xf
  v_mul_f32_dpp v27, v36, v27 row_newbcast:4 row_mask:0xf bank_mask:0xf
  v_mul_f32_dpp v28, v36, v28 row_newbcast:4 row_mask:0xf bank_mask:0xf
  v_mul_f32_dpp v29, v36, v29 row_newbcast:4 row_mask:0xf bank_mask:0xf
  v_mul_f32_dpp v30, v36, v30 row_newbcast:4 row_mask:0xf bank_mask:0xf
  v_mul_f32_dpp v31, v36, v31 row_newbcast:4 row_mask:0xf bank_mask:0xf
K1_LZ2A:
  s_nop 1
  v_add_f32 v4, v4, v37
  v_cvt_pk_bf16_f32 v44, v37, v38
  v_add_f32 v4, v4, v38
  s_waitcnt vmcnt(12)
  v_perm_b32 v40, v212, v208, s85
  v_perm_b32 v41, v212, v208, s86
  v_perm_b32 v42, v213, v209, s85
  v_perm_b32 v43, v213, v209, s86
  v_dot2c_f32_bf16_dpp v16, v44, v40 row_newbcast:0 row_mask:0xf bank_mask:0xf
  v_dot2c_f32_bf16_dpp v17, v44, v41 row_newbcast:0 row_mask:0xf bank_mask:0xf
  v_dot2c_f32_bf16_dpp v18, v44, v42 row_newbcast:0 row_mask:0xf bank_mask:0xf
  v_dot2c_f32_bf16_dpp v19, v44, v43 row_newbcast:0 row_mask:0xf bank_mask:0xf
  v_dot2c_f32_bf16_dpp v24, v44, v40 row_newbcast:4 row_mask:0xf bank_mask:0xf
  v_dot2c_f32_bf16_dpp v25, v44, v41 row_newbcast:4 row_mask:0xf bank_mask:0xf
  v_dot2c_f32_bf16_dpp v26, v44, v42 row_newbcast:4 row_mask:0xf bank_mask:0xf
  v_dot2c_f32_bf16_dpp v27, v44, v43 row_newbcast:4 row_mask:0xf bank_mask:0xf
  v_perm_b32 v40, v214, v210, s85
  v_perm_b32 v41, v214, v210, s86
  v_perm_b32 v42, v215, v211, s85
  v_perm_b32 v43, v215, v211, s86
  v_dot2c_f32_bf16_dpp v20, v44, v40 row_newbcast:0 row_mask:0xf bank_mask:0xf
  v_dot2c_f32_bf16_dpp v21, v44, v41 row_newbcast:0 row_mask:0xf bank_mask:0xf
  v_dot2c_f32_bf16_dpp v22, v44, v42 row_newbcast:0 row_mask:0xf bank_mask:0xf
  v_dot2c_f32_bf16_dpp v23, v44, v43 row_newbcast:0 row_mask:0xf bank_mask:0xf
  v_dot2c_f32_bf16_dpp v28, v44, v40 row_newbcast:4 row_mask:0xf bank_mask:0xf
  v_dot2c_f32_bf16_dpp v29, v44, v41 row_newbcast:4 row_mask:0xf bank_mask:0xf
  v_dot2c_f32_bf16_dpp v30, v44, v42 row_newbcast:4 row_mask:0xf bank_mask:0xf
  v_dot2c_f32_bf16_dpp v31, v44, v43 row_newbcast:4 row_mask:0xf bank_mask:0xf
  v_perm_b32 v40, v220, v216, s85
  v_perm_b32 v41, v220, v216, s86
  v_perm_b32 v42, v221, v217, s85
  v_perm_b32 v43, v221, v217, s86
  v_dot2c_f32_bf16_dpp v16, v44, v40 row_newbcast:8 row_mask:0xf bank_mask:0xf
  v_dot2c_f32_bf16_dpp v17, v44, v41 row_newbcast:8 row_mask:0xf bank_mask:0xf
  v_dot2c_f32_bf16_dpp v18, v44, v42 row_newbcast:8 row_mask:0xf bank_mask:0xf
  v_dot2c_f32_bf16_dpp v19, v44, v43 row_newbcast:8 row_mask:0xf bank_mask:0xf
  v_dot2c_f32_bf16_dpp v24, v44, v40 row_newbcast:12 row_mask:0xf bank_mask:0xf
  v_dot2c_f32_bf16_dpp v25, v44, v41 row_newbcast:12 row_mask:0xf bank_mask:0xf
  v_dot2c_f32_bf16_dpp v26, v44, v42 row_newbcast:12 row_mask:0xf bank_mask:0xf
  v_dot2c_f32_bf16_dpp v27, v44, v43 row_newbcast:12 row_mask:0xf bank_mask:0xf
  v_perm_b32 v40, v222, v218, s85
  v_perm_b32 v41, v222, v218, s86
  v_perm_b32 v42, v223, v219, s85
  v_perm_b32 v43, v223, v219, s86
  v_dot2c_f32_bf16_dpp v20, v44, v40 row_newbcast:8 row_mask:0xf bank_mask:0xf
  v_dot2c_f32_bf16_dpp v21, v44, v41 row_newbcast:8 row_mask:0xf bank_mask:0xf
  v_dot2c_f32_bf16_dpp v22, v44, v42 row_newbcast:8 row_mask:0xf bank_mask:0xf
  v_dot2c_f32_bf16_dpp v23, v44, v43 row_newbcast:8 row_mask:0xf bank_mask:0xf
  v_dot2c_f32_bf16_dpp v28, v44, v40 row_newbcast:12 row_mask:0xf bank_mask:0xf
  v_dot2c_f32_bf16_dpp v29, v44, v41 row_newbcast:12 row_mask:0xf bank_mask:0xf
  v_dot2c_f32_bf16_dpp v30, v44, v42 row_newbcast:12 row_mask:0xf bank_mask:0xf
  v_dot2c_f32_bf16_dpp v31, v44, v43 row_newbcast:12 row_mask:0xf bank_mask:0xf
  s_mov_b32 s83, 131072
  buffer_load_dwordx4 v[208:211], v2, s[8:11], s83 offen offset:0 nt
  buffer_load_dwordx4 v[212:215], v2, s[8:11], s83 offen offset:1024 nt
  buffer_load_dwordx4 v[216:219], v2, s[8:11], s83 offen offset:2048 nt
  buffer_load_dwordx4 v[220:223], v2, s[8:11], s83 offen offset:3072 nt
  v_mul_f32 v171, s66, v144
  v_mul_f32 v172, s66, v145
  v_mul_f32 v173, s66, v146
  v_mul_f32 v174, s66, v147
  v_cvt_pk_bf16_f32 v179, v171, v172
  v_lshlrev_b32 v171, 16, v179
  v_and_b32 v172, s87, v179
  v_cvt_pk_bf16_f32 v180, v173, v174
  v_lshlrev_b32 v173, 16, v180
  v_and_b32 v174, s87, v180
  v_add_f32 v171, v171, v153
  v_add_f32 v172, v172, v154
  v_add_f32 v173, v173, v155
  v_add_f32 v174, v174, v156
  v_cvt_pk_bf16_f32 v179, v171, v172
  v_lshlrev_b32 v171, 16, v179
  v_and_b32 v172, s87, v179
  v_cvt_pk_bf16_f32 v180, v173, v174
  v_lshlrev_b32 v173, 16, v180
  v_and_b32 v174, s87, v180
  v_mul_f32 v175, v171, v171
  v_mul_f32 v176, v172, v172
  v_mul_f32 v177, v173, v173
  v_mul_f32 v178, v174, v174
  v_fmaak_f32 v175, v175, v143, 0x40135761
  v_fmaak_f32 v176, v176, v143, 0x40135761
  v_fmaak_f32 v177, v177, v143, 0x40135761
  v_fmaak_f32 v178, v178, v143, 0x40135761
  v_mul_f32 v175, v175, v171
  v_mul_f32 v176, v176, v172
  v_mul_f32 v177, v177, v173
  v_mul_f32 v178, v178, v174
  v_exp_f32 v175, -v175
  v_exp_f32 v176, -v176
  v_exp_f32 v177, -v177
  v_exp_f32 v178, -v178
  v_add_f32 v175, 1.0, v175
  v_add_f32 v176, 1.0, v176
  v_add_f32 v177, 1.0, v177
  v_add_f32 v178, 1.0, v178
  v_rcp_f32 v175, v175
  v_rcp_f32 v176, v176
  v_rcp_f32 v177, v177
  v_rcp_f32 v178, v178
  v_mul_f32 v171, v171, v175
  v_mul_f32 v172, v172, v176
  v_mul_f32 v173, v173, v177
  v_mul_f32 v174, v174, v178
  v_cvt_pk_bf16_f32 v179, v171, v172
  v_cvt_pk_bf16_f32 v180, v173, v174
  v_dot2_f32_bf16 v164, v179, v136, 0
  v_dot2_f32_bf16 v164, v180, v137, v164
  v_mul_f32 v171, s66, v148
  v_mul_f32 v172, s66, v149
  v_mul_f32 v173, s66, v150
  v_mul_f32 v174, s66, v151
  v_cvt_pk_bf16_f32 v179, v171, v172
  v_lshlrev_b32 v171, 16, v179
  v_and_b32 v172, s87, v179
  v_cvt_pk_bf16_f32 v180, v173, v174
  v_lshlrev_b32 v173, 16, v180
  v_and_b32 v174, s87, v180
  v_add_f32 v171, v171, v157
  v_add_f32 v172, v172, v158
  v_add_f32 v173, v173, v159
  v_add_f32 v174, v174, v160
  v_cvt_pk_bf16_f32 v179, v171, v172
  v_lshlrev_b32 v171, 16, v179
  v_and_b32 v172, s87, v179
  v_cvt_pk_bf16_f32 v180, v173, v174
  v_lshlrev_b32 v173, 16, v180
  v_and_b32 v174, s87, v180
  v_mul_f32 v175, v171, v171
  v_mul_f32 v176, v172, v172
  v_mul_f32 v177, v173, v173
  v_mul_f32 v178, v174, v174
  v_fmaak_f32 v175, v175, v143, 0x40135761
  v_fmaak_f32 v176, v176, v143, 0x40135761
  v_fmaak_f32 v177, v177, v143, 0x40135761
  v_fmaak_f32 v178, v178, v143, 0x40135761
  v_mul_f32 v175, v175, v171
  v_mul_f32 v176, v176, v172
  v_mul_f32 v177, v177, v173
  v_mul_f32 v178, v178, v174
  v_exp_f32 v175, -v175
  v_exp_f32 v176, -v176
  v_exp_f32 v177, -v177
  v_exp_f32 v178, -v178
  v_add_f32 v175, 1.0, v175
  v_add_f32 v176, 1.0, v176
  v_add_f32 v177, 1.0, v177
  v_add_f32 v178, 1.0, v178
  v_rcp_f32 v175, v175
  v_rcp_f32 v176, v176
  v_rcp_f32 v177, v177
  v_rcp_f32 v178, v178
  v_mul_f32 v171, v171, v175
  v_mul_f32 v172, v172, v176
  v_mul_f32 v173, v173, v177
  v_mul_f32 v174, v174, v178
  v_cvt_pk_bf16_f32 v179, v171, v172
  v_cvt_pk_bf16_f32 v180, v173, v174
  v_dot2_f32_bf16 v164, v179, v138, v164
  v_dot2_f32_bf16 v164, v180, v139, v164
  v_mul_f32 v171, s67, v144
  v_mul_f32 v172, s67, v145
  v_mul_f32 v173, s67, v146
  v_mul_f32 v174, s67, v147
  v_cvt_pk_bf16_f32 v179, v171, v172
  v_lshlrev_b32 v171, 16, v179
  v_and_b32 v172, s87, v179
  v_cvt_pk_bf16_f32 v180, v173, v174
  v_lshlrev_b32 v173, 16, v180
  v_and_b32 v174, s87, v180
  v_add_f32 v171, v171, v153
  v_add_f32 v172, v172, v154
  v_add_f32 v173, v173, v155
  v_add_f32 v174, v174, v156
  v_cvt_pk_bf16_f32 v179, v171, v172
  v_lshlrev_b32 v171, 16, v179
  v_and_b32 v172, s87, v179
  v_cvt_pk_bf16_f32 v180, v173, v174
  v_lshlrev_b32 v173, 16, v180
  v_and_b32 v174, s87, v180
  v_mul_f32 v175, v171, v171
  v_mul_f32 v176, v172, v172
  v_mul_f32 v177, v173, v173
  v_mul_f32 v178, v174, v174
  v_fmaak_f32 v175, v175, v143, 0x40135761
  v_fmaak_f32 v176, v176, v143, 0x40135761
  v_fmaak_f32 v177, v177, v143, 0x40135761
  v_fmaak_f32 v178, v178, v143, 0x40135761
  v_mul_f32 v175, v175, v171
  v_mul_f32 v176, v176, v172
  v_mul_f32 v177, v177, v173
  v_mul_f32 v178, v178, v174
  v_exp_f32 v175, -v175
  v_exp_f32 v176, -v176
  v_exp_f32 v177, -v177
  v_exp_f32 v178, -v178
  v_add_f32 v175, 1.0, v175
  v_add_f32 v176, 1.0, v176
  v_add_f32 v177, 1.0, v177
  v_add_f32 v178, 1.0, v178
  v_rcp_f32 v175, v175
  v_rcp_f32 v176, v176
  v_rcp_f32 v177, v177
  v_rcp_f32 v178, v178
  v_mul_f32 v171, v171, v175
  v_mul_f32 v172, v172, v176
  v_mul_f32 v173, v173, v177
  v_mul_f32 v174, v174, v178
  v_cvt_pk_bf16_f32 v179, v171, v172
  v_cvt_pk_bf16_f32 v180, v173, v174
  v_dot2_f32_bf16 v165, v179, v136, 0
  v_dot2_f32_bf16 v165, v180, v137, v165
  v_mul_f32 v171, s67, v148
  v_mul_f32 v172, s67, v149
  v_mul_f32 v173, s67, v150
  v_mul_f32 v174, s67, v151
  v_cvt_pk_bf16_f32 v179, v171, v172
  v_lshlrev_b32 v171, 16, v179
  v_and_b32 v172, s87, v179
  v_cvt_pk_bf16_f32 v180, v173, v174
  v_lshlrev_b32 v173, 16, v180
  v_and_b32 v174, s87, v180
  v_add_f32 v171, v171, v157
  v_add_f32 v172, v172, v158
  v_add_f32 v173, v173, v159
  v_add_f32 v174, v174, v160
  v_cvt_pk_bf16_f32 v179, v171, v172
  v_lshlrev_b32 v171, 16, v179
  v_and_b32 v172, s87, v179
  v_cvt_pk_bf16_f32 v180, v173, v174
  v_lshlrev_b32 v173, 16, v180
  v_and_b32 v174, s87, v180
  v_mul_f32 v175, v171, v171
  v_mul_f32 v176, v172, v172
  v_mul_f32 v177, v173, v173
  v_mul_f32 v178, v174, v174
  v_fmaak_f32 v175, v175, v143, 0x40135761
  v_fmaak_f32 v176, v176, v143, 0x40135761
  v_fmaak_f32 v177, v177, v143, 0x40135761
  v_fmaak_f32 v178, v178, v143, 0x40135761
  v_mul_f32 v175, v175, v171
  v_mul_f32 v176, v176, v172
  v_mul_f32 v177, v177, v173
  v_mul_f32 v178, v178, v174
  v_exp_f32 v175, -v175
  v_exp_f32 v176, -v176
  v_exp_f32 v177, -v177
  v_exp_f32 v178, -v178
  v_add_f32 v175, 1.0, v175
  v_add_f32 v176, 1.0, v176
  v_add_f32 v177, 1.0, v177
  v_add_f32 v178, 1.0, v178
  v_rcp_f32 v175, v175
  v_rcp_f32 v176, v176
  v_rcp_f32 v177, v177
  v_rcp_f32 v178, v178
  v_mul_f32 v171, v171, v175
  v_mul_f32 v172, v172, v176
  v_mul_f32 v173, v173, v177
  v_mul_f32 v174, v174, v178
  v_cvt_pk_bf16_f32 v179, v171, v172
  v_cvt_pk_bf16_f32 v180, v173, v174
  v_dot2_f32_bf16 v165, v179, v138, v165
  v_dot2_f32_bf16 v165, v180, v139, v165
  s_waitcnt vmcnt(12)
  v_dot2_f32_bf16 v32, v224, v8, 0
  v_dot2_f32_bf16 v36, v224, v12, 0
  v_dot2_f32_bf16 v33, v228, v8, 0
  v_dot2_f32_bf16 v37, v228, v12, 0
  v_dot2_f32_bf16 v34, v232, v8, 0
  v_dot2_f32_bf16 v38, v232, v12, 0
  v_dot2_f32_bf16 v35, v236, v8, 0
  v_dot2_f32_bf16 v39, v236, v12, 0
  v_dot2_f32_bf16 v32, v225, v9, v32
  v_dot2_f32_bf16 v36, v225, v13, v36
  v_dot2_f32_bf16 v33, v229, v9, v33
  v_dot2_f32_bf16 v37, v229, v13, v37
  v_dot2_f32_bf16 v34, v233, v9, v34
  v_dot2_f32_bf16 v38, v233, v13, v38
  v_dot2_f32_bf16 v35, v237, v9, v35
  v_dot2_f32_bf16 v39, v237, v13, v39
  v_dot2_f32_bf16 v32, v226, v10, v32
  v_dot2_f32_bf16 v36, v226, v14, v36
  v_dot2_f32_bf16 v33, v230, v10, v33
  v_dot2_f32_bf16 v37, v230, v14, v37
  v_dot2_f32_bf16 v34, v234, v10, v34
  v_dot2_f32_bf16 v38, v234, v14, v38
  v_dot2_f32_bf16 v35, v238, v10, v35
  v_dot2_f32_bf16 v39, v238, v14, v39
  v_dot2_f32_bf16 v32, v227, v11, v32
  v_dot2_f32_bf16 v36, v227, v15, v36
  v_dot2_f32_bf16 v33, v231, v11, v33
  v_dot2_f32_bf16 v37, v231, v15, v37
  v_dot2_f32_bf16 v34, v235, v11, v34
  v_dot2_f32_bf16 v38, v235, v15, v38
  v_dot2_f32_bf16 v35, v239, v11, v35
  v_dot2_f32_bf16 v39, v239, v15, v39
  s_mov_b32 s83, 163840
  buffer_load_dwordx4 v[224:227], v2, s[4:7], s83 offen offset:0 nt
  buffer_load_dwordx4 v[228:231], v2, s[4:7], s83 offen offset:1024 nt
  buffer_load_dwordx4 v[232:235], v2, s[4:7], s83 offen offset:2048 nt
  buffer_load_dwordx4 v[236:239], v2, s[4:7], s83 offen offset:3072 nt
  v_add_f32_dpp v32, v32, v32 row_ror:8 row_mask:0xf bank_mask:0x3
  v_add_f32_dpp v33, v33, v33 row_ror:8 row_mask:0xf bank_mask:0x3
  v_add_f32_dpp v36, v36, v36 row_ror:8 row_mask:0xf bank_mask:0x3
  v_add_f32_dpp v37, v37, v37 row_ror:8 row_mask:0xf bank_mask:0x3
  v_add_f32_dpp v32, v34, v34 row_ror:8 row_mask:0xf bank_mask:0xc
  v_add_f32_dpp v33, v35, v35 row_ror:8 row_mask:0xf bank_mask:0xc
  v_add_f32_dpp v36, v38, v38 row_ror:8 row_mask:0xf bank_mask:0xc
  v_add_f32_dpp v37, v39, v39 row_ror:8 row_mask:0xf bank_mask:0xc
  v_add_f32_dpp v32, v32, v32 row_shl:4 row_mask:0xf bank_mask:0x5
  v_add_f32_dpp v33, v33, v33 row_shl:4 row_mask:0xf bank_mask:0x5
  s_nop 0
  v_add_f32_dpp v32, v36, v36 row_shr:4 row_mask:0xf bank_mask:0xa
  v_add_f32_dpp v33, v37, v37 row_shr:4 row_mask:0xf bank_mask:0xa
  s_nop 0
  v_add_f32_dpp v32, v32, v32 quad_perm:[1,0,3,2] row_mask:0xf bank_mask:0xf
  v_add_f32_dpp v33, v33, v33 quad_perm:[1,0,3,2] row_mask:0xf bank_mask:0xf
  s_nop 0
  v_add_f32_dpp v32, v32, v32 quad_perm:[2,3,0,1] row_mask:0xf bank_mask:0xf
  v_add_f32_dpp v33, v33, v33 quad_perm:[2,3,0,1] row_mask:0xf bank_mask:0xf
  v_cvt_pk_bf16_f32 v34, v32, v33
  v_lshlrev_b32 v32, 16, v34
  v_and_b32 v33, s87, v34
  v_mul_f32 v32, s88, v32
  v_mul_f32 v33, s88, v33
  v_cvt_pk_bf16_f32 v34, v32, v33
  v_lshlrev_b32 v32, 16, v34
  v_and_b32 v33, s87, v34
  v_fma_f32 v32, v32, s89, -v3
  v_fma_f32 v33, v33, s89, -v3
  v_max_f32 v35, v32, v33
  v_cmp_lt_f32 vcc, 0x41000000, v35
  v_exp_f32 v37, v32
  v_exp_f32 v38, v33
  s_cmp_eq_u64 vcc, 0
  s_cbranch_scc1 K1_LZ3A
  v_max_f32_dpp v35, v35, v35 row_ror:8 row_mask:0xf bank_mask:0xf
  v_max_f32 v35, 0, v35
  v_exp_f32 v36, -v35
  v_add_f32 v3, v3, v35
  v_sub_f32 v32, v32, v35
  v_sub_f32 v33, v33, v35
  v_exp_f32 v37, v32
  v_exp_f32 v38, v33
  v_mul_f32 v4, v4, v36
  v_mul_f32_dpp v16, v36, v16 row_newbcast:0 row_mask:0xf bank_mask:0xf
  v_mul_f32_dpp v17, v36, v17 row_newbcast:0 row_mask:0xf bank_mask:0xf
  v_mul_f32_dpp v18, v36, v18 row_newbcast:0 row_mask:0xf bank_mask:0xf
  v_mul_f32_dpp v19, v36, v19 row_newbcast:0 row_mask:0xf bank_mask:0xf
  v_mul_f32_dpp v20, v36, v20 row_newbcast:0 row_mask:0xf bank_mask:0xf
  v_mul_f32_dpp v21, v36, v21 row_newbcast:0 row_mask:0xf bank_mask:0xf
  v_mul_f32_dpp v22, v36, v22 row_newbcast:0 row_mask:0xf bank_mask:0xf
  v_mul_f32_dpp v23, v36, v23 row_newbcast:0 row_mask:0xf bank_mask:0xf
  v_mul_f32_dpp v24, v36, v24 row_newbcast:4 row_mask:0xf bank_mask:0xf
  v_mul_f32_dpp v25, v36, v25 row_newbcast:4 row_mask:0xf bank_mask:0xf
  v_mul_f32_dpp v26, v36, v26 row_newbcast:4 row_mask:0xf bank_mask:0xf
  v_mul_f32_dpp v27, v36, v27 row_newbcast:4 row_mask:0xf bank_mask:0xf
  v_mul_f32_dpp v28, v36, v28 row_newbcast:4 row_mask:0xf bank_mask:0xf
  v_mul_f32_dpp v29, v36, v29 row_newbcast:4 row_mask:0xf bank_mask:0xf
  v_mul_f32_dpp v30, v36, v30 row_newbcast:4 row_mask:0xf bank_mask:0xf
  v_mul_f32_dpp v31, v36, v31 row_newbcast:4 row_mask:0xf bank_mask:0xf
K1_LZ3A:
  s_nop 1
  v_add_f32 v4, v4, v37
  v_cvt_pk_bf16_f32 v44, v37, v38
  v_add_f32 v4, v4, v38
  s_waitcnt vmcnt(12)
  v_perm_b32 v40, v244, v240, s85
  v_perm_b32 v41, v244, v240, s86
  v_perm_b32 v42, v245, v241, s85
  v_perm_b32 v43, v245, v241, s86
  v_dot2c_f32_bf16_dpp v16, v44, v40 row_newbcast:0 row_mask:0xf bank_mask:0xf
  v_dot2c_f32_bf16_dpp v17, v44, v41 row_newbcast:0 row_mask:0xf bank_mask:0xf
  v_dot2c_f32_bf16_dpp v18, v44, v42 row_newbcast:0 row_mask:0xf bank_mask:0xf
  v_dot2c_f32_bf16_dpp v19, v44, v43 row_newbcast:0 row_mask:0xf bank_mask:0xf
  v_dot2c_f32_bf16_dpp v24, v44, v40 row_newbcast:4 row_mask:0xf bank_mask:0xf
  v_dot2c_f32_bf16_dpp v25, v44, v41 row_newbcast:4 row_mask:0xf bank_mask:0xf
  v_dot2c_f32_bf16_dpp v26, v44, v42 row_newbcast:4 row_mask:0xf bank_mask:0xf
  v_dot2c_f32_bf16_dpp v27, v44, v43 row_newbcast:4 row_mask:0xf bank_mask:0xf
  v_perm_b32 v40, v246, v242, s85
  v_perm_b32 v41, v246, v242, s86
  v_perm_b32 v42, v247, v243, s85
  v_perm_b32 v43, v247, v243, s86
  v_dot2c_f32_bf16_dpp v20, v44, v40 row_newbcast:0 row_mask:0xf bank_mask:0xf
  v_dot2c_f32_bf16_dpp v21, v44, v41 row_newbcast:0 row_mask:0xf bank_mask:0xf
  v_dot2c_f32_bf16_dpp v22, v44, v42 row_newbcast:0 row_mask:0xf bank_mask:0xf
  v_dot2c_f32_bf16_dpp v23, v44, v43 row_newbcast:0 row_mask:0xf bank_mask:0xf
  v_dot2c_f32_bf16_dpp v28, v44, v40 row_newbcast:4 row_mask:0xf bank_mask:0xf
  v_dot2c_f32_bf16_dpp v29, v44, v41 row_newbcast:4 row_mask:0xf bank_mask:0xf
  v_dot2c_f32_bf16_dpp v30, v44, v42 row_newbcast:4 row_mask:0xf bank_mask:0xf
  v_dot2c_f32_bf16_dpp v31, v44, v43 row_newbcast:4 row_mask:0xf bank_mask:0xf
  v_perm_b32 v40, v252, v248, s85
  v_perm_b32 v41, v252, v248, s86
  v_perm_b32 v42, v253, v249, s85
  v_perm_b32 v43, v253, v249, s86
  v_dot2c_f32_bf16_dpp v16, v44, v40 row_newbcast:8 row_mask:0xf bank_mask:0xf
  v_dot2c_f32_bf16_dpp v17, v44, v41 row_newbcast:8 row_mask:0xf bank_mask:0xf
  v_dot2c_f32_bf16_dpp v18, v44, v42 row_newbcast:8 row_mask:0xf bank_mask:0xf
  v_dot2c_f32_bf16_dpp v19, v44, v43 row_newbcast:8 row_mask:0xf bank_mask:0xf
  v_dot2c_f32_bf16_dpp v24, v44, v40 row_newbcast:12 row_mask:0xf bank_mask:0xf
  v_dot2c_f32_bf16_dpp v25, v44, v41 row_newbcast:12 row_mask:0xf bank_mask:0xf
  v_dot2c_f32_bf16_dpp v26, v44, v42 row_newbcast:12 row_mask:0xf bank_mask:0xf
  v_dot2c_f32_bf16_dpp v27, v44, v43 row_newbcast:12 row_mask:0xf bank_mask:0xf
  v_perm_b32 v40, v254, v250, s85
  v_perm_b32 v41, v254, v250, s86
  v_perm_b32 v42, v255, v251, s85
  v_perm_b32 v43, v255, v251, s86
  v_dot2c_f32_bf16_dpp v20, v44, v40 row_newbcast:8 row_mask:0xf bank_mask:0xf
  v_dot2c_f32_bf16_dpp v21, v44, v41 row_newbcast:8 row_mask:0xf bank_mask:0xf
  v_dot2c_f32_bf16_dpp v22, v44, v42 row_newbcast:8 row_mask:0xf bank_mask:0xf
  v_dot2c_f32_bf16_dpp v23, v44, v43 row_newbcast:8 row_mask:0xf bank_mask:0xf
  v_dot2c_f32_bf16_dpp v28, v44, v40 row_newbcast:12 row_mask:0xf bank_mask:0xf
  v_dot2c_f32_bf16_dpp v29, v44, v41 row_newbcast:12 row_mask:0xf bank_mask:0xf
  v_dot2c_f32_bf16_dpp v30, v44, v42 row_newbcast:12 row_mask:0xf bank_mask:0xf
  v_dot2c_f32_bf16_dpp v31, v44, v43 row_newbcast:12 row_mask:0xf bank_mask:0xf
  s_mov_b32 s83, 163840
  buffer_load_dwordx4 v[240:243], v2, s[8:11], s83 offen offset:0 nt
  buffer_load_dwordx4 v[244:247], v2, s[8:11], s83 offen offset:1024 nt
  buffer_load_dwordx4 v[248:251], v2, s[8:11], s83 offen offset:2048 nt
  buffer_load_dwordx4 v[252:255], v2, s[8:11], s83 offen offset:3072 nt
  v_mul_f32 v171, s68, v144
  v_mul_f32 v172, s68, v145
  v_mul_f32 v173, s68, v146
  v_mul_f32 v174, s68, v147
  v_cvt_pk_bf16_f32 v179, v171, v172
  v_lshlrev_b32 v171, 16, v179
  v_and_b32 v172, s87, v179
  v_cvt_pk_bf16_f32 v180, v173, v174
  v_lshlrev_b32 v173, 16, v180
  v_and_b32 v174, s87, v180
  v_add_f32 v171, v171, v153
  v_add_f32 v172, v172, v154
  v_add_f32 v173, v173, v155
  v_add_f32 v174, v174, v156
  v_cvt_pk_bf16_f32 v179, v171, v172
  v_lshlrev_b32 v171, 16, v179
  v_and_b32 v172, s87, v179
  v_cvt_pk_bf16_f32 v180, v173, v174
  v_lshlrev_b32 v173, 16, v180
  v_and_b32 v174, s87, v180
  v_mul_f32 v175, v171, v171
  v_mul_f32 v176, v172, v172
  v_mul_f32 v177, v173, v173
  v_mul_f32 v178, v174, v174
  v_fmaak_f32 v175, v175, v143, 0x40135761
  v_fmaak_f32 v176, v176, v143, 0x40135761
  v_fmaak_f32 v177, v177, v143, 0x40135761
  v_fmaak_f32 v178, v178, v143, 0x40135761
  v_mul_f32 v175, v175, v171
  v_mul_f32 v176, v176, v172
  v_mul_f32 v177, v177, v173
  v_mul_f32 v178, v178, v174
  v_exp_f32 v175, -v175
  v_exp_f32 v176, -v176
  v_exp_f32 v177, -v177
  v_exp_f32 v178, -v178
  v_add_f32 v175, 1.0, v175
  v_add_f32 v176, 1.0, v176
  v_add_f32 v177, 1.0, v177
  v_add_f32 v178, 1.0, v178
  v_rcp_f32 v175, v175
  v_rcp_f32 v176, v176
  v_rcp_f32 v177, v177
  v_rcp_f32 v178, v178
  v_mul_f32 v171, v171, v175
  v_mul_f32 v172, v172, v176
  v_mul_f32 v173, v173, v177
  v_mul_f32 v174, v174, v178
  v_cvt_pk_bf16_f32 v179, v171, v172
  v_cvt_pk_bf16_f32 v180, v173, v174
  v_dot2_f32_bf16 v166, v179, v136, 0
  v_dot2_f32_bf16 v166, v180, v137, v166
  v_mul_f32 v171, s68, v148
  v_mul_f32 v172, s68, v149
  v_mul_f32 v173, s68, v150
  v_mul_f32 v174, s68, v151
  v_cvt_pk_bf16_f32 v179, v171, v172
  v_lshlrev_b32 v171, 16, v179
  v_and_b32 v172, s87, v179
  v_cvt_pk_bf16_f32 v180, v173, v174
  v_lshlrev_b32 v173, 16, v180
  v_and_b32 v174, s87, v180
  v_add_f32 v171, v171, v157
  v_add_f32 v172, v172, v158
  v_add_f32 v173, v173, v159
  v_add_f32 v174, v174, v160
  v_cvt_pk_bf16_f32 v179, v171, v172
  v_lshlrev_b32 v171, 16, v179
  v_and_b32 v172, s87, v179
  v_cvt_pk_bf16_f32 v180, v173, v174
  v_lshlrev_b32 v173, 16, v180
  v_and_b32 v174, s87, v180
  v_mul_f32 v175, v171, v171
  v_mul_f32 v176, v172, v172
  v_mul_f32 v177, v173, v173
  v_mul_f32 v178, v174, v174
  v_fmaak_f32 v175, v175, v143, 0x40135761
  v_fmaak_f32 v176, v176, v143, 0x40135761
  v_fmaak_f32 v177, v177, v143, 0x40135761
  v_fmaak_f32 v178, v178, v143, 0x40135761
  v_mul_f32 v175, v175, v171
  v_mul_f32 v176, v176, v172
  v_mul_f32 v177, v177, v173
  v_mul_f32 v178, v178, v174
  v_exp_f32 v175, -v175
  v_exp_f32 v176, -v176
  v_exp_f32 v177, -v177
  v_exp_f32 v178, -v178
  v_add_f32 v175, 1.0, v175
  v_add_f32 v176, 1.0, v176
  v_add_f32 v177, 1.0, v177
  v_add_f32 v178, 1.0, v178
  v_rcp_f32 v175, v175
  v_rcp_f32 v176, v176
  v_rcp_f32 v177, v177
  v_rcp_f32 v178, v178
  v_mul_f32 v171, v171, v175
  v_mul_f32 v172, v172, v176
  v_mul_f32 v173, v173, v177
  v_mul_f32 v174, v174, v178
  v_cvt_pk_bf16_f32 v179, v171, v172
  v_cvt_pk_bf16_f32 v180, v173, v174
  v_dot2_f32_bf16 v166, v179, v138, v166
  v_dot2_f32_bf16 v166, v180, v139, v166
  v_mul_f32 v171, s69, v144
  v_mul_f32 v172, s69, v145
  v_mul_f32 v173, s69, v146
  v_mul_f32 v174, s69, v147
  v_cvt_pk_bf16_f32 v179, v171, v172
  v_lshlrev_b32 v171, 16, v179
  v_and_b32 v172, s87, v179
  v_cvt_pk_bf16_f32 v180, v173, v174
  v_lshlrev_b32 v173, 16, v180
  v_and_b32 v174, s87, v180
  v_add_f32 v171, v171, v153
  v_add_f32 v172, v172, v154
  v_add_f32 v173, v173, v155
  v_add_f32 v174, v174, v156
  v_cvt_pk_bf16_f32 v179, v171, v172
  v_lshlrev_b32 v171, 16, v179
  v_and_b32 v172, s87, v179
  v_cvt_pk_bf16_f32 v180, v173, v174
  v_lshlrev_b32 v173, 16, v180
  v_and_b32 v174, s87, v180
  v_mul_f32 v175, v171, v171
  v_mul_f32 v176, v172, v172
  v_mul_f32 v177, v173, v173
  v_mul_f32 v178, v174, v174
  v_fmaak_f32 v175, v175, v143, 0x40135761
  v_fmaak_f32 v176, v176, v143, 0x40135761
  v_fmaak_f32 v177, v177, v143, 0x40135761
  v_fmaak_f32 v178, v178, v143, 0x40135761
  v_mul_f32 v175, v175, v171
  v_mul_f32 v176, v176, v172
  v_mul_f32 v177, v177, v173
  v_mul_f32 v178, v178, v174
  v_exp_f32 v175, -v175
  v_exp_f32 v176, -v176
  v_exp_f32 v177, -v177
  v_exp_f32 v178, -v178
  v_add_f32 v175, 1.0, v175
  v_add_f32 v176, 1.0, v176
  v_add_f32 v177, 1.0, v177
  v_add_f32 v178, 1.0, v178
  v_rcp_f32 v175, v175
  v_rcp_f32 v176, v176
  v_rcp_f32 v177, v177
  v_rcp_f32 v178, v178
  v_mul_f32 v171, v171, v175
  v_mul_f32 v172, v172, v176
  v_mul_f32 v173, v173, v177
  v_mul_f32 v174, v174, v178
  v_cvt_pk_bf16_f32 v179, v171, v172
  v_cvt_pk_bf16_f32 v180, v173, v174
  v_dot2_f32_bf16 v167, v179, v136, 0
  v_dot2_f32_bf16 v167, v180, v137, v167
  v_mul_f32 v171, s69, v148
  v_mul_f32 v172, s69, v149
  v_mul_f32 v173, s69, v150
  v_mul_f32 v174, s69, v151
  v_cvt_pk_bf16_f32 v179, v171, v172
  v_lshlrev_b32 v171, 16, v179
  v_and_b32 v172, s87, v179
  v_cvt_pk_bf16_f32 v180, v173, v174
  v_lshlrev_b32 v173, 16, v180
  v_and_b32 v174, s87, v180
  v_add_f32 v171, v171, v157
  v_add_f32 v172, v172, v158
  v_add_f32 v173, v173, v159
  v_add_f32 v174, v174, v160
  v_cvt_pk_bf16_f32 v179, v171, v172
  v_lshlrev_b32 v171, 16, v179
  v_and_b32 v172, s87, v179
  v_cvt_pk_bf16_f32 v180, v173, v174
  v_lshlrev_b32 v173, 16, v180
  v_and_b32 v174, s87, v180
  v_mul_f32 v175, v171, v171
  v_mul_f32 v176, v172, v172
  v_mul_f32 v177, v173, v173
  v_mul_f32 v178, v174, v174
  v_fmaak_f32 v175, v175, v143, 0x40135761
  v_fmaak_f32 v176, v176, v143, 0x40135761
  v_fmaak_f32 v177, v177, v143, 0x40135761
  v_fmaak_f32 v178, v178, v143, 0x40135761
  v_mul_f32 v175, v175, v171
  v_mul_f32 v176, v176, v172
  v_mul_f32 v177, v177, v173
  v_mul_f32 v178, v178, v174
  v_exp_f32 v175, -v175
  v_exp_f32 v176, -v176
  v_exp_f32 v177, -v177
  v_exp_f32 v178, -v178
  v_add_f32 v175, 1.0, v175
  v_add_f32 v176, 1.0, v176
  v_add_f32 v177, 1.0, v177
  v_add_f32 v178, 1.0, v178
  v_rcp_f32 v175, v175
  v_rcp_f32 v176, v176
  v_rcp_f32 v177, v177
  v_rcp_f32 v178, v178
  v_mul_f32 v171, v171, v175
  v_mul_f32 v172, v172, v176
  v_mul_f32 v173, v173, v177
  v_mul_f32 v174, v174, v178
  v_cvt_pk_bf16_f32 v179, v171, v172
  v_cvt_pk_bf16_f32 v180, v173, v174
  v_dot2_f32_bf16 v167, v179, v138, v167
  v_dot2_f32_bf16 v167, v180, v139, v167
  s_waitcnt vmcnt(12)
  v_dot2_f32_bf16 v32, v192, v8, 0
  v_dot2_f32_bf16 v36, v192, v12, 0
  v_dot2_f32_bf16 v33, v196, v8, 0
  v_dot2_f32_bf16 v37, v196, v12, 0
  v_dot2_f32_bf16 v34, v200, v8, 0
  v_dot2_f32_bf16 v38, v200, v12, 0
  v_dot2_f32_bf16 v35, v204, v8, 0
  v_dot2_f32_bf16 v39, v204, v12, 0
  v_dot2_f32_bf16 v32, v193, v9, v32
  v_dot2_f32_bf16 v36, v193, v13, v36
  v_dot2_f32_bf16 v33, v197, v9, v33
  v_dot2_f32_bf16 v37, v197, v13, v37
  v_dot2_f32_bf16 v34, v201, v9, v34
  v_dot2_f32_bf16 v38, v201, v13, v38
  v_dot2_f32_bf16 v35, v205, v9, v35
  v_dot2_f32_bf16 v39, v205, v13, v39
  v_dot2_f32_bf16 v32, v194, v10, v32
  v_dot2_f32_bf16 v36, v194, v14, v36
  v_dot2_f32_bf16 v33, v198, v10, v33
  v_dot2_f32_bf16 v37, v198, v14, v37
  v_dot2_f32_bf16 v34, v202, v10, v34
  v_dot2_f32_bf16 v38, v202, v14, v38
  v_dot2_f32_bf16 v35, v206, v10, v35
  v_dot2_f32_bf16 v39, v206, v14, v39
  v_dot2_f32_bf16 v32, v195, v11, v32
  v_dot2_f32_bf16 v36, v195, v15, v36
  v_dot2_f32_bf16 v33, v199, v11, v33
  v_dot2_f32_bf16 v37, v199, v15, v37
  v_dot2_f32_bf16 v34, v203, v11, v34
  v_dot2_f32_bf16 v38, v203, v15, v38
  v_dot2_f32_bf16 v35, v207, v11, v35
  v_dot2_f32_bf16 v39, v207, v15, v39
  s_mov_b32 s83, 196608
  buffer_load_dwordx4 v[192:195], v2, s[4:7], s83 offen offset:0 nt
  buffer_load_dwordx4 v[196:199], v2, s[4:7], s83 offen offset:1024 nt
  buffer_load_dwordx4 v[200:203], v2, s[4:7], s83 offen offset:2048 nt
  buffer_load_dwordx4 v[204:207], v2, s[4:7], s83 offen offset:3072 nt
  v_add_f32_dpp v32, v32, v32 row_ror:8 row_mask:0xf bank_mask:0x3
  v_add_f32_dpp v33, v33, v33 row_ror:8 row_mask:0xf bank_mask:0x3
  v_add_f32_dpp v36, v36, v36 row_ror:8 row_mask:0xf bank_mask:0x3
  v_add_f32_dpp v37, v37, v37 row_ror:8 row_mask:0xf bank_mask:0x3
  v_add_f32_dpp v32, v34, v34 row_ror:8 row_mask:0xf bank_mask:0xc
  v_add_f32_dpp v33, v35, v35 row_ror:8 row_mask:0xf bank_mask:0xc
  v_add_f32_dpp v36, v38, v38 row_ror:8 row_mask:0xf bank_mask:0xc
  v_add_f32_dpp v37, v39, v39 row_ror:8 row_mask:0xf bank_mask:0xc
  v_add_f32_dpp v32, v32, v32 row_shl:4 row_mask:0xf bank_mask:0x5
  v_add_f32_dpp v33, v33, v33 row_shl:4 row_mask:0xf bank_mask:0x5
  s_nop 0
  v_add_f32_dpp v32, v36, v36 row_shr:4 row_mask:0xf bank_mask:0xa
  v_add_f32_dpp v33, v37, v37 row_shr:4 row_mask:0xf bank_mask:0xa
  s_nop 0
  v_add_f32_dpp v32, v32, v32 quad_perm:[1,0,3,2] row_mask:0xf bank_mask:0xf
  v_add_f32_dpp v33, v33, v33 quad_perm:[1,0,3,2] row_mask:0xf bank_mask:0xf
  s_nop 0
  v_add_f32_dpp v32, v32, v32 quad_perm:[2,3,0,1] row_mask:0xf bank_mask:0xf
  v_add_f32_dpp v33, v33, v33 quad_perm:[2,3,0,1] row_mask:0xf bank_mask:0xf
  v_cvt_pk_bf16_f32 v34, v32, v33
  v_lshlrev_b32 v32, 16, v34
  v_and_b32 v33, s87, v34
  v_mul_f32 v32, s88, v32
  v_mul_f32 v33, s88, v33
  v_cvt_pk_bf16_f32 v34, v32, v33
  v_lshlrev_b32 v32, 16, v34
  v_and_b32 v33, s87, v34
  v_fma_f32 v32, v32, s89, -v3
  v_fma_f32 v33, v33, s89, -v3
  v_max_f32 v35, v32, v33
  v_cmp_lt_f32 vcc, 0x41000000, v35
  v_exp_f32 v37, v32
  v_exp_f32 v38, v33
  s_cmp_eq_u64 vcc, 0
  s_cbranch_scc1 K1_LZ4A
  v_max_f32_dpp v35, v35, v35 row_ror:8 row_mask:0xf bank_mask:0xf
  v_max_f32 v35, 0, v35
  v_exp_f32 v36, -v35
  v_add_f32 v3, v3, v35
  v_sub_f32 v32, v32, v35
  v_sub_f32 v33, v33, v35
  v_exp_f32 v37, v32
  v_exp_f32 v38, v33
  v_mul_f32 v4, v4, v36
  v_mul_f32_dpp v16, v36, v16 row_newbcast:0 row_mask:0xf bank_mask:0xf
  v_mul_f32_dpp v17, v36, v17 row_newbcast:0 row_mask:0xf bank_mask:0xf
  v_mul_f32_dpp v18, v36, v18 row_newbcast:0 row_mask:0xf bank_mask:0xf
  v_mul_f32_dpp v19, v36, v19 row_newbcast:0 row_mask:0xf bank_mask:0xf
  v_mul_f32_dpp v20, v36, v20 row_newbcast:0 row_mask:0xf bank_mask:0xf
  v_mul_f32_dpp v21, v36, v21 row_newbcast:0 row_mask:0xf bank_mask:0xf
  v_mul_f32_dpp v22, v36, v22 row_newbcast:0 row_mask:0xf bank_mask:0xf
  v_mul_f32_dpp v23, v36, v23 row_newbcast:0 row_mask:0xf bank_mask:0xf
  v_mul_f32_dpp v24, v36, v24 row_newbcast:4 row_mask:0xf bank_mask:0xf
  v_mul_f32_dpp v25, v36, v25 row_newbcast:4 row_mask:0xf bank_mask:0xf
  v_mul_f32_dpp v26, v36, v26 row_newbcast:4 row_mask:0xf bank_mask:0xf
  v_mul_f32_dpp v27, v36, v27 row_newbcast:4 row_mask:0xf bank_mask:0xf
  v_mul_f32_dpp v28, v36, v28 row_newbcast:4 row_mask:0xf bank_mask:0xf
  v_mul_f32_dpp v29, v36, v29 row_newbcast:4 row_mask:0xf bank_mask:0xf
  v_mul_f32_dpp v30, v36, v30 row_newbcast:4 row_mask:0xf bank_mask:0xf
  v_mul_f32_dpp v31, v36, v31 row_newbcast:4 row_mask:0xf bank_mask:0xf
K1_LZ4A:
  s_nop 1
  v_add_f32 v4, v4, v37
  v_cvt_pk_bf16_f32 v44, v37, v38
  v_add_f32 v4, v4, v38
  s_waitcnt vmcnt(12)
  v_perm_b32 v40, v212, v208, s85
  v_perm_b32 v41, v212, v208, s86
  v_perm_b32 v42, v213, v209, s85
  v_perm_b32 v43, v213, v209, s86
  v_dot2c_f32_bf16_dpp v16, v44, v40 row_newbcast:0 row_mask:0xf bank_mask:0xf
  v_dot2c_f32_bf16_dpp v17, v44, v41 row_newbcast:0 row_mask:0xf bank_mask:0xf
  v_dot2c_f32_bf16_dpp v18, v44, v42 row_newbcast:0 row_mask:0xf bank_mask:0xf
  v_dot2c_f32_bf16_dpp v19, v44, v43 row_newbcast:0 row_mask:0xf bank_mask:0xf
  v_dot2c_f32_bf16_dpp v24, v44, v40 row_newbcast:4 row_mask:0xf bank_mask:0xf
  v_dot2c_f32_bf16_dpp v25, v44, v41 row_newbcast:4 row_mask:0xf bank_mask:0xf
  v_dot2c_f32_bf16_dpp v26, v44, v42 row_newbcast:4 row_mask:0xf bank_mask:0xf
  v_dot2c_f32_bf16_dpp v27, v44, v43 row_newbcast:4 row_mask:0xf bank_mask:0xf
  v_perm_b32 v40, v214, v210, s85
  v_perm_b32 v41, v214, v210, s86
  v_perm_b32 v42, v215, v211, s85
  v_perm_b32 v43, v215, v211, s86
  v_dot2c_f32_bf16_dpp v20, v44, v40 row_newbcast:0 row_mask:0xf bank_mask:0xf
  v_dot2c_f32_bf16_dpp v21, v44, v41 row_newbcast:0 row_mask:0xf bank_mask:0xf
  v_dot2c_f32_bf16_dpp v22, v44, v42 row_newbcast:0 row_mask:0xf bank_mask:0xf
  v_dot2c_f32_bf16_dpp v23, v44, v43 row_newbcast:0 row_mask:0xf bank_mask:0xf
  v_dot2c_f32_bf16_dpp v28, v44, v40 row_newbcast:4 row_mask:0xf bank_mask:0xf
  v_dot2c_f32_bf16_dpp v29, v44, v41 row_newbcast:4 row_mask:0xf bank_mask:0xf
  v_dot2c_f32_bf16_dpp v30, v44, v42 row_newbcast:4 row_mask:0xf bank_mask:0xf
  v_dot2c_f32_bf16_dpp v31, v44, v43 row_newbcast:4 row_mask:0xf bank_mask:0xf
  v_perm_b32 v40, v220, v216, s85
  v_perm_b32 v41, v220, v216, s86
  v_perm_b32 v42, v221, v217, s85
  v_perm_b32 v43, v221, v217, s86
  v_dot2c_f32_bf16_dpp v16, v44, v40 row_newbcast:8 row_mask:0xf bank_mask:0xf
  v_dot2c_f32_bf16_dpp v17, v44, v41 row_newbcast:8 row_mask:0xf bank_mask:0xf
  v_dot2c_f32_bf16_dpp v18, v44, v42 row_newbcast:8 row_mask:0xf bank_mask:0xf
  v_dot2c_f32_bf16_dpp v19, v44, v43 row_newbcast:8 row_mask:0xf bank_mask:0xf
  v_dot2c_f32_bf16_dpp v24, v44, v40 row_newbcast:12 row_mask:0xf bank_mask:0xf
  v_dot2c_f32_bf16_dpp v25, v44, v41 row_newbcast:12 row_mask:0xf bank_mask:0xf
  v_dot2c_f32_bf16_dpp v26, v44, v42 row_newbcast:12 row_mask:0xf bank_mask:0xf
  v_dot2c_f32_bf16_dpp v27, v44, v43 row_newbcast:12 row_mask:0xf bank_mask:0xf
  v_perm_b32 v40, v222, v218, s85
  v_perm_b32 v41, v222, v218, s86
  v_perm_b32 v42, v223, v219, s85
  v_perm_b32 v43, v223, v219, s86
  v_dot2c_f32_bf16_dpp v20, v44, v40 row_newbcast:8 row_mask:0xf bank_mask:0xf
  v_dot2c_f32_bf16_dpp v21, v44, v41 row_newbcast:8 row_mask:0xf bank_mask:0xf
  v_dot2c_f32_bf16_dpp v22, v44, v42 row_newbcast:8 row_mask:0xf bank_mask:0xf
  v_dot2c_f32_bf16_dpp v23, v44, v43 row_newbcast:8 row_mask:0xf bank_mask:0xf
  v_dot2c_f32_bf16_dpp v28, v44, v40 row_newbcast:12 row_mask:0xf bank_mask:0xf
  v_dot2c_f32_bf16_dpp v29, v44, v41 row_newbcast:12 row_mask:0xf bank_mask:0xf
  v_dot2c_f32_bf16_dpp v30, v44, v42 row_newbcast:12 row_mask:0xf bank_mask:0xf
  v_dot2c_f32_bf16_dpp v31, v44, v43 row_newbcast:12 row_mask:0xf bank_mask:0xf
  s_mov_b32 s83, 196608
  buffer_load_dwordx4 v[208:211], v2, s[8:11], s83 offen offset:0 nt
  buffer_load_dwordx4 v[212:215], v2, s[8:11], s83 offen offset:1024 nt
  buffer_load_dwordx4 v[216:219], v2, s[8:11], s83 offen offset:2048 nt
  buffer_load_dwordx4 v[220:223], v2, s[8:11], s83 offen offset:3072 nt
  v_mul_f32 v171, s70, v144
  v_mul_f32 v172, s70, v145
  v_mul_f32 v173, s70, v146
  v_mul_f32 v174, s70, v147
  v_cvt_pk_bf16_f32 v179, v171, v172
  v_lshlrev_b32 v171, 16, v179
  v_and_b32 v172, s87, v179
  v_cvt_pk_bf16_f32 v180, v173, v174
  v_lshlrev_b32 v173, 16, v180
  v_and_b32 v174, s87, v180
  v_add_f32 v171, v171, v153
  v_add_f32 v172, v172, v154
  v_add_f32 v173, v173, v155
  v_add_f32 v174, v174, v156
  v_cvt_pk_bf16_f32 v179, v171, v172
  v_lshlrev_b32 v171, 16, v179
  v_and_b32 v172, s87, v179
  v_cvt_pk_bf16_f32 v180, v173, v174
  v_lshlrev_b32 v173, 16, v180
  v_and_b32 v174, s87, v180
  v_mul_f32 v175, v171, v171
  v_mul_f32 v176, v172, v172
  v_mul_f32 v177, v173, v173
  v_mul_f32 v178, v174, v174
  v_fmaak_f32 v175, v175, v143, 0x40135761
  v_fmaak_f32 v176, v176, v143, 0x40135761
  v_fmaak_f32 v177, v177, v143, 0x40135761
  v_fmaak_f32 v178, v178, v143, 0x40135761
  v_mul_f32 v175, v175, v171
  v_mul_f32 v176, v176, v172
  v_mul_f32 v177, v177, v173
  v_mul_f32 v178, v178, v174
  v_exp_f32 v175, -v175
  v_exp_f32 v176, -v176
  v_exp_f32 v177, -v177
  v_exp_f32 v178, -v178
  v_add_f32 v175, 1.0, v175
  v_add_f32 v176, 1.0, v176
  v_add_f32 v177, 1.0, v177
  v_add_f32 v178, 1.0, v178
  v_rcp_f32 v175, v175
  v_rcp_f32 v176, v176
  v_rcp_f32 v177, v177
  v_rcp_f32 v178, v178
  v_mul_f32 v171, v171, v175
  v_mul_f32 v172, v172, v176
  v_mul_f32 v173, v173, v177
  v_mul_f32 v174, v174, v178
  v_cvt_pk_bf16_f32 v179, v171, v172
  v_cvt_pk_bf16_f32 v180, v173, v174
  v_dot2_f32_bf16 v168, v179, v136, 0
  v_dot2_f32_bf16 v168, v180, v137, v168
  v_mul_f32 v171, s70, v148
  v_mul_f32 v172, s70, v149
  v_mul_f32 v173, s70, v150
  v_mul_f32 v174, s70, v151
  v_cvt_pk_bf16_f32 v179, v171, v172
  v_lshlrev_b32 v171, 16, v179
  v_and_b32 v172, s87, v179
  v_cvt_pk_bf16_f32 v180, v173, v174
  v_lshlrev_b32 v173, 16, v180
  v_and_b32 v174, s87, v180
  v_add_f32 v171, v171, v157
  v_add_f32 v172, v172, v158
  v_add_f32 v173, v173, v159
  v_add_f32 v174, v174, v160
  v_cvt_pk_bf16_f32 v179, v171, v172
  v_lshlrev_b32 v171, 16, v179
  v_and_b32 v172, s87, v179
  v_cvt_pk_bf16_f32 v180, v173, v174
  v_lshlrev_b32 v173, 16, v180
  v_and_b32 v174, s87, v180
  v_mul_f32 v175, v171, v171
  v_mul_f32 v176, v172, v172
  v_mul_f32 v177, v173, v173
  v_mul_f32 v178, v174, v174
  v_fmaak_f32 v175, v175, v143, 0x40135761
  v_fmaak_f32 v176, v176, v143, 0x40135761
  v_fmaak_f32 v177, v177, v143, 0x40135761
  v_fmaak_f32 v178, v178, v143, 0x40135761
  v_mul_f32 v175, v175, v171
  v_mul_f32 v176, v176, v172
  v_mul_f32 v177, v177, v173
  v_mul_f32 v178, v178, v174
  v_exp_f32 v175, -v175
  v_exp_f32 v176, -v176
  v_exp_f32 v177, -v177
  v_exp_f32 v178, -v178
  v_add_f32 v175, 1.0, v175
  v_add_f32 v176, 1.0, v176
  v_add_f32 v177, 1.0, v177
  v_add_f32 v178, 1.0, v178
  v_rcp_f32 v175, v175
  v_rcp_f32 v176, v176
  v_rcp_f32 v177, v177
  v_rcp_f32 v178, v178
  v_mul_f32 v171, v171, v175
  v_mul_f32 v172, v172, v176
  v_mul_f32 v173, v173, v177
  v_mul_f32 v174, v174, v178
  v_cvt_pk_bf16_f32 v179, v171, v172
  v_cvt_pk_bf16_f32 v180, v173, v174
  v_dot2_f32_bf16 v168, v179, v138, v168
  v_dot2_f32_bf16 v168, v180, v139, v168
  v_mul_f32 v171, s71, v144
  v_mul_f32 v172, s71, v145
  v_mul_f32 v173, s71, v146
  v_mul_f32 v174, s71, v147
  v_cvt_pk_bf16_f32 v179, v171, v172
  v_lshlrev_b32 v171, 16, v179
  v_and_b32 v172, s87, v179
  v_cvt_pk_bf16_f32 v180, v173, v174
  v_lshlrev_b32 v173, 16, v180
  v_and_b32 v174, s87, v180
  v_add_f32 v171, v171, v153
  v_add_f32 v172, v172, v154
  v_add_f32 v173, v173, v155
  v_add_f32 v174, v174, v156
  v_cvt_pk_bf16_f32 v179, v171, v172
  v_lshlrev_b32 v171, 16, v179
  v_and_b32 v172, s87, v179
  v_cvt_pk_bf16_f32 v180, v173, v174
  v_lshlrev_b32 v173, 16, v180
  v_and_b32 v174, s87, v180
  v_mul_f32 v175, v171, v171
  v_mul_f32 v176, v172, v172
  v_mul_f32 v177, v173, v173
  v_mul_f32 v178, v174, v174
  v_fmaak_f32 v175, v175, v143, 0x40135761
  v_fmaak_f32 v176, v176, v143, 0x40135761
  v_fmaak_f32 v177, v177, v143, 0x40135761
  v_fmaak_f32 v178, v178, v143, 0x40135761
  v_mul_f32 v175, v175, v171
  v_mul_f32 v176, v176, v172
  v_mul_f32 v177, v177, v173
  v_mul_f32 v178, v178, v174
  v_exp_f32 v175, -v175
  v_exp_f32 v176, -v176
  v_exp_f32 v177, -v177
  v_exp_f32 v178, -v178
  v_add_f32 v175, 1.0, v175
  v_add_f32 v176, 1.0, v176
  v_add_f32 v177, 1.0, v177
  v_add_f32 v178, 1.0, v178
  v_rcp_f32 v175, v175
  v_rcp_f32 v176, v176
  v_rcp_f32 v177, v177
  v_rcp_f32 v178, v178
  v_mul_f32 v171, v171, v175
  v_mul_f32 v172, v172, v176
  v_mul_f32 v173, v173, v177
  v_mul_f32 v174, v174, v178
  v_cvt_pk_bf16_f32 v179, v171, v172
  v_cvt_pk_bf16_f32 v180, v173, v174
  v_dot2_f32_bf16 v169, v179, v136, 0
  v_dot2_f32_bf16 v169, v180, v137, v169
  v_mul_f32 v171, s71, v148
  v_mul_f32 v172, s71, v149
  v_mul_f32 v173, s71, v150
  v_mul_f32 v174, s71, v151
  v_cvt_pk_bf16_f32 v179, v171, v172
  v_lshlrev_b32 v171, 16, v179
  v_and_b32 v172, s87, v179
  v_cvt_pk_bf16_f32 v180, v173, v174
  v_lshlrev_b32 v173, 16, v180
  v_and_b32 v174, s87, v180
  v_add_f32 v171, v171, v157
  v_add_f32 v172, v172, v158
  v_add_f32 v173, v173, v159
  v_add_f32 v174, v174, v160
  v_cvt_pk_bf16_f32 v179, v171, v172
  v_lshlrev_b32 v171, 16, v179
  v_and_b32 v172, s87, v179
  v_cvt_pk_bf16_f32 v180, v173, v174
  v_lshlrev_b32 v173, 16, v180
  v_and_b32 v174, s87, v180
  v_mul_f32 v175, v171, v171
  v_mul_f32 v176, v172, v172
  v_mul_f32 v177, v173, v173
  v_mul_f32 v178, v174, v174
  v_fmaak_f32 v175, v175, v143, 0x40135761
  v_fmaak_f32 v176, v176, v143, 0x40135761
  v_fmaak_f32 v177, v177, v143, 0x40135761
  v_fmaak_f32 v178, v178, v143, 0x40135761
  v_mul_f32 v175, v175, v171
  v_mul_f32 v176, v176, v172
  v_mul_f32 v177, v177, v173
  v_mul_f32 v178, v178, v174
  v_exp_f32 v175, -v175
  v_exp_f32 v176, -v176
  v_exp_f32 v177, -v177
  v_exp_f32 v178, -v178
  v_add_f32 v175, 1.0, v175
  v_add_f32 v176, 1.0, v176
  v_add_f32 v177, 1.0, v177
  v_add_f32 v178, 1.0, v178
  v_rcp_f32 v175, v175
  v_rcp_f32 v176, v176
  v_rcp_f32 v177, v177
  v_rcp_f32 v178, v178
  v_mul_f32 v171, v171, v175
  v_mul_f32 v172, v172, v176
  v_mul_f32 v173, v173, v177
  v_mul_f32 v174, v174, v178
  v_cvt_pk_bf16_f32 v179, v171, v172
  v_cvt_pk_bf16_f32 v180, v173, v174
  v_dot2_f32_bf16 v169, v179, v138, v169
  v_dot2_f32_bf16 v169, v180, v139, v169
  s_mov_b32 s84, 0
  buffer_load_dwordx4 v[48:51], v46, s[16:19], s84 offen offset:0
  s_mov_b32 s84, 0
  buffer_load_dwordx4 v[52:55], v46, s[16:19], s84 offen offset:1152
  s_mov_b32 s84, 0
  buffer_load_dwordx4 v[56:59], v46, s[16:19], s84 offen offset:2304
  s_mov_b32 s84, 3456
  buffer_load_dwordx4 v[60:63], v46, s[16:19], s84 offen offset:0
  s_waitcnt vmcnt(16)
  v_dot2_f32_bf16 v32, v224, v8, 0
  v_dot2_f32_bf16 v36, v224, v12, 0
  v_dot2_f32_bf16 v33, v228, v8, 0
  v_dot2_f32_bf16 v37, v228, v12, 0
  v_dot2_f32_bf16 v34, v232, v8, 0
  v_dot2_f32_bf16 v38, v232, v12, 0
  v_dot2_f32_bf16 v35, v236, v8, 0
  v_dot2_f32_bf16 v39, v236, v12, 0
  v_dot2_f32_bf16 v32, v225, v9, v32
  v_dot2_f32_bf16 v36, v225, v13, v36
  v_dot2_f32_bf16 v33, v229, v9, v33
  v_dot2_f32_bf16 v37, v229, v13, v37
  v_dot2_f32_bf16 v34, v233, v9, v34
  v_dot2_f32_bf16 v38, v233, v13, v38
  v_dot2_f32_bf16 v35, v237, v9, v35
  v_dot2_f32_bf16 v39, v237, v13, v39
  v_dot2_f32_bf16 v32, v226, v10, v32
  v_dot2_f32_bf16 v36, v226, v14, v36
  v_dot2_f32_bf16 v33, v230, v10, v33
  v_dot2_f32_bf16 v37, v230, v14, v37
  v_dot2_f32_bf16 v34, v234, v10, v34
  v_dot2_f32_bf16 v38, v234, v14, v38
  v_dot2_f32_bf16 v35, v238, v10, v35
  v_dot2_f32_bf16 v39, v238, v14, v39
  v_dot2_f32_bf16 v32, v227, v11, v32
  v_dot2_f32_bf16 v36, v227, v15, v36
  v_dot2_f32_bf16 v33, v231, v11, v33
  v_dot2_f32_bf16 v37, v231, v15, v37
  v_dot2_f32_bf16 v34, v235, v11, v34
  v_dot2_f32_bf16 v38, v235, v15, v38
  v_dot2_f32_bf16 v35, v239, v11, v35
  v_dot2_f32_bf16 v39, v239, v15, v39
  s_mov_b32 s83, 229376
  buffer_load_dwordx4 v[224:227], v2, s[4:7], s83 offen offset:0 nt
  buffer_load_dwordx4 v[228:231], v2, s[4:7], s83 offen offset:1024 nt
  buffer_load_dwordx4 v[232:235], v2, s[4:7], s83 offen offset:2048 nt
  buffer_load_dwordx4 v[236:239], v2, s[4:7], s83 offen offset:3072 nt
  v_add_f32_dpp v32, v32, v32 row_ror:8 row_mask:0xf bank_mask:0x3
  v_add_f32_dpp v33, v33, v33 row_ror:8 row_mask:0xf bank_mask:0x3
  v_add_f32_dpp v36, v36, v36 row_ror:8 row_mask:0xf bank_mask:0x3
  v_add_f32_dpp v37, v37, v37 row_ror:8 row_mask:0xf bank_mask:0x3
  v_add_f32_dpp v32, v34, v34 row_ror:8 row_mask:0xf bank_mask:0xc
  v_add_f32_dpp v33, v35, v35 row_ror:8 row_mask:0xf bank_mask:0xc
  v_add_f32_dpp v36, v38, v38 row_ror:8 row_mask:0xf bank_mask:0xc
  v_add_f32_dpp v37, v39, v39 row_ror:8 row_mask:0xf bank_mask:0xc
  v_add_f32_dpp v32, v32, v32 row_shl:4 row_mask:0xf bank_mask:0x5
  v_add_f32_dpp v33, v33, v33 row_shl:4 row_mask:0xf bank_mask:0x5
  s_nop 0
  v_add_f32_dpp v32, v36, v36 row_shr:4 row_mask:0xf bank_mask:0xa
  v_add_f32_dpp v33, v37, v37 row_shr:4 row_mask:0xf bank_mask:0xa
  s_nop 0
  v_add_f32_dpp v32, v32, v32 quad_perm:[1,0,3,2] row_mask:0xf bank_mask:0xf
  v_add_f32_dpp v33, v33, v33 quad_perm:[1,0,3,2] row_mask:0xf bank_mask:0xf
  s_nop 0
  v_add_f32_dpp v32, v32, v32 quad_perm:[2,3,0,1] row_mask:0xf bank_mask:0xf
  v_add_f32_dpp v33, v33, v33 quad_perm:[2,3,0,1] row_mask:0xf bank_mask:0xf
  v_cvt_pk_bf16_f32 v34, v32, v33
  v_lshlrev_b32 v32, 16, v34
  v_and_b32 v33, s87, v34
  v_mul_f32 v32, s88, v32
  v_mul_f32 v33, s88, v33
  v_cvt_pk_bf16_f32 v34, v32, v33
  v_lshlrev_b32 v32, 16, v34
  v_and_b32 v33, s87, v34
  v_fma_f32 v32, v32, s89, -v3
  v_fma_f32 v33, v33, s89, -v3
  v_max_f32 v35, v32, v33
  v_cmp_lt_f32 vcc, 0x41000000, v35
  v_exp_f32 v37, v32
  v_exp_f32 v38, v33
  s_cmp_eq_u64 vcc, 0
  s_cbranch_scc1 K1_LZ5A
  v_max_f32_dpp v35, v35, v35 row_ror:8 row_mask:0xf bank_mask:0xf
  v_max_f32 v35, 0, v35
  v_exp_f32 v36, -v35
  v_add_f32 v3, v3, v35
  v_sub_f32 v32, v32, v35
  v_sub_f32 v33, v33, v35
  v_exp_f32 v37, v32
  v_exp_f32 v38, v33
  v_mul_f32 v4, v4, v36
  v_mul_f32_dpp v16, v36, v16 row_newbcast:0 row_mask:0xf bank_mask:0xf
  v_mul_f32_dpp v17, v36, v17 row_newbcast:0 row_mask:0xf bank_mask:0xf
  v_mul_f32_dpp v18, v36, v18 row_newbcast:0 row_mask:0xf bank_mask:0xf
  v_mul_f32_dpp v19, v36, v19 row_newbcast:0 row_mask:0xf bank_mask:0xf
  v_mul_f32_dpp v20, v36, v20 row_newbcast:0 row_mask:0xf bank_mask:0xf
  v_mul_f32_dpp v21, v36, v21 row_newbcast:0 row_mask:0xf bank_mask:0xf
  v_mul_f32_dpp v22, v36, v22 row_newbcast:0 row_mask:0xf bank_mask:0xf
  v_mul_f32_dpp v23, v36, v23 row_newbcast:0 row_mask:0xf bank_mask:0xf
  v_mul_f32_dpp v24, v36, v24 row_newbcast:4 row_mask:0xf bank_mask:0xf
  v_mul_f32_dpp v25, v36, v25 row_newbcast:4 row_mask:0xf bank_mask:0xf
  v_mul_f32_dpp v26, v36, v26 row_newbcast:4 row_mask:0xf bank_mask:0xf
  v_mul_f32_dpp v27, v36, v27 row_newbcast:4 row_mask:0xf bank_mask:0xf
  v_mul_f32_dpp v28, v36, v28 row_newbcast:4 row_mask:0xf bank_mask:0xf
  v_mul_f32_dpp v29, v36, v29 row_newbcast:4 row_mask:0xf bank_mask:0xf
  v_mul_f32_dpp v30, v36, v30 row_newbcast:4 row_mask:0xf bank_mask:0xf
  v_mul_f32_dpp v31, v36, v31 row_newbcast:4 row_mask:0xf bank_mask:0xf
K1_LZ5A:
  s_nop 1
  v_add_f32 v4, v4, v37
  v_cvt_pk_bf16_f32 v44, v37, v38
  v_add_f32 v4, v4, v38
  s_waitcnt vmcnt(16)
  v_perm_b32 v40, v244, v240, s85
  v_perm_b32 v41, v244, v240, s86
  v_perm_b32 v42, v245, v241, s85
  v_perm_b32 v43, v245, v241, s86
  v_dot2c_f32_bf16_dpp v16, v44, v40 row_newbcast:0 row_mask:0xf bank_mask:0xf
  v_dot2c_f32_bf16_dpp v17, v44, v41 row_newbcast:0 row_mask:0xf bank_mask:0xf
  v_dot2c_f32_bf16_dpp v18, v44, v42 row_newbcast:0 row_mask:0xf bank_mask:0xf
  v_dot2c_f32_bf16_dpp v19, v44, v43 row_newbcast:0 row_mask:0xf bank_mask:0xf
  v_dot2c_f32_bf16_dpp v24, v44, v40 row_newbcast:4 row_mask:0xf bank_mask:0xf
  v_dot2c_f32_bf16_dpp v25, v44, v41 row_newbcast:4 row_mask:0xf bank_mask:0xf
  v_dot2c_f32_bf16_dpp v26, v44, v42 row_newbcast:4 row_mask:0xf bank_mask:0xf
  v_dot2c_f32_bf16_dpp v27, v44, v43 row_newbcast:4 row_mask:0xf bank_mask:0xf
  v_perm_b32 v40, v246, v242, s85
  v_perm_b32 v41, v246, v242, s86
  v_perm_b32 v42, v247, v243, s85
  v_perm_b32 v43, v247, v243, s86
  v_dot2c_f32_bf16_dpp v20, v44, v40 row_newbcast:0 row_mask:0xf bank_mask:0xf
  v_dot2c_f32_bf16_dpp v21, v44, v41 row_newbcast:0 row_mask:0xf bank_mask:0xf
  v_dot2c_f32_bf16_dpp v22, v44, v42 row_newbcast:0 row_mask:0xf bank_mask:0xf
  v_dot2c_f32_bf16_dpp v23, v44, v43 row_newbcast:0 row_mask:0xf bank_mask:0xf
  v_dot2c_f32_bf16_dpp v28, v44, v40 row_newbcast:4 row_mask:0xf bank_mask:0xf
  v_dot2c_f32_bf16_dpp v29, v44, v41 row_newbcast:4 row_mask:0xf bank_mask:0xf
  v_dot2c_f32_bf16_dpp v30, v44, v42 row_newbcast:4 row_mask:0xf bank_mask:0xf
  v_dot2c_f32_bf16_dpp v31, v44, v43 row_newbcast:4 row_mask:0xf bank_mask:0xf
  v_perm_b32 v40, v252, v248, s85
  v_perm_b32 v41, v252, v248, s86
  v_perm_b32 v42, v253, v249, s85
  v_perm_b32 v43, v253, v249, s86
  v_dot2c_f32_bf16_dpp v16, v44, v40 row_newbcast:8 row_mask:0xf bank_mask:0xf
  v_dot2c_f32_bf16_dpp v17, v44, v41 row_newbcast:8 row_mask:0xf bank_mask:0xf
  v_dot2c_f32_bf16_dpp v18, v44, v42 row_newbcast:8 row_mask:0xf bank_mask:0xf
  v_dot2c_f32_bf16_dpp v19, v44, v43 row_newbcast:8 row_mask:0xf bank_mask:0xf
  v_dot2c_f32_bf16_dpp v24, v44, v40 row_newbcast:12 row_mask:0xf bank_mask:0xf
  v_dot2c_f32_bf16_dpp v25, v44, v41 row_newbcast:12 row_mask:0xf bank_mask:0xf
  v_dot2c_f32_bf16_dpp v26, v44, v42 row_newbcast:12 row_mask:0xf bank_mask:0xf
  v_dot2c_f32_bf16_dpp v27, v44, v43 row_newbcast:12 row_mask:0xf bank_mask:0xf
  v_perm_b32 v40, v254, v250, s85
  v_perm_b32 v41, v254, v250, s86
  v_perm_b32 v42, v255, v251, s85
  v_perm_b32 v43, v255, v251, s86
  v_dot2c_f32_bf16_dpp v20, v44, v40 row_newbcast:8 row_mask:0xf bank_mask:0xf
  v_dot2c_f32_bf16_dpp v21, v44, v41 row_newbcast:8 row_mask:0xf bank_mask:0xf
  v_dot2c_f32_bf16_dpp v22, v44, v42 row_newbcast:8 row_mask:0xf bank_mask:0xf
  v_dot2c_f32_bf16_dpp v23, v44, v43 row_newbcast:8 row_mask:0xf bank_mask:0xf
  v_dot2c_f32_bf16_dpp v28, v44, v40 row_newbcast:12 row_mask:0xf bank_mask:0xf
  v_dot2c_f32_bf16_dpp v29, v44, v41 row_newbcast:12 row_mask:0xf bank_mask:0xf
  v_dot2c_f32_bf16_dpp v30, v44, v42 row_newbcast:12 row_mask:0xf bank_mask:0xf
  v_dot2c_f32_bf16_dpp v31, v44, v43 row_newbcast:12 row_mask:0xf bank_mask:0xf
  s_mov_b32 s83, 229376
  buffer_load_dwordx4 v[240:243], v2, s[8:11], s83 offen offset:0 nt
  buffer_load_dwordx4 v[244:247], v2, s[8:11], s83 offen offset:1024 nt
  buffer_load_dwordx4 v[248:251], v2, s[8:11], s83 offen offset:2048 nt
  buffer_load_dwordx4 v[252:255], v2, s[8:11], s83 offen offset:3072 nt
  v_mul_f32 v171, s72, v144
  v_mul_f32 v172, s72, v145
  v_mul_f32 v173, s72, v146
  v_mul_f32 v174, s72, v147
  v_cvt_pk_bf16_f32 v179, v171, v172
  v_lshlrev_b32 v171, 16, v179
  v_and_b32 v172, s87, v179
  v_cvt_pk_bf16_f32 v180, v173, v174
  v_lshlrev_b32 v173, 16, v180
  v_and_b32 v174, s87, v180
  v_add_f32 v171, v171, v153
  v_add_f32 v172, v172, v154
  v_add_f32 v173, v173, v155
  v_add_f32 v174, v174, v156
  v_cvt_pk_bf16_f32 v179, v171, v172
  v_lshlrev_b32 v171, 16, v179
  v_and_b32 v172, s87, v179
  v_cvt_pk_bf16_f32 v180, v173, v174
  v_lshlrev_b32 v173, 16, v180
  v_and_b32 v174, s87, v180
  v_mul_f32 v175, v171, v171
  v_mul_f32 v176, v172, v172
  v_mul_f32 v177, v173, v173
  v_mul_f32 v178, v174, v174
  v_fmaak_f32 v175, v175, v143, 0x40135761
  v_fmaak_f32 v176, v176, v143, 0x40135761
  v_fmaak_f32 v177, v177, v143, 0x40135761
  v_fmaak_f32 v178, v178, v143, 0x40135761
  v_mul_f32 v175, v175, v171
  v_mul_f32 v176, v176, v172
  v_mul_f32 v177, v177, v173
  v_mul_f32 v178, v178, v174
  v_exp_f32 v175, -v175
  v_exp_f32 v176, -v176
  v_exp_f32 v177, -v177
  v_exp_f32 v178, -v178
  v_add_f32 v175, 1.0, v175
  v_add_f32 v176, 1.0, v176
  v_add_f32 v177, 1.0, v177
  v_add_f32 v178, 1.0, v178
  v_rcp_f32 v175, v175
  v_rcp_f32 v176, v176
  v_rcp_f32 v177, v177
  v_rcp_f32 v178, v178
  v_mul_f32 v171, v171, v175
  v_mul_f32 v172, v172, v176
  v_mul_f32 v173, v173, v177
  v_mul_f32 v174, v174, v178
  v_cvt_pk_bf16_f32 v179, v171, v172
  v_cvt_pk_bf16_f32 v180, v173, v174
  v_dot2_f32_bf16 v170, v179, v136, 0
  v_dot2_f32_bf16 v170, v180, v137, v170
  v_mul_f32 v171, s72, v148
  v_mul_f32 v172, s72, v149
  v_mul_f32 v173, s72, v150
  v_mul_f32 v174, s72, v151
  v_cvt_pk_bf16_f32 v179, v171, v172
  v_lshlrev_b32 v171, 16, v179
  v_and_b32 v172, s87, v179
  v_cvt_pk_bf16_f32 v180, v173, v174
  v_lshlrev_b32 v173, 16, v180
  v_and_b32 v174, s87, v180
  v_add_f32 v171, v171, v157
  v_add_f32 v172, v172, v158
  v_add_f32 v173, v173, v159
  v_add_f32 v174, v174, v160
  v_cvt_pk_bf16_f32 v179, v171, v172
  v_lshlrev_b32 v171, 16, v179
  v_and_b32 v172, s87, v179
  v_cvt_pk_bf16_f32 v180, v173, v174
  v_lshlrev_b32 v173, 16, v180
  v_and_b32 v174, s87, v180
  v_mul_f32 v175, v171, v171
  v_mul_f32 v176, v172, v172
  v_mul_f32 v177, v173, v173
  v_mul_f32 v178, v174, v174
  v_fmaak_f32 v175, v175, v143, 0x40135761
  v_fmaak_f32 v176, v176, v143, 0x40135761
  v_fmaak_f32 v177, v177, v143, 0x40135761
  v_fmaak_f32 v178, v178, v143, 0x40135761
  v_mul_f32 v175, v175, v171
  v_mul_f32 v176, v176, v172
  v_mul_f32 v177, v177, v173
  v_mul_f32 v178, v178, v174
  v_exp_f32 v175, -v175
  v_exp_f32 v176, -v176
  v_exp_f32 v177, -v177
  v_exp_f32 v178, -v178
  v_add_f32 v175, 1.0, v175
  v_add_f32 v176, 1.0, v176
  v_add_f32 v177, 1.0, v177
  v_add_f32 v178, 1.0, v178
  v_rcp_f32 v175, v175
  v_rcp_f32 v176, v176
  v_rcp_f32 v177, v177
  v_rcp_f32 v178, v178
  v_mul_f32 v171, v171, v175
  v_mul_f32 v172, v172, v176
  v_mul_f32 v173, v173, v177
  v_mul_f32 v174, v174, v178
  v_cvt_pk_bf16_f32 v179, v171, v172
  v_cvt_pk_bf16_f32 v180, v173, v174
  v_dot2_f32_bf16 v170, v179, v138, v170
  v_dot2_f32_bf16 v170, v180, v139, v170
  v_mul_f32 v171, s64, v152
  v_mul_f32 v172, s65, v152
  v_mul_f32 v173, s66, v152
  v_mul_f32 v174, s67, v152
  v_cvt_pk_bf16_f32 v179, v171, v172
  v_lshlrev_b32 v171, 16, v179
  v_and_b32 v172, s87, v179
  v_cvt_pk_bf16_f32 v180, v173, v174
  v_lshlrev_b32 v173, 16, v180
  v_and_b32 v174, s87, v180
  v_add_f32 v171, v171, v161
  v_add_f32 v172, v172, v161
  v_add_f32 v173, v173, v161
  v_add_f32 v174, v174, v161
  v_cvt_pk_bf16_f32 v179, v171, v172
  v_lshlrev_b32 v171, 16, v179
  v_and_b32 v172, s87, v179
  v_cvt_pk_bf16_f32 v180, v173, v174
  v_lshlrev_b32 v173, 16, v180
  v_and_b32 v174, s87, v180
  v_mul_f32 v175, v171, v171
  v_mul_f32 v176, v172, v172
  v_mul_f32 v177, v173, v173
  v_mul_f32 v178, v174, v174
  v_fmaak_f32 v175, v175, v143, 0x40135761
  v_fmaak_f32 v176, v176, v143, 0x40135761
  v_fmaak_f32 v177, v177, v143, 0x40135761
  v_fmaak_f32 v178, v178, v143, 0x40135761
  v_mul_f32 v175, v175, v171
  v_mul_f32 v176, v176, v172
  v_mul_f32 v177, v177, v173
  v_mul_f32 v178, v178, v174
  v_exp_f32 v175, -v175
  v_exp_f32 v176, -v176
  v_exp_f32 v177, -v177
  v_exp_f32 v178, -v178
  v_add_f32 v175, 1.0, v175
  v_add_f32 v176, 1.0, v176
  v_add_f32 v177, 1.0, v177
  v_add_f32 v178, 1.0, v178
  v_rcp_f32 v175, v175
  v_rcp_f32 v176, v176
  v_rcp_f32 v177, v177
  v_rcp_f32 v178, v178
  v_mul_f32 v171, v171, v175
  v_mul_f32 v172, v172, v176
  v_mul_f32 v173, v173, v177
  v_mul_f32 v174, v174, v178
  v_cvt_pk_bf16_f32 v179, v171, v172
  v_lshlrev_b32 v171, 16, v179
  v_and_b32 v172, s87, v179
  v_cvt_pk_bf16_f32 v180, v173, v174
  v_lshlrev_b32 v173, 16, v180
  v_and_b32 v174, s87, v180
  v_fmac_f32 v162, v171, v142
  v_fmac_f32 v163, v172, v142
  v_fmac_f32 v164, v173, v142
  v_fmac_f32 v165, v174, v142
  v_mul_f32 v171, s68, v152
  v_mul_f32 v172, s69, v152
  v_mul_f32 v173, s70, v152
  v_mul_f32 v174, s71, v152
  v_cvt_pk_bf16_f32 v179, v171, v172
  v_lshlrev_b32 v171, 16, v179
  v_and_b32 v172, s87, v179
  v_cvt_pk_bf16_f32 v180, v173, v174
  v_lshlrev_b32 v173, 16, v180
  v_and_b32 v174, s87, v180
  v_add_f32 v171, v171, v161
  v_add_f32 v172, v172, v161
  v_add_f32 v173, v173, v161
  v_add_f32 v174, v174, v161
  v_cvt_pk_bf16_f32 v179, v171, v172
  v_lshlrev_b32 v171, 16, v179
  v_and_b32 v172, s87, v179
  v_cvt_pk_bf16_f32 v180, v173, v174
  v_lshlrev_b32 v173, 16, v180
  v_and_b32 v174, s87, v180
  v_mul_f32 v175, v171, v171
  v_mul_f32 v176, v172, v172
  v_mul_f32 v177, v173, v173
  v_mul_f32 v178, v174, v174
  v_fmaak_f32 v175, v175, v143, 0x40135761
  v_fmaak_f32 v176, v176, v143, 0x40135761
  v_fmaak_f32 v177, v177, v143, 0x40135761
  v_fmaak_f32 v178, v178, v143, 0x40135761
  v_mul_f32 v175, v175, v171
  v_mul_f32 v176, v176, v172
  v_mul_f32 v177, v177, v173
  v_mul_f32 v178, v178, v174
  v_exp_f32 v175, -v175
  v_exp_f32 v176, -v176
  v_exp_f32 v177, -v177
  v_exp_f32 v178, -v178
  v_add_f32 v175, 1.0, v175
  v_add_f32 v176, 1.0, v176
  v_add_f32 v177, 1.0, v177
  v_add_f32 v178, 1.0, v178
  v_rcp_f32 v175, v175
  v_rcp_f32 v176, v176
  v_rcp_f32 v177, v177
  v_rcp_f32 v178, v178
  v_mul_f32 v171, v171, v175
  v_mul_f32 v172, v172, v176
  v_mul_f32 v173, v173, v177
  v_mul_f32 v174, v174, v178
  v_cvt_pk_bf16_f32 v179, v171, v172
  v_lshlrev_b32 v171, 16, v179
  v_and_b32 v172, s87, v179
  v_cvt_pk_bf16_f32 v180, v173, v174
  v_lshlrev_b32 v173, 16, v180
  v_and_b32 v174, s87, v180
  v_fmac_f32 v166, v171, v142
  v_fmac_f32 v167, v172, v142
  v_fmac_f32 v168, v173, v142
  v_fmac_f32 v169, v174, v142
  v_mul_f32 v171, s72, v152
  v_cvt_pk_bf16_f32 v171, v171, v171
  v_and_b32 v171, s87, v171
  v_add_f32 v171, v171, v161
  v_cvt_pk_bf16_f32 v171, v171, v171
  v_and_b32 v171, s87, v171
  v_mul_f32 v175, v171, v171
  v_fmaak_f32 v175, v175, v143, 0x40135761
  v_mul_f32 v175, v175, v171
  v_exp_f32 v175, -v175
  s_nop 0
  v_add_f32 v175, 1.0, v175
  v_rcp_f32 v175, v175
  s_nop 0
  v_mul_f32 v171, v171, v175
  v_cvt_pk_bf16_f32 v171, v171, v171
  v_and_b32 v171, s87, v171
  v_fmac_f32 v170, v171, v142
  v_add_f32_dpp v162, v162, v162 row_ror:8 row_mask:0xf bank_mask:0xf
  v_add_f32_dpp v163, v163, v163 row_ror:8 row_mask:0xf bank_mask:0xf
  v_add_f32_dpp v164, v164, v164 row_ror:8 row_mask:0xf bank_mask:0xf
  v_add_f32_dpp v165, v165, v165 row_ror:8 row_mask:0xf bank_mask:0xf
  v_add_f32_dpp v166, v166, v166 row_ror:8 row_mask:0xf bank_mask:0xf
  v_add_f32_dpp v167, v167, v167 row_ror:8 row_mask:0xf bank_mask:0xf
  v_add_f32_dpp v168, v168, v168 row_ror:8 row_mask:0xf bank_mask:0xf
  v_add_f32_dpp v169, v169, v169 row_ror:8 row_mask:0xf bank_mask:0xf
  v_add_f32_dpp v170, v170, v170 row_ror:8 row_mask:0xf bank_mask:0xf
  v_add_f32_dpp v162, v162, v162 row_ror:4 row_mask:0xf bank_mask:0xf
  v_add_f32_dpp v163, v163, v163 row_ror:4 row_mask:0xf bank_mask:0xf
  v_add_f32_dpp v164, v164, v164 row_ror:4 row_mask:0xf bank_mask:0xf
  v_add_f32_dpp v165, v165, v165 row_ror:4 row_mask:0xf bank_mask:0xf
  v_add_f32_dpp v166, v166, v166 row_ror:4 row_mask:0xf bank_mask:0xf
  v_add_f32_dpp v167, v167, v167 row_ror:4 row_mask:0xf bank_mask:0xf
  v_add_f32_dpp v168, v168, v168 row_ror:4 row_mask:0xf bank_mask:0xf
  v_add_f32_dpp v169, v169, v169 row_ror:4 row_mask:0xf bank_mask:0xf
  v_add_f32_dpp v170, v170, v170 row_ror:4 row_mask:0xf bank_mask:0xf
  v_add_f32_dpp v162, v162, v162 row_ror:2 row_mask:0xf bank_mask:0xf
  v_add_f32_dpp v163, v163, v163 row_ror:2 row_mask:0xf bank_mask:0xf
  v_add_f32_dpp v164, v164, v164 row_ror:2 row_mask:0xf bank_mask:0xf
  v_add_f32_dpp v165, v165, v165 row_ror:2 row_mask:0xf bank_mask:0xf
  v_add_f32_dpp v166, v166, v166 row_ror:2 row_mask:0xf bank_mask:0xf
  v_add_f32_dpp v167, v167, v167 row_ror:2 row_mask:0xf bank_mask:0xf
  v_add_f32_dpp v168, v168, v168 row_ror:2 row_mask:0xf bank_mask:0xf
  v_add_f32_dpp v169, v169, v169 row_ror:2 row_mask:0xf bank_mask:0xf
  v_add_f32_dpp v170, v170, v170 row_ror:2 row_mask:0xf bank_mask:0xf
  v_add_f32_dpp v162, v162, v162 row_ror:1 row_mask:0xf bank_mask:0xf
  v_add_f32_dpp v163, v163, v163 row_ror:1 row_mask:0xf bank_mask:0xf
  v_add_f32_dpp v164, v164, v164 row_ror:1 row_mask:0xf bank_mask:0xf
  v_add_f32_dpp v165, v165, v165 row_ror:1 row_mask:0xf bank_mask:0xf
  v_add_f32_dpp v166, v166, v166 row_ror:1 row_mask:0xf bank_mask:0xf
  v_add_f32_dpp v167, v167, v167 row_ror:1 row_mask:0xf bank_mask:0xf
  v_add_f32_dpp v168, v168, v168 row_ror:1 row_mask:0xf bank_mask:0xf
  v_add_f32_dpp v169, v169, v169 row_ror:1 row_mask:0xf bank_mask:0xf
  v_add_f32_dpp v170, v170, v170 row_ror:1 row_mask:0xf bank_mask:0xf
  v_mov_b32 v171, v162
  v_mov_b32 v172, v163
  v_mov_b32 v173, v164
  v_mov_b32 v174, v165
  v_mov_b32 v175, v166
  v_mov_b32 v176, v167
  v_mov_b32 v177, v168
  v_mov_b32 v178, v169
  v_mov_b32 v179, v170
  v_permlane16_swap_b32 v162, v171
  v_permlane16_swap_b32 v163, v172
  v_permlane16_swap_b32 v164, v173
  v_permlane16_swap_b32 v165, v174
  v_permlane16_swap_b32 v166, v175
  v_permlane16_swap_b32 v167, v176
  v_permlane16_swap_b32 v168, v177
  v_permlane16_swap_b32 v169, v178
  v_permlane16_swap_b32 v170, v179
  v_add_f32 v162, v162, v171
  v_add_f32 v163, v163, v172
  v_add_f32 v164, v164, v173
  v_add_f32 v165, v165, v174
  v_add_f32 v166, v166, v175
  v_add_f32 v167, v167, v176
  v_add_f32 v168, v168, v177
  v_add_f32 v169, v169, v178
  v_add_f32 v170, v170, v179
  v_mov_b32 v171, v162
  v_mov_b32 v172, v163
  v_mov_b32 v173, v164
  v_mov_b32 v174, v165
  v_mov_b32 v175, v166
  v_mov_b32 v176, v167
  v_mov_b32 v177, v168
  v_mov_b32 v178, v169
  v_mov_b32 v179, v170
  v_permlane32_swap_b32 v162, v171
  v_permlane32_swap_b32 v163, v172
  v_permlane32_swap_b32 v164, v173
  v_permlane32_swap_b32 v165, v174
  v_permlane32_swap_b32 v166, v175
  v_permlane32_swap_b32 v167, v176
  v_permlane32_swap_b32 v168, v177
  v_permlane32_swap_b32 v169, v178
  v_permlane32_swap_b32 v170, v179
  v_add_f32 v162, v162, v171
  v_add_f32 v163, v163, v172
  v_add_f32 v164, v164, v173
  v_add_f32 v165, v165, v174
  v_add_f32 v166, v166, v175
  v_add_f32 v167, v167, v176
  v_add_f32 v168, v168, v177
  v_add_f32 v169, v169, v178
  v_add_f32 v170, v170, v179
  s_lshl_b32 s83, s82, 6
  v_mov_b32 v171, s83
  ds_write_b32 v171, v162 offset:8704
  ds_write_b32 v171, v163 offset:8708
  ds_write_b32 v171, v164 offset:8712
  ds_write_b32 v171, v165 offset:8716
  ds_write_b32 v171, v166 offset:8720
  ds_write_b32 v171, v167 offset:8724
  ds_write_b32 v171, v168 offset:8728
  ds_write_b32 v171, v169 offset:8732
  ds_write_b32 v171, v170 offset:8736
  s_mov_b32 s84, 3456
  buffer_load_dwordx4 v[64:67], v46, s[16:19], s84 offen offset:1152
  s_mov_b32 s84, 3456
  buffer_load_dwordx4 v[68:71], v46, s[16:19], s84 offen offset:2304
  s_mov_b32 s84, 6912
  buffer_load_dwordx4 v[72:75], v46, s[16:19], s84 offen offset:0
  s_mov_b32 s84, 6912
  buffer_load_dwordx4 v[76:79], v46, s[16:19], s84 offen offset:1152
  s_waitcnt vmcnt(20)
  v_dot2_f32_bf16 v32, v192, v8, 0
  v_dot2_f32_bf16 v36, v192, v12, 0
  v_dot2_f32_bf16 v33, v196, v8, 0
  v_dot2_f32_bf16 v37, v196, v12, 0
  v_dot2_f32_bf16 v34, v200, v8, 0
  v_dot2_f32_bf16 v38, v200, v12, 0
  v_dot2_f32_bf16 v35, v204, v8, 0
  v_dot2_f32_bf16 v39, v204, v12, 0
  v_dot2_f32_bf16 v32, v193, v9, v32
  v_dot2_f32_bf16 v36, v193, v13, v36
  v_dot2_f32_bf16 v33, v197, v9, v33
  v_dot2_f32_bf16 v37, v197, v13, v37
  v_dot2_f32_bf16 v34, v201, v9, v34
  v_dot2_f32_bf16 v38, v201, v13, v38
  v_dot2_f32_bf16 v35, v205, v9, v35
  v_dot2_f32_bf16 v39, v205, v13, v39
  v_dot2_f32_bf16 v32, v194, v10, v32
  v_dot2_f32_bf16 v36, v194, v14, v36
  v_dot2_f32_bf16 v33, v198, v10, v33
  v_dot2_f32_bf16 v37, v198, v14, v37
  v_dot2_f32_bf16 v34, v202, v10, v34
  v_dot2_f32_bf16 v38, v202, v14, v38
  v_dot2_f32_bf16 v35, v206, v10, v35
  v_dot2_f32_bf16 v39, v206, v14, v39
  v_dot2_f32_bf16 v32, v195, v11, v32
  v_dot2_f32_bf16 v36, v195, v15, v36
  v_dot2_f32_bf16 v33, v199, v11, v33
  v_dot2_f32_bf16 v37, v199, v15, v37
  v_dot2_f32_bf16 v34, v203, v11, v34
  v_dot2_f32_bf16 v38, v203, v15, v38
  v_dot2_f32_bf16 v35, v207, v11, v35
  v_dot2_f32_bf16 v39, v207, v15, v39
  s_mov_b32 s83, 262144
  buffer_load_dwordx4 v[192:195], v2, s[4:7], s83 offen offset:0 nt
  buffer_load_dwordx4 v[196:199], v2, s[4:7], s83 offen offset:1024 nt
  buffer_load_dwordx4 v[200:203], v2, s[4:7], s83 offen offset:2048 nt
  buffer_load_dwordx4 v[204:207], v2, s[4:7], s83 offen offset:3072 nt
  v_add_f32_dpp v32, v32, v32 row_ror:8 row_mask:0xf bank_mask:0x3
  v_add_f32_dpp v33, v33, v33 row_ror:8 row_mask:0xf bank_mask:0x3
  v_add_f32_dpp v36, v36, v36 row_ror:8 row_mask:0xf bank_mask:0x3
  v_add_f32_dpp v37, v37, v37 row_ror:8 row_mask:0xf bank_mask:0x3
  v_add_f32_dpp v32, v34, v34 row_ror:8 row_mask:0xf bank_mask:0xc
  v_add_f32_dpp v33, v35, v35 row_ror:8 row_mask:0xf bank_mask:0xc
  v_add_f32_dpp v36, v38, v38 row_ror:8 row_mask:0xf bank_mask:0xc
  v_add_f32_dpp v37, v39, v39 row_ror:8 row_mask:0xf bank_mask:0xc
  v_add_f32_dpp v32, v32, v32 row_shl:4 row_mask:0xf bank_mask:0x5
  v_add_f32_dpp v33, v33, v33 row_shl:4 row_mask:0xf bank_mask:0x5
  s_nop 0
  v_add_f32_dpp v32, v36, v36 row_shr:4 row_mask:0xf bank_mask:0xa
  v_add_f32_dpp v33, v37, v37 row_shr:4 row_mask:0xf bank_mask:0xa
  s_nop 0
  v_add_f32_dpp v32, v32, v32 quad_perm:[1,0,3,2] row_mask:0xf bank_mask:0xf
  v_add_f32_dpp v33, v33, v33 quad_perm:[1,0,3,2] row_mask:0xf bank_mask:0xf
  s_nop 0
  v_add_f32_dpp v32, v32, v32 quad_perm:[2,3,0,1] row_mask:0xf bank_mask:0xf
  v_add_f32_dpp v33, v33, v33 quad_perm:[2,3,0,1] row_mask:0xf bank_mask:0xf
  v_cvt_pk_bf16_f32 v34, v32, v33
  v_lshlrev_b32 v32, 16, v34
  v_and_b32 v33, s87, v34
  v_mul_f32 v32, s88, v32
  v_mul_f32 v33, s88, v33
  v_cvt_pk_bf16_f32 v34, v32, v33
  v_lshlrev_b32 v32, 16, v34
  v_and_b32 v33, s87, v34
  v_fma_f32 v32, v32, s89, -v3
  v_fma_f32 v33, v33, s89, -v3
  v_max_f32 v35, v32, v33
  v_cmp_lt_f32 vcc, 0x41000000, v35
  v_exp_f32 v37, v32
  v_exp_f32 v38, v33
  s_cmp_eq_u64 vcc, 0
  s_cbranch_scc1 K1_LZ6A
  v_max_f32_dpp v35, v35, v35 row_ror:8 row_mask:0xf bank_mask:0xf
  v_max_f32 v35, 0, v35
  v_exp_f32 v36, -v35
  v_add_f32 v3, v3, v35
  v_sub_f32 v32, v32, v35
  v_sub_f32 v33, v33, v35
  v_exp_f32 v37, v32
  v_exp_f32 v38, v33
  v_mul_f32 v4, v4, v36
  v_mul_f32_dpp v16, v36, v16 row_newbcast:0 row_mask:0xf bank_mask:0xf
  v_mul_f32_dpp v17, v36, v17 row_newbcast:0 row_mask:0xf bank_mask:0xf
  v_mul_f32_dpp v18, v36, v18 row_newbcast:0 row_mask:0xf bank_mask:0xf
  v_mul_f32_dpp v19, v36, v19 row_newbcast:0 row_mask:0xf bank_mask:0xf
  v_mul_f32_dpp v20, v36, v20 row_newbcast:0 row_mask:0xf bank_mask:0xf
  v_mul_f32_dpp v21, v36, v21 row_newbcast:0 row_mask:0xf bank_mask:0xf
  v_mul_f32_dpp v22, v36, v22 row_newbcast:0 row_mask:0xf bank_mask:0xf
  v_mul_f32_dpp v23, v36, v23 row_newbcast:0 row_mask:0xf bank_mask:0xf
  v_mul_f32_dpp v24, v36, v24 row_newbcast:4 row_mask:0xf bank_mask:0xf
  v_mul_f32_dpp v25, v36, v25 row_newbcast:4 row_mask:0xf bank_mask:0xf
  v_mul_f32_dpp v26, v36, v26 row_newbcast:4 row_mask:0xf bank_mask:0xf
  v_mul_f32_dpp v27, v36, v27 row_newbcast:4 row_mask:0xf bank_mask:0xf
  v_mul_f32_dpp v28, v36, v28 row_newbcast:4 row_mask:0xf bank_mask:0xf
  v_mul_f32_dpp v29, v36, v29 row_newbcast:4 row_mask:0xf bank_mask:0xf
  v_mul_f32_dpp v30, v36, v30 row_newbcast:4 row_mask:0xf bank_mask:0xf
  v_mul_f32_dpp v31, v36, v31 row_newbcast:4 row_mask:0xf bank_mask:0xf
K1_LZ6A:
  s_nop 1
  v_add_f32 v4, v4, v37
  v_cvt_pk_bf16_f32 v44, v37, v38
  v_add_f32 v4, v4, v38
  s_waitcnt vmcnt(20)
  v_perm_b32 v40, v212, v208, s85
  v_perm_b32 v41, v212, v208, s86
  v_perm_b32 v42, v213, v209, s85
  v_perm_b32 v43, v213, v209, s86
  v_dot2c_f32_bf16_dpp v16, v44, v40 row_newbcast:0 row_mask:0xf bank_mask:0xf
  v_dot2c_f32_bf16_dpp v17, v44, v41 row_newbcast:0 row_mask:0xf bank_mask:0xf
  v_dot2c_f32_bf16_dpp v18, v44, v42 row_newbcast:0 row_mask:0xf bank_mask:0xf
  v_dot2c_f32_bf16_dpp v19, v44, v43 row_newbcast:0 row_mask:0xf bank_mask:0xf
  v_dot2c_f32_bf16_dpp v24, v44, v40 row_newbcast:4 row_mask:0xf bank_mask:0xf
  v_dot2c_f32_bf16_dpp v25, v44, v41 row_newbcast:4 row_mask:0xf bank_mask:0xf
  v_dot2c_f32_bf16_dpp v26, v44, v42 row_newbcast:4 row_mask:0xf bank_mask:0xf
  v_dot2c_f32_bf16_dpp v27, v44, v43 row_newbcast:4 row_mask:0xf bank_mask:0xf
  v_perm_b32 v40, v214, v210, s85
  v_perm_b32 v41, v214, v210, s86
  v_perm_b32 v42, v215, v211, s85
  v_perm_b32 v43, v215, v211, s86
  v_dot2c_f32_bf16_dpp v20, v44, v40 row_newbcast:0 row_mask:0xf bank_mask:0xf
  v_dot2c_f32_bf16_dpp v21, v44, v41 row_newbcast:0 row_mask:0xf bank_mask:0xf
  v_dot2c_f32_bf16_dpp v22, v44, v42 row_newbcast:0 row_mask:0xf bank_mask:0xf
  v_dot2c_f32_bf16_dpp v23, v44, v43 row_newbcast:0 row_mask:0xf bank_mask:0xf
  v_dot2c_f32_bf16_dpp v28, v44, v40 row_newbcast:4 row_mask:0xf bank_mask:0xf
  v_dot2c_f32_bf16_dpp v29, v44, v41 row_newbcast:4 row_mask:0xf bank_mask:0xf
  v_dot2c_f32_bf16_dpp v30, v44, v42 row_newbcast:4 row_mask:0xf bank_mask:0xf
  v_dot2c_f32_bf16_dpp v31, v44, v43 row_newbcast:4 row_mask:0xf bank_mask:0xf
  v_perm_b32 v40, v220, v216, s85
  v_perm_b32 v41, v220, v216, s86
  v_perm_b32 v42, v221, v217, s85
  v_perm_b32 v43, v221, v217, s86
  v_dot2c_f32_bf16_dpp v16, v44, v40 row_newbcast:8 row_mask:0xf bank_mask:0xf
  v_dot2c_f32_bf16_dpp v17, v44, v41 row_newbcast:8 row_mask:0xf bank_mask:0xf
  v_dot2c_f32_bf16_dpp v18, v44, v42 row_newbcast:8 row_mask:0xf bank_mask:0xf
  v_dot2c_f32_bf16_dpp v19, v44, v43 row_newbcast:8 row_mask:0xf bank_mask:0xf
  v_dot2c_f32_bf16_dpp v24, v44, v40 row_newbcast:12 row_mask:0xf bank_mask:0xf
  v_dot2c_f32_bf16_dpp v25, v44, v41 row_newbcast:12 row_mask:0xf bank_mask:0xf
  v_dot2c_f32_bf16_dpp v26, v44, v42 row_newbcast:12 row_mask:0xf bank_mask:0xf
  v_dot2c_f32_bf16_dpp v27, v44, v43 row_newbcast:12 row_mask:0xf bank_mask:0xf
  v_perm_b32 v40, v222, v218, s85
  v_perm_b32 v41, v222, v218, s86
  v_perm_b32 v42, v223, v219, s85
  v_perm_b32 v43, v223, v219, s86
  v_dot2c_f32_bf16_dpp v20, v44, v40 row_newbcast:8 row_mask:0xf bank_mask:0xf
  v_dot2c_f32_bf16_dpp v21, v44, v41 row_newbcast:8 row_mask:0xf bank_mask:0xf
  v_dot2c_f32_bf16_dpp v22, v44, v42 row_newbcast:8 row_mask:0xf bank_mask:0xf
  v_dot2c_f32_bf16_dpp v23, v44, v43 row_newbcast:8 row_mask:0xf bank_mask:0xf
  v_dot2c_f32_bf16_dpp v28, v44, v40 row_newbcast:12 row_mask:0xf bank_mask:0xf
  v_dot2c_f32_bf16_dpp v29, v44, v41 row_newbcast:12 row_mask:0xf bank_mask:0xf
  v_dot2c_f32_bf16_dpp v30, v44, v42 row_newbcast:12 row_mask:0xf bank_mask:0xf
  v_dot2c_f32_bf16_dpp v31, v44, v43 row_newbcast:12 row_mask:0xf bank_mask:0xf
  s_mov_b32 s83, 262144
  buffer_load_dwordx4 v[208:211], v2, s[8:11], s83 offen offset:0 nt
  buffer_load_dwordx4 v[212:215], v2, s[8:11], s83 offen offset:1024 nt
  buffer_load_dwordx4 v[216:219], v2, s[8:11], s83 offen offset:2048 nt
  buffer_load_dwordx4 v[220:223], v2, s[8:11], s83 offen offset:3072 nt
  s_waitcnt vmcnt(22)
  v_perm_b32 v45, v52, v48, s85
  v_perm_b32 v52, v52, v48, s86
  v_perm_b32 v48, v53, v49, s85
  v_perm_b32 v53, v53, v49, s86
  v_perm_b32 v49, v54, v50, s85
  v_perm_b32 v54, v54, v50, s86
  v_perm_b32 v50, v55, v51, s85
  v_perm_b32 v55, v55, v51, s86
  s_waitcnt vmcnt(20)
  v_perm_b32 v51, v60, v56, s85
  v_perm_b32 v60, v60, v56, s86
  v_perm_b32 v56, v61, v57, s85
  v_perm_b32 v61, v61, v57, s86
  v_perm_b32 v57, v62, v58, s85
  v_perm_b32 v62, v62, v58, s86
  v_perm_b32 v58, v63, v59, s85
  v_perm_b32 v63, v63, v59, s86
  s_mov_b32 s84, 6912
  buffer_load_dwordx4 v[80:83], v46, s[16:19], s84 offen offset:2304
  s_mov_b32 s84, 10368
  buffer_load_dwordx4 v[84:87], v46, s[16:19], s84 offen offset:0
  s_mov_b32 s84, 10368
  buffer_load_dwordx4 v[88:91], v46, s[16:19], s84 offen offset:1152
  s_mov_b32 s84, 10368
  buffer_load_dwordx4 v[92:95], v46, s[16:19], s84 offen offset:2304
  s_waitcnt vmcnt(20)
  v_dot2_f32_bf16 v32, v224, v8, 0
  v_dot2_f32_bf16 v36, v224, v12, 0
  v_dot2_f32_bf16 v33, v228, v8, 0
  v_dot2_f32_bf16 v37, v228, v12, 0
  v_dot2_f32_bf16 v34, v232, v8, 0
  v_dot2_f32_bf16 v38, v232, v12, 0
  v_dot2_f32_bf16 v35, v236, v8, 0
  v_dot2_f32_bf16 v39, v236, v12, 0
  v_dot2_f32_bf16 v32, v225, v9, v32
  v_dot2_f32_bf16 v36, v225, v13, v36
  v_dot2_f32_bf16 v33, v229, v9, v33
  v_dot2_f32_bf16 v37, v229, v13, v37
  v_dot2_f32_bf16 v34, v233, v9, v34
  v_dot2_f32_bf16 v38, v233, v13, v38
  v_dot2_f32_bf16 v35, v237, v9, v35
  v_dot2_f32_bf16 v39, v237, v13, v39
  v_dot2_f32_bf16 v32, v226, v10, v32
  v_dot2_f32_bf16 v36, v226, v14, v36
  v_dot2_f32_bf16 v33, v230, v10, v33
  v_dot2_f32_bf16 v37, v230, v14, v37
  v_dot2_f32_bf16 v34, v234, v10, v34
  v_dot2_f32_bf16 v38, v234, v14, v38
  v_dot2_f32_bf16 v35, v238, v10, v35
  v_dot2_f32_bf16 v39, v238, v14, v39
  v_dot2_f32_bf16 v32, v227, v11, v32
  v_dot2_f32_bf16 v36, v227, v15, v36
  v_dot2_f32_bf16 v33, v231, v11, v33
  v_dot2_f32_bf16 v37, v231, v15, v37
  v_dot2_f32_bf16 v34, v235, v11, v34
  v_dot2_f32_bf16 v38, v235, v15, v38
  v_dot2_f32_bf16 v35, v239, v11, v35
  v_dot2_f32_bf16 v39, v239, v15, v39
  s_mov_b32 s83, 294912
  buffer_load_dwordx4 v[224:227], v2, s[4:7], s83 offen offset:0 nt
  buffer_load_dwordx4 v[228:231], v2, s[4:7], s83 offen offset:1024 nt
  buffer_load_dwordx4 v[232:235], v2, s[4:7], s83 offen offset:2048 nt
  buffer_load_dwordx4 v[236:239], v2, s[4:7], s83 offen offset:3072 nt
  v_add_f32_dpp v32, v32, v32 row_ror:8 row_mask:0xf bank_mask:0x3
  v_add_f32_dpp v33, v33, v33 row_ror:8 row_mask:0xf bank_mask:0x3
  v_add_f32_dpp v36, v36, v36 row_ror:8 row_mask:0xf bank_mask:0x3
  v_add_f32_dpp v37, v37, v37 row_ror:8 row_mask:0xf bank_mask:0x3
  v_add_f32_dpp v32, v34, v34 row_ror:8 row_mask:0xf bank_mask:0xc
  v_add_f32_dpp v33, v35, v35 row_ror:8 row_mask:0xf bank_mask:0xc
  v_add_f32_dpp v36, v38, v38 row_ror:8 row_mask:0xf bank_mask:0xc
  v_add_f32_dpp v37, v39, v39 row_ror:8 row_mask:0xf bank_mask:0xc
  v_add_f32_dpp v32, v32, v32 row_shl:4 row_mask:0xf bank_mask:0x5
  v_add_f32_dpp v33, v33, v33 row_shl:4 row_mask:0xf bank_mask:0x5
  s_nop 0
  v_add_f32_dpp v32, v36, v36 row_shr:4 row_mask:0xf bank_mask:0xa
  v_add_f32_dpp v33, v37, v37 row_shr:4 row_mask:0xf bank_mask:0xa
  s_nop 0
  v_add_f32_dpp v32, v32, v32 quad_perm:[1,0,3,2] row_mask:0xf bank_mask:0xf
  v_add_f32_dpp v33, v33, v33 quad_perm:[1,0,3,2] row_mask:0xf bank_mask:0xf
  s_nop 0
  v_add_f32_dpp v32, v32, v32 quad_perm:[2,3,0,1] row_mask:0xf bank_mask:0xf
  v_add_f32_dpp v33, v33, v33 quad_perm:[2,3,0,1] row_mask:0xf bank_mask:0xf
  v_cvt_pk_bf16_f32 v34, v32, v33
  v_lshlrev_b32 v32, 16, v34
  v_and_b32 v33, s87, v34
  v_mul_f32 v32, s88, v32
  v_mul_f32 v33, s88, v33
  v_cvt_pk_bf16_f32 v34, v32, v33
  v_lshlrev_b32 v32, 16, v34
  v_and_b32 v33, s87, v34
  v_fma_f32 v32, v32, s89, -v3
  v_fma_f32 v33, v33, s89, -v3
  v_max_f32 v35, v32, v33
  v_cmp_lt_f32 vcc, 0x41000000, v35
  v_exp_f32 v37, v32
  v_exp_f32 v38, v33
  s_cmp_eq_u64 vcc, 0
  s_cbranch_scc1 K1_LZ7A
  v_max_f32_dpp v35, v35, v35 row_ror:8 row_mask:0xf bank_mask:0xf
  v_max_f32 v35, 0, v35
  v_exp_f32 v36, -v35
  v_add_f32 v3, v3, v35
  v_sub_f32 v32, v32, v35
  v_sub_f32 v33, v33, v35
  v_exp_f32 v37, v32
  v_exp_f32 v38, v33
  v_mul_f32 v4, v4, v36
  v_mul_f32_dpp v16, v36, v16 row_newbcast:0 row_mask:0xf bank_mask:0xf
  v_mul_f32_dpp v17, v36, v17 row_newbcast:0 row_mask:0xf bank_mask:0xf
  v_mul_f32_dpp v18, v36, v18 row_newbcast:0 row_mask:0xf bank_mask:0xf
  v_mul_f32_dpp v19, v36, v19 row_newbcast:0 row_mask:0xf bank_mask:0xf
  v_mul_f32_dpp v20, v36, v20 row_newbcast:0 row_mask:0xf bank_mask:0xf
  v_mul_f32_dpp v21, v36, v21 row_newbcast:0 row_mask:0xf bank_mask:0xf
  v_mul_f32_dpp v22, v36, v22 row_newbcast:0 row_mask:0xf bank_mask:0xf
  v_mul_f32_dpp v23, v36, v23 row_newbcast:0 row_mask:0xf bank_mask:0xf
  v_mul_f32_dpp v24, v36, v24 row_newbcast:4 row_mask:0xf bank_mask:0xf
  v_mul_f32_dpp v25, v36, v25 row_newbcast:4 row_mask:0xf bank_mask:0xf
  v_mul_f32_dpp v26, v36, v26 row_newbcast:4 row_mask:0xf bank_mask:0xf
  v_mul_f32_dpp v27, v36, v27 row_newbcast:4 row_mask:0xf bank_mask:0xf
  v_mul_f32_dpp v28, v36, v28 row_newbcast:4 row_mask:0xf bank_mask:0xf
  v_mul_f32_dpp v29, v36, v29 row_newbcast:4 row_mask:0xf bank_mask:0xf
  v_mul_f32_dpp v30, v36, v30 row_newbcast:4 row_mask:0xf bank_mask:0xf
  v_mul_f32_dpp v31, v36, v31 row_newbcast:4 row_mask:0xf bank_mask:0xf
K1_LZ7A:
  s_nop 1
  v_add_f32 v4, v4, v37
  v_cvt_pk_bf16_f32 v44, v37, v38
  v_add_f32 v4, v4, v38
  s_waitcnt vmcnt(20)
  v_perm_b32 v40, v244, v240, s85
  v_perm_b32 v41, v244, v240, s86
  v_perm_b32 v42, v245, v241, s85
  v_perm_b32 v43, v245, v241, s86
  v_dot2c_f32_bf16_dpp v16, v44, v40 row_newbcast:0 row_mask:0xf bank_mask:0xf
  v_dot2c_f32_bf16_dpp v17, v44, v41 row_newbcast:0 row_mask:0xf bank_mask:0xf
  v_dot2c_f32_bf16_dpp v18, v44, v42 row_newbcast:0 row_mask:0xf bank_mask:0xf
  v_dot2c_f32_bf16_dpp v19, v44, v43 row_newbcast:0 row_mask:0xf bank_mask:0xf
  v_dot2c_f32_bf16_dpp v24, v44, v40 row_newbcast:4 row_mask:0xf bank_mask:0xf
  v_dot2c_f32_bf16_dpp v25, v44, v41 row_newbcast:4 row_mask:0xf bank_mask:0xf
  v_dot2c_f32_bf16_dpp v26, v44, v42 row_newbcast:4 row_mask:0xf bank_mask:0xf
  v_dot2c_f32_bf16_dpp v27, v44, v43 row_newbcast:4 row_mask:0xf bank_mask:0xf
  v_perm_b32 v40, v246, v242, s85
  v_perm_b32 v41, v246, v242, s86
  v_perm_b32 v42, v247, v243, s85
  v_perm_b32 v43, v247, v243, s86
  v_dot2c_f32_bf16_dpp v20, v44, v40 row_newbcast:0 row_mask:0xf bank_mask:0xf
  v_dot2c_f32_bf16_dpp v21, v44, v41 row_newbcast:0 row_mask:0xf bank_mask:0xf
  v_dot2c_f32_bf16_dpp v22, v44, v42 row_newbcast:0 row_mask:0xf bank_mask:0xf
  v_dot2c_f32_bf16_dpp v23, v44, v43 row_newbcast:0 row_mask:0xf bank_mask:0xf
  v_dot2c_f32_bf16_dpp v28, v44, v40 row_newbcast:4 row_mask:0xf bank_mask:0xf
  v_dot2c_f32_bf16_dpp v29, v44, v41 row_newbcast:4 row_mask:0xf bank_mask:0xf
  v_dot2c_f32_bf16_dpp v30, v44, v42 row_newbcast:4 row_mask:0xf bank_mask:0xf
  v_dot2c_f32_bf16_dpp v31, v44, v43 row_newbcast:4 row_mask:0xf bank_mask:0xf
  v_perm_b32 v40, v252, v248, s85
  v_perm_b32 v41, v252, v248, s86
  v_perm_b32 v42, v253, v249, s85
  v_perm_b32 v43, v253, v249, s86
  v_dot2c_f32_bf16_dpp v16, v44, v40 row_newbcast:8 row_mask:0xf bank_mask:0xf
  v_dot2c_f32_bf16_dpp v17, v44, v41 row_newbcast:8 row_mask:0xf bank_mask:0xf
  v_dot2c_f32_bf16_dpp v18, v44, v42 row_newbcast:8 row_mask:0xf bank_mask:0xf
  v_dot2c_f32_bf16_dpp v19, v44, v43 row_newbcast:8 row_mask:0xf bank_mask:0xf
  v_dot2c_f32_bf16_dpp v24, v44, v40 row_newbcast:12 row_mask:0xf bank_mask:0xf
  v_dot2c_f32_bf16_dpp v25, v44, v41 row_newbcast:12 row_mask:0xf bank_mask:0xf
  v_dot2c_f32_bf16_dpp v26, v44, v42 row_newbcast:12 row_mask:0xf bank_mask:0xf
  v_dot2c_f32_bf16_dpp v27, v44, v43 row_newbcast:12 row_mask:0xf bank_mask:0xf
  v_perm_b32 v40, v254, v250, s85
  v_perm_b32 v41, v254, v250, s86
  v_perm_b32 v42, v255, v251, s85
  v_perm_b32 v43, v255, v251, s86
  v_dot2c_f32_bf16_dpp v20, v44, v40 row_newbcast:8 row_mask:0xf bank_mask:0xf
  v_dot2c_f32_bf16_dpp v21, v44, v41 row_newbcast:8 row_mask:0xf bank_mask:0xf
  v_dot2c_f32_bf16_dpp v22, v44, v42 row_newbcast:8 row_mask:0xf bank_mask:0xf
  v_dot2c_f32_bf16_dpp v23, v44, v43 row_newbcast:8 row_mask:0xf bank_mask:0xf
  v_dot2c_f32_bf16_dpp v28, v44, v40 row_newbcast:12 row_mask:0xf bank_mask:0xf
  v_dot2c_f32_bf16_dpp v29, v44, v41 row_newbcast:12 row_mask:0xf bank_mask:0xf
  v_dot2c_f32_bf16_dpp v30, v44, v42 row_newbcast:12 row_mask:0xf bank_mask:0xf
  v_dot2c_f32_bf16_dpp v31, v44, v43 row_newbcast:12 row_mask:0xf bank_mask:0xf
  s_mov_b32 s83, 294912
  buffer_load_dwordx4 v[240:243], v2, s[8:11], s83 offen offset:0 nt
  buffer_load_dwordx4 v[244:247], v2, s[8:11], s83 offen offset:1024 nt
  buffer_load_dwordx4 v[248:251], v2, s[8:11], s83 offen offset:2048 nt
  buffer_load_dwordx4 v[252:255], v2, s[8:11], s83 offen offset:3072 nt
  s_waitcnt vmcnt(22)
  v_perm_b32 v59, v68, v64, s85
  v_perm_b32 v68, v68, v64, s86
  v_perm_b32 v64, v69, v65, s85
  v_perm_b32 v69, v69, v65, s86
  v_perm_b32 v65, v70, v66, s85
  v_perm_b32 v70, v70, v66, s86
  v_perm_b32 v66, v71, v67, s85
  v_perm_b32 v71, v71, v67, s86
  s_waitcnt vmcnt(20)
  v_perm_b32 v67, v76, v72, s85
  v_perm_b32 v76, v76, v72, s86
  v_perm_b32 v72, v77, v73, s85
  v_perm_b32 v77, v77, v73, s86
  v_perm_b32 v73, v78, v74, s85
  v_perm_b32 v78, v78, v74, s86
  v_perm_b32 v74, v79, v75, s85
  v_perm_b32 v79, v79, v75, s86
  s_mov_b32 s84, 13824
  buffer_load_dwordx4 v[96:99], v46, s[16:19], s84 offen offset:0
  s_mov_b32 s84, 13824
  buffer_load_dwordx4 v[100:103], v46, s[16:19], s84 offen offset:1152
  s_mov_b32 s84, 13824
  buffer_load_dwordx4 v[104:107], v46, s[16:19], s84 offen offset:2304
  s_mov_b32 s84, 17280
  buffer_load_dwordx4 v[108:111], v46, s[16:19], s84 offen offset:0
  s_waitcnt vmcnt(20)
  v_dot2_f32_bf16 v32, v192, v8, 0
  v_dot2_f32_bf16 v36, v192, v12, 0
  v_dot2_f32_bf16 v33, v196, v8, 0
  v_dot2_f32_bf16 v37, v196, v12, 0
  v_dot2_f32_bf16 v34, v200, v8, 0
  v_dot2_f32_bf16 v38, v200, v12, 0
  v_dot2_f32_bf16 v35, v204, v8, 0
  v_dot2_f32_bf16 v39, v204, v12, 0
  v_dot2_f32_bf16 v32, v193, v9, v32
  v_dot2_f32_bf16 v36, v193, v13, v36
  v_dot2_f32_bf16 v33, v197, v9, v33
  v_dot2_f32_bf16 v37, v197, v13, v37
  v_dot2_f32_bf16 v34, v201, v9, v34
  v_dot2_f32_bf16 v38, v201, v13, v38
  v_dot2_f32_bf16 v35, v205, v9, v35
  v_dot2_f32_bf16 v39, v205, v13, v39
  v_dot2_f32_bf16 v32, v194, v10, v32
  v_dot2_f32_bf16 v36, v194, v14, v36
  v_dot2_f32_bf16 v33, v198, v10, v33
  v_dot2_f32_bf16 v37, v198, v14, v37
  v_dot2_f32_bf16 v34, v202, v10, v34
  v_dot2_f32_bf16 v38, v202, v14, v38
  v_dot2_f32_bf16 v35, v206, v10, v35
  v_dot2_f32_bf16 v39, v206, v14, v39
  v_dot2_f32_bf16 v32, v195, v11, v32
  v_dot2_f32_bf16 v36, v195, v15, v36
  v_dot2_f32_bf16 v33, v199, v11, v33
  v_dot2_f32_bf16 v37, v199, v15, v37
  v_dot2_f32_bf16 v34, v203, v11, v34
  v_dot2_f32_bf16 v38, v203, v15, v38
  v_dot2_f32_bf16 v35, v207, v11, v35
  v_dot2_f32_bf16 v39, v207, v15, v39
  s_mov_b32 s83, 327680
  buffer_load_dwordx4 v[192:195], v2, s[4:7], s83 offen offset:0 nt
  buffer_load_dwordx4 v[196:199], v2, s[4:7], s83 offen offset:1024 nt
  buffer_load_dwordx4 v[200:203], v2, s[4:7], s83 offen offset:2048 nt
  buffer_load_dwordx4 v[204:207], v2, s[4:7], s83 offen offset:3072 nt
  v_add_f32_dpp v32, v32, v32 row_ror:8 row_mask:0xf bank_mask:0x3
  v_add_f32_dpp v33, v33, v33 row_ror:8 row_mask:0xf bank_mask:0x3
  v_add_f32_dpp v36, v36, v36 row_ror:8 row_mask:0xf bank_mask:0x3
  v_add_f32_dpp v37, v37, v37 row_ror:8 row_mask:0xf bank_mask:0x3
  v_add_f32_dpp v32, v34, v34 row_ror:8 row_mask:0xf bank_mask:0xc
  v_add_f32_dpp v33, v35, v35 row_ror:8 row_mask:0xf bank_mask:0xc
  v_add_f32_dpp v36, v38, v38 row_ror:8 row_mask:0xf bank_mask:0xc
  v_add_f32_dpp v37, v39, v39 row_ror:8 row_mask:0xf bank_mask:0xc
  v_add_f32_dpp v32, v32, v32 row_shl:4 row_mask:0xf bank_mask:0x5
  v_add_f32_dpp v33, v33, v33 row_shl:4 row_mask:0xf bank_mask:0x5
  s_nop 0
  v_add_f32_dpp v32, v36, v36 row_shr:4 row_mask:0xf bank_mask:0xa
  v_add_f32_dpp v33, v37, v37 row_shr:4 row_mask:0xf bank_mask:0xa
  s_nop 0
  v_add_f32_dpp v32, v32, v32 quad_perm:[1,0,3,2] row_mask:0xf bank_mask:0xf
  v_add_f32_dpp v33, v33, v33 quad_perm:[1,0,3,2] row_mask:0xf bank_mask:0xf
  s_nop 0
  v_add_f32_dpp v32, v32, v32 quad_perm:[2,3,0,1] row_mask:0xf bank_mask:0xf
  v_add_f32_dpp v33, v33, v33 quad_perm:[2,3,0,1] row_mask:0xf bank_mask:0xf
  v_cvt_pk_bf16_f32 v34, v32, v33
  v_lshlrev_b32 v32, 16, v34
  v_and_b32 v33, s87, v34
  v_mul_f32 v32, s88, v32
  v_mul_f32 v33, s88, v33
  v_cvt_pk_bf16_f32 v34, v32, v33
  v_lshlrev_b32 v32, 16, v34
  v_and_b32 v33, s87, v34
  v_fma_f32 v32, v32, s89, -v3
  v_fma_f32 v33, v33, s89, -v3
  v_max_f32 v35, v32, v33
  v_cmp_lt_f32 vcc, 0x41000000, v35
  v_exp_f32 v37, v32
  v_exp_f32 v38, v33
  s_cmp_eq_u64 vcc, 0
  s_cbranch_scc1 K1_LZ8A
  v_max_f32_dpp v35, v35, v35 row_ror:8 row_mask:0xf bank_mask:0xf
  v_max_f32 v35, 0, v35
  v_exp_f32 v36, -v35
  v_add_f32 v3, v3, v35
  v_sub_f32 v32, v32, v35
  v_sub_f32 v33, v33, v35
  v_exp_f32 v37, v32
  v_exp_f32 v38, v33
  v_mul_f32 v4, v4, v36
  v_mul_f32_dpp v16, v36, v16 row_newbcast:0 row_mask:0xf bank_mask:0xf
  v_mul_f32_dpp v17, v36, v17 row_newbcast:0 row_mask:0xf bank_mask:0xf
  v_mul_f32_dpp v18, v36, v18 row_newbcast:0 row_mask:0xf bank_mask:0xf
  v_mul_f32_dpp v19, v36, v19 row_newbcast:0 row_mask:0xf bank_mask:0xf
  v_mul_f32_dpp v20, v36, v20 row_newbcast:0 row_mask:0xf bank_mask:0xf
  v_mul_f32_dpp v21, v36, v21 row_newbcast:0 row_mask:0xf bank_mask:0xf
  v_mul_f32_dpp v22, v36, v22 row_newbcast:0 row_mask:0xf bank_mask:0xf
  v_mul_f32_dpp v23, v36, v23 row_newbcast:0 row_mask:0xf bank_mask:0xf
  v_mul_f32_dpp v24, v36, v24 row_newbcast:4 row_mask:0xf bank_mask:0xf
  v_mul_f32_dpp v25, v36, v25 row_newbcast:4 row_mask:0xf bank_mask:0xf
  v_mul_f32_dpp v26, v36, v26 row_newbcast:4 row_mask:0xf bank_mask:0xf
  v_mul_f32_dpp v27, v36, v27 row_newbcast:4 row_mask:0xf bank_mask:0xf
  v_mul_f32_dpp v28, v36, v28 row_newbcast:4 row_mask:0xf bank_mask:0xf
  v_mul_f32_dpp v29, v36, v29 row_newbcast:4 row_mask:0xf bank_mask:0xf
  v_mul_f32_dpp v30, v36, v30 row_newbcast:4 row_mask:0xf bank_mask:0xf
  v_mul_f32_dpp v31, v36, v31 row_newbcast:4 row_mask:0xf bank_mask:0xf
K1_LZ8A:
  s_nop 1
  v_add_f32 v4, v4, v37
  v_cvt_pk_bf16_f32 v44, v37, v38
  v_add_f32 v4, v4, v38
  s_waitcnt vmcnt(20)
  v_perm_b32 v40, v212, v208, s85
  v_perm_b32 v41, v212, v208, s86
  v_perm_b32 v42, v213, v209, s85
  v_perm_b32 v43, v213, v209, s86
  v_dot2c_f32_bf16_dpp v16, v44, v40 row_newbcast:0 row_mask:0xf bank_mask:0xf
  v_dot2c_f32_bf16_dpp v17, v44, v41 row_newbcast:0 row_mask:0xf bank_mask:0xf
  v_dot2c_f32_bf16_dpp v18, v44, v42 row_newbcast:0 row_mask:0xf bank_mask:0xf
  v_dot2c_f32_bf16_dpp v19, v44, v43 row_newbcast:0 row_mask:0xf bank_mask:0xf
  v_dot2c_f32_bf16_dpp v24, v44, v40 row_newbcast:4 row_mask:0xf bank_mask:0xf
  v_dot2c_f32_bf16_dpp v25, v44, v41 row_newbcast:4 row_mask:0xf bank_mask:0xf
  v_dot2c_f32_bf16_dpp v26, v44, v42 row_newbcast:4 row_mask:0xf bank_mask:0xf
  v_dot2c_f32_bf16_dpp v27, v44, v43 row_newbcast:4 row_mask:0xf bank_mask:0xf
  v_perm_b32 v40, v214, v210, s85
  v_perm_b32 v41, v214, v210, s86
  v_perm_b32 v42, v215, v211, s85
  v_perm_b32 v43, v215, v211, s86
  v_dot2c_f32_bf16_dpp v20, v44, v40 row_newbcast:0 row_mask:0xf bank_mask:0xf
  v_dot2c_f32_bf16_dpp v21, v44, v41 row_newbcast:0 row_mask:0xf bank_mask:0xf
  v_dot2c_f32_bf16_dpp v22, v44, v42 row_newbcast:0 row_mask:0xf bank_mask:0xf
  v_dot2c_f32_bf16_dpp v23, v44, v43 row_newbcast:0 row_mask:0xf bank_mask:0xf
  v_dot2c_f32_bf16_dpp v28, v44, v40 row_newbcast:4 row_mask:0xf bank_mask:0xf
  v_dot2c_f32_bf16_dpp v29, v44, v41 row_newbcast:4 row_mask:0xf bank_mask:0xf
  v_dot2c_f32_bf16_dpp v30, v44, v42 row_newbcast:4 row_mask:0xf bank_mask:0xf
  v_dot2c_f32_bf16_dpp v31, v44, v43 row_newbcast:4 row_mask:0xf bank_mask:0xf
  v_perm_b32 v40, v220, v216, s85
  v_perm_b32 v41, v220, v216, s86
  v_perm_b32 v42, v221, v217, s85
  v_perm_b32 v43, v221, v217, s86
  v_dot2c_f32_bf16_dpp v16, v44, v40 row_newbcast:8 row_mask:0xf bank_mask:0xf
  v_dot2c_f32_bf16_dpp v17, v44, v41 row_newbcast:8 row_mask:0xf bank_mask:0xf
  v_dot2c_f32_bf16_dpp v18, v44, v42 row_newbcast:8 row_mask:0xf bank_mask:0xf
  v_dot2c_f32_bf16_dpp v19, v44, v43 row_newbcast:8 row_mask:0xf bank_mask:0xf
  v_dot2c_f32_bf16_dpp v24, v44, v40 row_newbcast:12 row_mask:0xf bank_mask:0xf
  v_dot2c_f32_bf16_dpp v25, v44, v41 row_newbcast:12 row_mask:0xf bank_mask:0xf
  v_dot2c_f32_bf16_dpp v26, v44, v42 row_newbcast:12 row_mask:0xf bank_mask:0xf
  v_dot2c_f32_bf16_dpp v27, v44, v43 row_newbcast:12 row_mask:0xf bank_mask:0xf
  v_perm_b32 v40, v222, v218, s85
  v_perm_b32 v41, v222, v218, s86
  v_perm_b32 v42, v223, v219, s85
  v_perm_b32 v43, v223, v219, s86
  v_dot2c_f32_bf16_dpp v20, v44, v40 row_newbcast:8 row_mask:0xf bank_mask:0xf
  v_dot2c_f32_bf16_dpp v21, v44, v41 row_newbcast:8 row_mask:0xf bank_mask:0xf
  v_dot2c_f32_bf16_dpp v22, v44, v42 row_newbcast:8 row_mask:0xf bank_mask:0xf
  v_dot2c_f32_bf16_dpp v23, v44, v43 row_newbcast:8 row_mask:0xf bank_mask:0xf
  v_dot2c_f32_bf16_dpp v28, v44, v40 row_newbcast:12 row_mask:0xf bank_mask:0xf
  v_dot2c_f32_bf16_dpp v29, v44, v41 row_newbcast:12 row_mask:0xf bank_mask:0xf
  v_dot2c_f32_bf16_dpp v30, v44, v42 row_newbcast:12 row_mask:0xf bank_mask:0xf
  v_dot2c_f32_bf16_dpp v31, v44, v43 row_newbcast:12 row_mask:0xf bank_mask:0xf
  s_mov_b32 s83, 327680
  buffer_load_dwordx4 v[208:211], v2, s[8:11], s83 offen offset:0 nt
  buffer_load_dwordx4 v[212:215], v2, s[8:11], s83 offen offset:1024 nt
  buffer_load_dwordx4 v[216:219], v2, s[8:11], s83 offen offset:2048 nt
  buffer_load_dwordx4 v[220:223], v2, s[8:11], s83 offen offset:3072 nt
  s_waitcnt vmcnt(22)
  v_perm_b32 v75, v84, v80, s85
  v_perm_b32 v84, v84, v80, s86
  v_perm_b32 v80, v85, v81, s85
  v_perm_b32 v85, v85, v81, s86
  v_perm_b32 v81, v86, v82, s85
  v_perm_b32 v86, v86, v82, s86
  v_perm_b32 v82, v87, v83, s85
  v_perm_b32 v87, v87, v83, s86
  s_waitcnt vmcnt(20)
  v_perm_b32 v83, v92, v88, s85
  v_perm_b32 v92, v92, v88, s86
  v_perm_b32 v88, v93, v89, s85
  v_perm_b32 v93, v93, v89, s86
  v_perm_b32 v89, v94, v90, s85
  v_perm_b32 v94, v94, v90, s86
  v_perm_b32 v90, v95, v91, s85
  v_perm_b32 v95, v95, v91, s86
  s_mov_b32 s84, 17280
  buffer_load_dwordx4 v[112:115], v46, s[16:19], s84 offen offset:1152
  s_mov_b32 s84, 17280
  buffer_load_dwordx4 v[116:119], v46, s[16:19], s84 offen offset:2304
  s_mov_b32 s84, 20736
  buffer_load_dwordx4 v[120:123], v46, s[16:19], s84 offen offset:0
  s_mov_b32 s84, 20736
  buffer_load_dwordx4 v[124:127], v46, s[16:19], s84 offen offset:1152
  s_waitcnt vmcnt(20)
  v_dot2_f32_bf16 v32, v224, v8, 0
  v_dot2_f32_bf16 v36, v224, v12, 0
  v_dot2_f32_bf16 v33, v228, v8, 0
  v_dot2_f32_bf16 v37, v228, v12, 0
  v_dot2_f32_bf16 v34, v232, v8, 0
  v_dot2_f32_bf16 v38, v232, v12, 0
  v_dot2_f32_bf16 v35, v236, v8, 0
  v_dot2_f32_bf16 v39, v236, v12, 0
  v_dot2_f32_bf16 v32, v225, v9, v32
  v_dot2_f32_bf16 v36, v225, v13, v36
  v_dot2_f32_bf16 v33, v229, v9, v33
  v_dot2_f32_bf16 v37, v229, v13, v37
  v_dot2_f32_bf16 v34, v233, v9, v34
  v_dot2_f32_bf16 v38, v233, v13, v38
  v_dot2_f32_bf16 v35, v237, v9, v35
  v_dot2_f32_bf16 v39, v237, v13, v39
  v_dot2_f32_bf16 v32, v226, v10, v32
  v_dot2_f32_bf16 v36, v226, v14, v36
  v_dot2_f32_bf16 v33, v230, v10, v33
  v_dot2_f32_bf16 v37, v230, v14, v37
  v_dot2_f32_bf16 v34, v234, v10, v34
  v_dot2_f32_bf16 v38, v234, v14, v38
  v_dot2_f32_bf16 v35, v238, v10, v35
  v_dot2_f32_bf16 v39, v238, v14, v39
  v_dot2_f32_bf16 v32, v227, v11, v32
  v_dot2_f32_bf16 v36, v227, v15, v36
  v_dot2_f32_bf16 v33, v231, v11, v33
  v_dot2_f32_bf16 v37, v231, v15, v37
  v_dot2_f32_bf16 v34, v235, v11, v34
  v_dot2_f32_bf16 v38, v235, v15, v38
  v_dot2_f32_bf16 v35, v239, v11, v35
  v_dot2_f32_bf16 v39, v239, v15, v39
  s_mov_b32 s83, 360448
  buffer_load_dwordx4 v[224:227], v2, s[4:7], s83 offen offset:0 nt
  buffer_load_dwordx4 v[228:231], v2, s[4:7], s83 offen offset:1024 nt
  buffer_load_dwordx4 v[232:235], v2, s[4:7], s83 offen offset:2048 nt
  buffer_load_dwordx4 v[236:239], v2, s[4:7], s83 offen offset:3072 nt
  v_add_f32_dpp v32, v32, v32 row_ror:8 row_mask:0xf bank_mask:0x3
  v_add_f32_dpp v33, v33, v33 row_ror:8 row_mask:0xf bank_mask:0x3
  v_add_f32_dpp v36, v36, v36 row_ror:8 row_mask:0xf bank_mask:0x3
  v_add_f32_dpp v37, v37, v37 row_ror:8 row_mask:0xf bank_mask:0x3
  v_add_f32_dpp v32, v34, v34 row_ror:8 row_mask:0xf bank_mask:0xc
  v_add_f32_dpp v33, v35, v35 row_ror:8 row_mask:0xf bank_mask:0xc
  v_add_f32_dpp v36, v38, v38 row_ror:8 row_mask:0xf bank_mask:0xc
  v_add_f32_dpp v37, v39, v39 row_ror:8 row_mask:0xf bank_mask:0xc
  v_add_f32_dpp v32, v32, v32 row_shl:4 row_mask:0xf bank_mask:0x5
  v_add_f32_dpp v33, v33, v33 row_shl:4 row_mask:0xf bank_mask:0x5
  s_nop 0
  v_add_f32_dpp v32, v36, v36 row_shr:4 row_mask:0xf bank_mask:0xa
  v_add_f32_dpp v33, v37, v37 row_shr:4 row_mask:0xf bank_mask:0xa
  s_nop 0
  v_add_f32_dpp v32, v32, v32 quad_perm:[1,0,3,2] row_mask:0xf bank_mask:0xf
  v_add_f32_dpp v33, v33, v33 quad_perm:[1,0,3,2] row_mask:0xf bank_mask:0xf
  s_nop 0
  v_add_f32_dpp v32, v32, v32 quad_perm:[2,3,0,1] row_mask:0xf bank_mask:0xf
  v_add_f32_dpp v33, v33, v33 quad_perm:[2,3,0,1] row_mask:0xf bank_mask:0xf
  v_cvt_pk_bf16_f32 v34, v32, v33
  v_lshlrev_b32 v32, 16, v34
  v_and_b32 v33, s87, v34
  v_mul_f32 v32, s88, v32
  v_mul_f32 v33, s88, v33
  v_cvt_pk_bf16_f32 v34, v32, v33
  v_lshlrev_b32 v32, 16, v34
  v_and_b32 v33, s87, v34
  v_fma_f32 v32, v32, s89, -v3
  v_fma_f32 v33, v33, s89, -v3
  v_max_f32 v35, v32, v33
  v_cmp_lt_f32 vcc, 0x41000000, v35
  v_exp_f32 v37, v32
  v_exp_f32 v38, v33
  s_cmp_eq_u64 vcc, 0
  s_cbranch_scc1 K1_LZ9A
  v_max_f32_dpp v35, v35, v35 row_ror:8 row_mask:0xf bank_mask:0xf
  v_max_f32 v35, 0, v35
  v_exp_f32 v36, -v35
  v_add_f32 v3, v3, v35
  v_sub_f32 v32, v32, v35
  v_sub_f32 v33, v33, v35
  v_exp_f32 v37, v32
  v_exp_f32 v38, v33
  v_mul_f32 v4, v4, v36
  v_mul_f32_dpp v16, v36, v16 row_newbcast:0 row_mask:0xf bank_mask:0xf
  v_mul_f32_dpp v17, v36, v17 row_newbcast:0 row_mask:0xf bank_mask:0xf
  v_mul_f32_dpp v18, v36, v18 row_newbcast:0 row_mask:0xf bank_mask:0xf
  v_mul_f32_dpp v19, v36, v19 row_newbcast:0 row_mask:0xf bank_mask:0xf
  v_mul_f32_dpp v20, v36, v20 row_newbcast:0 row_mask:0xf bank_mask:0xf
  v_mul_f32_dpp v21, v36, v21 row_newbcast:0 row_mask:0xf bank_mask:0xf
  v_mul_f32_dpp v22, v36, v22 row_newbcast:0 row_mask:0xf bank_mask:0xf
  v_mul_f32_dpp v23, v36, v23 row_newbcast:0 row_mask:0xf bank_mask:0xf
  v_mul_f32_dpp v24, v36, v24 row_newbcast:4 row_mask:0xf bank_mask:0xf
  v_mul_f32_dpp v25, v36, v25 row_newbcast:4 row_mask:0xf bank_mask:0xf
  v_mul_f32_dpp v26, v36, v26 row_newbcast:4 row_mask:0xf bank_mask:0xf
  v_mul_f32_dpp v27, v36, v27 row_newbcast:4 row_mask:0xf bank_mask:0xf
  v_mul_f32_dpp v28, v36, v28 row_newbcast:4 row_mask:0xf bank_mask:0xf
  v_mul_f32_dpp v29, v36, v29 row_newbcast:4 row_mask:0xf bank_mask:0xf
  v_mul_f32_dpp v30, v36, v30 row_newbcast:4 row_mask:0xf bank_mask:0xf
  v_mul_f32_dpp v31, v36, v31 row_newbcast:4 row_mask:0xf bank_mask:0xf
K1_LZ9A:
  s_nop 1
  v_add_f32 v4, v4, v37
  v_cvt_pk_bf16_f32 v44, v37, v38
  v_add_f32 v4, v4, v38
  s_waitcnt vmcnt(20)
  v_perm_b32 v40, v244, v240, s85
  v_perm_b32 v41, v244, v240, s86
  v_perm_b32 v42, v245, v241, s85
  v_perm_b32 v43, v245, v241, s86
  v_dot2c_f32_bf16_dpp v16, v44, v40 row_newbcast:0 row_mask:0xf bank_mask:0xf
  v_dot2c_f32_bf16_dpp v17, v44, v41 row_newbcast:0 row_mask:0xf bank_mask:0xf
  v_dot2c_f32_bf16_dpp v18, v44, v42 row_newbcast:0 row_mask:0xf bank_mask:0xf
  v_dot2c_f32_bf16_dpp v19, v44, v43 row_newbcast:0 row_mask:0xf bank_mask:0xf
  v_dot2c_f32_bf16_dpp v24, v44, v40 row_newbcast:4 row_mask:0xf bank_mask:0xf
  v_dot2c_f32_bf16_dpp v25, v44, v41 row_newbcast:4 row_mask:0xf bank_mask:0xf
  v_dot2c_f32_bf16_dpp v26, v44, v42 row_newbcast:4 row_mask:0xf bank_mask:0xf
  v_dot2c_f32_bf16_dpp v27, v44, v43 row_newbcast:4 row_mask:0xf bank_mask:0xf
  v_perm_b32 v40, v246, v242, s85
  v_perm_b32 v41, v246, v242, s86
  v_perm_b32 v42, v247, v243, s85
  v_perm_b32 v43, v247, v243, s86
  v_dot2c_f32_bf16_dpp v20, v44, v40 row_newbcast:0 row_mask:0xf bank_mask:0xf
  v_dot2c_f32_bf16_dpp v21, v44, v41 row_newbcast:0 row_mask:0xf bank_mask:0xf
  v_dot2c_f32_bf16_dpp v22, v44, v42 row_newbcast:0 row_mask:0xf bank_mask:0xf
  v_dot2c_f32_bf16_dpp v23, v44, v43 row_newbcast:0 row_mask:0xf bank_mask:0xf
  v_dot2c_f32_bf16_dpp v28, v44, v40 row_newbcast:4 row_mask:0xf bank_mask:0xf
  v_dot2c_f32_bf16_dpp v29, v44, v41 row_newbcast:4 row_mask:0xf bank_mask:0xf
  v_dot2c_f32_bf16_dpp v30, v44, v42 row_newbcast:4 row_mask:0xf bank_mask:0xf
  v_dot2c_f32_bf16_dpp v31, v44, v43 row_newbcast:4 row_mask:0xf bank_mask:0xf
  v_perm_b32 v40, v252, v248, s85
  v_perm_b32 v41, v252, v248, s86
  v_perm_b32 v42, v253, v249, s85
  v_perm_b32 v43, v253, v249, s86
  v_dot2c_f32_bf16_dpp v16, v44, v40 row_newbcast:8 row_mask:0xf bank_mask:0xf
  v_dot2c_f32_bf16_dpp v17, v44, v41 row_newbcast:8 row_mask:0xf bank_mask:0xf
  v_dot2c_f32_bf16_dpp v18, v44, v42 row_newbcast:8 row_mask:0xf bank_mask:0xf
  v_dot2c_f32_bf16_dpp v19, v44, v43 row_newbcast:8 row_mask:0xf bank_mask:0xf
  v_dot2c_f32_bf16_dpp v24, v44, v40 row_newbcast:12 row_mask:0xf bank_mask:0xf
  v_dot2c_f32_bf16_dpp v25, v44, v41 row_newbcast:12 row_mask:0xf bank_mask:0xf
  v_dot2c_f32_bf16_dpp v26, v44, v42 row_newbcast:12 row_mask:0xf bank_mask:0xf
  v_dot2c_f32_bf16_dpp v27, v44, v43 row_newbcast:12 row_mask:0xf bank_mask:0xf
  v_perm_b32 v40, v254, v250, s85
  v_perm_b32 v41, v254, v250, s86
  v_perm_b32 v42, v255, v251, s85
  v_perm_b32 v43, v255, v251, s86
  v_dot2c_f32_bf16_dpp v20, v44, v40 row_newbcast:8 row_mask:0xf bank_mask:0xf
  v_dot2c_f32_bf16_dpp v21, v44, v41 row_newbcast:8 row_mask:0xf bank_mask:0xf
  v_dot2c_f32_bf16_dpp v22, v44, v42 row_newbcast:8 row_mask:0xf bank_mask:0xf
  v_dot2c_f32_bf16_dpp v23, v44, v43 row_newbcast:8 row_mask:0xf bank_mask:0xf
  v_dot2c_f32_bf16_dpp v28, v44, v40 row_newbcast:12 row_mask:0xf bank_mask:0xf
  v_dot2c_f32_bf16_dpp v29, v44, v41 row_newbcast:12 row_mask:0xf bank_mask:0xf
  v_dot2c_f32_bf16_dpp v30, v44, v42 row_newbcast:12 row_mask:0xf bank_mask:0xf
  v_dot2c_f32_bf16_dpp v31, v44, v43 row_newbcast:12 row_mask:0xf bank_mask:0xf
  s_mov_b32 s83, 360448
  buffer_load_dwordx4 v[240:243], v2, s[8:11], s83 offen offset:0 nt
  buffer_load_dwordx4 v[244:247], v2, s[8:11], s83 offen offset:1024 nt
  buffer_load_dwordx4 v[248:251], v2, s[8:11], s83 offen offset:2048 nt
  buffer_load_dwordx4 v[252:255], v2, s[8:11], s83 offen offset:3072 nt
  s_waitcnt vmcnt(22)
  v_perm_b32 v91, v100, v96, s85
  v_perm_b32 v100, v100, v96, s86
  v_perm_b32 v96, v101, v97, s85
  v_perm_b32 v101, v101, v97, s86
  v_perm_b32 v97, v102, v98, s85
  v_perm_b32 v102, v102, v98, s86
  v_perm_b32 v98, v103, v99, s85
  v_perm_b32 v103, v103, v99, s86
  s_waitcnt vmcnt(20)
  v_perm_b32 v99, v108, v104, s85
  v_perm_b32 v108, v108, v104, s86
  v_perm_b32 v104, v109, v105, s85
  v_perm_b32 v109, v109, v105, s86
  v_perm_b32 v105, v110, v106, s85
  v_perm_b32 v110, v110, v106, s86
  v_perm_b32 v106, v111, v107, s85
  v_perm_b32 v111, v111, v107, s86
  s_mov_b32 s84, 20736
  buffer_load_dwordx4 v[128:131], v46, s[16:19], s84 offen offset:2304
  s_mov_b32 s84, 24192
  buffer_load_dwordx4 v[132:135], v46, s[16:19], s84 offen offset:0
  s_mov_b32 s84, 24192
  buffer_load_dwordx4 v[136:139], v46, s[16:19], s84 offen offset:1152
  s_mov_b32 s84, 24192
  buffer_load_dwordx4 v[140:143], v46, s[16:19], s84 offen offset:2304
  s_waitcnt vmcnt(20)
  v_dot2_f32_bf16 v32, v192, v8, 0
  v_dot2_f32_bf16 v36, v192, v12, 0
  v_dot2_f32_bf16 v33, v196, v8, 0
  v_dot2_f32_bf16 v37, v196, v12, 0
  v_dot2_f32_bf16 v34, v200, v8, 0
  v_dot2_f32_bf16 v38, v200, v12, 0
  v_dot2_f32_bf16 v35, v204, v8, 0
  v_dot2_f32_bf16 v39, v204, v12, 0
  v_dot2_f32_bf16 v32, v193, v9, v32
  v_dot2_f32_bf16 v36, v193, v13, v36
  v_dot2_f32_bf16 v33, v197, v9, v33
  v_dot2_f32_bf16 v37, v197, v13, v37
  v_dot2_f32_bf16 v34, v201, v9, v34
  v_dot2_f32_bf16 v38, v201, v13, v38
  v_dot2_f32_bf16 v35, v205, v9, v35
  v_dot2_f32_bf16 v39, v205, v13, v39
  v_dot2_f32_bf16 v32, v194, v10, v32
  v_dot2_f32_bf16 v36, v194, v14, v36
  v_dot2_f32_bf16 v33, v198, v10, v33
  v_dot2_f32_bf16 v37, v198, v14, v37
  v_dot2_f32_bf16 v34, v202, v10, v34
  v_dot2_f32_bf16 v38, v202, v14, v38
  v_dot2_f32_bf16 v35, v206, v10, v35
  v_dot2_f32_bf16 v39, v206, v14, v39
  v_dot2_f32_bf16 v32, v195, v11, v32
  v_dot2_f32_bf16 v36, v195, v15, v36
  v_dot2_f32_bf16 v33, v199, v11, v33
  v_dot2_f32_bf16 v37, v199, v15, v37
  v_dot2_f32_bf16 v34, v203, v11, v34
  v_dot2_f32_bf16 v38, v203, v15, v38
  v_dot2_f32_bf16 v35, v207, v11, v35
  v_dot2_f32_bf16 v39, v207, v15, v39
  s_mov_b32 s83, 393216
  buffer_load_dwordx4 v[192:195], v2, s[4:7], s83 offen offset:0 nt
  buffer_load_dwordx4 v[196:199], v2, s[4:7], s83 offen offset:1024 nt
  buffer_load_dwordx4 v[200:203], v2, s[4:7], s83 offen offset:2048 nt
  buffer_load_dwordx4 v[204:207], v2, s[4:7], s83 offen offset:3072 nt
  v_add_f32_dpp v32, v32, v32 row_ror:8 row_mask:0xf bank_mask:0x3
  v_add_f32_dpp v33, v33, v33 row_ror:8 row_mask:0xf bank_mask:0x3
  v_add_f32_dpp v36, v36, v36 row_ror:8 row_mask:0xf bank_mask:0x3
  v_add_f32_dpp v37, v37, v37 row_ror:8 row_mask:0xf bank_mask:0x3
  v_add_f32_dpp v32, v34, v34 row_ror:8 row_mask:0xf bank_mask:0xc
  v_add_f32_dpp v33, v35, v35 row_ror:8 row_mask:0xf bank_mask:0xc
  v_add_f32_dpp v36, v38, v38 row_ror:8 row_mask:0xf bank_mask:0xc
  v_add_f32_dpp v37, v39, v39 row_ror:8 row_mask:0xf bank_mask:0xc
  v_add_f32_dpp v32, v32, v32 row_shl:4 row_mask:0xf bank_mask:0x5
  v_add_f32_dpp v33, v33, v33 row_shl:4 row_mask:0xf bank_mask:0x5
  s_nop 0
  v_add_f32_dpp v32, v36, v36 row_shr:4 row_mask:0xf bank_mask:0xa
  v_add_f32_dpp v33, v37, v37 row_shr:4 row_mask:0xf bank_mask:0xa
  s_nop 0
  v_add_f32_dpp v32, v32, v32 quad_perm:[1,0,3,2] row_mask:0xf bank_mask:0xf
  v_add_f32_dpp v33, v33, v33 quad_perm:[1,0,3,2] row_mask:0xf bank_mask:0xf
  s_nop 0
  v_add_f32_dpp v32, v32, v32 quad_perm:[2,3,0,1] row_mask:0xf bank_mask:0xf
  v_add_f32_dpp v33, v33, v33 quad_perm:[2,3,0,1] row_mask:0xf bank_mask:0xf
  v_cvt_pk_bf16_f32 v34, v32, v33
  v_lshlrev_b32 v32, 16, v34
  v_and_b32 v33, s87, v34
  v_mul_f32 v32, s88, v32
  v_mul_f32 v33, s88, v33
  v_cvt_pk_bf16_f32 v34, v32, v33
  v_lshlrev_b32 v32, 16, v34
  v_and_b32 v33, s87, v34
  v_fma_f32 v32, v32, s89, -v3
  v_fma_f32 v33, v33, s89, -v3
  v_max_f32 v35, v32, v33
  v_cmp_lt_f32 vcc, 0x41000000, v35
  v_exp_f32 v37, v32
  v_exp_f32 v38, v33
  s_cmp_eq_u64 vcc, 0
  s_cbranch_scc1 K1_LZ10A
  v_max_f32_dpp v35, v35, v35 row_ror:8 row_mask:0xf bank_mask:0xf
  v_max_f32 v35, 0, v35
  v_exp_f32 v36, -v35
  v_add_f32 v3, v3, v35
  v_sub_f32 v32, v32, v35
  v_sub_f32 v33, v33, v35
  v_exp_f32 v37, v32
  v_exp_f32 v38, v33
  v_mul_f32 v4, v4, v36
  v_mul_f32_dpp v16, v36, v16 row_newbcast:0 row_mask:0xf bank_mask:0xf
  v_mul_f32_dpp v17, v36, v17 row_newbcast:0 row_mask:0xf bank_mask:0xf
  v_mul_f32_dpp v18, v36, v18 row_newbcast:0 row_mask:0xf bank_mask:0xf
  v_mul_f32_dpp v19, v36, v19 row_newbcast:0 row_mask:0xf bank_mask:0xf
  v_mul_f32_dpp v20, v36, v20 row_newbcast:0 row_mask:0xf bank_mask:0xf
  v_mul_f32_dpp v21, v36, v21 row_newbcast:0 row_mask:0xf bank_mask:0xf
  v_mul_f32_dpp v22, v36, v22 row_newbcast:0 row_mask:0xf bank_mask:0xf
  v_mul_f32_dpp v23, v36, v23 row_newbcast:0 row_mask:0xf bank_mask:0xf
  v_mul_f32_dpp v24, v36, v24 row_newbcast:4 row_mask:0xf bank_mask:0xf
  v_mul_f32_dpp v25, v36, v25 row_newbcast:4 row_mask:0xf bank_mask:0xf
  v_mul_f32_dpp v26, v36, v26 row_newbcast:4 row_mask:0xf bank_mask:0xf
  v_mul_f32_dpp v27, v36, v27 row_newbcast:4 row_mask:0xf bank_mask:0xf
  v_mul_f32_dpp v28, v36, v28 row_newbcast:4 row_mask:0xf bank_mask:0xf
  v_mul_f32_dpp v29, v36, v29 row_newbcast:4 row_mask:0xf bank_mask:0xf
  v_mul_f32_dpp v30, v36, v30 row_newbcast:4 row_mask:0xf bank_mask:0xf
  v_mul_f32_dpp v31, v36, v31 row_newbcast:4 row_mask:0xf bank_mask:0xf
K1_LZ10A:
  s_nop 1
  v_add_f32 v4, v4, v37
  v_cvt_pk_bf16_f32 v44, v37, v38
  v_add_f32 v4, v4, v38
  s_waitcnt vmcnt(20)
  v_perm_b32 v40, v212, v208, s85
  v_perm_b32 v41, v212, v208, s86
  v_perm_b32 v42, v213, v209, s85
  v_perm_b32 v43, v213, v209, s86
  v_dot2c_f32_bf16_dpp v16, v44, v40 row_newbcast:0 row_mask:0xf bank_mask:0xf
  v_dot2c_f32_bf16_dpp v17, v44, v41 row_newbcast:0 row_mask:0xf bank_mask:0xf
  v_dot2c_f32_bf16_dpp v18, v44, v42 row_newbcast:0 row_mask:0xf bank_mask:0xf
  v_dot2c_f32_bf16_dpp v19, v44, v43 row_newbcast:0 row_mask:0xf bank_mask:0xf
  v_dot2c_f32_bf16_dpp v24, v44, v40 row_newbcast:4 row_mask:0xf bank_mask:0xf
  v_dot2c_f32_bf16_dpp v25, v44, v41 row_newbcast:4 row_mask:0xf bank_mask:0xf
  v_dot2c_f32_bf16_dpp v26, v44, v42 row_newbcast:4 row_mask:0xf bank_mask:0xf
  v_dot2c_f32_bf16_dpp v27, v44, v43 row_newbcast:4 row_mask:0xf bank_mask:0xf
  v_perm_b32 v40, v214, v210, s85
  v_perm_b32 v41, v214, v210, s86
  v_perm_b32 v42, v215, v211, s85
  v_perm_b32 v43, v215, v211, s86
  v_dot2c_f32_bf16_dpp v20, v44, v40 row_newbcast:0 row_mask:0xf bank_mask:0xf
  v_dot2c_f32_bf16_dpp v21, v44, v41 row_newbcast:0 row_mask:0xf bank_mask:0xf
  v_dot2c_f32_bf16_dpp v22, v44, v42 row_newbcast:0 row_mask:0xf bank_mask:0xf
  v_dot2c_f32_bf16_dpp v23, v44, v43 row_newbcast:0 row_mask:0xf bank_mask:0xf
  v_dot2c_f32_bf16_dpp v28, v44, v40 row_newbcast:4 row_mask:0xf bank_mask:0xf
  v_dot2c_f32_bf16_dpp v29, v44, v41 row_newbcast:4 row_mask:0xf bank_mask:0xf
  v_dot2c_f32_bf16_dpp v30, v44, v42 row_newbcast:4 row_mask:0xf bank_mask:0xf
  v_dot2c_f32_bf16_dpp v31, v44, v43 row_newbcast:4 row_mask:0xf bank_mask:0xf
  v_perm_b32 v40, v220, v216, s85
  v_perm_b32 v41, v220, v216, s86
  v_perm_b32 v42, v221, v217, s85
  v_perm_b32 v43, v221, v217, s86
  v_dot2c_f32_bf16_dpp v16, v44, v40 row_newbcast:8 row_mask:0xf bank_mask:0xf
  v_dot2c_f32_bf16_dpp v17, v44, v41 row_newbcast:8 row_mask:0xf bank_mask:0xf
  v_dot2c_f32_bf16_dpp v18, v44, v42 row_newbcast:8 row_mask:0xf bank_mask:0xf
  v_dot2c_f32_bf16_dpp v19, v44, v43 row_newbcast:8 row_mask:0xf bank_mask:0xf
  v_dot2c_f32_bf16_dpp v24, v44, v40 row_newbcast:12 row_mask:0xf bank_mask:0xf
  v_dot2c_f32_bf16_dpp v25, v44, v41 row_newbcast:12 row_mask:0xf bank_mask:0xf
  v_dot2c_f32_bf16_dpp v26, v44, v42 row_newbcast:12 row_mask:0xf bank_mask:0xf
  v_dot2c_f32_bf16_dpp v27, v44, v43 row_newbcast:12 row_mask:0xf bank_mask:0xf
  v_perm_b32 v40, v222, v218, s85
  v_perm_b32 v41, v222, v218, s86
  v_perm_b32 v42, v223, v219, s85
  v_perm_b32 v43, v223, v219, s86
  v_dot2c_f32_bf16_dpp v20, v44, v40 row_newbcast:8 row_mask:0xf bank_mask:0xf
  v_dot2c_f32_bf16_dpp v21, v44, v41 row_newbcast:8 row_mask:0xf bank_mask:0xf
  v_dot2c_f32_bf16_dpp v22, v44, v42 row_newbcast:8 row_mask:0xf bank_mask:0xf
  v_dot2c_f32_bf16_dpp v23, v44, v43 row_newbcast:8 row_mask:0xf bank_mask:0xf
  v_dot2c_f32_bf16_dpp v28, v44, v40 row_newbcast:12 row_mask:0xf bank_mask:0xf
  v_dot2c_f32_bf16_dpp v29, v44, v41 row_newbcast:12 row_mask:0xf bank_mask:0xf
  v_dot2c_f32_bf16_dpp v30, v44, v42 row_newbcast:12 row_mask:0xf bank_mask:0xf
  v_dot2c_f32_bf16_dpp v31, v44, v43 row_newbcast:12 row_mask:0xf bank_mask:0xf
  s_mov_b32 s83, 393216
  buffer_load_dwordx4 v[208:211], v2, s[8:11], s83 offen offset:0 nt
  buffer_load_dwordx4 v[212:215], v2, s[8:11], s83 offen offset:1024 nt
  buffer_load_dwordx4 v[216:219], v2, s[8:11], s83 offen offset:2048 nt
  buffer_load_dwordx4 v[220:223], v2, s[8:11], s83 offen offset:3072 nt
  s_waitcnt vmcnt(22)
  v_perm_b32 v107, v116, v112, s85
  v_perm_b32 v116, v116, v112, s86
  v_perm_b32 v112, v117, v113, s85
  v_perm_b32 v117, v117, v113, s86
  v_perm_b32 v113, v118, v114, s85
  v_perm_b32 v118, v118, v114, s86
  v_perm_b32 v114, v119, v115, s85
  v_perm_b32 v119, v119, v115, s86
  s_waitcnt vmcnt(20)
  v_perm_b32 v115, v124, v120, s85
  v_perm_b32 v124, v124, v120, s86
  v_perm_b32 v120, v125, v121, s85
  v_perm_b32 v125, v125, v121, s86
  v_perm_b32 v121, v126, v122, s85
  v_perm_b32 v126, v126, v122, s86
  v_perm_b32 v122, v127, v123, s85
  v_perm_b32 v127, v127, v123, s86
  s_mov_b32 s84, 27648
  buffer_load_dwordx4 v[144:147], v46, s[16:19], s84 offen offset:0
  s_mov_b32 s84, 27648
  buffer_load_dwordx4 v[148:151], v46, s[16:19], s84 offen offset:1152
  s_mov_b32 s84, 27648
  buffer_load_dwordx4 v[152:155], v46, s[16:19], s84 offen offset:2304
  s_mov_b32 s84, 31104
  buffer_load_dwordx4 v[156:159], v46, s[16:19], s84 offen offset:0
  s_waitcnt vmcnt(20)
  v_dot2_f32_bf16 v32, v224, v8, 0
  v_dot2_f32_bf16 v36, v224, v12, 0
  v_dot2_f32_bf16 v33, v228, v8, 0
  v_dot2_f32_bf16 v37, v228, v12, 0
  v_dot2_f32_bf16 v34, v232, v8, 0
  v_dot2_f32_bf16 v38, v232, v12, 0
  v_dot2_f32_bf16 v35, v236, v8, 0
  v_dot2_f32_bf16 v39, v236, v12, 0
  v_dot2_f32_bf16 v32, v225, v9, v32
  v_dot2_f32_bf16 v36, v225, v13, v36
  v_dot2_f32_bf16 v33, v229, v9, v33
  v_dot2_f32_bf16 v37, v229, v13, v37
  v_dot2_f32_bf16 v34, v233, v9, v34
  v_dot2_f32_bf16 v38, v233, v13, v38
  v_dot2_f32_bf16 v35, v237, v9, v35
  v_dot2_f32_bf16 v39, v237, v13, v39
  v_dot2_f32_bf16 v32, v226, v10, v32
  v_dot2_f32_bf16 v36, v226, v14, v36
  v_dot2_f32_bf16 v33, v230, v10, v33
  v_dot2_f32_bf16 v37, v230, v14, v37
  v_dot2_f32_bf16 v34, v234, v10, v34
  v_dot2_f32_bf16 v38, v234, v14, v38
  v_dot2_f32_bf16 v35, v238, v10, v35
  v_dot2_f32_bf16 v39, v238, v14, v39
  v_dot2_f32_bf16 v32, v227, v11, v32
  v_dot2_f32_bf16 v36, v227, v15, v36
  v_dot2_f32_bf16 v33, v231, v11, v33
  v_dot2_f32_bf16 v37, v231, v15, v37
  v_dot2_f32_bf16 v34, v235, v11, v34
  v_dot2_f32_bf16 v38, v235, v15, v38
  v_dot2_f32_bf16 v35, v239, v11, v35
  v_dot2_f32_bf16 v39, v239, v15, v39
  s_mov_b32 s83, 425984
  buffer_load_dwordx4 v[224:227], v2, s[4:7], s83 offen offset:0 nt
  buffer_load_dwordx4 v[228:231], v2, s[4:7], s83 offen offset:1024 nt
  buffer_load_dwordx4 v[232:235], v2, s[4:7], s83 offen offset:2048 nt
  buffer_load_dwordx4 v[236:239], v2, s[4:7], s83 offen offset:3072 nt
  v_add_f32_dpp v32, v32, v32 row_ror:8 row_mask:0xf bank_mask:0x3
  v_add_f32_dpp v33, v33, v33 row_ror:8 row_mask:0xf bank_mask:0x3
  v_add_f32_dpp v36, v36, v36 row_ror:8 row_mask:0xf bank_mask:0x3
  v_add_f32_dpp v37, v37, v37 row_ror:8 row_mask:0xf bank_mask:0x3
  v_add_f32_dpp v32, v34, v34 row_ror:8 row_mask:0xf bank_mask:0xc
  v_add_f32_dpp v33, v35, v35 row_ror:8 row_mask:0xf bank_mask:0xc
  v_add_f32_dpp v36, v38, v38 row_ror:8 row_mask:0xf bank_mask:0xc
  v_add_f32_dpp v37, v39, v39 row_ror:8 row_mask:0xf bank_mask:0xc
  v_add_f32_dpp v32, v32, v32 row_shl:4 row_mask:0xf bank_mask:0x5
  v_add_f32_dpp v33, v33, v33 row_shl:4 row_mask:0xf bank_mask:0x5
  s_nop 0
  v_add_f32_dpp v32, v36, v36 row_shr:4 row_mask:0xf bank_mask:0xa
  v_add_f32_dpp v33, v37, v37 row_shr:4 row_mask:0xf bank_mask:0xa
  s_nop 0
  v_add_f32_dpp v32, v32, v32 quad_perm:[1,0,3,2] row_mask:0xf bank_mask:0xf
  v_add_f32_dpp v33, v33, v33 quad_perm:[1,0,3,2] row_mask:0xf bank_mask:0xf
  s_nop 0
  v_add_f32_dpp v32, v32, v32 quad_perm:[2,3,0,1] row_mask:0xf bank_mask:0xf
  v_add_f32_dpp v33, v33, v33 quad_perm:[2,3,0,1] row_mask:0xf bank_mask:0xf
  v_cvt_pk_bf16_f32 v34, v32, v33
  v_lshlrev_b32 v32, 16, v34
  v_and_b32 v33, s87, v34
  v_mul_f32 v32, s88, v32
  v_mul_f32 v33, s88, v33
  v_cvt_pk_bf16_f32 v34, v32, v33
  v_lshlrev_b32 v32, 16, v34
  v_and_b32 v33, s87, v34
  v_fma_f32 v32, v32, s89, -v3
  v_fma_f32 v33, v33, s89, -v3
  v_max_f32 v35, v32, v33
  v_cmp_lt_f32 vcc, 0x41000000, v35
  v_exp_f32 v37, v32
  v_exp_f32 v38, v33
  s_cmp_eq_u64 vcc, 0
  s_cbranch_scc1 K1_LZ11A
  v_max_f32_dpp v35, v35, v35 row_ror:8 row_mask:0xf bank_mask:0xf
  v_max_f32 v35, 0, v35
  v_exp_f32 v36, -v35
  v_add_f32 v3, v3, v35
  v_sub_f32 v32, v32, v35
  v_sub_f32 v33, v33, v35
  v_exp_f32 v37, v32
  v_exp_f32 v38, v33
  v_mul_f32 v4, v4, v36
  v_mul_f32_dpp v16, v36, v16 row_newbcast:0 row_mask:0xf bank_mask:0xf
  v_mul_f32_dpp v17, v36, v17 row_newbcast:0 row_mask:0xf bank_mask:0xf
  v_mul_f32_dpp v18, v36, v18 row_newbcast:0 row_mask:0xf bank_mask:0xf
  v_mul_f32_dpp v19, v36, v19 row_newbcast:0 row_mask:0xf bank_mask:0xf
  v_mul_f32_dpp v20, v36, v20 row_newbcast:0 row_mask:0xf bank_mask:0xf
  v_mul_f32_dpp v21, v36, v21 row_newbcast:0 row_mask:0xf bank_mask:0xf
  v_mul_f32_dpp v22, v36, v22 row_newbcast:0 row_mask:0xf bank_mask:0xf
  v_mul_f32_dpp v23, v36, v23 row_newbcast:0 row_mask:0xf bank_mask:0xf
  v_mul_f32_dpp v24, v36, v24 row_newbcast:4 row_mask:0xf bank_mask:0xf
  v_mul_f32_dpp v25, v36, v25 row_newbcast:4 row_mask:0xf bank_mask:0xf
  v_mul_f32_dpp v26, v36, v26 row_newbcast:4 row_mask:0xf bank_mask:0xf
  v_mul_f32_dpp v27, v36, v27 row_newbcast:4 row_mask:0xf bank_mask:0xf
  v_mul_f32_dpp v28, v36, v28 row_newbcast:4 row_mask:0xf bank_mask:0xf
  v_mul_f32_dpp v29, v36, v29 row_newbcast:4 row_mask:0xf bank_mask:0xf
  v_mul_f32_dpp v30, v36, v30 row_newbcast:4 row_mask:0xf bank_mask:0xf
  v_mul_f32_dpp v31, v36, v31 row_newbcast:4 row_mask:0xf bank_mask:0xf
K1_LZ11A:
  s_nop 1
  v_add_f32 v4, v4, v37
  v_cvt_pk_bf16_f32 v44, v37, v38
  v_add_f32 v4, v4, v38
  s_waitcnt vmcnt(20)
  v_perm_b32 v40, v244, v240, s85
  v_perm_b32 v41, v244, v240, s86
  v_perm_b32 v42, v245, v241, s85
  v_perm_b32 v43, v245, v241, s86
  v_dot2c_f32_bf16_dpp v16, v44, v40 row_newbcast:0 row_mask:0xf bank_mask:0xf
  v_dot2c_f32_bf16_dpp v17, v44, v41 row_newbcast:0 row_mask:0xf bank_mask:0xf
  v_dot2c_f32_bf16_dpp v18, v44, v42 row_newbcast:0 row_mask:0xf bank_mask:0xf
  v_dot2c_f32_bf16_dpp v19, v44, v43 row_newbcast:0 row_mask:0xf bank_mask:0xf
  v_dot2c_f32_bf16_dpp v24, v44, v40 row_newbcast:4 row_mask:0xf bank_mask:0xf
  v_dot2c_f32_bf16_dpp v25, v44, v41 row_newbcast:4 row_mask:0xf bank_mask:0xf
  v_dot2c_f32_bf16_dpp v26, v44, v42 row_newbcast:4 row_mask:0xf bank_mask:0xf
  v_dot2c_f32_bf16_dpp v27, v44, v43 row_newbcast:4 row_mask:0xf bank_mask:0xf
  v_perm_b32 v40, v246, v242, s85
  v_perm_b32 v41, v246, v242, s86
  v_perm_b32 v42, v247, v243, s85
  v_perm_b32 v43, v247, v243, s86
  v_dot2c_f32_bf16_dpp v20, v44, v40 row_newbcast:0 row_mask:0xf bank_mask:0xf
  v_dot2c_f32_bf16_dpp v21, v44, v41 row_newbcast:0 row_mask:0xf bank_mask:0xf
  v_dot2c_f32_bf16_dpp v22, v44, v42 row_newbcast:0 row_mask:0xf bank_mask:0xf
  v_dot2c_f32_bf16_dpp v23, v44, v43 row_newbcast:0 row_mask:0xf bank_mask:0xf
  v_dot2c_f32_bf16_dpp v28, v44, v40 row_newbcast:4 row_mask:0xf bank_mask:0xf
  v_dot2c_f32_bf16_dpp v29, v44, v41 row_newbcast:4 row_mask:0xf bank_mask:0xf
  v_dot2c_f32_bf16_dpp v30, v44, v42 row_newbcast:4 row_mask:0xf bank_mask:0xf
  v_dot2c_f32_bf16_dpp v31, v44, v43 row_newbcast:4 row_mask:0xf bank_mask:0xf
  v_perm_b32 v40, v252, v248, s85
  v_perm_b32 v41, v252, v248, s86
  v_perm_b32 v42, v253, v249, s85
  v_perm_b32 v43, v253, v249, s86
  v_dot2c_f32_bf16_dpp v16, v44, v40 row_newbcast:8 row_mask:0xf bank_mask:0xf
  v_dot2c_f32_bf16_dpp v17, v44, v41 row_newbcast:8 row_mask:0xf bank_mask:0xf
  v_dot2c_f32_bf16_dpp v18, v44, v42 row_newbcast:8 row_mask:0xf bank_mask:0xf
  v_dot2c_f32_bf16_dpp v19, v44, v43 row_newbcast:8 row_mask:0xf bank_mask:0xf
  v_dot2c_f32_bf16_dpp v24, v44, v40 row_newbcast:12 row_mask:0xf bank_mask:0xf
  v_dot2c_f32_bf16_dpp v25, v44, v41 row_newbcast:12 row_mask:0xf bank_mask:0xf
  v_dot2c_f32_bf16_dpp v26, v44, v42 row_newbcast:12 row_mask:0xf bank_mask:0xf
  v_dot2c_f32_bf16_dpp v27, v44, v43 row_newbcast:12 row_mask:0xf bank_mask:0xf
  v_perm_b32 v40, v254, v250, s85
  v_perm_b32 v41, v254, v250, s86
  v_perm_b32 v42, v255, v251, s85
  v_perm_b32 v43, v255, v251, s86
  v_dot2c_f32_bf16_dpp v20, v44, v40 row_newbcast:8 row_mask:0xf bank_mask:0xf
  v_dot2c_f32_bf16_dpp v21, v44, v41 row_newbcast:8 row_mask:0xf bank_mask:0xf
  v_dot2c_f32_bf16_dpp v22, v44, v42 row_newbcast:8 row_mask:0xf bank_mask:0xf
  v_dot2c_f32_bf16_dpp v23, v44, v43 row_newbcast:8 row_mask:0xf bank_mask:0xf
  v_dot2c_f32_bf16_dpp v28, v44, v40 row_newbcast:12 row_mask:0xf bank_mask:0xf
  v_dot2c_f32_bf16_dpp v29, v44, v41 row_newbcast:12 row_mask:0xf bank_mask:0xf
  v_dot2c_f32_bf16_dpp v30, v44, v42 row_newbcast:12 row_mask:0xf bank_mask:0xf
  v_dot2c_f32_bf16_dpp v31, v44, v43 row_newbcast:12 row_mask:0xf bank_mask:0xf
  s_mov_b32 s83, 425984
  buffer_load_dwordx4 v[240:243], v2, s[8:11], s83 offen offset:0 nt
  buffer_load_dwordx4 v[244:247], v2, s[8:11], s83 offen offset:1024 nt
  buffer_load_dwordx4 v[248:251], v2, s[8:11], s83 offen offset:2048 nt
  buffer_load_dwordx4 v[252:255], v2, s[8:11], s83 offen offset:3072 nt
  s_waitcnt vmcnt(22)
  v_perm_b32 v123, v132, v128, s85
  v_perm_b32 v132, v132, v128, s86
  v_perm_b32 v128, v133, v129, s85
  v_perm_b32 v133, v133, v129, s86
  v_perm_b32 v129, v134, v130, s85
  v_perm_b32 v134, v134, v130, s86
  v_perm_b32 v130, v135, v131, s85
  v_perm_b32 v135, v135, v131, s86
  s_waitcnt vmcnt(20)
  v_perm_b32 v131, v140, v136, s85
  v_perm_b32 v140, v140, v136, s86
  v_perm_b32 v136, v141, v137, s85
  v_perm_b32 v141, v141, v137, s86
  v_perm_b32 v137, v142, v138, s85
  v_perm_b32 v142, v142, v138, s86
  v_perm_b32 v138, v143, v139, s85
  v_perm_b32 v143, v143, v139, s86
  s_mov_b32 s84, 31104
  buffer_load_dwordx4 v[160:163], v46, s[16:19], s84 offen offset:1152
  s_mov_b32 s84, 31104
  buffer_load_dwordx4 v[164:167], v46, s[16:19], s84 offen offset:2304
  s_mov_b32 s84, 34560
  buffer_load_dwordx4 v[168:171], v46, s[16:19], s84 offen offset:0
  s_mov_b32 s84, 34560
  buffer_load_dwordx4 v[172:175], v46, s[16:19], s84 offen offset:1152
  s_waitcnt vmcnt(20)
  v_dot2_f32_bf16 v32, v192, v8, 0
  v_dot2_f32_bf16 v36, v192, v12, 0
  v_dot2_f32_bf16 v33, v196, v8, 0
  v_dot2_f32_bf16 v37, v196, v12, 0
  v_dot2_f32_bf16 v34, v200, v8, 0
  v_dot2_f32_bf16 v38, v200, v12, 0
  v_dot2_f32_bf16 v35, v204, v8, 0
  v_dot2_f32_bf16 v39, v204, v12, 0
  v_dot2_f32_bf16 v32, v193, v9, v32
  v_dot2_f32_bf16 v36, v193, v13, v36
  v_dot2_f32_bf16 v33, v197, v9, v33
  v_dot2_f32_bf16 v37, v197, v13, v37
  v_dot2_f32_bf16 v34, v201, v9, v34
  v_dot2_f32_bf16 v38, v201, v13, v38
  v_dot2_f32_bf16 v35, v205, v9, v35
  v_dot2_f32_bf16 v39, v205, v13, v39
  v_dot2_f32_bf16 v32, v194, v10, v32
  v_dot2_f32_bf16 v36, v194, v14, v36
  v_dot2_f32_bf16 v33, v198, v10, v33
  v_dot2_f32_bf16 v37, v198, v14, v37
  v_dot2_f32_bf16 v34, v202, v10, v34
  v_dot2_f32_bf16 v38, v202, v14, v38
  v_dot2_f32_bf16 v35, v206, v10, v35
  v_dot2_f32_bf16 v39, v206, v14, v39
  v_dot2_f32_bf16 v32, v195, v11, v32
  v_dot2_f32_bf16 v36, v195, v15, v36
  v_dot2_f32_bf16 v33, v199, v11, v33
  v_dot2_f32_bf16 v37, v199, v15, v37
  v_dot2_f32_bf16 v34, v203, v11, v34
  v_dot2_f32_bf16 v38, v203, v15, v38
  v_dot2_f32_bf16 v35, v207, v11, v35
  v_dot2_f32_bf16 v39, v207, v15, v39
  s_mov_b32 s83, 458752
  buffer_load_dwordx4 v[192:195], v2, s[4:7], s83 offen offset:0 nt
  buffer_load_dwordx4 v[196:199], v2, s[4:7], s83 offen offset:1024 nt
  buffer_load_dwordx4 v[200:203], v2, s[4:7], s83 offen offset:2048 nt
  buffer_load_dwordx4 v[204:207], v2, s[4:7], s83 offen offset:3072 nt
  v_add_f32_dpp v32, v32, v32 row_ror:8 row_mask:0xf bank_mask:0x3
  v_add_f32_dpp v33, v33, v33 row_ror:8 row_mask:0xf bank_mask:0x3
  v_add_f32_dpp v36, v36, v36 row_ror:8 row_mask:0xf bank_mask:0x3
  v_add_f32_dpp v37, v37, v37 row_ror:8 row_mask:0xf bank_mask:0x3
  v_add_f32_dpp v32, v34, v34 row_ror:8 row_mask:0xf bank_mask:0xc
  v_add_f32_dpp v33, v35, v35 row_ror:8 row_mask:0xf bank_mask:0xc
  v_add_f32_dpp v36, v38, v38 row_ror:8 row_mask:0xf bank_mask:0xc
  v_add_f32_dpp v37, v39, v39 row_ror:8 row_mask:0xf bank_mask:0xc
  v_add_f32_dpp v32, v32, v32 row_shl:4 row_mask:0xf bank_mask:0x5
  v_add_f32_dpp v33, v33, v33 row_shl:4 row_mask:0xf bank_mask:0x5
  s_nop 0
  v_add_f32_dpp v32, v36, v36 row_shr:4 row_mask:0xf bank_mask:0xa
  v_add_f32_dpp v33, v37, v37 row_shr:4 row_mask:0xf bank_mask:0xa
  s_nop 0
  v_add_f32_dpp v32, v32, v32 quad_perm:[1,0,3,2] row_mask:0xf bank_mask:0xf
  v_add_f32_dpp v33, v33, v33 quad_perm:[1,0,3,2] row_mask:0xf bank_mask:0xf
  s_nop 0
  v_add_f32_dpp v32, v32, v32 quad_perm:[2,3,0,1] row_mask:0xf bank_mask:0xf
  v_add_f32_dpp v33, v33, v33 quad_perm:[2,3,0,1] row_mask:0xf bank_mask:0xf
  v_cvt_pk_bf16_f32 v34, v32, v33
  v_lshlrev_b32 v32, 16, v34
  v_and_b32 v33, s87, v34
  v_mul_f32 v32, s88, v32
  v_mul_f32 v33, s88, v33
  v_cvt_pk_bf16_f32 v34, v32, v33
  v_lshlrev_b32 v32, 16, v34
  v_and_b32 v33, s87, v34
  v_fma_f32 v32, v32, s89, -v3
  v_fma_f32 v33, v33, s89, -v3
  v_max_f32 v35, v32, v33
  v_cmp_lt_f32 vcc, 0x41000000, v35
  v_exp_f32 v37, v32
  v_exp_f32 v38, v33
  s_cmp_eq_u64 vcc, 0
  s_cbranch_scc1 K1_LZ12A
  v_max_f32_dpp v35, v35, v35 row_ror:8 row_mask:0xf bank_mask:0xf
  v_max_f32 v35, 0, v35
  v_exp_f32 v36, -v35
  v_add_f32 v3, v3, v35
  v_sub_f32 v32, v32, v35
  v_sub_f32 v33, v33, v35
  v_exp_f32 v37, v32
  v_exp_f32 v38, v33
  v_mul_f32 v4, v4, v36
  v_mul_f32_dpp v16, v36, v16 row_newbcast:0 row_mask:0xf bank_mask:0xf
  v_mul_f32_dpp v17, v36, v17 row_newbcast:0 row_mask:0xf bank_mask:0xf
  v_mul_f32_dpp v18, v36, v18 row_newbcast:0 row_mask:0xf bank_mask:0xf
  v_mul_f32_dpp v19, v36, v19 row_newbcast:0 row_mask:0xf bank_mask:0xf
  v_mul_f32_dpp v20, v36, v20 row_newbcast:0 row_mask:0xf bank_mask:0xf
  v_mul_f32_dpp v21, v36, v21 row_newbcast:0 row_mask:0xf bank_mask:0xf
  v_mul_f32_dpp v22, v36, v22 row_newbcast:0 row_mask:0xf bank_mask:0xf
  v_mul_f32_dpp v23, v36, v23 row_newbcast:0 row_mask:0xf bank_mask:0xf
  v_mul_f32_dpp v24, v36, v24 row_newbcast:4 row_mask:0xf bank_mask:0xf
  v_mul_f32_dpp v25, v36, v25 row_newbcast:4 row_mask:0xf bank_mask:0xf
  v_mul_f32_dpp v26, v36, v26 row_newbcast:4 row_mask:0xf bank_mask:0xf
  v_mul_f32_dpp v27, v36, v27 row_newbcast:4 row_mask:0xf bank_mask:0xf
  v_mul_f32_dpp v28, v36, v28 row_newbcast:4 row_mask:0xf bank_mask:0xf
  v_mul_f32_dpp v29, v36, v29 row_newbcast:4 row_mask:0xf bank_mask:0xf
  v_mul_f32_dpp v30, v36, v30 row_newbcast:4 row_mask:0xf bank_mask:0xf
  v_mul_f32_dpp v31, v36, v31 row_newbcast:4 row_mask:0xf bank_mask:0xf
K1_LZ12A:
  s_nop 1
  v_add_f32 v4, v4, v37
  v_cvt_pk_bf16_f32 v44, v37, v38
  v_add_f32 v4, v4, v38
  s_waitcnt vmcnt(20)
  v_perm_b32 v40, v212, v208, s85
  v_perm_b32 v41, v212, v208, s86
  v_perm_b32 v42, v213, v209, s85
  v_perm_b32 v43, v213, v209, s86
  v_dot2c_f32_bf16_dpp v16, v44, v40 row_newbcast:0 row_mask:0xf bank_mask:0xf
  v_dot2c_f32_bf16_dpp v17, v44, v41 row_newbcast:0 row_mask:0xf bank_mask:0xf
  v_dot2c_f32_bf16_dpp v18, v44, v42 row_newbcast:0 row_mask:0xf bank_mask:0xf
  v_dot2c_f32_bf16_dpp v19, v44, v43 row_newbcast:0 row_mask:0xf bank_mask:0xf
  v_dot2c_f32_bf16_dpp v24, v44, v40 row_newbcast:4 row_mask:0xf bank_mask:0xf
  v_dot2c_f32_bf16_dpp v25, v44, v41 row_newbcast:4 row_mask:0xf bank_mask:0xf
  v_dot2c_f32_bf16_dpp v26, v44, v42 row_newbcast:4 row_mask:0xf bank_mask:0xf
  v_dot2c_f32_bf16_dpp v27, v44, v43 row_newbcast:4 row_mask:0xf bank_mask:0xf
  v_perm_b32 v40, v214, v210, s85
  v_perm_b32 v41, v214, v210, s86
  v_perm_b32 v42, v215, v211, s85
  v_perm_b32 v43, v215, v211, s86
  v_dot2c_f32_bf16_dpp v20, v44, v40 row_newbcast:0 row_mask:0xf bank_mask:0xf
  v_dot2c_f32_bf16_dpp v21, v44, v41 row_newbcast:0 row_mask:0xf bank_mask:0xf
  v_dot2c_f32_bf16_dpp v22, v44, v42 row_newbcast:0 row_mask:0xf bank_mask:0xf
  v_dot2c_f32_bf16_dpp v23, v44, v43 row_newbcast:0 row_mask:0xf bank_mask:0xf
  v_dot2c_f32_bf16_dpp v28, v44, v40 row_newbcast:4 row_mask:0xf bank_mask:0xf
  v_dot2c_f32_bf16_dpp v29, v44, v41 row_newbcast:4 row_mask:0xf bank_mask:0xf
  v_dot2c_f32_bf16_dpp v30, v44, v42 row_newbcast:4 row_mask:0xf bank_mask:0xf
  v_dot2c_f32_bf16_dpp v31, v44, v43 row_newbcast:4 row_mask:0xf bank_mask:0xf
  v_perm_b32 v40, v220, v216, s85
  v_perm_b32 v41, v220, v216, s86
  v_perm_b32 v42, v221, v217, s85
  v_perm_b32 v43, v221, v217, s86
  v_dot2c_f32_bf16_dpp v16, v44, v40 row_newbcast:8 row_mask:0xf bank_mask:0xf
  v_dot2c_f32_bf16_dpp v17, v44, v41 row_newbcast:8 row_mask:0xf bank_mask:0xf
  v_dot2c_f32_bf16_dpp v18, v44, v42 row_newbcast:8 row_mask:0xf bank_mask:0xf
  v_dot2c_f32_bf16_dpp v19, v44, v43 row_newbcast:8 row_mask:0xf bank_mask:0xf
  v_dot2c_f32_bf16_dpp v24, v44, v40 row_newbcast:12 row_mask:0xf bank_mask:0xf
  v_dot2c_f32_bf16_dpp v25, v44, v41 row_newbcast:12 row_mask:0xf bank_mask:0xf
  v_dot2c_f32_bf16_dpp v26, v44, v42 row_newbcast:12 row_mask:0xf bank_mask:0xf
  v_dot2c_f32_bf16_dpp v27, v44, v43 row_newbcast:12 row_mask:0xf bank_mask:0xf
  v_perm_b32 v40, v222, v218, s85
  v_perm_b32 v41, v222, v218, s86
  v_perm_b32 v42, v223, v219, s85
  v_perm_b32 v43, v223, v219, s86
  v_dot2c_f32_bf16_dpp v20, v44, v40 row_newbcast:8 row_mask:0xf bank_mask:0xf
  v_dot2c_f32_bf16_dpp v21, v44, v41 row_newbcast:8 row_mask:0xf bank_mask:0xf
  v_dot2c_f32_bf16_dpp v22, v44, v42 row_newbcast:8 row_mask:0xf bank_mask:0xf
  v_dot2c_f32_bf16_dpp v23, v44, v43 row_newbcast:8 row_mask:0xf bank_mask:0xf
  v_dot2c_f32_bf16_dpp v28, v44, v40 row_newbcast:12 row_mask:0xf bank_mask:0xf
  v_dot2c_f32_bf16_dpp v29, v44, v41 row_newbcast:12 row_mask:0xf bank_mask:0xf
  v_dot2c_f32_bf16_dpp v30, v44, v42 row_newbcast:12 row_mask:0xf bank_mask:0xf
  v_dot2c_f32_bf16_dpp v31, v44, v43 row_newbcast:12 row_mask:0xf bank_mask:0xf
  s_mov_b32 s83, 458752
  buffer_load_dwordx4 v[208:211], v2, s[8:11], s83 offen offset:0 nt
  buffer_load_dwordx4 v[212:215], v2, s[8:11], s83 offen offset:1024 nt
  buffer_load_dwordx4 v[216:219], v2, s[8:11], s83 offen offset:2048 nt
  buffer_load_dwordx4 v[220:223], v2, s[8:11], s83 offen offset:3072 nt
  s_waitcnt vmcnt(22)
  v_perm_b32 v139, v148, v144, s85
  v_perm_b32 v148, v148, v144, s86
  v_perm_b32 v144, v149, v145, s85
  v_perm_b32 v149, v149, v145, s86
  v_perm_b32 v145, v150, v146, s85
  v_perm_b32 v150, v150, v146, s86
  v_perm_b32 v146, v151, v147, s85
  v_perm_b32 v151, v151, v147, s86
  s_waitcnt vmcnt(20)
  v_perm_b32 v147, v156, v152, s85
  v_perm_b32 v156, v156, v152, s86
  v_perm_b32 v152, v157, v153, s85
  v_perm_b32 v157, v157, v153, s86
  v_perm_b32 v153, v158, v154, s85
  v_perm_b32 v158, v158, v154, s86
  v_perm_b32 v154, v159, v155, s85
  v_perm_b32 v159, v159, v155, s86
  buffer_load_dwordx4 v[176:179], v47, s[16:19], 0 offen offset:0
  buffer_load_dwordx4 v[180:183], v47, s[16:19], 0 offen offset:1152
  buffer_load_dwordx4 v[184:187], v47, s[16:19], 0 offen offset:2304
  buffer_load_dwordx4 v[188:191], v47, s[16:19], 0 offen offset:3456
  s_waitcnt vmcnt(20)
  v_dot2_f32_bf16 v32, v224, v8, 0
  v_dot2_f32_bf16 v36, v224, v12, 0
  v_dot2_f32_bf16 v33, v228, v8, 0
  v_dot2_f32_bf16 v37, v228, v12, 0
  v_dot2_f32_bf16 v34, v232, v8, 0
  v_dot2_f32_bf16 v38, v232, v12, 0
  v_dot2_f32_bf16 v35, v236, v8, 0
  v_dot2_f32_bf16 v39, v236, v12, 0
  v_dot2_f32_bf16 v32, v225, v9, v32
  v_dot2_f32_bf16 v36, v225, v13, v36
  v_dot2_f32_bf16 v33, v229, v9, v33
  v_dot2_f32_bf16 v37, v229, v13, v37
  v_dot2_f32_bf16 v34, v233, v9, v34
  v_dot2_f32_bf16 v38, v233, v13, v38
  v_dot2_f32_bf16 v35, v237, v9, v35
  v_dot2_f32_bf16 v39, v237, v13, v39
  v_dot2_f32_bf16 v32, v226, v10, v32
  v_dot2_f32_bf16 v36, v226, v14, v36
  v_dot2_f32_bf16 v33, v230, v10, v33
  v_dot2_f32_bf16 v37, v230, v14, v37
  v_dot2_f32_bf16 v34, v234, v10, v34
  v_dot2_f32_bf16 v38, v234, v14, v38
  v_dot2_f32_bf16 v35, v238, v10, v35
  v_dot2_f32_bf16 v39, v238, v14, v39
  v_dot2_f32_bf16 v32, v227, v11, v32
  v_dot2_f32_bf16 v36, v227, v15, v36
  v_dot2_f32_bf16 v33, v231, v11, v33
  v_dot2_f32_bf16 v37, v231, v15, v37
  v_dot2_f32_bf16 v34, v235, v11, v34
  v_dot2_f32_bf16 v38, v235, v15, v38
  v_dot2_f32_bf16 v35, v239, v11, v35
  v_dot2_f32_bf16 v39, v239, v15, v39
  s_mov_b32 s83, 491520
  buffer_load_dwordx4 v[224:227], v2, s[4:7], s83 offen offset:0 nt
  buffer_load_dwordx4 v[228:231], v2, s[4:7], s83 offen offset:1024 nt
  buffer_load_dwordx4 v[232:235], v2, s[4:7], s83 offen offset:2048 nt
  buffer_load_dwordx4 v[236:239], v2, s[4:7], s83 offen offset:3072 nt
  v_add_f32_dpp v32, v32, v32 row_ror:8 row_mask:0xf bank_mask:0x3
  v_add_f32_dpp v33, v33, v33 row_ror:8 row_mask:0xf bank_mask:0x3
  v_add_f32_dpp v36, v36, v36 row_ror:8 row_mask:0xf bank_mask:0x3
  v_add_f32_dpp v37, v37, v37 row_ror:8 row_mask:0xf bank_mask:0x3
  v_add_f32_dpp v32, v34, v34 row_ror:8 row_mask:0xf bank_mask:0xc
  v_add_f32_dpp v33, v35, v35 row_ror:8 row_mask:0xf bank_mask:0xc
  v_add_f32_dpp v36, v38, v38 row_ror:8 row_mask:0xf bank_mask:0xc
  v_add_f32_dpp v37, v39, v39 row_ror:8 row_mask:0xf bank_mask:0xc
  v_add_f32_dpp v32, v32, v32 row_shl:4 row_mask:0xf bank_mask:0x5
  v_add_f32_dpp v33, v33, v33 row_shl:4 row_mask:0xf bank_mask:0x5
  s_nop 0
  v_add_f32_dpp v32, v36, v36 row_shr:4 row_mask:0xf bank_mask:0xa
  v_add_f32_dpp v33, v37, v37 row_shr:4 row_mask:0xf bank_mask:0xa
  s_nop 0
  v_add_f32_dpp v32, v32, v32 quad_perm:[1,0,3,2] row_mask:0xf bank_mask:0xf
  v_add_f32_dpp v33, v33, v33 quad_perm:[1,0,3,2] row_mask:0xf bank_mask:0xf
  s_nop 0
  v_add_f32_dpp v32, v32, v32 quad_perm:[2,3,0,1] row_mask:0xf bank_mask:0xf
  v_add_f32_dpp v33, v33, v33 quad_perm:[2,3,0,1] row_mask:0xf bank_mask:0xf
  v_cvt_pk_bf16_f32 v34, v32, v33
  v_lshlrev_b32 v32, 16, v34
  v_and_b32 v33, s87, v34
  v_mul_f32 v32, s88, v32
  v_mul_f32 v33, s88, v33
  v_cvt_pk_bf16_f32 v34, v32, v33
  v_lshlrev_b32 v32, 16, v34
  v_and_b32 v33, s87, v34
  v_fma_f32 v32, v32, s89, -v3
  v_fma_f32 v33, v33, s89, -v3
  v_max_f32 v35, v32, v33
  v_cmp_lt_f32 vcc, 0x41000000, v35
  v_exp_f32 v37, v32
  v_exp_f32 v38, v33
  s_cmp_eq_u64 vcc, 0
  s_cbranch_scc1 K1_LZ13A
  v_max_f32_dpp v35, v35, v35 row_ror:8 row_mask:0xf bank_mask:0xf
  v_max_f32 v35, 0, v35
  v_exp_f32 v36, -v35
  v_add_f32 v3, v3, v35
  v_sub_f32 v32, v32, v35
  v_sub_f32 v33, v33, v35
  v_exp_f32 v37, v32
  v_exp_f32 v38, v33
  v_mul_f32 v4, v4, v36
  v_mul_f32_dpp v16, v36, v16 row_newbcast:0 row_mask:0xf bank_mask:0xf
  v_mul_f32_dpp v17, v36, v17 row_newbcast:0 row_mask:0xf bank_mask:0xf
  v_mul_f32_dpp v18, v36, v18 row_newbcast:0 row_mask:0xf bank_mask:0xf
  v_mul_f32_dpp v19, v36, v19 row_newbcast:0 row_mask:0xf bank_mask:0xf
  v_mul_f32_dpp v20, v36, v20 row_newbcast:0 row_mask:0xf bank_mask:0xf
  v_mul_f32_dpp v21, v36, v21 row_newbcast:0 row_mask:0xf bank_mask:0xf
  v_mul_f32_dpp v22, v36, v22 row_newbcast:0 row_mask:0xf bank_mask:0xf
  v_mul_f32_dpp v23, v36, v23 row_newbcast:0 row_mask:0xf bank_mask:0xf
  v_mul_f32_dpp v24, v36, v24 row_newbcast:4 row_mask:0xf bank_mask:0xf
  v_mul_f32_dpp v25, v36, v25 row_newbcast:4 row_mask:0xf bank_mask:0xf
  v_mul_f32_dpp v26, v36, v26 row_newbcast:4 row_mask:0xf bank_mask:0xf
  v_mul_f32_dpp v27, v36, v27 row_newbcast:4 row_mask:0xf bank_mask:0xf
  v_mul_f32_dpp v28, v36, v28 row_newbcast:4 row_mask:0xf bank_mask:0xf
  v_mul_f32_dpp v29, v36, v29 row_newbcast:4 row_mask:0xf bank_mask:0xf
  v_mul_f32_dpp v30, v36, v30 row_newbcast:4 row_mask:0xf bank_mask:0xf
  v_mul_f32_dpp v31, v36, v31 row_newbcast:4 row_mask:0xf bank_mask:0xf
K1_LZ13A:
  s_nop 1
  v_add_f32 v4, v4, v37
  v_cvt_pk_bf16_f32 v44, v37, v38
  v_add_f32 v4, v4, v38
  s_waitcnt vmcnt(20)
  v_perm_b32 v40, v244, v240, s85
  v_perm_b32 v41, v244, v240, s86
  v_perm_b32 v42, v245, v241, s85
  v_perm_b32 v43, v245, v241, s86
  v_dot2c_f32_bf16_dpp v16, v44, v40 row_newbcast:0 row_mask:0xf bank_mask:0xf
  v_dot2c_f32_bf16_dpp v17, v44, v41 row_newbcast:0 row_mask:0xf bank_mask:0xf
  v_dot2c_f32_bf16_dpp v18, v44, v42 row_newbcast:0 row_mask:0xf bank_mask:0xf
  v_dot2c_f32_bf16_dpp v19, v44, v43 row_newbcast:0 row_mask:0xf bank_mask:0xf
  v_dot2c_f32_bf16_dpp v24, v44, v40 row_newbcast:4 row_mask:0xf bank_mask:0xf
  v_dot2c_f32_bf16_dpp v25, v44, v41 row_newbcast:4 row_mask:0xf bank_mask:0xf
  v_dot2c_f32_bf16_dpp v26, v44, v42 row_newbcast:4 row_mask:0xf bank_mask:0xf
  v_dot2c_f32_bf16_dpp v27, v44, v43 row_newbcast:4 row_mask:0xf bank_mask:0xf
  v_perm_b32 v40, v246, v242, s85
  v_perm_b32 v41, v246, v242, s86
  v_perm_b32 v42, v247, v243, s85
  v_perm_b32 v43, v247, v243, s86
  v_dot2c_f32_bf16_dpp v20, v44, v40 row_newbcast:0 row_mask:0xf bank_mask:0xf
  v_dot2c_f32_bf16_dpp v21, v44, v41 row_newbcast:0 row_mask:0xf bank_mask:0xf
  v_dot2c_f32_bf16_dpp v22, v44, v42 row_newbcast:0 row_mask:0xf bank_mask:0xf
  v_dot2c_f32_bf16_dpp v23, v44, v43 row_newbcast:0 row_mask:0xf bank_mask:0xf
  v_dot2c_f32_bf16_dpp v28, v44, v40 row_newbcast:4 row_mask:0xf bank_mask:0xf
  v_dot2c_f32_bf16_dpp v29, v44, v41 row_newbcast:4 row_mask:0xf bank_mask:0xf
  v_dot2c_f32_bf16_dpp v30, v44, v42 row_newbcast:4 row_mask:0xf bank_mask:0xf
  v_dot2c_f32_bf16_dpp v31, v44, v43 row_newbcast:4 row_mask:0xf bank_mask:0xf
  v_perm_b32 v40, v252, v248, s85
  v_perm_b32 v41, v252, v248, s86
  v_perm_b32 v42, v253, v249, s85
  v_perm_b32 v43, v253, v249, s86
  v_dot2c_f32_bf16_dpp v16, v44, v40 row_newbcast:8 row_mask:0xf bank_mask:0xf
  v_dot2c_f32_bf16_dpp v17, v44, v41 row_newbcast:8 row_mask:0xf bank_mask:0xf
  v_dot2c_f32_bf16_dpp v18, v44, v42 row_newbcast:8 row_mask:0xf bank_mask:0xf
  v_dot2c_f32_bf16_dpp v19, v44, v43 row_newbcast:8 row_mask:0xf bank_mask:0xf
  v_dot2c_f32_bf16_dpp v24, v44, v40 row_newbcast:12 row_mask:0xf bank_mask:0xf
  v_dot2c_f32_bf16_dpp v25, v44, v41 row_newbcast:12 row_mask:0xf bank_mask:0xf
  v_dot2c_f32_bf16_dpp v26, v44, v42 row_newbcast:12 row_mask:0xf bank_mask:0xf
  v_dot2c_f32_bf16_dpp v27, v44, v43 row_newbcast:12 row_mask:0xf bank_mask:0xf
  v_perm_b32 v40, v254, v250, s85
  v_perm_b32 v41, v254, v250, s86
  v_perm_b32 v42, v255, v251, s85
  v_perm_b32 v43, v255, v251, s86
  v_dot2c_f32_bf16_dpp v20, v44, v40 row_newbcast:8 row_mask:0xf bank_mask:0xf
  v_dot2c_f32_bf16_dpp v21, v44, v41 row_newbcast:8 row_mask:0xf bank_mask:0xf
  v_dot2c_f32_bf16_dpp v22, v44, v42 row_newbcast:8 row_mask:0xf bank_mask:0xf
  v_dot2c_f32_bf16_dpp v23, v44, v43 row_newbcast:8 row_mask:0xf bank_mask:0xf
  v_dot2c_f32_bf16_dpp v28, v44, v40 row_newbcast:12 row_mask:0xf bank_mask:0xf
  v_dot2c_f32_bf16_dpp v29, v44, v41 row_newbcast:12 row_mask:0xf bank_mask:0xf
  v_dot2c_f32_bf16_dpp v30, v44, v42 row_newbcast:12 row_mask:0xf bank_mask:0xf
  v_dot2c_f32_bf16_dpp v31, v44, v43 row_newbcast:12 row_mask:0xf bank_mask:0xf
  s_mov_b32 s83, 491520
  buffer_load_dwordx4 v[240:243], v2, s[8:11], s83 offen offset:0 nt
  buffer_load_dwordx4 v[244:247], v2, s[8:11], s83 offen offset:1024 nt
  buffer_load_dwordx4 v[248:251], v2, s[8:11], s83 offen offset:2048 nt
  buffer_load_dwordx4 v[252:255], v2, s[8:11], s83 offen offset:3072 nt
  s_waitcnt vmcnt(22)
  v_perm_b32 v155, v164, v160, s85
  v_perm_b32 v164, v164, v160, s86
  v_perm_b32 v160, v165, v161, s85
  v_perm_b32 v165, v165, v161, s86
  v_perm_b32 v161, v166, v162, s85
  v_perm_b32 v166, v166, v162, s86
  v_perm_b32 v162, v167, v163, s85
  v_perm_b32 v167, v167, v163, s86
  s_waitcnt vmcnt(20)
  v_perm_b32 v163, v172, v168, s85
  v_perm_b32 v172, v172, v168, s86
  v_perm_b32 v168, v173, v169, s85
  v_perm_b32 v173, v173, v169, s86
  v_perm_b32 v169, v174, v170, s85
  v_perm_b32 v174, v174, v170, s86
  v_perm_b32 v170, v175, v171, s85
  v_perm_b32 v175, v175, v171, s86
  s_waitcnt vmcnt(16)
  v_dot2_f32_bf16 v32, v192, v8, 0
  v_dot2_f32_bf16 v36, v192, v12, 0
  v_dot2_f32_bf16 v33, v196, v8, 0
  v_dot2_f32_bf16 v37, v196, v12, 0
  v_dot2_f32_bf16 v34, v200, v8, 0
  v_dot2_f32_bf16 v38, v200, v12, 0
  v_dot2_f32_bf16 v35, v204, v8, 0
  v_dot2_f32_bf16 v39, v204, v12, 0
  v_dot2_f32_bf16 v32, v193, v9, v32
  v_dot2_f32_bf16 v36, v193, v13, v36
  v_dot2_f32_bf16 v33, v197, v9, v33
  v_dot2_f32_bf16 v37, v197, v13, v37
  v_dot2_f32_bf16 v34, v201, v9, v34
  v_dot2_f32_bf16 v38, v201, v13, v38
  v_dot2_f32_bf16 v35, v205, v9, v35
  v_dot2_f32_bf16 v39, v205, v13, v39
  v_dot2_f32_bf16 v32, v194, v10, v32
  v_dot2_f32_bf16 v36, v194, v14, v36
  v_dot2_f32_bf16 v33, v198, v10, v33
  v_dot2_f32_bf16 v37, v198, v14, v37
  v_dot2_f32_bf16 v34, v202, v10, v34
  v_dot2_f32_bf16 v38, v202, v14, v38
  v_dot2_f32_bf16 v35, v206, v10, v35
  v_dot2_f32_bf16 v39, v206, v14, v39
  v_dot2_f32_bf16 v32, v195, v11, v32
  v_dot2_f32_bf16 v36, v195, v15, v36
  v_dot2_f32_bf16 v33, v199, v11, v33
  v_dot2_f32_bf16 v37, v199, v15, v37
  v_dot2_f32_bf16 v34, v203, v11, v34
  v_dot2_f32_bf16 v38, v203, v15, v38
  v_dot2_f32_bf16 v35, v207, v11, v35
  v_dot2_f32_bf16 v39, v207, v15, v39
  v_add_f32_dpp v32, v32, v32 row_ror:8 row_mask:0xf bank_mask:0x3
  v_add_f32_dpp v33, v33, v33 row_ror:8 row_mask:0xf bank_mask:0x3
  v_add_f32_dpp v36, v36, v36 row_ror:8 row_mask:0xf bank_mask:0x3
  v_add_f32_dpp v37, v37, v37 row_ror:8 row_mask:0xf bank_mask:0x3
  v_add_f32_dpp v32, v34, v34 row_ror:8 row_mask:0xf bank_mask:0xc
  v_add_f32_dpp v33, v35, v35 row_ror:8 row_mask:0xf bank_mask:0xc
  v_add_f32_dpp v36, v38, v38 row_ror:8 row_mask:0xf bank_mask:0xc
  v_add_f32_dpp v37, v39, v39 row_ror:8 row_mask:0xf bank_mask:0xc
  v_add_f32_dpp v32, v32, v32 row_shl:4 row_mask:0xf bank_mask:0x5
  v_add_f32_dpp v33, v33, v33 row_shl:4 row_mask:0xf bank_mask:0x5
  s_nop 0
  v_add_f32_dpp v32, v36, v36 row_shr:4 row_mask:0xf bank_mask:0xa
  v_add_f32_dpp v33, v37, v37 row_shr:4 row_mask:0xf bank_mask:0xa
  s_nop 0
  v_add_f32_dpp v32, v32, v32 quad_perm:[1,0,3,2] row_mask:0xf bank_mask:0xf
  v_add_f32_dpp v33, v33, v33 quad_perm:[1,0,3,2] row_mask:0xf bank_mask:0xf
  s_nop 0
  v_add_f32_dpp v32, v32, v32 quad_perm:[2,3,0,1] row_mask:0xf bank_mask:0xf
  v_add_f32_dpp v33, v33, v33 quad_perm:[2,3,0,1] row_mask:0xf bank_mask:0xf
  v_cvt_pk_bf16_f32 v34, v32, v33
  v_lshlrev_b32 v32, 16, v34
  v_and_b32 v33, s87, v34
  v_mul_f32 v32, s88, v32
  v_mul_f32 v33, s88, v33
  v_cvt_pk_bf16_f32 v34, v32, v33
  v_lshlrev_b32 v32, 16, v34
  v_and_b32 v33, s87, v34
  v_fma_f32 v32, v32, s89, -v3
  v_fma_f32 v33, v33, s89, -v3
  v_max_f32 v35, v32, v33
  v_cmp_lt_f32 vcc, 0x41000000, v35
  v_exp_f32 v37, v32
  v_exp_f32 v38, v33
  s_cmp_eq_u64 vcc, 0
  s_cbranch_scc1 K1_LZ14A
  v_max_f32_dpp v35, v35, v35 row_ror:8 row_mask:0xf bank_mask:0xf
  v_max_f32 v35, 0, v35
  v_exp_f32 v36, -v35
  v_add_f32 v3, v3, v35
  v_sub_f32 v32, v32, v35
  v_sub_f32 v33, v33, v35
  v_exp_f32 v37, v32
  v_exp_f32 v38, v33
  v_mul_f32 v4, v4, v36
  v_mul_f32_dpp v16, v36, v16 row_newbcast:0 row_mask:0xf bank_mask:0xf
  v_mul_f32_dpp v17, v36, v17 row_newbcast:0 row_mask:0xf bank_mask:0xf
  v_mul_f32_dpp v18, v36, v18 row_newbcast:0 row_mask:0xf bank_mask:0xf
  v_mul_f32_dpp v19, v36, v19 row_newbcast:0 row_mask:0xf bank_mask:0xf
  v_mul_f32_dpp v20, v36, v20 row_newbcast:0 row_mask:0xf bank_mask:0xf
  v_mul_f32_dpp v21, v36, v21 row_newbcast:0 row_mask:0xf bank_mask:0xf
  v_mul_f32_dpp v22, v36, v22 row_newbcast:0 row_mask:0xf bank_mask:0xf
  v_mul_f32_dpp v23, v36, v23 row_newbcast:0 row_mask:0xf bank_mask:0xf
  v_mul_f32_dpp v24, v36, v24 row_newbcast:4 row_mask:0xf bank_mask:0xf
  v_mul_f32_dpp v25, v36, v25 row_newbcast:4 row_mask:0xf bank_mask:0xf
  v_mul_f32_dpp v26, v36, v26 row_newbcast:4 row_mask:0xf bank_mask:0xf
  v_mul_f32_dpp v27, v36, v27 row_newbcast:4 row_mask:0xf bank_mask:0xf
  v_mul_f32_dpp v28, v36, v28 row_newbcast:4 row_mask:0xf bank_mask:0xf
  v_mul_f32_dpp v29, v36, v29 row_newbcast:4 row_mask:0xf bank_mask:0xf
  v_mul_f32_dpp v30, v36, v30 row_newbcast:4 row_mask:0xf bank_mask:0xf
  v_mul_f32_dpp v31, v36, v31 row_newbcast:4 row_mask:0xf bank_mask:0xf
K1_LZ14A:
  s_nop 1
  v_add_f32 v4, v4, v37
  v_cvt_pk_bf16_f32 v44, v37, v38
  v_add_f32 v4, v4, v38
  s_waitcnt vmcnt(12)
  v_perm_b32 v40, v212, v208, s85
  v_perm_b32 v41, v212, v208, s86
  v_perm_b32 v42, v213, v209, s85
  v_perm_b32 v43, v213, v209, s86
  v_dot2c_f32_bf16_dpp v16, v44, v40 row_newbcast:0 row_mask:0xf bank_mask:0xf
  v_dot2c_f32_bf16_dpp v17, v44, v41 row_newbcast:0 row_mask:0xf bank_mask:0xf
  v_dot2c_f32_bf16_dpp v18, v44, v42 row_newbcast:0 row_mask:0xf bank_mask:0xf
  v_dot2c_f32_bf16_dpp v19, v44, v43 row_newbcast:0 row_mask:0xf bank_mask:0xf
  v_dot2c_f32_bf16_dpp v24, v44, v40 row_newbcast:4 row_mask:0xf bank_mask:0xf
  v_dot2c_f32_bf16_dpp v25, v44, v41 row_newbcast:4 row_mask:0xf bank_mask:0xf
  v_dot2c_f32_bf16_dpp v26, v44, v42 row_newbcast:4 row_mask:0xf bank_mask:0xf
  v_dot2c_f32_bf16_dpp v27, v44, v43 row_newbcast:4 row_mask:0xf bank_mask:0xf
  v_perm_b32 v40, v214, v210, s85
  v_perm_b32 v41, v214, v210, s86
  v_perm_b32 v42, v215, v211, s85
  v_perm_b32 v43, v215, v211, s86
  v_dot2c_f32_bf16_dpp v20, v44, v40 row_newbcast:0 row_mask:0xf bank_mask:0xf
  v_dot2c_f32_bf16_dpp v21, v44, v41 row_newbcast:0 row_mask:0xf bank_mask:0xf
  v_dot2c_f32_bf16_dpp v22, v44, v42 row_newbcast:0 row_mask:0xf bank_mask:0xf
  v_dot2c_f32_bf16_dpp v23, v44, v43 row_newbcast:0 row_mask:0xf bank_mask:0xf
  v_dot2c_f32_bf16_dpp v28, v44, v40 row_newbcast:4 row_mask:0xf bank_mask:0xf
  v_dot2c_f32_bf16_dpp v29, v44, v41 row_newbcast:4 row_mask:0xf bank_mask:0xf
  v_dot2c_f32_bf16_dpp v30, v44, v42 row_newbcast:4 row_mask:0xf bank_mask:0xf
  v_dot2c_f32_bf16_dpp v31, v44, v43 row_newbcast:4 row_mask:0xf bank_mask:0xf
  v_perm_b32 v40, v220, v216, s85
  v_perm_b32 v41, v220, v216, s86
  v_perm_b32 v42, v221, v217, s85
  v_perm_b32 v43, v221, v217, s86
  v_dot2c_f32_bf16_dpp v16, v44, v40 row_newbcast:8 row_mask:0xf bank_mask:0xf
  v_dot2c_f32_bf16_dpp v17, v44, v41 row_newbcast:8 row_mask:0xf bank_mask:0xf
  v_dot2c_f32_bf16_dpp v18, v44, v42 row_newbcast:8 row_mask:0xf bank_mask:0xf
  v_dot2c_f32_bf16_dpp v19, v44, v43 row_newbcast:8 row_mask:0xf bank_mask:0xf
  v_dot2c_f32_bf16_dpp v24, v44, v40 row_newbcast:12 row_mask:0xf bank_mask:0xf
  v_dot2c_f32_bf16_dpp v25, v44, v41 row_newbcast:12 row_mask:0xf bank_mask:0xf
  v_dot2c_f32_bf16_dpp v26, v44, v42 row_newbcast:12 row_mask:0xf bank_mask:0xf
  v_dot2c_f32_bf16_dpp v27, v44, v43 row_newbcast:12 row_mask:0xf bank_mask:0xf
  v_perm_b32 v40, v222, v218, s85
  v_perm_b32 v41, v222, v218, s86
  v_perm_b32 v42, v223, v219, s85
  v_perm_b32 v43, v223, v219, s86
  v_dot2c_f32_bf16_dpp v20, v44, v40 row_newbcast:8 row_mask:0xf bank_mask:0xf
  v_dot2c_f32_bf16_dpp v21, v44, v41 row_newbcast:8 row_mask:0xf bank_mask:0xf
  v_dot2c_f32_bf16_dpp v22, v44, v42 row_newbcast:8 row_mask:0xf bank_mask:0xf
  v_dot2c_f32_bf16_dpp v23, v44, v43 row_newbcast:8 row_mask:0xf bank_mask:0xf
  v_dot2c_f32_bf16_dpp v28, v44, v40 row_newbcast:12 row_mask:0xf bank_mask:0xf
  v_dot2c_f32_bf16_dpp v29, v44, v41 row_newbcast:12 row_mask:0xf bank_mask:0xf
  v_dot2c_f32_bf16_dpp v30, v44, v42 row_newbcast:12 row_mask:0xf bank_mask:0xf
  v_dot2c_f32_bf16_dpp v31, v44, v43 row_newbcast:12 row_mask:0xf bank_mask:0xf
  s_waitcnt vmcnt(10)
  v_perm_b32 v171, v180, v176, s85
  v_perm_b32 v180, v180, v176, s86
  v_perm_b32 v176, v181, v177, s85
  v_perm_b32 v181, v181, v177, s86
  v_perm_b32 v177, v182, v178, s85
  v_perm_b32 v182, v182, v178, s86
  v_perm_b32 v178, v183, v179, s85
  v_perm_b32 v183, v183, v179, s86
  s_waitcnt vmcnt(8)
  v_perm_b32 v179, v188, v184, s85
  v_perm_b32 v188, v188, v184, s86
  v_perm_b32 v184, v189, v185, s85
  v_perm_b32 v189, v189, v185, s86
  v_perm_b32 v185, v190, v186, s85
  v_perm_b32 v190, v190, v186, s86
  v_perm_b32 v186, v191, v187, s85
  v_perm_b32 v191, v191, v187, s86
  v_and_b32 v5, 15, v1
  v_lshlrev_b32 v5, 5, v5
  v_bfe_u32 v6, v1, 4, 1
  v_lshl_add_u32 v5, v6, 4, v5
  v_lshrrev_b32 v6, 5, v1
  v_lshl_add_u32 v5, v6, 9, v5
  s_lshl_b32 s83, s82, 10
  s_add_u32 s83, s83, 147456
  v_add_u32 v207, s83, v5
  v_bfe_u32 v6, v1, 2, 1
  v_lshlrev_b32 v6, 5, v6
  s_lshl_b32 s83, s82, 2
  v_add_u32 v199, s83, v6
  v_lshrrev_b32 v5, 3, v1
  v_and_b32 v6, 7, v1
  s_lshl_b32 s83, s82, 7
  s_add_u32 s83, s83, 147456
  s_lshr_b32 s84, s82, 2
  s_lshl_b32 s84, s84, 5
  v_lshl_add_u32 v201, v6, 2, s84
  v_lshl_add_u32 v200, v5, 4, s83
  v_lshl_add_u32 v200, v6, 10, v200
  s_lshr_b32 s84, s84, 2
  v_mov_b32 v202, s84
  s_mul_i32 s83, s82, 2304
  v_lshlrev_b32 v6, 5, v6
  v_lshl_add_u32 v204, v5, 2, v6
  v_add_u32 v204, s83, v204
  v_lshl_add_u32 v203, v1, 5, s83
  v_lshlrev_b32 v206, 4, v0
  v_cmp_le_u32 vcc, 144, v0
  v_mov_b32 v5, 6912
  s_nop 0
  v_cndmask_b32 v205, 0, v5, vcc
  v_add_u32 v205, v205, v206
  s_waitcnt vmcnt(4)
  s_mov_b32 s24, s54
  s_mov_b32 s25, s55
  s_mov_b32 s26, 2
  s_mov_b32 s27, 0x20000
  v_mov_b32 v7, 0
  buffer_load_ushort v192, v7, s[24:27], 0 offen
  s_mul_i32 s83, s90, 18
  s_add_u32 s20, s36, s83
  s_addc_u32 s21, s37, 0
  s_mov_b32 s22, 18
  s_mov_b32 s23, 0x20000
  v_lshrrev_b32 v196, 2, v1
  v_and_b32 v195, 7, v1
  v_cmp_eq_u32 vcc, 0, v195
  v_mov_b32 v195, 16
  s_nop 0
  v_cndmask_b32 v196, v195, v196, vcc
  buffer_load_ushort v193, v196, s[20:23], 0 offen
  s_mov_b32 s32, s58
  s_mov_b32 s33, s59
  s_mov_b32 s34, 256
  s_mov_b32 s35, 0x20000
  v_lshlrev_b32 v195, 2, v1
  buffer_load_dword v194, v195, s[32:35], 0 offen sc1
  v_dot2_f32_bf16 v32, v224, v8, 0
  v_dot2_f32_bf16 v36, v224, v12, 0
  v_dot2_f32_bf16 v33, v228, v8, 0
  v_dot2_f32_bf16 v37, v228, v12, 0
  v_dot2_f32_bf16 v34, v232, v8, 0
  v_dot2_f32_bf16 v38, v232, v12, 0
  v_dot2_f32_bf16 v35, v236, v8, 0
  v_dot2_f32_bf16 v39, v236, v12, 0
  v_dot2_f32_bf16 v32, v225, v9, v32
  v_dot2_f32_bf16 v36, v225, v13, v36
  v_dot2_f32_bf16 v33, v229, v9, v33
  v_dot2_f32_bf16 v37, v229, v13, v37
  v_dot2_f32_bf16 v34, v233, v9, v34
  v_dot2_f32_bf16 v38, v233, v13, v38
  v_dot2_f32_bf16 v35, v237, v9, v35
  v_dot2_f32_bf16 v39, v237, v13, v39
  v_dot2_f32_bf16 v32, v226, v10, v32
  v_dot2_f32_bf16 v36, v226, v14, v36
  v_dot2_f32_bf16 v33, v230, v10, v33
  v_dot2_f32_bf16 v37, v230, v14, v37
  v_dot2_f32_bf16 v34, v234, v10, v34
  v_dot2_f32_bf16 v38, v234, v14, v38
  v_dot2_f32_bf16 v35, v238, v10, v35
  v_dot2_f32_bf16 v39, v238, v14, v39
  v_dot2_f32_bf16 v32, v227, v11, v32
  v_dot2_f32_bf16 v36, v227, v15, v36
  v_dot2_f32_bf16 v33, v231, v11, v33
  v_dot2_f32_bf16 v37, v231, v15, v37
  v_dot2_f32_bf16 v34, v235, v11, v34
  v_dot2_f32_bf16 v38, v235, v15, v38
  v_dot2_f32_bf16 v35, v239, v11, v35
  v_dot2_f32_bf16 v39, v239, v15, v39
  v_add_f32_dpp v32, v32, v32 row_ror:8 row_mask:0xf bank_mask:0x3
  v_add_f32_dpp v33, v33, v33 row_ror:8 row_mask:0xf bank_mask:0x3
  v_add_f32_dpp v36, v36, v36 row_ror:8 row_mask:0xf bank_mask:0x3
  v_add_f32_dpp v37, v37, v37 row_ror:8 row_mask:0xf bank_mask:0x3
  v_add_f32_dpp v32, v34, v34 row_ror:8 row_mask:0xf bank_mask:0xc
  v_add_f32_dpp v33, v35, v35 row_ror:8 row_mask:0xf bank_mask:0xc
  v_add_f32_dpp v36, v38, v38 row_ror:8 row_mask:0xf bank_mask:0xc
  v_add_f32_dpp v37, v39, v39 row_ror:8 row_mask:0xf bank_mask:0xc
  v_add_f32_dpp v32, v32, v32 row_shl:4 row_mask:0xf bank_mask:0x5
  v_add_f32_dpp v33, v33, v33 row_shl:4 row_mask:0xf bank_mask:0x5
  s_nop 0
  v_add_f32_dpp v32, v36, v36 row_shr:4 row_mask:0xf bank_mask:0xa
  v_add_f32_dpp v33, v37, v37 row_shr:4 row_mask:0xf bank_mask:0xa
  s_nop 0
  v_add_f32_dpp v32, v32, v32 quad_perm:[1,0,3,2] row_mask:0xf bank_mask:0xf
  v_add_f32_dpp v33, v33, v33 quad_perm:[1,0,3,2] row_mask:0xf bank_mask:0xf
  s_nop 0
  v_add_f32_dpp v32, v32, v32 quad_perm:[2,3,0,1] row_mask:0xf bank_mask:0xf
  v_add_f32_dpp v33, v33, v33 quad_perm:[2,3,0,1] row_mask:0xf bank_mask:0xf
  v_cvt_pk_bf16_f32 v34, v32, v33
  v_lshlrev_b32 v32, 16, v34
  v_and_b32 v33, s87, v34
  v_mul_f32 v32, s88, v32
  v_mul_f32 v33, s88, v33
  v_cvt_pk_bf16_f32 v34, v32, v33
  v_lshlrev_b32 v32, 16, v34
  v_and_b32 v33, s87, v34
  v_max_f32 v35, v32, v33
  s_nop 1
  v_max_f32_dpp v35, v35, v35 row_ror:8 row_mask:0xf bank_mask:0xf
  v_mul_f32 v35, s89, v35
  v_max_f32 v35, v35, v3
  v_mov_b32 v37, v35
  s_nop 1
  v_permlane16_swap_b32 v35, v37
  v_max_f32 v35, v35, v37
  v_mov_b32 v37, v35
  s_nop 1
  v_permlane32_swap_b32 v35, v37
  v_max_f32 v35, v35, v37
  v_sub_f32 v36, v3, v35
  v_fma_f32 v32, v32, s89, -v35
  v_fma_f32 v33, v33, s89, -v35
  v_exp_f32 v36, v36
  v_exp_f32 v32, v32
  v_exp_f32 v33, v33
  v_mov_b32 v3, v35
  v_fma_f32 v4, v4, v36, v32
  v_cvt_pk_bf16_f32 v44, v32, v33
  v_add_f32 v4, v4, v33
  v_mul_f32_dpp v16, v36, v16 row_newbcast:0 row_mask:0xf bank_mask:0xf
  v_mul_f32_dpp v17, v36, v17 row_newbcast:0 row_mask:0xf bank_mask:0xf
  v_mul_f32_dpp v18, v36, v18 row_newbcast:0 row_mask:0xf bank_mask:0xf
  v_mul_f32_dpp v19, v36, v19 row_newbcast:0 row_mask:0xf bank_mask:0xf
  v_mul_f32_dpp v20, v36, v20 row_newbcast:0 row_mask:0xf bank_mask:0xf
  v_mul_f32_dpp v21, v36, v21 row_newbcast:0 row_mask:0xf bank_mask:0xf
  v_mul_f32_dpp v22, v36, v22 row_newbcast:0 row_mask:0xf bank_mask:0xf
  v_mul_f32_dpp v23, v36, v23 row_newbcast:0 row_mask:0xf bank_mask:0xf
  v_mul_f32_dpp v24, v36, v24 row_newbcast:4 row_mask:0xf bank_mask:0xf
  v_mul_f32_dpp v25, v36, v25 row_newbcast:4 row_mask:0xf bank_mask:0xf
  v_mul_f32_dpp v26, v36, v26 row_newbcast:4 row_mask:0xf bank_mask:0xf
  v_mul_f32_dpp v27, v36, v27 row_newbcast:4 row_mask:0xf bank_mask:0xf
  v_mul_f32_dpp v28, v36, v28 row_newbcast:4 row_mask:0xf bank_mask:0xf
  v_mul_f32_dpp v29, v36, v29 row_newbcast:4 row_mask:0xf bank_mask:0xf
  v_mul_f32_dpp v30, v36, v30 row_newbcast:4 row_mask:0xf bank_mask:0xf
  v_mul_f32_dpp v31, v36, v31 row_newbcast:4 row_mask:0xf bank_mask:0xf
  ds_write_b32 v199, v3 offset:9216
  v_add_f32_dpp v4, v4, v4 row_ror:8 row_mask:0xf bank_mask:0xf
  v_mov_b32 v37, v4
  s_nop 1
  v_permlane16_swap_b32 v4, v37
  v_add_f32 v4, v4, v37
  v_mov_b32 v37, v4
  s_nop 1
  v_permlane32_swap_b32 v4, v37
  v_add_f32 v4, v4, v37
  ds_write_b32 v199, v4 offset:9280
  s_waitcnt vmcnt(3)
  v_perm_b32 v40, v244, v240, s85
  v_perm_b32 v41, v244, v240, s86
  v_perm_b32 v42, v245, v241, s85
  v_perm_b32 v43, v245, v241, s86
  v_dot2c_f32_bf16_dpp v16, v44, v40 row_newbcast:0 row_mask:0xf bank_mask:0xf
  v_dot2c_f32_bf16_dpp v17, v44, v41 row_newbcast:0 row_mask:0xf bank_mask:0xf
  v_dot2c_f32_bf16_dpp v18, v44, v42 row_newbcast:0 row_mask:0xf bank_mask:0xf
  v_dot2c_f32_bf16_dpp v19, v44, v43 row_newbcast:0 row_mask:0xf bank_mask:0xf
  v_dot2c_f32_bf16_dpp v24, v44, v40 row_newbcast:4 row_mask:0xf bank_mask:0xf
  v_dot2c_f32_bf16_dpp v25, v44, v41 row_newbcast:4 row_mask:0xf bank_mask:0xf
  v_dot2c_f32_bf16_dpp v26, v44, v42 row_newbcast:4 row_mask:0xf bank_mask:0xf
  v_dot2c_f32_bf16_dpp v27, v44, v43 row_newbcast:4 row_mask:0xf bank_mask:0xf
  v_perm_b32 v40, v246, v242, s85
  v_perm_b32 v41, v246, v242, s86
  v_perm_b32 v42, v247, v243, s85
  v_perm_b32 v43, v247, v243, s86
  v_dot2c_f32_bf16_dpp v20, v44, v40 row_newbcast:0 row_mask:0xf bank_mask:0xf
  v_dot2c_f32_bf16_dpp v21, v44, v41 row_newbcast:0 row_mask:0xf bank_mask:0xf
  v_dot2c_f32_bf16_dpp v22, v44, v42 row_newbcast:0 row_mask:0xf bank_mask:0xf
  v_dot2c_f32_bf16_dpp v23, v44, v43 row_newbcast:0 row_mask:0xf bank_mask:0xf
  v_dot2c_f32_bf16_dpp v28, v44, v40 row_newbcast:4 row_mask:0xf bank_mask:0xf
  v_dot2c_f32_bf16_dpp v29, v44, v41 row_newbcast:4 row_mask:0xf bank_mask:0xf
  v_dot2c_f32_bf16_dpp v30, v44, v42 row_newbcast:4 row_mask:0xf bank_mask:0xf
  v_dot2c_f32_bf16_dpp v31, v44, v43 row_newbcast:4 row_mask:0xf bank_mask:0xf
  v_perm_b32 v40, v252, v248, s85
  v_perm_b32 v41, v252, v248, s86
  v_perm_b32 v42, v253, v249, s85
  v_perm_b32 v43, v253, v249, s86
  v_dot2c_f32_bf16_dpp v16, v44, v40 row_newbcast:8 row_mask:0xf bank_mask:0xf
  v_dot2c_f32_bf16_dpp v17, v44, v41 row_newbcast:8 row_mask:0xf bank_mask:0xf
  v_dot2c_f32_bf16_dpp v18, v44, v42 row_newbcast:8 row_mask:0xf bank_mask:0xf
  v_dot2c_f32_bf16_dpp v19, v44, v43 row_newbcast:8 row_mask:0xf bank_mask:0xf
  v_dot2c_f32_bf16_dpp v24, v44, v40 row_newbcast:12 row_mask:0xf bank_mask:0xf
  v_dot2c_f32_bf16_dpp v25, v44, v41 row_newbcast:12 row_mask:0xf bank_mask:0xf
  v_dot2c_f32_bf16_dpp v26, v44, v42 row_newbcast:12 row_mask:0xf bank_mask:0xf
  v_dot2c_f32_bf16_dpp v27, v44, v43 row_newbcast:12 row_mask:0xf bank_mask:0xf
  v_perm_b32 v40, v254, v250, s85
  v_perm_b32 v41, v254, v250, s86
  v_perm_b32 v42, v255, v251, s85
  v_perm_b32 v43, v255, v251, s86
  v_dot2c_f32_bf16_dpp v20, v44, v40 row_newbcast:8 row_mask:0xf bank_mask:0xf
  v_dot2c_f32_bf16_dpp v21, v44, v41 row_newbcast:8 row_mask:0xf bank_mask:0xf
  v_dot2c_f32_bf16_dpp v22, v44, v42 row_newbcast:8 row_mask:0xf bank_mask:0xf
  v_dot2c_f32_bf16_dpp v23, v44, v43 row_newbcast:8 row_mask:0xf bank_mask:0xf
  v_dot2c_f32_bf16_dpp v28, v44, v40 row_newbcast:12 row_mask:0xf bank_mask:0xf
  v_dot2c_f32_bf16_dpp v29, v44, v41 row_newbcast:12 row_mask:0xf bank_mask:0xf
  v_dot2c_f32_bf16_dpp v30, v44, v42 row_newbcast:12 row_mask:0xf bank_mask:0xf
  v_dot2c_f32_bf16_dpp v31, v44, v43 row_newbcast:12 row_mask:0xf bank_mask:0xf
  v_permlane32_swap_b32 v16, v24
  v_permlane32_swap_b32 v17, v25
  v_permlane32_swap_b32 v18, v26
  v_permlane32_swap_b32 v19, v27
  v_permlane32_swap_b32 v20, v28
  v_permlane32_swap_b32 v21, v29
  v_permlane32_swap_b32 v22, v30
  v_permlane32_swap_b32 v23, v31
  v_add_f32 v16, v16, v24
  v_add_f32 v17, v17, v25
  v_add_f32 v18, v18, v26
  v_add_f32 v19, v19, v27
  v_add_f32 v20, v20, v28
  v_add_f32 v21, v21, v29
  v_add_f32 v22, v22, v30
  v_add_f32 v23, v23, v31
  v_permlane16_swap_b32 v16, v20
  v_permlane16_swap_b32 v17, v21
  v_permlane16_swap_b32 v18, v22
  v_permlane16_swap_b32 v19, v23
  v_add_f32 v16, v16, v20
  v_add_f32 v17, v17, v21
  v_add_f32 v18, v18, v22
  v_add_f32 v19, v19, v23
  ds_write_b128 v207, v[16:19]
  s_waitcnt lgkmcnt(0)
  s_barrier
  ds_read_b32 v240, v201 offset:9216
  ds_read_b32 v248, v201 offset:9280
  ds_read_b128 v[208:211], v200
  s_waitcnt lgkmcnt(2)
  v_max_f32_dpp v32, v240, v240 quad_perm:[1,0,3,2] row_mask:0xf bank_mask:0xf
  s_nop 1
  v_max_f32_dpp v32, v32, v32 quad_perm:[2,3,0,1] row_mask:0xf bank_mask:0xf
  s_nop 1
  v_max_f32_dpp v32, v32, v32 row_half_mirror row_mask:0xf bank_mask:0xf
  v_sub_f32 v240, v240, v32
  v_exp_f32 v240, v240
  s_waitcnt lgkmcnt(0)
  v_mul_f32 v33, v240, v248
  v_mul_f32 v34, v240, v208
  v_mul_f32 v35, v240, v209
  v_mul_f32 v36, v240, v210
  v_mul_f32 v37, v240, v211
  v_add_f32_dpp v34, v34, v34 quad_perm:[1,0,3,2] row_mask:0xf bank_mask:0xf
  v_add_f32_dpp v35, v35, v35 quad_perm:[1,0,3,2] row_mask:0xf bank_mask:0xf
  v_add_f32_dpp v36, v36, v36 quad_perm:[1,0,3,2] row_mask:0xf bank_mask:0xf
  v_add_f32_dpp v37, v37, v37 quad_perm:[1,0,3,2] row_mask:0xf bank_mask:0xf
  v_add_f32_dpp v33, v33, v33 quad_perm:[1,0,3,2] row_mask:0xf bank_mask:0xf
  v_add_f32_dpp v34, v34, v34 quad_perm:[2,3,0,1] row_mask:0xf bank_mask:0xf
  v_add_f32_dpp v35, v35, v35 quad_perm:[2,3,0,1] row_mask:0xf bank_mask:0xf
  v_add_f32_dpp v36, v36, v36 quad_perm:[2,3,0,1] row_mask:0xf bank_mask:0xf
  v_add_f32_dpp v37, v37, v37 quad_perm:[2,3,0,1] row_mask:0xf bank_mask:0xf
  v_add_f32_dpp v33, v33, v33 quad_perm:[2,3,0,1] row_mask:0xf bank_mask:0xf
  v_add_f32_dpp v34, v34, v34 row_half_mirror row_mask:0xf bank_mask:0xf
  v_add_f32_dpp v35, v35, v35 row_half_mirror row_mask:0xf bank_mask:0xf
  v_add_f32_dpp v36, v36, v36 row_half_mirror row_mask:0xf bank_mask:0xf
  v_add_f32_dpp v37, v37, v37 row_half_mirror row_mask:0xf bank_mask:0xf
  v_add_f32_dpp v33, v33, v33 row_half_mirror row_mask:0xf bank_mask:0xf
  v_cvt_pk_bf16_f32 v38, v34, v35
  v_cvt_pk_bf16_f32 v39, v36, v37
  v_readlane_b32 s64, v38, 0
  v_readlane_b32 s65, v39, 0
  v_readlane_b32 s66, v38, 8
  v_readlane_b32 s67, v39, 8
  v_readlane_b32 s68, v38, 16
  v_readlane_b32 s69, v39, 16
  v_readlane_b32 s70, v38, 24
  v_readlane_b32 s71, v39, 24
  v_readlane_b32 s72, v38, 32
  v_readlane_b32 s73, v39, 32
  v_readlane_b32 s74, v38, 40
  v_readlane_b32 s75, v39, 40
  v_readlane_b32 s76, v38, 48
  v_readlane_b32 s77, v39, 48
  v_readlane_b32 s78, v38, 56
  v_readlane_b32 s79, v39, 56
  ds_write_b64 v202, v[32:33] offset:9344
  v_dot2_f32_bf16 v24, v171, v38, 0
  v_dot2_f32_bf16 v25, v180, v38, 0
  v_dot2_f32_bf16 v26, v176, v38, 0
  v_dot2_f32_bf16 v27, v181, v38, 0
  v_dot2_f32_bf16 v28, v177, v38, 0
  v_dot2_f32_bf16 v29, v182, v38, 0
  v_dot2_f32_bf16 v30, v178, v38, 0
  v_dot2_f32_bf16 v31, v183, v38, 0
  v_dot2_f32_bf16 v24, v179, v39, v24
  v_dot2_f32_bf16 v25, v188, v39, v25
  v_dot2_f32_bf16 v26, v184, v39, v26
  v_dot2_f32_bf16 v27, v189, v39, v27
  v_dot2_f32_bf16 v28, v185, v39, v28
  v_dot2_f32_bf16 v29, v190, v39, v29
  v_dot2_f32_bf16 v30, v186, v39, v30
  v_dot2_f32_bf16 v31, v191, v39, v31
  v_dot2_f32_bf16 v16, v45, s64, 0
  v_dot2_f32_bf16 v17, v52, s64, 0
  v_dot2_f32_bf16 v18, v48, s64, 0
  v_dot2_f32_bf16 v19, v53, s64, 0
  v_dot2_f32_bf16 v20, v49, s64, 0
  v_dot2_f32_bf16 v21, v54, s64, 0
  v_dot2_f32_bf16 v22, v50, s64, 0
  v_dot2_f32_bf16 v23, v55, s64, 0
  v_dot2_f32_bf16 v16, v51, s65, v16
  v_dot2_f32_bf16 v17, v60, s65, v17
  v_dot2_f32_bf16 v18, v56, s65, v18
  v_dot2_f32_bf16 v19, v61, s65, v19
  v_dot2_f32_bf16 v20, v57, s65, v20
  v_dot2_f32_bf16 v21, v62, s65, v21
  v_dot2_f32_bf16 v22, v58, s65, v22
  v_dot2_f32_bf16 v23, v63, s65, v23
  v_dot2_f32_bf16 v16, v59, s66, v16
  v_dot2_f32_bf16 v17, v68, s66, v17
  v_dot2_f32_bf16 v18, v64, s66, v18
  v_dot2_f32_bf16 v19, v69, s66, v19
  v_dot2_f32_bf16 v20, v65, s66, v20
  v_dot2_f32_bf16 v21, v70, s66, v21
  v_dot2_f32_bf16 v22, v66, s66, v22
  v_dot2_f32_bf16 v23, v71, s66, v23
  v_dot2_f32_bf16 v16, v67, s67, v16
  v_dot2_f32_bf16 v17, v76, s67, v17
  v_dot2_f32_bf16 v18, v72, s67, v18
  v_dot2_f32_bf16 v19, v77, s67, v19
  v_dot2_f32_bf16 v20, v73, s67, v20
  v_dot2_f32_bf16 v21, v78, s67, v21
  v_dot2_f32_bf16 v22, v74, s67, v22
  v_dot2_f32_bf16 v23, v79, s67, v23
  v_dot2_f32_bf16 v16, v75, s68, v16
  v_dot2_f32_bf16 v17, v84, s68, v17
  v_dot2_f32_bf16 v18, v80, s68, v18
  v_dot2_f32_bf16 v19, v85, s68, v19
  v_dot2_f32_bf16 v20, v81, s68, v20
  v_dot2_f32_bf16 v21, v86, s68, v21
  v_dot2_f32_bf16 v22, v82, s68, v22
  v_dot2_f32_bf16 v23, v87, s68, v23
  v_dot2_f32_bf16 v16, v83, s69, v16
  v_dot2_f32_bf16 v17, v92, s69, v17
  v_dot2_f32_bf16 v18, v88, s69, v18
  v_dot2_f32_bf16 v19, v93, s69, v19
  v_dot2_f32_bf16 v20, v89, s69, v20
  v_dot2_f32_bf16 v21, v94, s69, v21
  v_dot2_f32_bf16 v22, v90, s69, v22
  v_dot2_f32_bf16 v23, v95, s69, v23
  v_dot2_f32_bf16 v16, v91, s70, v16
  v_dot2_f32_bf16 v17, v100, s70, v17
  v_dot2_f32_bf16 v18, v96, s70, v18
  v_dot2_f32_bf16 v19, v101, s70, v19
  v_dot2_f32_bf16 v20, v97, s70, v20
  v_dot2_f32_bf16 v21, v102, s70, v21
  v_dot2_f32_bf16 v22, v98, s70, v22
  v_dot2_f32_bf16 v23, v103, s70, v23
  v_dot2_f32_bf16 v16, v99, s71, v16
  v_dot2_f32_bf16 v17, v108, s71, v17
  v_dot2_f32_bf16 v18, v104, s71, v18
  v_dot2_f32_bf16 v19, v109, s71, v19
  v_dot2_f32_bf16 v20, v105, s71, v20
  v_dot2_f32_bf16 v21, v110, s71, v21
  v_dot2_f32_bf16 v22, v106, s71, v22
  v_dot2_f32_bf16 v23, v111, s71, v23
  v_dot2_f32_bf16 v16, v107, s72, v16
  v_dot2_f32_bf16 v17, v116, s72, v17
  v_dot2_f32_bf16 v18, v112, s72, v18
  v_dot2_f32_bf16 v19, v117, s72, v19
  v_dot2_f32_bf16 v20, v113, s72, v20
  v_dot2_f32_bf16 v21, v118, s72, v21
  v_dot2_f32_bf16 v22, v114, s72, v22
  v_dot2_f32_bf16 v23, v119, s72, v23
  v_dot2_f32_bf16 v16, v115, s73, v16
  v_dot2_f32_bf16 v17, v124, s73, v17
  v_dot2_f32_bf16 v18, v120, s73, v18
  v_dot2_f32_bf16 v19, v125, s73, v19
  v_dot2_f32_bf16 v20, v121, s73, v20
  v_dot2_f32_bf16 v21, v126, s73, v21
  v_dot2_f32_bf16 v22, v122, s73, v22
  v_dot2_f32_bf16 v23, v127, s73, v23
  v_dot2_f32_bf16 v16, v123, s74, v16
  v_dot2_f32_bf16 v17, v132, s74, v17
  v_dot2_f32_bf16 v18, v128, s74, v18
  v_dot2_f32_bf16 v19, v133, s74, v19
  v_dot2_f32_bf16 v20, v129, s74, v20
  v_dot2_f32_bf16 v21, v134, s74, v21
  v_dot2_f32_bf16 v22, v130, s74, v22
  v_dot2_f32_bf16 v23, v135, s74, v23
  v_dot2_f32_bf16 v16, v131, s75, v16
  v_dot2_f32_bf16 v17, v140, s75, v17
  v_dot2_f32_bf16 v18, v136, s75, v18
  v_dot2_f32_bf16 v19, v141, s75, v19
  v_dot2_f32_bf16 v20, v137, s75, v20
  v_dot2_f32_bf16 v21, v142, s75, v21
  v_dot2_f32_bf16 v22, v138, s75, v22
  v_dot2_f32_bf16 v23, v143, s75, v23
  v_dot2_f32_bf16 v16, v139, s76, v16
  v_dot2_f32_bf16 v17, v148, s76, v17
  v_dot2_f32_bf16 v18, v144, s76, v18
  v_dot2_f32_bf16 v19, v149, s76, v19
  v_dot2_f32_bf16 v20, v145, s76, v20
  v_dot2_f32_bf16 v21, v150, s76, v21
  v_dot2_f32_bf16 v22, v146, s76, v22
  v_dot2_f32_bf16 v23, v151, s76, v23
  v_dot2_f32_bf16 v16, v147, s77, v16
  v_dot2_f32_bf16 v17, v156, s77, v17
  v_dot2_f32_bf16 v18, v152, s77, v18
  v_dot2_f32_bf16 v19, v157, s77, v19
  v_dot2_f32_bf16 v20, v153, s77, v20
  v_dot2_f32_bf16 v21, v158, s77, v21
  v_dot2_f32_bf16 v22, v154, s77, v22
  v_dot2_f32_bf16 v23, v159, s77, v23
  v_dot2_f32_bf16 v16, v155, s78, v16
  v_dot2_f32_bf16 v17, v164, s78, v17
  v_dot2_f32_bf16 v18, v160, s78, v18
  v_dot2_f32_bf16 v19, v165, s78, v19
  v_dot2_f32_bf16 v20, v161, s78, v20
  v_dot2_f32_bf16 v21, v166, s78, v21
  v_dot2_f32_bf16 v22, v162, s78, v22
  v_dot2_f32_bf16 v23, v167, s78, v23
  v_dot2_f32_bf16 v16, v163, s79, v16
  v_dot2_f32_bf16 v17, v172, s79, v17
  v_dot2_f32_bf16 v18, v168, s79, v18
  v_dot2_f32_bf16 v19, v173, s79, v19
  v_dot2_f32_bf16 v20, v169, s79, v20
  v_dot2_f32_bf16 v21, v174, s79, v21
  v_dot2_f32_bf16 v22, v170, s79, v22
  v_dot2_f32_bf16 v23, v175, s79, v23
  v_permlane32_swap_b32 v24, v28
  v_permlane32_swap_b32 v25, v29
  v_permlane32_swap_b32 v26, v30
  v_permlane32_swap_b32 v27, v31
  v_add_f32 v24, v24, v28
  v_add_f32 v25, v25, v29
  v_add_f32 v26, v26, v30
  v_add_f32 v27, v27, v31
  s_nop 0
  v_permlane16_swap_b32 v24, v26
  v_permlane16_swap_b32 v25, v27
  v_add_f32 v24, v24, v26
  v_add_f32 v25, v25, v27
  s_nop 0
  v_add_f32_dpp v24, v24, v24 row_ror:8 row_mask:0xf bank_mask:0x3
  s_nop 1
  v_add_f32_dpp v24, v25, v25 row_ror:8 row_mask:0xf bank_mask:0xc
  ds_write_b128 v203, v[16:19] offset:16384
  ds_write_b128 v203, v[20:23] offset:16400
  ds_write_b32 v204, v24 offset:18432
  s_waitcnt lgkmcnt(0)
  s_barrier
  s_cmp_ge_u32 s82, 5
  s_cbranch_scc1 K1_W5A
  v_cmp_gt_u32 vcc, 288, v0
  s_nop 0
  s_and_saveexec_b64 s[96:97], vcc
  ds_read_b128 v[208:211], v205 offset:16384
  ds_read_b128 v[212:215], v205 offset:18688
  ds_read_b128 v[216:219], v205 offset:20992
  ds_read_b128 v[220:223], v205 offset:23296
  s_waitcnt lgkmcnt(0)
  v_add_f32 v208, v208, v212
  v_add_f32 v216, v216, v220
  v_add_f32 v209, v209, v213
  v_add_f32 v217, v217, v221
  v_add_f32 v210, v210, v214
  v_add_f32 v218, v218, v222
  v_add_f32 v211, v211, v215
  v_add_f32 v219, v219, v223
  v_add_f32 v208, v208, v216
  v_add_f32 v209, v209, v217
  v_add_f32 v210, v210, v218
  v_add_f32 v211, v211, v219
  buffer_store_dwordx4 v[208:211], v206, s[28:31], 0 offen sc1
  s_branch K1_FINA
K1_W5A:
  s_nop 4
  s_cmp_lg_u32 s82, 5
  s_cbranch_scc1 K1_W6A
  s_mov_b64 exec, 1
  v_mov_b32 v5, 0
  ds_read_b128 v[208:211], v5 offset:9344
  s_waitcnt lgkmcnt(0)
  s_movk_i32 s83, 4608
  buffer_store_dwordx4 v[208:211], v5, s[28:31], s83 offen sc1
  s_branch K1_FINA
K1_W6A:
  s_nop 4
  s_cmp_lg_u32 s82, 6
  s_cbranch_scc1 K1_FINA
  v_lshlrev_b32 v5, 1, v196
  ds_read_b32 v208, v5 offset:8704
  ds_read_b32 v209, v5 offset:8768
  ds_read_b32 v210, v5 offset:8832
  ds_read_b32 v211, v5 offset:8896
  ds_read_b32 v212, v5 offset:8960
  ds_read_b32 v213, v5 offset:9024
  ds_read_b32 v214, v5 offset:9088
  ds_read_b32 v215, v5 offset:9152
  s_waitcnt lgkmcnt(0)
  v_add_f32 v208, v208, v212
  v_add_f32 v209, v209, v213
  v_add_f32 v210, v210, v214
  v_add_f32 v211, v211, v215
  v_add_f32 v208, v208, v210
  v_add_f32 v209, v209, v211
  v_add_f32 v208, v208, v209
  v_cvt_pk_bf16_f32 v208, v208, v208
  v_and_b32 v208, s87, v208
  s_waitcnt vmcnt(0)
  v_lshlrev_b32 v216, 16, v192
  v_add_f32 v208, v208, v216
  v_cvt_pk_bf16_f32 v208, v208, v208
  v_and_b32 v208, s87, v208
  v_mul_f32 v209, s89, v208
  v_exp_f32 v209, -v209
  s_nop 0
  v_add_f32 v209, 1.0, v209
  v_rcp_f32 v210, v209
  s_nop 0
  v_mul_f32 v211, v208, v210
  v_fma_f32 v212, -v211, v209, v208
  v_fma_f32 v211, v212, v210, v211
  v_cvt_pk_bf16_f32 v211, v211, v211
  v_and_b32 v211, s87, v211
  v_mov_b32 v197, v211
  s_mov_b64 exec, -1
  v_mul_u32_u24 v5, 5120, v1
  s_mul_i32 s84, s81, 36
  v_add_u32 v6, s84, v5
  s_mul_i32 s83, s80, 327680
  s_add_u32 s28, s60, s83
  s_addc_u32 s29, s61, 0
  s_mov_b32 s30, 327680
  s_mov_b32 s31, 0x20000
  s_mul_i32 s83, s90, 18
  s_add_u32 s24, s56, s83
  s_addc_u32 s25, s57, 0
  s_mov_b32 s26, 18
  s_mov_b32 s27, 0x20000
  v_and_b32 v7, 7, v1
  v_cmp_eq_u32 s[96:97], 2, v7
  s_mov_b32 s91, 0
K1_STA:
  s_nop 4
  v_cndmask_b32 v198, 0, v194, s[96:97]
  s_nop 1
  v_add_u32_dpp v198, v198, v198 row_ror:8 row_mask:0xf bank_mask:0xf
  s_nop 1
  v_add_u32_dpp v198, v198, v198 row_ror:4 row_mask:0xf bank_mask:0xf
  s_nop 1
  v_add_u32_dpp v198, v198, v198 row_ror:2 row_mask:0xf bank_mask:0xf
  s_nop 1
  v_add_u32_dpp v198, v198, v198 row_ror:1 row_mask:0xf bank_mask:0xf
  v_mov_b32 v199, v198
  s_nop 1
  v_permlane16_swap_b32 v198, v199
  v_add_u32 v198, v198, v199
  v_mov_b32 v199, v198
  s_nop 1
  v_permlane32_swap_b32 v198, v199
  v_add_u32 v198, v198, v199
  s_nop 0
  v_readfirstlane_b32 s83, v198
  s_nop 1
  s_cmp_eq_u32 s83, 256
  s_cbranch_scc1 K1_STOKA
  s_add_u32 s91, s91, 1
  s_cmp_gt_u32 s91, 20000
  s_cbranch_scc1 K1_STOKA
  s_sleep 16
  buffer_load_dword v194, v195, s[32:35], 0 offen sc1
  s_waitcnt vmcnt(0)
  s_branch K1_STA
K1_STOKA:
  s_nop 4
  s_mov_b64 s[96:97], -1
  s_movk_i32 s84, 4608
K1_PLA:
  s_nop 4
  s_mov_b64 exec, s[96:97]
  buffer_load_dwordx4 v[232:235], v5, s[28:31], s84 offen sc1
  buffer_load_dwordx4 v[208:211], v6, s[28:31], 0 offen sc1
  buffer_load_dwordx4 v[212:215], v6, s[28:31], 0 offen offset:16 sc1
  buffer_load_dword v216, v6, s[28:31], 0 offen offset:32 sc1
  buffer_load_dwordx4 v[220:223], v6, s[28:31], 0 offen offset:2304 sc1
  buffer_load_dwordx4 v[224:227], v6, s[28:31], 0 offen offset:2320 sc1
  buffer_load_dword v228, v6, s[28:31], 0 offen offset:2336 sc1
  s_waitcnt vmcnt(0)
  v_max3_u32 v198, v208, v209, v210
  v_max3_u32 v199, v211, v212, v213
  v_max3_u32 v198, v198, v214, v215
  v_max3_u32 v199, v199, v216, v220
  v_max3_u32 v198, v198, v221, v222
  v_max3_u32 v199, v199, v223, v224
  v_max3_u32 v198, v198, v225, v226
  v_max3_u32 v199, v199, v227, v228
  v_max3_u32 v198, v198, v232, v233
  v_max3_u32 v199, v199, v234, v235
  v_max_u32 v198, v198, v199
  v_cmp_eq_u32 s[96:97], -1, v198
  s_nop 1
  s_cmp_eq_u64 s[96:97], 0
  s_cbranch_scc1 K1_PDA
  s_add_u32 s91, s91, 1
  s_cmp_gt_u32 s91, 20000
  s_cbranch_scc1 K1_PDA
  s_bcnt1_i32_b64 s83, s[96:97]
  s_cmp_le_u32 s83, 8
  s_cbranch_scc1 K1_PSA
  s_sleep 24
K1_PSA:
  s_nop 4
  s_sleep 4
  s_branch K1_PLA
K1_PDA:
  s_nop 4
  s_mov_b64 exec, -1
  v_max_f32_dpp v242, v232, v232 quad_perm:[1,0,3,2] row_mask:0xf bank_mask:0xf
  s_nop 1
  v_max_f32_dpp v242, v242, v242 quad_perm:[2,3,0,1] row_mask:0xf bank_mask:0xf
  v_sub_f32 v242, v232, v242
  v_exp_f32 v240, v242
  s_nop 0
  v_mul_f32 v242, v240, v233
  s_nop 1
  v_add_f32_dpp v242, v242, v242 quad_perm:[1,0,3,2] row_mask:0xf bank_mask:0xf
  s_nop 1
  v_add_f32_dpp v242, v242, v242 quad_perm:[2,3,0,1] row_mask:0xf bank_mask:0xf
  v_rcp_f32 v242, v242
  s_nop 0
  v_mul_f32 v240, v240, v242
  v_max_f32_dpp v242, v234, v234 quad_perm:[1,0,3,2] row_mask:0xf bank_mask:0xf
  s_nop 1
  v_max_f32_dpp v242, v242, v242 quad_perm:[2,3,0,1] row_mask:0xf bank_mask:0xf
  v_sub_f32 v242, v234, v242
  v_exp_f32 v241, v242
  s_nop 0
  v_mul_f32 v242, v241, v235
  s_nop 1
  v_add_f32_dpp v242, v242, v242 quad_perm:[1,0,3,2] row_mask:0xf bank_mask:0xf
  s_nop 1
  v_add_f32_dpp v242, v242, v242 quad_perm:[2,3,0,1] row_mask:0xf bank_mask:0xf
  v_rcp_f32 v242, v242
  s_nop 0
  v_mul_f32 v241, v241, v242
  v_mul_f32 v208, v240, v208
  v_mul_f32 v209, v240, v209
  v_mul_f32 v210, v240, v210
  v_mul_f32 v211, v240, v211
  v_mul_f32 v212, v240, v212
  v_mul_f32 v213, v240, v213
  v_mul_f32 v214, v240, v214
  v_mul_f32 v215, v240, v215
  v_mul_f32 v216, v240, v216
  v_fmac_f32 v208, v241, v220
  v_fmac_f32 v209, v241, v221
  v_fmac_f32 v210, v241, v222
  v_fmac_f32 v211, v241, v223
  v_fmac_f32 v212, v241, v224
  v_fmac_f32 v213, v241, v225
  v_fmac_f32 v214, v241, v226
  v_fmac_f32 v215, v241, v227
  v_fmac_f32 v216, v241, v228
  v_mov_b32 v220, v216
  v_permlane32_swap_b32 v208, v212
  v_permlane32_swap_b32 v209, v213
  v_permlane32_swap_b32 v210, v214
  v_permlane32_swap_b32 v211, v215
  v_permlane32_swap_b32 v216, v220
  v_add_f32 v208, v208, v212
  v_add_f32 v209, v209, v213
  v_add_f32 v210, v210, v214
  v_add_f32 v211, v211, v215
  v_add_f32 v216, v216, v220
  v_mov_b32 v220, v216
  v_permlane16_swap_b32 v208, v210
  v_permlane16_swap_b32 v209, v211
  v_permlane16_swap_b32 v216, v220
  v_add_f32 v208, v208, v210
  v_add_f32 v209, v209, v211
  v_add_f32 v216, v216, v220
  v_and_b32 v242, 7, v1
  v_cmp_eq_u32 vcc, 0, v242
  v_add_f32_dpp v208, v208, v208 row_ror:8 row_mask:0xf bank_mask:0x3
  v_add_f32_dpp v216, v216, v216 row_ror:8 row_mask:0xf bank_mask:0xf
  s_nop 0
  v_add_f32_dpp v208, v209, v209 row_ror:8 row_mask:0xf bank_mask:0xc
  v_add_f32_dpp v216, v216, v216 quad_perm:[1,0,3,2] row_mask:0xf bank_mask:0xf
  s_nop 0
  v_add_f32_dpp v208, v208, v208 quad_perm:[1,0,3,2] row_mask:0xf bank_mask:0xf
  v_add_f32_dpp v216, v216, v216 quad_perm:[2,3,0,1] row_mask:0xf bank_mask:0xf
  s_nop 0
  v_add_f32_dpp v208, v208, v208 quad_perm:[2,3,0,1] row_mask:0xf bank_mask:0xf
  v_add_f32_dpp v216, v216, v216 row_half_mirror row_mask:0xf bank_mask:0xf
  s_nop 0
  v_add_f32_dpp v208, v208, v208 row_half_mirror row_mask:0xf bank_mask:0xf
  v_cndmask_b32 v208, v216, v208, vcc
  v_cvt_pk_bf16_f32 v208, v208, v208
  v_and_b32 v208, s87, v208
  v_mul_f32 v208, v208, v197
  v_cvt_pk_bf16_f32 v208, v208, v208
  v_and_b32 v208, s87, v208
  v_lshlrev_b32 v193, 16, v193
  v_add_f32 v208, v208, v193
  v_cvt_pk_bf16_f32 v208, v208, v208
  s_mov_b32 exec_lo, 0x01010103
  s_mov_b32 exec_hi, 0x01010101
  buffer_store_short v208, v196, s[24:27], 0 offen
K1_FINA:
  s_nop 4
  s_endpgm
K1_GB:
  s_nop 4
  s_mov_b32 s96, 0
  buffer_load_dwordx4 v[48:51], v7, s[12:15], s96 offen
  s_mov_b32 s96, 8192
  buffer_load_dwordx4 v[52:55], v7, s[12:15], s96 offen
  s_mov_b32 s96, 16384
  buffer_load_dwordx4 v[56:59], v7, s[12:15], s96 offen
  s_mov_b32 s96, 24576
  buffer_load_dwordx4 v[60:63], v7, s[12:15], s96 offen
  s_mov_b32 s96, 32768
  buffer_load_dwordx4 v[64:67], v7, s[12:15], s96 offen
  s_mov_b32 s96, 40960
  buffer_load_dwordx4 v[68:71], v7, s[12:15], s96 offen
  s_waitcnt vmcnt(6)
  v_lshlrev_b32 v16, 16, v16
  v_lshlrev_b32 v17, 16, v17
  v_lshlrev_b32 v18, 16, v18
  v_lshlrev_b32 v19, 16, v19
  v_lshlrev_b32 v20, 16, v20
  v_lshlrev_b32 v21, 16, v21
  v_lshlrev_b32 v22, 16, v22
  v_lshlrev_b32 v23, 16, v23
  v_lshlrev_b32 v24, 16, v24
  v_add_f32 v34, v16, v17
  v_add_f32 v34, v34, v18
  v_add_f32 v34, v34, v19
  v_add_f32 v34, v34, v20
  v_add_f32 v34, v34, v21
  v_add_f32 v34, v34, v22
  v_add_f32 v34, v34, v23
  v_add_f32 v34, v34, v24
  s_nop 1
  v_add_f32_dpp v34, v34, v34 row_ror:8 row_mask:0xf bank_mask:0xf
  s_nop 1
  v_add_f32_dpp v34, v34, v34 row_ror:4 row_mask:0xf bank_mask:0xf
  s_nop 1
  v_add_f32_dpp v34, v34, v34 row_ror:2 row_mask:0xf bank_mask:0xf
  s_nop 1
  v_add_f32_dpp v34, v34, v34 row_ror:1 row_mask:0xf bank_mask:0xf
  v_mov_b32 v35, v34
  s_nop 1
  v_permlane16_swap_b32 v34, v35
  v_add_f32 v34, v34, v35
  v_mov_b32 v35, v34
  s_nop 1
  v_permlane32_swap_b32 v34, v35
  v_add_f32 v34, v34, v35
  v_mul_f32 v36, 0x3ae38e39, v34
  v_sub_f32 v25, v16, v36
  v_sub_f32 v26, v17, v36
  v_sub_f32 v27, v18, v36
  v_sub_f32 v28, v19, v36
  v_sub_f32 v29, v20, v36
  v_sub_f32 v30, v21, v36
  v_sub_f32 v31, v22, v36
  v_sub_f32 v32, v23, v36
  v_sub_f32 v33, v24, v36
  v_mul_f32 v37, v25, v25
  v_fmac_f32 v37, v26, v26
  v_fmac_f32 v37, v27, v27
  v_fmac_f32 v37, v28, v28
  v_fmac_f32 v37, v29, v29
  v_fmac_f32 v37, v30, v30
  v_fmac_f32 v37, v31, v31
  v_fmac_f32 v37, v32, v32
  v_fmac_f32 v37, v33, v33
  s_nop 1
  v_add_f32_dpp v37, v37, v37 row_ror:8 row_mask:0xf bank_mask:0xf
  s_nop 1
  v_add_f32_dpp v37, v37, v37 row_ror:4 row_mask:0xf bank_mask:0xf
  s_nop 1
  v_add_f32_dpp v37, v37, v37 row_ror:2 row_mask:0xf bank_mask:0xf
  s_nop 1
  v_add_f32_dpp v37, v37, v37 row_ror:1 row_mask:0xf bank_mask:0xf
  v_mov_b32 v35, v37
  s_nop 1
  v_permlane16_swap_b32 v37, v35
  v_add_f32 v37, v37, v35
  v_mov_b32 v35, v37
  s_nop 1
  v_permlane32_swap_b32 v37, v35
  v_add_f32 v37, v37, v35
  v_mul_f32 v37, 0x3ae38e39, v37
  v_cvt_pk_bf16_f32 v35, v36, v37
  v_lshlrev_b32 v36, 16, v35
  v_and_b32 v37, s87, v35
  v_add_f32 v37, 0x3727c5ac, v37
  v_cvt_pk_bf16_f32 v37, v37, v37
  v_and_b32 v37, s87, v37
  v_sqrt_f32 v38, v37
  s_nop 0
  v_cvt_pk_bf16_f32 v38, v38, v38
  v_and_b32 v38, s87, v38
  v_rcp_f32 v39, v38
  v_sub_f32 v25, v16, v36
  v_sub_f32 v26, v17, v36
  v_sub_f32 v27, v18, v36
  v_sub_f32 v28, v19, v36
  v_sub_f32 v29, v20, v36
  v_sub_f32 v30, v21, v36
  v_sub_f32 v31, v22, v36
  v_sub_f32 v32, v23, v36
  v_sub_f32 v33, v24, v36
  v_cvt_pk_bf16_f32 v35, v25, v26
  v_lshlrev_b32 v25, 16, v35
  v_and_b32 v26, s87, v35
  v_cvt_pk_bf16_f32 v35, v27, v28
  v_lshlrev_b32 v27, 16, v35
  v_and_b32 v28, s87, v35
  v_cvt_pk_bf16_f32 v35, v29, v30
  v_lshlrev_b32 v29, 16, v35
  v_and_b32 v30, s87, v35
  v_cvt_pk_bf16_f32 v35, v31, v32
  v_lshlrev_b32 v31, 16, v35
  v_and_b32 v32, s87, v35
  v_cvt_pk_bf16_f32 v33, v33, v33
  v_and_b32 v33, s87, v33
  v_mul_f32 v34, v25, v39
  v_fma_f32 v35, -v34, v38, v25
  v_fma_f32 v25, v35, v39, v34
  v_mul_f32 v34, v26, v39
  v_fma_f32 v35, -v34, v38, v26
  v_fma_f32 v26, v35, v39, v34
  v_mul_f32 v34, v27, v39
  v_fma_f32 v35, -v34, v38, v27
  v_fma_f32 v27, v35, v39, v34
  v_mul_f32 v34, v28, v39
  v_fma_f32 v35, -v34, v38, v28
  v_fma_f32 v28, v35, v39, v34
  v_mul_f32 v34, v29, v39
  v_fma_f32 v35, -v34, v38, v29
  v_fma_f32 v29, v35, v39, v34
  v_mul_f32 v34, v30, v39
  v_fma_f32 v35, -v34, v38, v30
  v_fma_f32 v30, v35, v39, v34
  v_mul_f32 v34, v31, v39
  v_fma_f32 v35, -v34, v38, v31
  v_fma_f32 v31, v35, v39, v34
  v_mul_f32 v34, v32, v39
  v_fma_f32 v35, -v34, v38, v32
  v_fma_f32 v32, v35, v39, v34
  v_mul_f32 v34, v33, v39
  v_fma_f32 v35, -v34, v38, v33
  v_fma_f32 v33, v35, v39, v34
  v_cvt_pk_bf16_f32 v35, v25, v26
  v_lshlrev_b32 v25, 16, v35
  v_and_b32 v26, s87, v35
  v_cvt_pk_bf16_f32 v35, v27, v28
  v_lshlrev_b32 v27, 16, v35
  v_and_b32 v28, s87, v35
  v_cvt_pk_bf16_f32 v35, v29, v30
  v_lshlrev_b32 v29, 16, v35
  v_and_b32 v30, s87, v35
  v_cvt_pk_bf16_f32 v35, v31, v32
  v_lshlrev_b32 v31, 16, v35
  v_and_b32 v32, s87, v35
  v_cvt_pk_bf16_f32 v33, v33, v33
  v_and_b32 v33, s87, v33
  ds_write_b16_d16_hi v6, v25 offset:0
  ds_write_b16_d16_hi v6, v26 offset:2
  ds_write_b16_d16_hi v6, v27 offset:4
  ds_write_b16_d16_hi v6, v28 offset:6
  ds_write_b16_d16_hi v6, v29 offset:8
  ds_write_b16_d16_hi v6, v30 offset:10
  ds_write_b16_d16_hi v6, v31 offset:12
  ds_write_b16_d16_hi v6, v32 offset:14
  ds_write_b16_d16_hi v6, v33 offset:16
  s_waitcnt lgkmcnt(0)
  s_barrier
  v_mov_b32 v41, 0
  ds_read_b32 v40, v41 offset:9408
  s_waitcnt lgkmcnt(0)
  v_readfirstlane_b32 s101, v40
  s_mov_b32 s91, s62
  s_nop 1
  s_lshr_b32 s62, s101, 4
  s_and_b32 s62, s62, 15
  s_and_b32 s63, s101, 3
  s_bfe_u32 s80, s101, 131074
  s_lshl_b32 s81, s62, 2
  s_or_b32 s81, s81, s63
  s_lshl_b32 s90, s80, 6
  s_or_b32 s90, s90, s81
  s_lshl_b32 s83, s90, 19
  s_add_u32 s4, s38, s83
  s_addc_u32 s5, s39, 0
  s_mov_b32 s6, 524288
  s_mov_b32 s7, 0x20000
  s_add_u32 s8, s40, s83
  s_addc_u32 s9, s41, 0
  s_mov_b32 s10, 524288
  s_mov_b32 s11, 0x20000
  s_mul_i32 s83, s90, 5120
  s_add_u32 s28, s60, s83
  s_addc_u32 s29, s61, 0
  s_mov_b32 s30, 5120
  s_mov_b32 s31, 0x20000
  s_cmp_eq_u32 s91, s62
  s_cbranch_scc1 K1_GOB
  s_waitcnt vmcnt(0)
K1_RQ2B:
  s_nop 4
  s_lshl_b32 s83, s62, 9
  s_sub_u32 s84, 4718592, s83
  s_add_u32 s12, s42, s83
  s_addc_u32 s13, s43, 0
  s_mov_b32 s14, s84
  s_mov_b32 s15, 0x20000
  s_mov_b32 s96, 0
  buffer_load_dwordx4 v[48:51], v7, s[12:15], s96 offen
  s_mov_b32 s96, 8192
  buffer_load_dwordx4 v[52:55], v7, s[12:15], s96 offen
  s_mov_b32 s96, 16384
  buffer_load_dwordx4 v[56:59], v7, s[12:15], s96 offen
  s_mov_b32 s96, 24576
  buffer_load_dwordx4 v[60:63], v7, s[12:15], s96 offen
  s_mov_b32 s96, 32768
  buffer_load_dwordx4 v[64:67], v7, s[12:15], s96 offen
  s_mov_b32 s96, 40960
  buffer_load_dwordx4 v[68:71], v7, s[12:15], s96 offen
K1_GOB:
  s_nop 4
  s_mov_b32 s83, 0
  buffer_load_dwordx4 v[192:195], v2, s[4:7], s83 offen offset:0 nt
  s_mov_b32 s83, 0
  buffer_load_dwordx4 v[196:199], v2, s[4:7], s83 offen offset:1024 nt
  s_mov_b32 s83, 0
  buffer_load_dwordx4 v[200:203], v2, s[4:7], s83 offen offset:2048 nt
  s_mov_b32 s83, 0
  buffer_load_dwordx4 v[204:207], v2, s[4:7], s83 offen offset:3072 nt
  s_mov_b32 s83, 0
  buffer_load_dwordx4 v[208:211], v2, s[8:11], s83 offen offset:0 nt
  s_mov_b32 s83, 0
  buffer_load_dwordx4 v[212:215], v2, s[8:11], s83 offen offset:1024 nt
  s_mov_b32 s83, 0
  buffer_load_dwordx4 v[216:219], v2, s[8:11], s83 offen offset:2048 nt
  s_mov_b32 s83, 0
  buffer_load_dwordx4 v[220:223], v2, s[8:11], s83 offen offset:3072 nt
  s_mov_b32 s83, 32768
  buffer_load_dwordx4 v[224:227], v2, s[4:7], s83 offen offset:0 nt
  s_mov_b32 s83, 32768
  buffer_load_dwordx4 v[228:231], v2, s[4:7], s83 offen offset:1024 nt
  s_mov_b32 s83, 32768
  buffer_load_dwordx4 v[232:235], v2, s[4:7], s83 offen offset:2048 nt
  s_mov_b32 s83, 32768
  buffer_load_dwordx4 v[236:239], v2, s[4:7], s83 offen offset:3072 nt
  s_mov_b32 s83, 32768
  buffer_load_dwordx4 v[240:243], v2, s[8:11], s83 offen offset:0 nt
  s_mov_b32 s83, 32768
  buffer_load_dwordx4 v[244:247], v2, s[8:11], s83 offen offset:1024 nt
  s_mov_b32 s83, 32768
  buffer_load_dwordx4 v[248:251], v2, s[8:11], s83 offen offset:2048 nt
  s_mov_b32 s83, 32768
  buffer_load_dwordx4 v[252:255], v2, s[8:11], s83 offen offset:3072 nt
  s_lshl_b32 s84, s82, 14
  s_add_u32 s84, s84, 16384
  s_mov_b32 m0, s84
  s_mov_b32 s83, 65536
  buffer_load_dwordx4 v2, s[4:7], s83 offen offset:0 nt lds
  s_lshl_b32 s84, s82, 14
  s_add_u32 s84, s84, 16384
  s_mov_b32 m0, s84
  s_mov_b32 s83, 65536
  buffer_load_dwordx4 v2, s[4:7], s83 offen offset:1024 nt lds
  s_lshl_b32 s84, s82, 14
  s_add_u32 s84, s84, 16384
  s_mov_b32 m0, s84
  s_mov_b32 s83, 65536
  buffer_load_dwordx4 v2, s[4:7], s83 offen offset:2048 nt lds
  s_lshl_b32 s84, s82, 14
  s_add_u32 s84, s84, 16384
  s_mov_b32 m0, s84
  s_mov_b32 s83, 65536
  buffer_load_dwordx4 v2, s[4:7], s83 offen offset:3072 nt lds
  s_lshl_b32 s84, s82, 14
  s_add_u32 s84, s84, 20480
  s_mov_b32 m0, s84
  s_mov_b32 s83, 65536
  buffer_load_dwordx4 v2, s[8:11], s83 offen offset:0 nt lds
  s_lshl_b32 s84, s82, 14
  s_add_u32 s84, s84, 20480
  s_mov_b32 m0, s84
  s_mov_b32 s83, 65536
  buffer_load_dwordx4 v2, s[8:11], s83 offen offset:1024 nt lds
  s_lshl_b32 s84, s82, 14
  s_add_u32 s84, s84, 20480
  s_mov_b32 m0, s84
  s_mov_b32 s83, 65536
  buffer_load_dwordx4 v2, s[8:11], s83 offen offset:2048 nt lds
  s_lshl_b32 s84, s82, 14
  s_add_u32 s84, s84, 20480
  s_mov_b32 m0, s84
  s_mov_b32 s83, 65536
  buffer_load_dwordx4 v2, s[8:11], s83 offen offset:3072 nt lds
  s_lshl_b32 s84, s82, 14
  s_add_u32 s84, s84, 24576
  s_mov_b32 m0, s84
  s_mov_b32 s83, 98304
  buffer_load_dwordx4 v2, s[4:7], s83 offen offset:0 nt lds
  s_lshl_b32 s84, s82, 14
  s_add_u32 s84, s84, 24576
  s_mov_b32 m0, s84
  s_mov_b32 s83, 98304
  buffer_load_dwordx4 v2, s[4:7], s83 offen offset:1024 nt lds
  s_lshl_b32 s84, s82, 14
  s_add_u32 s84, s84, 24576
  s_mov_b32 m0, s84
  s_mov_b32 s83, 98304
  buffer_load_dwordx4 v2, s[4:7], s83 offen offset:2048 nt lds
  s_lshl_b32 s84, s82, 14
  s_add_u32 s84, s84, 24576
  s_mov_b32 m0, s84
  s_mov_b32 s83, 98304
  buffer_load_dwordx4 v2, s[4:7], s83 offen offset:3072 nt lds
  s_lshl_b32 s84, s82, 14
  s_add_u32 s84, s84, 28672
  s_mov_b32 m0, s84
  s_mov_b32 s83, 98304
  buffer_load_dwordx4 v2, s[8:11], s83 offen offset:0 nt lds
  s_lshl_b32 s84, s82, 14
  s_add_u32 s84, s84, 28672
  s_mov_b32 m0, s84
  s_mov_b32 s83, 98304
  buffer_load_dwordx4 v2, s[8:11], s83 offen offset:1024 nt lds
  s_lshl_b32 s84, s82, 14
  s_add_u32 s84, s84, 28672
  s_mov_b32 m0, s84
  s_mov_b32 s83, 98304
  buffer_load_dwordx4 v2, s[8:11], s83 offen offset:2048 nt lds
  s_lshl_b32 s84, s82, 14
  s_add_u32 s84, s84, 28672
  s_mov_b32 m0, s84
  s_mov_b32 s83, 98304
  buffer_load_dwordx4 v2, s[8:11], s83 offen offset:3072 nt lds
  s_mov_b32 s96, 49152
  buffer_load_dwordx4 v[72:75], v7, s[12:15], s96 offen
  s_mov_b32 s96, 57344
  buffer_load_dwordx4 v[76:79], v7, s[12:15], s96 offen
  s_mov_b32 s96, 65536
  buffer_load_dwordx4 v[80:83], v7, s[12:15], s96 offen
  s_mov_b32 s96, 73728
  buffer_load_dwordx4 v[84:87], v7, s[12:15], s96 offen
  s_mov_b32 s96, 81920
  buffer_load_dwordx4 v[88:91], v7, s[12:15], s96 offen
  s_mov_b32 s96, 90112
  buffer_load_dwordx4 v[92:95], v7, s[12:15], s96 offen
  s_mov_b32 s96, 98304
  buffer_load_dwordx4 v[96:99], v7, s[12:15], s96 offen
  s_mov_b32 s96, 106496
  buffer_load_dwordx4 v[100:103], v7, s[12:15], s96 offen
  s_mov_b32 s96, 114688
  buffer_load_dwordx4 v[104:107], v7, s[12:15], s96 offen
  s_mov_b32 s96, 122880
  buffer_load_dwordx4 v[108:111], v7, s[12:15], s96 offen
  s_mov_b32 s96, 131072
  buffer_load_dwordx4 v[112:115], v7, s[12:15], s96 offen
  s_mov_b32 s96, 139264
  buffer_load_dwordx4 v[116:119], v7, s[12:15], s96 offen
  s_mov_b32 s96, 147456
  buffer_load_dwordx4 v[120:123], v7, s[12:15], s96 offen
  s_mov_b32 s96, 155648
  buffer_load_dwordx4 v[124:127], v7, s[12:15], s96 offen
  s_mov_b32 s96, 163840
  buffer_load_dwordx4 v[128:131], v7, s[12:15], s96 offen
  s_mov_b32 s96, 172032
  buffer_load_dwordx4 v[132:135], v7, s[12:15], s96 offen
  s_mov_b32 s96, 180224
  buffer_load_dwordx4 v[136:139], v7, s[12:15], s96 offen
  s_mov_b32 s96, 188416
  buffer_load_dwordx4 v[140:143], v7, s[12:15], s96 offen
  s_mov_b32 s96, 196608
  buffer_load_dwordx4 v[144:147], v7, s[12:15], s96 offen
  s_mov_b32 s96, 204800
  buffer_load_dwordx4 v[148:151], v7, s[12:15], s96 offen
  s_mov_b32 s96, 212992
  buffer_load_dwordx4 v[152:155], v7, s[12:15], s96 offen
  s_mov_b32 s96, 221184
  buffer_load_dwordx4 v[156:159], v7, s[12:15], s96 offen
  s_mov_b32 s96, 229376
  buffer_load_dwordx4 v[160:163], v7, s[12:15], s96 offen
  s_mov_b32 s96, 237568
  buffer_load_dwordx4 v[164:167], v7, s[12:15], s96 offen
  s_waitcnt vmcnt(58)
  s_mov_b32 s96, 245760
  buffer_load_dwordx4 v[168:171], v7, s[12:15], s96 offen
  s_mov_b32 s96, 253952
  buffer_load_dwordx4 v[172:175], v7, s[12:15], s96 offen
  s_mov_b32 s96, 262144
  buffer_load_dwordx4 v[176:179], v7, s[12:15], s96 offen
  s_mov_b32 s96, 270336
  buffer_load_dwordx4 v[180:183], v7, s[12:15], s96 offen
  s_waitcnt vmcnt(58)
  s_mov_b32 s96, 278528
  buffer_load_dwordx4 v[184:187], v7, s[12:15], s96 offen
  s_mov_b32 s96, 286720
  buffer_load_dwordx4 v[188:191], v7, s[12:15], s96 offen
  s_mul_i32 s83, s62, 294912
  s_add_u32 s16, s44, s83
  s_addc_u32 s17, s45, 0
  s_mov_b32 s18, 294912
  s_mov_b32 s19, 0x20000
  s_mov_b32 s24, s48
  s_mov_b32 s25, s49
  s_mov_b32 s26, 9216
  s_mov_b32 s27, 0x20000
  s_mov_b32 s32, s50
  s_mov_b32 s33, s51
  s_mov_b32 s34, 9216
  s_mov_b32 s35, 0x20000
  s_mov_b32 s92, s52
  s_mov_b32 s93, s53
  s_mov_b32 s94, 9216
  s_mov_b32 s95, 0x20000
  v_lshrrev_b32 v5, 5, v0
  v_mul_u32_u24 v5, 72, v5
  s_mul_i32 s83, s80, 1152
  v_add_u32 v5, s83, v5
  ds_read_b64 v[16:17], v5 offset:0
  ds_read_b64 v[18:19], v5 offset:8
  ds_read_b64 v[20:21], v5 offset:16
  ds_read_b64 v[22:23], v5 offset:24
  ds_read_b64 v[24:25], v5 offset:32
  ds_read_b64 v[26:27], v5 offset:40
  ds_read_b64 v[28:29], v5 offset:48
  ds_read_b64 v[30:31], v5 offset:56
  ds_read_b64 v[32:33], v5 offset:64
  s_waitcnt lgkmcnt(0)
  v_perm_b32 v42, v52, v48, s85
  v_perm_b32 v43, v52, v48, s86
  v_perm_b32 v44, v53, v49, s85
  v_perm_b32 v45, v53, v49, s86
  v_dot2_f32_bf16 v34, v42, v16, 0
  v_dot2_f32_bf16 v35, v43, v16, 0
  v_dot2_f32_bf16 v36, v44, v16, 0
  v_dot2_f32_bf16 v37, v45, v16, 0
  v_perm_b32 v42, v54, v50, s85
  v_perm_b32 v43, v54, v50, s86
  v_perm_b32 v44, v55, v51, s85
  v_perm_b32 v45, v55, v51, s86
  v_dot2_f32_bf16 v38, v42, v16, 0
  v_dot2_f32_bf16 v39, v43, v16, 0
  v_dot2_f32_bf16 v40, v44, v16, 0
  v_dot2_f32_bf16 v41, v45, v16, 0
  v_perm_b32 v42, v60, v56, s85
  v_perm_b32 v43, v60, v56, s86
  v_perm_b32 v44, v61, v57, s85
  v_perm_b32 v45, v61, v57, s86
  v_dot2_f32_bf16 v34, v42, v17, v34
  v_dot2_f32_bf16 v35, v43, v17, v35
  v_dot2_f32_bf16 v36, v44, v17, v36
  v_dot2_f32_bf16 v37, v45, v17, v37
  v_perm_b32 v42, v62, v58, s85
  v_perm_b32 v43, v62, v58, s86
  v_perm_b32 v44, v63, v59, s85
  v_perm_b32 v45, v63, v59, s86
  v_dot2_f32_bf16 v38, v42, v17, v38
  v_dot2_f32_bf16 v39, v43, v17, v39
  v_dot2_f32_bf16 v40, v44, v17, v40
  v_dot2_f32_bf16 v41, v45, v17, v41
  v_perm_b32 v42, v68, v64, s85
  v_perm_b32 v43, v68, v64, s86
  v_perm_b32 v44, v69, v65, s85
  v_perm_b32 v45, v69, v65, s86
  v_dot2_f32_bf16 v34, v42, v18, v34
  v_dot2_f32_bf16 v35, v43, v18, v35
  v_dot2_f32_bf16 v36, v44, v18, v36
  v_dot2_f32_bf16 v37, v45, v18, v37
  v_perm_b32 v42, v70, v66, s85
  v_perm_b32 v43, v70, v66, s86
  v_perm_b32 v44, v71, v67, s85
  v_perm_b32 v45, v71, v67, s86
  v_dot2_f32_bf16 v38, v42, v18, v38
  v_dot2_f32_bf16 v39, v43, v18, v39
  v_dot2_f32_bf16 v40, v44, v18, v40
  v_dot2_f32_bf16 v41, v45, v18, v41
  s_waitcnt vmcnt(28)
  v_perm_b32 v42, v76, v72, s85
  v_perm_b32 v43, v76, v72, s86
  v_perm_b32 v44, v77, v73, s85
  v_perm_b32 v45, v77, v73, s86
  v_dot2_f32_bf16 v34, v42, v19, v34
  v_dot2_f32_bf16 v35, v43, v19, v35
  v_dot2_f32_bf16 v36, v44, v19, v36
  v_dot2_f32_bf16 v37, v45, v19, v37
  v_perm_b32 v42, v78, v74, s85
  v_perm_b32 v43, v78, v74, s86
  v_perm_b32 v44, v79, v75, s85
  v_perm_b32 v45, v79, v75, s86
  v_dot2_f32_bf16 v38, v42, v19, v38
  v_dot2_f32_bf16 v39, v43, v19, v39
  v_dot2_f32_bf16 v40, v44, v19, v40
  v_dot2_f32_bf16 v41, v45, v19, v41
  s_waitcnt vmcnt(26)
  v_perm_b32 v42, v84, v80, s85
  v_perm_b32 v43, v84, v80, s86
  v_perm_b32 v44, v85, v81, s85
  v_perm_b32 v45, v85, v81, s86
  v_dot2_f32_bf16 v34, v42, v20, v34
  v_dot2_f32_bf16 v35, v43, v20, v35
  v_dot2_f32_bf16 v36, v44, v20, v36
  v_dot2_f32_bf16 v37, v45, v20, v37
  v_perm_b32 v42, v86, v82, s85
  v_perm_b32 v43, v86, v82, s86
  v_perm_b32 v44, v87, v83, s85
  v_perm_b32 v45, v87, v83, s86
  v_dot2_f32_bf16 v38, v42, v20, v38
  v_dot2_f32_bf16 v39, v43, v20, v39
  v_dot2_f32_bf16 v40, v44, v20, v40
  v_dot2_f32_bf16 v41, v45, v20, v41
  s_waitcnt vmcnt(24)
  v_perm_b32 v42, v92, v88, s85
  v_perm_b32 v43, v92, v88, s86
  v_perm_b32 v44, v93, v89, s85
  v_perm_b32 v45, v93, v89, s86
  v_dot2_f32_bf16 v34, v42, v21, v34
  v_dot2_f32_bf16 v35, v43, v21, v35
  v_dot2_f32_bf16 v36, v44, v21, v36
  v_dot2_f32_bf16 v37, v45, v21, v37
  v_perm_b32 v42, v94, v90, s85
  v_perm_b32 v43, v94, v90, s86
  v_perm_b32 v44, v95, v91, s85
  v_perm_b32 v45, v95, v91, s86
  v_dot2_f32_bf16 v38, v42, v21, v38
  v_dot2_f32_bf16 v39, v43, v21, v39
  v_dot2_f32_bf16 v40, v44, v21, v40
  v_dot2_f32_bf16 v41, v45, v21, v41
  s_waitcnt vmcnt(22)
  v_perm_b32 v42, v100, v96, s85
  v_perm_b32 v43, v100, v96, s86
  v_perm_b32 v44, v101, v97, s85
  v_perm_b32 v45, v101, v97, s86
  v_dot2_f32_bf16 v34, v42, v22, v34
  v_dot2_f32_bf16 v35, v43, v22, v35
  v_dot2_f32_bf16 v36, v44, v22, v36
  v_dot2_f32_bf16 v37, v45, v22, v37
  v_perm_b32 v42, v102, v98, s85
  v_perm_b32 v43, v102, v98, s86
  v_perm_b32 v44, v103, v99, s85
  v_perm_b32 v45, v103, v99, s86
  v_dot2_f32_bf16 v38, v42, v22, v38
  v_dot2_f32_bf16 v39, v43, v22, v39
  v_dot2_f32_bf16 v40, v44, v22, v40
  v_dot2_f32_bf16 v41, v45, v22, v41
  s_waitcnt vmcnt(20)
  v_perm_b32 v42, v108, v104, s85
  v_perm_b32 v43, v108, v104, s86
  v_perm_b32 v44, v109, v105, s85
  v_perm_b32 v45, v109, v105, s86
  v_dot2_f32_bf16 v34, v42, v23, v34
  v_dot2_f32_bf16 v35, v43, v23, v35
  v_dot2_f32_bf16 v36, v44, v23, v36
  v_dot2_f32_bf16 v37, v45, v23, v37
  v_perm_b32 v42, v110, v106, s85
  v_perm_b32 v43, v110, v106, s86
  v_perm_b32 v44, v111, v107, s85
  v_perm_b32 v45, v111, v107, s86
  v_dot2_f32_bf16 v38, v42, v23, v38
  v_dot2_f32_bf16 v39, v43, v23, v39
  v_dot2_f32_bf16 v40, v44, v23, v40
  v_dot2_f32_bf16 v41, v45, v23, v41
  s_waitcnt vmcnt(18)
  v_perm_b32 v42, v116, v112, s85
  v_perm_b32 v43, v116, v112, s86
  v_perm_b32 v44, v117, v113, s85
  v_perm_b32 v45, v117, v113, s86
  v_dot2_f32_bf16 v34, v42, v24, v34
  v_dot2_f32_bf16 v35, v43, v24, v35
  v_dot2_f32_bf16 v36, v44, v24, v36
  v_dot2_f32_bf16 v37, v45, v24, v37
  v_perm_b32 v42, v118, v114, s85
  v_perm_b32 v43, v118, v114, s86
  v_perm_b32 v44, v119, v115, s85
  v_perm_b32 v45, v119, v115, s86
  v_dot2_f32_bf16 v38, v42, v24, v38
  v_dot2_f32_bf16 v39, v43, v24, v39
  v_dot2_f32_bf16 v40, v44, v24, v40
  v_dot2_f32_bf16 v41, v45, v24, v41
  s_waitcnt vmcnt(16)
  v_perm_b32 v42, v124, v120, s85
  v_perm_b32 v43, v124, v120, s86
  v_perm_b32 v44, v125, v121, s85
  v_perm_b32 v45, v125, v121, s86
  v_dot2_f32_bf16 v34, v42, v25, v34
  v_dot2_f32_bf16 v35, v43, v25, v35
  v_dot2_f32_bf16 v36, v44, v25, v36
  v_dot2_f32_bf16 v37, v45, v25, v37
  v_perm_b32 v42, v126, v122, s85
  v_perm_b32 v43, v126, v122, s86
  v_perm_b32 v44, v127, v123, s85
  v_perm_b32 v45, v127, v123, s86
  v_dot2_f32_bf16 v38, v42, v25, v38
  v_dot2_f32_bf16 v39, v43, v25, v39
  v_dot2_f32_bf16 v40, v44, v25, v40
  v_dot2_f32_bf16 v41, v45, v25, v41
  s_waitcnt vmcnt(14)
  v_perm_b32 v42, v132, v128, s85
  v_perm_b32 v43, v132, v128, s86
  v_perm_b32 v44, v133, v129, s85
  v_perm_b32 v45, v133, v129, s86
  v_dot2_f32_bf16 v34, v42, v26, v34
  v_dot2_f32_bf16 v35, v43, v26, v35
  v_dot2_f32_bf16 v36, v44, v26, v36
  v_dot2_f32_bf16 v37, v45, v26, v37
  v_perm_b32 v42, v134, v130, s85
  v_perm_b32 v43, v134, v130, s86
  v_perm_b32 v44, v135, v131, s85
  v_perm_b32 v45, v135, v131, s86
  v_dot2_f32_bf16 v38, v42, v26, v38
  v_dot2_f32_bf16 v39, v43, v26, v39
  v_dot2_f32_bf16 v40, v44, v26, v40
  v_dot2_f32_bf16 v41, v45, v26, v41
  s_waitcnt vmcnt(12)
  v_perm_b32 v42, v140, v136, s85
  v_perm_b32 v43, v140, v136, s86
  v_perm_b32 v44, v141, v137, s85
  v_perm_b32 v45, v141, v137, s86
  v_dot2_f32_bf16 v34, v42, v27, v34
  v_dot2_f32_bf16 v35, v43, v27, v35
  v_dot2_f32_bf16 v36, v44, v27, v36
  v_dot2_f32_bf16 v37, v45, v27, v37
  v_perm_b32 v42, v142, v138, s85
  v_perm_b32 v43, v142, v138, s86
  v_perm_b32 v44, v143, v139, s85
  v_perm_b32 v45, v143, v139, s86
  v_dot2_f32_bf16 v38, v42, v27, v38
  v_dot2_f32_bf16 v39, v43, v27, v39
  v_dot2_f32_bf16 v40, v44, v27, v40
  v_dot2_f32_bf16 v41, v45, v27, v41
  s_waitcnt vmcnt(10)
  v_perm_b32 v42, v148, v144, s85
  v_perm_b32 v43, v148, v144, s86
  v_perm_b32 v44, v149, v145, s85
  v_perm_b32 v45, v149, v145, s86
  v_dot2_f32_bf16 v34, v42, v28, v34
  v_dot2_f32_bf16 v35, v43, v28, v35
  v_dot2_f32_bf16 v36, v44, v28, v36
  v_dot2_f32_bf16 v37, v45, v28, v37
  v_perm_b32 v42, v150, v146, s85
  v_perm_b32 v43, v150, v146, s86
  v_perm_b32 v44, v151, v147, s85
  v_perm_b32 v45, v151, v147, s86
  v_dot2_f32_bf16 v38, v42, v28, v38
  v_dot2_f32_bf16 v39, v43, v28, v39
  v_dot2_f32_bf16 v40, v44, v28, v40
  v_dot2_f32_bf16 v41, v45, v28, v41
  s_waitcnt vmcnt(8)
  v_perm_b32 v42, v156, v152, s85
  v_perm_b32 v43, v156, v152, s86
  v_perm_b32 v44, v157, v153, s85
  v_perm_b32 v45, v157, v153, s86
  v_dot2_f32_bf16 v34, v42, v29, v34
  v_dot2_f32_bf16 v35, v43, v29, v35
  v_dot2_f32_bf16 v36, v44, v29, v36
  v_dot2_f32_bf16 v37, v45, v29, v37
  v_perm_b32 v42, v158, v154, s85
  v_perm_b32 v43, v158, v154, s86
  v_perm_b32 v44, v159, v155, s85
  v_perm_b32 v45, v159, v155, s86
  v_dot2_f32_bf16 v38, v42, v29, v38
  v_dot2_f32_bf16 v39, v43, v29, v39
  v_dot2_f32_bf16 v40, v44, v29, v40
  v_dot2_f32_bf16 v41, v45, v29, v41
  s_waitcnt vmcnt(6)
  v_perm_b32 v42, v164, v160, s85
  v_perm_b32 v43, v164, v160, s86
  v_perm_b32 v44, v165, v161, s85
  v_perm_b32 v45, v165, v161, s86
  v_dot2_f32_bf16 v34, v42, v30, v34
  v_dot2_f32_bf16 v35, v43, v30, v35
  v_dot2_f32_bf16 v36, v44, v30, v36
  v_dot2_f32_bf16 v37, v45, v30, v37
  v_perm_b32 v42, v166, v162, s85
  v_perm_b32 v43, v166, v162, s86
  v_perm_b32 v44, v167, v163, s85
  v_perm_b32 v45, v167, v163, s86
  v_dot2_f32_bf16 v38, v42, v30, v38
  v_dot2_f32_bf16 v39, v43, v30, v39
  v_dot2_f32_bf16 v40, v44, v30, v40
  v_dot2_f32_bf16 v41, v45, v30, v41
  s_waitcnt vmcnt(4)
  v_perm_b32 v42, v172, v168, s85
  v_perm_b32 v43, v172, v168, s86
  v_perm_b32 v44, v173, v169, s85
  v_perm_b32 v45, v173, v169, s86
  v_dot2_f32_bf16 v34, v42, v31, v34
  v_dot2_f32_bf16 v35, v43, v31, v35
  v_dot2_f32_bf16 v36, v44, v31, v36
  v_dot2_f32_bf16 v37, v45, v31, v37
  v_perm_b32 v42, v174, v170, s85
  v_perm_b32 v43, v174, v170, s86
  v_perm_b32 v44, v175, v171, s85
  v_perm_b32 v45, v175, v171, s86
  v_dot2_f32_bf16 v38, v42, v31, v38
  v_dot2_f32_bf16 v39, v43, v31, v39
  v_dot2_f32_bf16 v40, v44, v31, v40
  v_dot2_f32_bf16 v41, v45, v31, v41
  s_waitcnt vmcnt(2)
  v_perm_b32 v42, v180, v176, s85
  v_perm_b32 v43, v180, v176, s86
  v_perm_b32 v44, v181, v177, s85
  v_perm_b32 v45, v181, v177, s86
  v_dot2_f32_bf16 v34, v42, v32, v34
  v_dot2_f32_bf16 v35, v43, v32, v35
  v_dot2_f32_bf16 v36, v44, v32, v36
  v_dot2_f32_bf16 v37, v45, v32, v37
  v_perm_b32 v42, v182, v178, s85
  v_perm_b32 v43, v182, v178, s86
  v_perm_b32 v44, v183, v179, s85
  v_perm_b32 v45, v183, v179, s86
  v_dot2_f32_bf16 v38, v42, v32, v38
  v_dot2_f32_bf16 v39, v43, v32, v39
  v_dot2_f32_bf16 v40, v44, v32, v40
  v_dot2_f32_bf16 v41, v45, v32, v41
  s_waitcnt vmcnt(0)
  v_perm_b32 v42, v188, v184, s85
  v_perm_b32 v43, v188, v184, s86
  v_perm_b32 v44, v189, v185, s85
  v_perm_b32 v45, v189, v185, s86
  v_dot2_f32_bf16 v34, v42, v33, v34
  v_dot2_f32_bf16 v35, v43, v33, v35
  v_dot2_f32_bf16 v36, v44, v33, v36
  v_dot2_f32_bf16 v37, v45, v33, v37
  v_perm_b32 v42, v190, v186, s85
  v_perm_b32 v43, v190, v186, s86
  v_perm_b32 v44, v191, v187, s85
  v_perm_b32 v45, v191, v187, s86
  v_dot2_f32_bf16 v38, v42, v33, v38
  v_dot2_f32_bf16 v39, v43, v33, v39
  v_dot2_f32_bf16 v40, v44, v33, v40
  v_dot2_f32_bf16 v41, v45, v33, v41
  v_lshlrev_b32 v5, 4, v0
  v_lshlrev_b32 v6, 1, v0
  buffer_load_dwordx4 v[128:131], v5, s[24:27], 0 offen
  s_movk_i32 s83, 8192
  buffer_load_ushort v140, v6, s[24:27], s83 offen
  buffer_load_dwordx4 v[132:135], v5, s[32:35], 0 offen
  s_movk_i32 s83, 8192
  buffer_load_ushort v141, v6, s[32:35], s83 offen
  buffer_load_dwordx4 v[136:139], v5, s[92:95], 0 offen
  s_movk_i32 s83, 8192
  buffer_load_ushort v142, v6, s[92:95], s83 offen
  v_permlane32_swap_b32 v34, v38
  v_permlane32_swap_b32 v35, v39
  v_permlane32_swap_b32 v36, v40
  v_permlane32_swap_b32 v37, v41
  v_add_f32 v34, v34, v38
  v_add_f32 v35, v35, v39
  v_add_f32 v36, v36, v40
  v_add_f32 v37, v37, v41
  v_and_b32 v5, 31, v1
  v_lshlrev_b32 v5, 5, v5
  v_lshrrev_b32 v6, 5, v1
  v_lshl_add_u32 v5, v6, 4, v5
  s_lshl_b32 s83, s82, 10
  s_add_u32 s83, s83, 147456
  v_add_u32 v5, s83, v5
  ds_write_b128 v5, v[34:37]
  s_waitcnt lgkmcnt(0)
  s_barrier
  v_lshlrev_b32 v5, 4, v1
  v_add_u32 v5, 147456, v5
  ds_read_b128 v[48:51], v5 offset:0
  ds_read_b128 v[52:55], v5 offset:1024
  ds_read_b128 v[56:59], v5 offset:2048
  ds_read_b128 v[60:63], v5 offset:3072
  ds_read_b128 v[64:67], v5 offset:4096
  ds_read_b128 v[68:71], v5 offset:5120
  ds_read_b128 v[72:75], v5 offset:6144
  ds_read_b128 v[76:79], v5 offset:7168
  s_waitcnt lgkmcnt(0)
  v_add_f32 v48, v48, v64
  v_add_f32 v49, v49, v65
  v_add_f32 v50, v50, v66
  v_add_f32 v51, v51, v67
  v_add_f32 v52, v52, v68
  v_add_f32 v53, v53, v69
  v_add_f32 v54, v54, v70
  v_add_f32 v55, v55, v71
  v_add_f32 v56, v56, v72
  v_add_f32 v57, v57, v73
  v_add_f32 v58, v58, v74
  v_add_f32 v59, v59, v75
  v_add_f32 v60, v60, v76
  v_add_f32 v61, v61, v77
  v_add_f32 v62, v62, v78
  v_add_f32 v63, v63, v79
  v_add_f32 v48, v48, v56
  v_add_f32 v49, v49, v57
  v_add_f32 v50, v50, v58
  v_add_f32 v51, v51, v59
  v_add_f32 v52, v52, v60
  v_add_f32 v53, v53, v61
  v_add_f32 v54, v54, v62
  v_add_f32 v55, v55, v63
  v_add_f32 v48, v48, v52
  v_add_f32 v49, v49, v53
  v_add_f32 v50, v50, v54
  v_add_f32 v51, v51, v55
  v_cvt_pk_bf16_f32 v48, v48, v49
  v_cvt_pk_bf16_f32 v49, v50, v51
  s_lshl_b32 s83, s82, 9
  v_lshlrev_b32 v5, 3, v1
  v_add_u32 v5, s83, v5
  ds_write_b64 v5, v[48:49] offset:4608
  v_and_b32 v5, 15, v1
  v_lshlrev_b32 v5, 4, v5
  v_add_u32 v5, s83, v5
  s_waitcnt lgkmcnt(0)
  ds_read_b128 v[8:11], v5 offset:4608
  ds_read_b128 v[12:15], v5 offset:4864
  v_mov_b32 v16, 0
  v_mov_b32 v17, 0
  v_mov_b32 v18, 0
  v_mov_b32 v19, 0
  v_mov_b32 v20, 0
  v_mov_b32 v21, 0
  v_mov_b32 v22, 0
  v_mov_b32 v23, 0
  v_mov_b32 v24, 0
  v_mov_b32 v25, 0
  v_mov_b32 v26, 0
  v_mov_b32 v27, 0
  v_mov_b32 v28, 0
  v_mov_b32 v29, 0
  v_mov_b32 v30, 0
  v_mov_b32 v31, 0
  v_mov_b32 v3, 0xf149f2ca
  v_mov_b32 v4, 0
  s_waitcnt lgkmcnt(0)
  s_mul_i32 s83, s82, 36864
  v_lshlrev_b32 v46, 4, v1
  v_add_u32 v46, s83, v46
  v_lshrrev_b32 v5, 3, v1
  v_mul_u32_u24 v5, 4608, v5
  v_and_b32 v6, 7, v1
  v_lshl_add_u32 v5, v6, 4, v5
  s_add_u32 s83, s83, 1024
  v_add_u32 v47, s83, v5
  v_dot2_f32_bf16 v32, v192, v8, 0
  v_dot2_f32_bf16 v36, v192, v12, 0
  v_dot2_f32_bf16 v33, v196, v8, 0
  v_dot2_f32_bf16 v37, v196, v12, 0
  v_dot2_f32_bf16 v34, v200, v8, 0
  v_dot2_f32_bf16 v38, v200, v12, 0
  v_dot2_f32_bf16 v35, v204, v8, 0
  v_dot2_f32_bf16 v39, v204, v12, 0
  v_dot2_f32_bf16 v32, v193, v9, v32
  v_dot2_f32_bf16 v36, v193, v13, v36
  v_dot2_f32_bf16 v33, v197, v9, v33
  v_dot2_f32_bf16 v37, v197, v13, v37
  v_dot2_f32_bf16 v34, v201, v9, v34
  v_dot2_f32_bf16 v38, v201, v13, v38
  v_dot2_f32_bf16 v35, v205, v9, v35
  v_dot2_f32_bf16 v39, v205, v13, v39
  v_dot2_f32_bf16 v32, v194, v10, v32
  v_dot2_f32_bf16 v36, v194, v14, v36
  v_dot2_f32_bf16 v33, v198, v10, v33
  v_dot2_f32_bf16 v37, v198, v14, v37
  v_dot2_f32_bf16 v34, v202, v10, v34
  v_dot2_f32_bf16 v38, v202, v14, v38
  v_dot2_f32_bf16 v35, v206, v10, v35
  v_dot2_f32_bf16 v39, v206, v14, v39
  v_dot2_f32_bf16 v32, v195, v11, v32
  v_dot2_f32_bf16 v36, v195, v15, v36
  v_dot2_f32_bf16 v33, v199, v11, v33
  v_dot2_f32_bf16 v37, v199, v15, v37
  v_dot2_f32_bf16 v34, v203, v11, v34
  v_dot2_f32_bf16 v38, v203, v15, v38
  v_dot2_f32_bf16 v35, v207, v11, v35
  v_dot2_f32_bf16 v39, v207, v15, v39
  s_mov_b32 s83, 131072
  buffer_load_dwordx4 v[192:195], v2, s[4:7], s83 offen offset:0 nt
  buffer_load_dwordx4 v[196:199], v2, s[4:7], s83 offen offset:1024 nt
  buffer_load_dwordx4 v[200:203], v2, s[4:7], s83 offen offset:2048 nt
  buffer_load_dwordx4 v[204:207], v2, s[4:7], s83 offen offset:3072 nt
  v_add_f32_dpp v32, v32, v32 row_ror:8 row_mask:0xf bank_mask:0x3
  v_add_f32_dpp v33, v33, v33 row_ror:8 row_mask:0xf bank_mask:0x3
  v_add_f32_dpp v36, v36, v36 row_ror:8 row_mask:0xf bank_mask:0x3
  v_add_f32_dpp v37, v37, v37 row_ror:8 row_mask:0xf bank_mask:0x3
  v_add_f32_dpp v32, v34, v34 row_ror:8 row_mask:0xf bank_mask:0xc
  v_add_f32_dpp v33, v35, v35 row_ror:8 row_mask:0xf bank_mask:0xc
  v_add_f32_dpp v36, v38, v38 row_ror:8 row_mask:0xf bank_mask:0xc
  v_add_f32_dpp v37, v39, v39 row_ror:8 row_mask:0xf bank_mask:0xc
  v_add_f32_dpp v32, v32, v32 row_shl:4 row_mask:0xf bank_mask:0x5
  v_add_f32_dpp v33, v33, v33 row_shl:4 row_mask:0xf bank_mask:0x5
  s_nop 0
  v_add_f32_dpp v32, v36, v36 row_shr:4 row_mask:0xf bank_mask:0xa
  v_add_f32_dpp v33, v37, v37 row_shr:4 row_mask:0xf bank_mask:0xa
  s_nop 0
  v_add_f32_dpp v32, v32, v32 quad_perm:[1,0,3,2] row_mask:0xf bank_mask:0xf
  v_add_f32_dpp v33, v33, v33 quad_perm:[1,0,3,2] row_mask:0xf bank_mask:0xf
  s_nop 0
  v_add_f32_dpp v32, v32, v32 quad_perm:[2,3,0,1] row_mask:0xf bank_mask:0xf
  v_add_f32_dpp v33, v33, v33 quad_perm:[2,3,0,1] row_mask:0xf bank_mask:0xf
  v_cvt_pk_bf16_f32 v34, v32, v33
  v_lshlrev_b32 v32, 16, v34
  v_and_b32 v33, s87, v34
  v_mul_f32 v32, s88, v32
  v_mul_f32 v33, s88, v33
  v_cvt_pk_bf16_f32 v34, v32, v33
  v_lshlrev_b32 v32, 16, v34
  v_and_b32 v33, s87, v34
  v_max_f32 v35, v32, v33
  s_nop 1
  v_max_f32_dpp v35, v35, v35 row_ror:8 row_mask:0xf bank_mask:0xf
  v_mul_f32 v35, s89, v35
  v_max_f32 v35, v35, v3
  v_sub_f32 v36, v3, v35
  v_fma_f32 v32, v32, s89, -v35
  v_fma_f32 v33, v33, s89, -v35
  v_exp_f32 v36, v36
  v_exp_f32 v32, v32
  v_exp_f32 v33, v33
  v_mov_b32 v3, v35
  v_fma_f32 v4, v4, v36, v32
  v_cvt_pk_bf16_f32 v44, v32, v33
  v_add_f32 v4, v4, v33
  v_mul_f32_dpp v16, v36, v16 row_newbcast:0 row_mask:0xf bank_mask:0xf
  v_mul_f32_dpp v17, v36, v17 row_newbcast:0 row_mask:0xf bank_mask:0xf
  v_mul_f32_dpp v18, v36, v18 row_newbcast:0 row_mask:0xf bank_mask:0xf
  v_mul_f32_dpp v19, v36, v19 row_newbcast:0 row_mask:0xf bank_mask:0xf
  v_mul_f32_dpp v20, v36, v20 row_newbcast:0 row_mask:0xf bank_mask:0xf
  v_mul_f32_dpp v21, v36, v21 row_newbcast:0 row_mask:0xf bank_mask:0xf
  v_mul_f32_dpp v22, v36, v22 row_newbcast:0 row_mask:0xf bank_mask:0xf
  v_mul_f32_dpp v23, v36, v23 row_newbcast:0 row_mask:0xf bank_mask:0xf
  v_mul_f32_dpp v24, v36, v24 row_newbcast:4 row_mask:0xf bank_mask:0xf
  v_mul_f32_dpp v25, v36, v25 row_newbcast:4 row_mask:0xf bank_mask:0xf
  v_mul_f32_dpp v26, v36, v26 row_newbcast:4 row_mask:0xf bank_mask:0xf
  v_mul_f32_dpp v27, v36, v27 row_newbcast:4 row_mask:0xf bank_mask:0xf
  v_mul_f32_dpp v28, v36, v28 row_newbcast:4 row_mask:0xf bank_mask:0xf
  v_mul_f32_dpp v29, v36, v29 row_newbcast:4 row_mask:0xf bank_mask:0xf
  v_mul_f32_dpp v30, v36, v30 row_newbcast:4 row_mask:0xf bank_mask:0xf
  v_mul_f32_dpp v31, v36, v31 row_newbcast:4 row_mask:0xf bank_mask:0xf
  v_perm_b32 v40, v212, v208, s85
  v_perm_b32 v41, v212, v208, s86
  v_perm_b32 v42, v213, v209, s85
  v_perm_b32 v43, v213, v209, s86
  v_dot2c_f32_bf16_dpp v16, v44, v40 row_newbcast:0 row_mask:0xf bank_mask:0xf
  v_dot2c_f32_bf16_dpp v17, v44, v41 row_newbcast:0 row_mask:0xf bank_mask:0xf
  v_dot2c_f32_bf16_dpp v18, v44, v42 row_newbcast:0 row_mask:0xf bank_mask:0xf
  v_dot2c_f32_bf16_dpp v19, v44, v43 row_newbcast:0 row_mask:0xf bank_mask:0xf
  v_dot2c_f32_bf16_dpp v24, v44, v40 row_newbcast:4 row_mask:0xf bank_mask:0xf
  v_dot2c_f32_bf16_dpp v25, v44, v41 row_newbcast:4 row_mask:0xf bank_mask:0xf
  v_dot2c_f32_bf16_dpp v26, v44, v42 row_newbcast:4 row_mask:0xf bank_mask:0xf
  v_dot2c_f32_bf16_dpp v27, v44, v43 row_newbcast:4 row_mask:0xf bank_mask:0xf
  v_perm_b32 v40, v214, v210, s85
  v_perm_b32 v41, v214, v210, s86
  v_perm_b32 v42, v215, v211, s85
  v_perm_b32 v43, v215, v211, s86
  v_dot2c_f32_bf16_dpp v20, v44, v40 row_newbcast:0 row_mask:0xf bank_mask:0xf
  v_dot2c_f32_bf16_dpp v21, v44, v41 row_newbcast:0 row_mask:0xf bank_mask:0xf
  v_dot2c_f32_bf16_dpp v22, v44, v42 row_newbcast:0 row_mask:0xf bank_mask:0xf
  v_dot2c_f32_bf16_dpp v23, v44, v43 row_newbcast:0 row_mask:0xf bank_mask:0xf
  v_dot2c_f32_bf16_dpp v28, v44, v40 row_newbcast:4 row_mask:0xf bank_mask:0xf
  v_dot2c_f32_bf16_dpp v29, v44, v41 row_newbcast:4 row_mask:0xf bank_mask:0xf
  v_dot2c_f32_bf16_dpp v30, v44, v42 row_newbcast:4 row_mask:0xf bank_mask:0xf
  v_dot2c_f32_bf16_dpp v31, v44, v43 row_newbcast:4 row_mask:0xf bank_mask:0xf
  v_perm_b32 v40, v220, v216, s85
  v_perm_b32 v41, v220, v216, s86
  v_perm_b32 v42, v221, v217, s85
  v_perm_b32 v43, v221, v217, s86
  v_dot2c_f32_bf16_dpp v16, v44, v40 row_newbcast:8 row_mask:0xf bank_mask:0xf
  v_dot2c_f32_bf16_dpp v17, v44, v41 row_newbcast:8 row_mask:0xf bank_mask:0xf
  v_dot2c_f32_bf16_dpp v18, v44, v42 row_newbcast:8 row_mask:0xf bank_mask:0xf
  v_dot2c_f32_bf16_dpp v19, v44, v43 row_newbcast:8 row_mask:0xf bank_mask:0xf
  v_dot2c_f32_bf16_dpp v24, v44, v40 row_newbcast:12 row_mask:0xf bank_mask:0xf
  v_dot2c_f32_bf16_dpp v25, v44, v41 row_newbcast:12 row_mask:0xf bank_mask:0xf
  v_dot2c_f32_bf16_dpp v26, v44, v42 row_newbcast:12 row_mask:0xf bank_mask:0xf
  v_dot2c_f32_bf16_dpp v27, v44, v43 row_newbcast:12 row_mask:0xf bank_mask:0xf
  v_perm_b32 v40, v222, v218, s85
  v_perm_b32 v41, v222, v218, s86
  v_perm_b32 v42, v223, v219, s85
  v_perm_b32 v43, v223, v219, s86
  v_dot2c_f32_bf16_dpp v20, v44, v40 row_newbcast:8 row_mask:0xf bank_mask:0xf
  v_dot2c_f32_bf16_dpp v21, v44, v41 row_newbcast:8 row_mask:0xf bank_mask:0xf
  v_dot2c_f32_bf16_dpp v22, v44, v42 row_newbcast:8 row_mask:0xf bank_mask:0xf
  v_dot2c_f32_bf16_dpp v23, v44, v43 row_newbcast:8 row_mask:0xf bank_mask:0xf
  v_dot2c_f32_bf16_dpp v28, v44, v40 row_newbcast:12 row_mask:0xf bank_mask:0xf
  v_dot2c_f32_bf16_dpp v29, v44, v41 row_newbcast:12 row_mask:0xf bank_mask:0xf
  v_dot2c_f32_bf16_dpp v30, v44, v42 row_newbcast:12 row_mask:0xf bank_mask:0xf
  v_dot2c_f32_bf16_dpp v31, v44, v43 row_newbcast:12 row_mask:0xf bank_mask:0xf
  s_mov_b32 s83, 131072
  buffer_load_dwordx4 v[208:211], v2, s[8:11], s83 offen offset:0 nt
  buffer_load_dwordx4 v[212:215], v2, s[8:11], s83 offen offset:1024 nt
  buffer_load_dwordx4 v[216:219], v2, s[8:11], s83 offen offset:2048 nt
  buffer_load_dwordx4 v[220:223], v2, s[8:11], s83 offen offset:3072 nt
  v_dot2_f32_bf16 v32, v224, v8, 0
  v_dot2_f32_bf16 v36, v224, v12, 0
  v_dot2_f32_bf16 v33, v228, v8, 0
  v_dot2_f32_bf16 v37, v228, v12, 0
  v_dot2_f32_bf16 v34, v232, v8, 0
  v_dot2_f32_bf16 v38, v232, v12, 0
  v_dot2_f32_bf16 v35, v236, v8, 0
  v_dot2_f32_bf16 v39, v236, v12, 0
  v_dot2_f32_bf16 v32, v225, v9, v32
  v_dot2_f32_bf16 v36, v225, v13, v36
  v_dot2_f32_bf16 v33, v229, v9, v33
  v_dot2_f32_bf16 v37, v229, v13, v37
  v_dot2_f32_bf16 v34, v233, v9, v34
  v_dot2_f32_bf16 v38, v233, v13, v38
  v_dot2_f32_bf16 v35, v237, v9, v35
  v_dot2_f32_bf16 v39, v237, v13, v39
  v_dot2_f32_bf16 v32, v226, v10, v32
  v_dot2_f32_bf16 v36, v226, v14, v36
  v_dot2_f32_bf16 v33, v230, v10, v33
  v_dot2_f32_bf16 v37, v230, v14, v37
  v_dot2_f32_bf16 v34, v234, v10, v34
  v_dot2_f32_bf16 v38, v234, v14, v38
  v_dot2_f32_bf16 v35, v238, v10, v35
  v_dot2_f32_bf16 v39, v238, v14, v39
  v_dot2_f32_bf16 v32, v227, v11, v32
  v_dot2_f32_bf16 v36, v227, v15, v36
  v_dot2_f32_bf16 v33, v231, v11, v33
  v_dot2_f32_bf16 v37, v231, v15, v37
  v_dot2_f32_bf16 v34, v235, v11, v34
  v_dot2_f32_bf16 v38, v235, v15, v38
  v_dot2_f32_bf16 v35, v239, v11, v35
  v_dot2_f32_bf16 v39, v239, v15, v39
  s_mov_b32 s83, 163840
  buffer_load_dwordx4 v[224:227], v2, s[4:7], s83 offen offset:0 nt
  buffer_load_dwordx4 v[228:231], v2, s[4:7], s83 offen offset:1024 nt
  buffer_load_dwordx4 v[232:235], v2, s[4:7], s83 offen offset:2048 nt
  buffer_load_dwordx4 v[236:239], v2, s[4:7], s83 offen offset:3072 nt
  v_add_f32_dpp v32, v32, v32 row_ror:8 row_mask:0xf bank_mask:0x3
  v_add_f32_dpp v33, v33, v33 row_ror:8 row_mask:0xf bank_mask:0x3
  v_add_f32_dpp v36, v36, v36 row_ror:8 row_mask:0xf bank_mask:0x3
  v_add_f32_dpp v37, v37, v37 row_ror:8 row_mask:0xf bank_mask:0x3
  v_add_f32_dpp v32, v34, v34 row_ror:8 row_mask:0xf bank_mask:0xc
  v_add_f32_dpp v33, v35, v35 row_ror:8 row_mask:0xf bank_mask:0xc
  v_add_f32_dpp v36, v38, v38 row_ror:8 row_mask:0xf bank_mask:0xc
  v_add_f32_dpp v37, v39, v39 row_ror:8 row_mask:0xf bank_mask:0xc
  v_add_f32_dpp v32, v32, v32 row_shl:4 row_mask:0xf bank_mask:0x5
  v_add_f32_dpp v33, v33, v33 row_shl:4 row_mask:0xf bank_mask:0x5
  s_nop 0
  v_add_f32_dpp v32, v36, v36 row_shr:4 row_mask:0xf bank_mask:0xa
  v_add_f32_dpp v33, v37, v37 row_shr:4 row_mask:0xf bank_mask:0xa
  s_nop 0
  v_add_f32_dpp v32, v32, v32 quad_perm:[1,0,3,2] row_mask:0xf bank_mask:0xf
  v_add_f32_dpp v33, v33, v33 quad_perm:[1,0,3,2] row_mask:0xf bank_mask:0xf
  s_nop 0
  v_add_f32_dpp v32, v32, v32 quad_perm:[2,3,0,1] row_mask:0xf bank_mask:0xf
  v_add_f32_dpp v33, v33, v33 quad_perm:[2,3,0,1] row_mask:0xf bank_mask:0xf
  v_cvt_pk_bf16_f32 v34, v32, v33
  v_lshlrev_b32 v32, 16, v34
  v_and_b32 v33, s87, v34
  v_mul_f32 v32, s88, v32
  v_mul_f32 v33, s88, v33
  v_cvt_pk_bf16_f32 v34, v32, v33
  v_lshlrev_b32 v32, 16, v34
  v_and_b32 v33, s87, v34
  v_fma_f32 v32, v32, s89, -v3
  v_fma_f32 v33, v33, s89, -v3
  v_max_f32 v35, v32, v33
  v_cmp_lt_f32 vcc, 0x41000000, v35
  v_exp_f32 v37, v32
  v_exp_f32 v38, v33
  s_cmp_eq_u64 vcc, 0
  s_cbranch_scc1 K1_LZ1B
  v_max_f32_dpp v35, v35, v35 row_ror:8 row_mask:0xf bank_mask:0xf
  v_max_f32 v35, 0, v35
  v_exp_f32 v36, -v35
  v_add_f32 v3, v3, v35
  v_sub_f32 v32, v32, v35
  v_sub_f32 v33, v33, v35
  v_exp_f32 v37, v32
  v_exp_f32 v38, v33
  v_mul_f32 v4, v4, v36
  v_mul_f32_dpp v16, v36, v16 row_newbcast:0 row_mask:0xf bank_mask:0xf
  v_mul_f32_dpp v17, v36, v17 row_newbcast:0 row_mask:0xf bank_mask:0xf
  v_mul_f32_dpp v18, v36, v18 row_newbcast:0 row_mask:0xf bank_mask:0xf
  v_mul_f32_dpp v19, v36, v19 row_newbcast:0 row_mask:0xf bank_mask:0xf
  v_mul_f32_dpp v20, v36, v20 row_newbcast:0 row_mask:0xf bank_mask:0xf
  v_mul_f32_dpp v21, v36, v21 row_newbcast:0 row_mask:0xf bank_mask:0xf
  v_mul_f32_dpp v22, v36, v22 row_newbcast:0 row_mask:0xf bank_mask:0xf
  v_mul_f32_dpp v23, v36, v23 row_newbcast:0 row_mask:0xf bank_mask:0xf
  v_mul_f32_dpp v24, v36, v24 row_newbcast:4 row_mask:0xf bank_mask:0xf
  v_mul_f32_dpp v25, v36, v25 row_newbcast:4 row_mask:0xf bank_mask:0xf
  v_mul_f32_dpp v26, v36, v26 row_newbcast:4 row_mask:0xf bank_mask:0xf
  v_mul_f32_dpp v27, v36, v27 row_newbcast:4 row_mask:0xf bank_mask:0xf
  v_mul_f32_dpp v28, v36, v28 row_newbcast:4 row_mask:0xf bank_mask:0xf
  v_mul_f32_dpp v29, v36, v29 row_newbcast:4 row_mask:0xf bank_mask:0xf
  v_mul_f32_dpp v30, v36, v30 row_newbcast:4 row_mask:0xf bank_mask:0xf
  v_mul_f32_dpp v31, v36, v31 row_newbcast:4 row_mask:0xf bank_mask:0xf
K1_LZ1B:
  s_nop 1
  v_add_f32 v4, v4, v37
  v_cvt_pk_bf16_f32 v44, v37, v38
  v_add_f32 v4, v4, v38
  v_perm_b32 v40, v244, v240, s85
  v_perm_b32 v41, v244, v240, s86
  v_perm_b32 v42, v245, v241, s85
  v_perm_b32 v43, v245, v241, s86
  v_dot2c_f32_bf16_dpp v16, v44, v40 row_newbcast:0 row_mask:0xf bank_mask:0xf
  v_dot2c_f32_bf16_dpp v17, v44, v41 row_newbcast:0 row_mask:0xf bank_mask:0xf
  v_dot2c_f32_bf16_dpp v18, v44, v42 row_newbcast:0 row_mask:0xf bank_mask:0xf
  v_dot2c_f32_bf16_dpp v19, v44, v43 row_newbcast:0 row_mask:0xf bank_mask:0xf
  v_dot2c_f32_bf16_dpp v24, v44, v40 row_newbcast:4 row_mask:0xf bank_mask:0xf
  v_dot2c_f32_bf16_dpp v25, v44, v41 row_newbcast:4 row_mask:0xf bank_mask:0xf
  v_dot2c_f32_bf16_dpp v26, v44, v42 row_newbcast:4 row_mask:0xf bank_mask:0xf
  v_dot2c_f32_bf16_dpp v27, v44, v43 row_newbcast:4 row_mask:0xf bank_mask:0xf
  v_perm_b32 v40, v246, v242, s85
  v_perm_b32 v41, v246, v242, s86
  v_perm_b32 v42, v247, v243, s85
  v_perm_b32 v43, v247, v243, s86
  v_dot2c_f32_bf16_dpp v20, v44, v40 row_newbcast:0 row_mask:0xf bank_mask:0xf
  v_dot2c_f32_bf16_dpp v21, v44, v41 row_newbcast:0 row_mask:0xf bank_mask:0xf
  v_dot2c_f32_bf16_dpp v22, v44, v42 row_newbcast:0 row_mask:0xf bank_mask:0xf
  v_dot2c_f32_bf16_dpp v23, v44, v43 row_newbcast:0 row_mask:0xf bank_mask:0xf
  v_dot2c_f32_bf16_dpp v28, v44, v40 row_newbcast:4 row_mask:0xf bank_mask:0xf
  v_dot2c_f32_bf16_dpp v29, v44, v41 row_newbcast:4 row_mask:0xf bank_mask:0xf
  v_dot2c_f32_bf16_dpp v30, v44, v42 row_newbcast:4 row_mask:0xf bank_mask:0xf
  v_dot2c_f32_bf16_dpp v31, v44, v43 row_newbcast:4 row_mask:0xf bank_mask:0xf
  v_perm_b32 v40, v252, v248, s85
  v_perm_b32 v41, v252, v248, s86
  v_perm_b32 v42, v253, v249, s85
  v_perm_b32 v43, v253, v249, s86
  v_dot2c_f32_bf16_dpp v16, v44, v40 row_newbcast:8 row_mask:0xf bank_mask:0xf
  v_dot2c_f32_bf16_dpp v17, v44, v41 row_newbcast:8 row_mask:0xf bank_mask:0xf
  v_dot2c_f32_bf16_dpp v18, v44, v42 row_newbcast:8 row_mask:0xf bank_mask:0xf
  v_dot2c_f32_bf16_dpp v19, v44, v43 row_newbcast:8 row_mask:0xf bank_mask:0xf
  v_dot2c_f32_bf16_dpp v24, v44, v40 row_newbcast:12 row_mask:0xf bank_mask:0xf
  v_dot2c_f32_bf16_dpp v25, v44, v41 row_newbcast:12 row_mask:0xf bank_mask:0xf
  v_dot2c_f32_bf16_dpp v26, v44, v42 row_newbcast:12 row_mask:0xf bank_mask:0xf
  v_dot2c_f32_bf16_dpp v27, v44, v43 row_newbcast:12 row_mask:0xf bank_mask:0xf
  v_perm_b32 v40, v254, v250, s85
  v_perm_b32 v41, v254, v250, s86
  v_perm_b32 v42, v255, v251, s85
  v_perm_b32 v43, v255, v251, s86
  v_dot2c_f32_bf16_dpp v20, v44, v40 row_newbcast:8 row_mask:0xf bank_mask:0xf
  v_dot2c_f32_bf16_dpp v21, v44, v41 row_newbcast:8 row_mask:0xf bank_mask:0xf
  v_dot2c_f32_bf16_dpp v22, v44, v42 row_newbcast:8 row_mask:0xf bank_mask:0xf
  v_dot2c_f32_bf16_dpp v23, v44, v43 row_newbcast:8 row_mask:0xf bank_mask:0xf
  v_dot2c_f32_bf16_dpp v28, v44, v40 row_newbcast:12 row_mask:0xf bank_mask:0xf
  v_dot2c_f32_bf16_dpp v29, v44, v41 row_newbcast:12 row_mask:0xf bank_mask:0xf
  v_dot2c_f32_bf16_dpp v30, v44, v42 row_newbcast:12 row_mask:0xf bank_mask:0xf
  v_dot2c_f32_bf16_dpp v31, v44, v43 row_newbcast:12 row_mask:0xf bank_mask:0xf
  s_mov_b32 s83, 163840
  buffer_load_dwordx4 v[240:243], v2, s[8:11], s83 offen offset:0 nt
  buffer_load_dwordx4 v[244:247], v2, s[8:11], s83 offen offset:1024 nt
  buffer_load_dwordx4 v[248:251], v2, s[8:11], s83 offen offset:2048 nt
  buffer_load_dwordx4 v[252:255], v2, s[8:11], s83 offen offset:3072 nt
  v_mul_u32_u24 v183, 18, v1
  s_mul_i32 s83, s80, 1152
  v_add_u32 v183, s83, v183
  v_mov_b32 v144, 0
  v_mov_b32 v145, 0
  v_mov_b32 v146, 0
  v_mov_b32 v147, 0
  v_mov_b32 v148, 0
  v_mov_b32 v149, 0
  v_mov_b32 v150, 0
  v_mov_b32 v151, 0
  v_mov_b32 v152, 0
  ds_read_u16_d16_hi v144, v183 offset:0
  ds_read_u16_d16_hi v145, v183 offset:2
  ds_read_u16_d16_hi v146, v183 offset:4
  ds_read_u16_d16_hi v147, v183 offset:6
  ds_read_u16_d16_hi v148, v183 offset:8
  ds_read_u16_d16_hi v149, v183 offset:10
  ds_read_u16_d16_hi v150, v183 offset:12
  ds_read_u16_d16_hi v151, v183 offset:14
  ds_read_u16_d16_hi v152, v183 offset:16
  s_waitcnt lgkmcnt(0)
  v_add_f32 v171, v144, v145
  v_add_f32 v171, v171, v146
  v_add_f32 v171, v171, v147
  v_add_f32 v171, v171, v148
  v_add_f32 v171, v171, v149
  v_add_f32 v171, v171, v150
  v_add_f32 v171, v171, v151
  v_add_f32 v171, v171, v152
  s_nop 1
  v_add_f32_dpp v171, v171, v171 row_ror:8 row_mask:0xf bank_mask:0xf
  s_nop 1
  v_add_f32_dpp v171, v171, v171 row_ror:4 row_mask:0xf bank_mask:0xf
  s_nop 1
  v_add_f32_dpp v171, v171, v171 row_ror:2 row_mask:0xf bank_mask:0xf
  s_nop 1
  v_add_f32_dpp v171, v171, v171 row_ror:1 row_mask:0xf bank_mask:0xf
  v_mov_b32 v172, v171
  s_nop 1
  v_permlane16_swap_b32 v171, v172
  v_add_f32 v171, v171, v172
  v_mov_b32 v172, v171
  s_nop 1
  v_permlane32_swap_b32 v171, v172
  v_add_f32 v171, v171, v172
  v_mul_f32 v173, 0x3ae38e39, v171
  v_sub_f32 v153, v144, v173
  v_sub_f32 v154, v145, v173
  v_sub_f32 v155, v146, v173
  v_sub_f32 v156, v147, v173
  v_sub_f32 v157, v148, v173
  v_sub_f32 v158, v149, v173
  v_sub_f32 v159, v150, v173
  v_sub_f32 v160, v151, v173
  v_sub_f32 v161, v152, v173
  v_mul_f32 v174, v153, v153
  v_fmac_f32 v174, v154, v154
  v_fmac_f32 v174, v155, v155
  v_fmac_f32 v174, v156, v156
  v_fmac_f32 v174, v157, v157
  v_fmac_f32 v174, v158, v158
  v_fmac_f32 v174, v159, v159
  v_fmac_f32 v174, v160, v160
  v_fmac_f32 v174, v161, v161
  s_nop 1
  v_add_f32_dpp v174, v174, v174 row_ror:8 row_mask:0xf bank_mask:0xf
  s_nop 1
  v_add_f32_dpp v174, v174, v174 row_ror:4 row_mask:0xf bank_mask:0xf
  s_nop 1
  v_add_f32_dpp v174, v174, v174 row_ror:2 row_mask:0xf bank_mask:0xf
  s_nop 1
  v_add_f32_dpp v174, v174, v174 row_ror:1 row_mask:0xf bank_mask:0xf
  v_mov_b32 v172, v174
  s_nop 1
  v_permlane16_swap_b32 v174, v172
  v_add_f32 v174, v174, v172
  v_mov_b32 v172, v174
  s_nop 1
  v_permlane32_swap_b32 v174, v172
  v_add_f32 v174, v174, v172
  v_mul_f32 v174, 0x3ae38e39, v174
  v_cvt_pk_bf16_f32 v172, v173, v174
  v_lshlrev_b32 v173, 16, v172
  v_and_b32 v174, s87, v172
  v_add_f32 v174, 0x3727c5ac, v174
  v_cvt_pk_bf16_f32 v174, v174, v174
  v_and_b32 v174, s87, v174
  v_sqrt_f32 v175, v174
  s_nop 0
  v_cvt_pk_bf16_f32 v175, v175, v175
  v_and_b32 v175, s87, v175
  v_rcp_f32 v176, v175
  v_sub_f32 v153, v144, v173
  v_sub_f32 v154, v145, v173
  v_sub_f32 v155, v146, v173
  v_sub_f32 v156, v147, v173
  v_sub_f32 v157, v148, v173
  v_sub_f32 v158, v149, v173
  v_sub_f32 v159, v150, v173
  v_sub_f32 v160, v151, v173
  v_sub_f32 v161, v152, v173
  v_cvt_pk_bf16_f32 v172, v153, v154
  v_lshlrev_b32 v153, 16, v172
  v_and_b32 v154, s87, v172
  v_cvt_pk_bf16_f32 v172, v155, v156
  v_lshlrev_b32 v155, 16, v172
  v_and_b32 v156, s87, v172
  v_cvt_pk_bf16_f32 v172, v157, v158
  v_lshlrev_b32 v157, 16, v172
  v_and_b32 v158, s87, v172
  v_cvt_pk_bf16_f32 v172, v159, v160
  v_lshlrev_b32 v159, 16, v172
  v_and_b32 v160, s87, v172
  v_cvt_pk_bf16_f32 v161, v161, v161
  v_and_b32 v161, s87, v161
  v_mul_f32 v171, v153, v176
  v_fma_f32 v172, -v171, v175, v153
  v_fma_f32 v153, v172, v176, v171
  v_mul_f32 v171, v154, v176
  v_fma_f32 v172, -v171, v175, v154
  v_fma_f32 v154, v172, v176, v171
  v_mul_f32 v171, v155, v176
  v_fma_f32 v172, -v171, v175, v155
  v_fma_f32 v155, v172, v176, v171
  v_mul_f32 v171, v156, v176
  v_fma_f32 v172, -v171, v175, v156
  v_fma_f32 v156, v172, v176, v171
  v_mul_f32 v171, v157, v176
  v_fma_f32 v172, -v171, v175, v157
  v_fma_f32 v157, v172, v176, v171
  v_mul_f32 v171, v158, v176
  v_fma_f32 v172, -v171, v175, v158
  v_fma_f32 v158, v172, v176, v171
  v_mul_f32 v171, v159, v176
  v_fma_f32 v172, -v171, v175, v159
  v_fma_f32 v159, v172, v176, v171
  v_mul_f32 v171, v160, v176
  v_fma_f32 v172, -v171, v175, v160
  v_fma_f32 v160, v172, v176, v171
  v_mul_f32 v171, v161, v176
  v_fma_f32 v172, -v171, v175, v161
  v_fma_f32 v161, v172, v176, v171
  v_cvt_pk_bf16_f32 v172, v153, v154
  v_lshlrev_b32 v153, 16, v172
  v_and_b32 v154, s87, v172
  v_cvt_pk_bf16_f32 v172, v155, v156
  v_lshlrev_b32 v155, 16, v172
  v_and_b32 v156, s87, v172
  v_cvt_pk_bf16_f32 v172, v157, v158
  v_lshlrev_b32 v157, 16, v172
  v_and_b32 v158, s87, v172
  v_cvt_pk_bf16_f32 v172, v159, v160
  v_lshlrev_b32 v159, 16, v172
  v_and_b32 v160, s87, v172
  v_cvt_pk_bf16_f32 v161, v161, v161
  v_and_b32 v161, s87, v161
  v_readlane_b32 s64, v153, s81
  v_readlane_b32 s65, v154, s81
  v_readlane_b32 s66, v155, s81
  v_readlane_b32 s67, v156, s81
  v_readlane_b32 s68, v157, s81
  v_readlane_b32 s69, v158, s81
  v_readlane_b32 s70, v159, s81
  v_readlane_b32 s71, v160, s81
  v_readlane_b32 s72, v161, s81
  s_waitcnt vmcnt(16)
  v_mov_b32 v143, 0x3dd2d3e8
  v_lshlrev_b32 v144, 16, v128
  v_and_b32 v145, s87, v128
  v_lshlrev_b32 v153, 16, v132
  v_and_b32 v154, s87, v132
  v_lshlrev_b32 v146, 16, v129
  v_and_b32 v147, s87, v129
  v_lshlrev_b32 v155, 16, v133
  v_and_b32 v156, s87, v133
  v_lshlrev_b32 v148, 16, v130
  v_and_b32 v149, s87, v130
  v_lshlrev_b32 v157, 16, v134
  v_and_b32 v158, s87, v134
  v_lshlrev_b32 v150, 16, v131
  v_and_b32 v151, s87, v131
  v_lshlrev_b32 v159, 16, v135
  v_and_b32 v160, s87, v135
  v_lshlrev_b32 v152, 16, v140
  v_lshlrev_b32 v161, 16, v141
  v_lshlrev_b32 v142, 16, v142
  v_mul_f32 v171, s64, v144
  v_mul_f32 v172, s64, v145
  v_mul_f32 v173, s64, v146
  v_mul_f32 v174, s64, v147
  v_cvt_pk_bf16_f32 v179, v171, v172
  v_lshlrev_b32 v171, 16, v179
  v_and_b32 v172, s87, v179
  v_cvt_pk_bf16_f32 v180, v173, v174
  v_lshlrev_b32 v173, 16, v180
  v_and_b32 v174, s87, v180
  v_add_f32 v171, v171, v153
  v_add_f32 v172, v172, v154
  v_add_f32 v173, v173, v155
  v_add_f32 v174, v174, v156
  v_cvt_pk_bf16_f32 v179, v171, v172
  v_lshlrev_b32 v171, 16, v179
  v_and_b32 v172, s87, v179
  v_cvt_pk_bf16_f32 v180, v173, v174
  v_lshlrev_b32 v173, 16, v180
  v_and_b32 v174, s87, v180
  v_mul_f32 v175, v171, v171
  v_mul_f32 v176, v172, v172
  v_mul_f32 v177, v173, v173
  v_mul_f32 v178, v174, v174
  v_fmaak_f32 v175, v175, v143, 0x40135761
  v_fmaak_f32 v176, v176, v143, 0x40135761
  v_fmaak_f32 v177, v177, v143, 0x40135761
  v_fmaak_f32 v178, v178, v143, 0x40135761
  v_mul_f32 v175, v175, v171
  v_mul_f32 v176, v176, v172
  v_mul_f32 v177, v177, v173
  v_mul_f32 v178, v178, v174
  v_exp_f32 v175, -v175
  v_exp_f32 v176, -v176
  v_exp_f32 v177, -v177
  v_exp_f32 v178, -v178
  v_add_f32 v175, 1.0, v175
  v_add_f32 v176, 1.0, v176
  v_add_f32 v177, 1.0, v177
  v_add_f32 v178, 1.0, v178
  v_rcp_f32 v175, v175
  v_rcp_f32 v176, v176
  v_rcp_f32 v177, v177
  v_rcp_f32 v178, v178
  v_mul_f32 v171, v171, v175
  v_mul_f32 v172, v172, v176
  v_mul_f32 v173, v173, v177
  v_mul_f32 v174, v174, v178
  v_cvt_pk_bf16_f32 v179, v171, v172
  v_cvt_pk_bf16_f32 v180, v173, v174
  v_dot2_f32_bf16 v162, v179, v136, 0
  v_dot2_f32_bf16 v162, v180, v137, v162
  v_mul_f32 v171, s64, v148
  v_mul_f32 v172, s64, v149
  v_mul_f32 v173, s64, v150
  v_mul_f32 v174, s64, v151
  v_cvt_pk_bf16_f32 v179, v171, v172
  v_lshlrev_b32 v171, 16, v179
  v_and_b32 v172, s87, v179
  v_cvt_pk_bf16_f32 v180, v173, v174
  v_lshlrev_b32 v173, 16, v180
  v_and_b32 v174, s87, v180
  v_add_f32 v171, v171, v157
  v_add_f32 v172, v172, v158
  v_add_f32 v173, v173, v159
  v_add_f32 v174, v174, v160
  v_cvt_pk_bf16_f32 v179, v171, v172
  v_lshlrev_b32 v171, 16, v179
  v_and_b32 v172, s87, v179
  v_cvt_pk_bf16_f32 v180, v173, v174
  v_lshlrev_b32 v173, 16, v180
  v_and_b32 v174, s87, v180
  v_mul_f32 v175, v171, v171
  v_mul_f32 v176, v172, v172
  v_mul_f32 v177, v173, v173
  v_mul_f32 v178, v174, v174
  v_fmaak_f32 v175, v175, v143, 0x40135761
  v_fmaak_f32 v176, v176, v143, 0x40135761
  v_fmaak_f32 v177, v177, v143, 0x40135761
  v_fmaak_f32 v178, v178, v143, 0x40135761
  v_mul_f32 v175, v175, v171
  v_mul_f32 v176, v176, v172
  v_mul_f32 v177, v177, v173
  v_mul_f32 v178, v178, v174
  v_exp_f32 v175, -v175
  v_exp_f32 v176, -v176
  v_exp_f32 v177, -v177
  v_exp_f32 v178, -v178
  v_add_f32 v175, 1.0, v175
  v_add_f32 v176, 1.0, v176
  v_add_f32 v177, 1.0, v177
  v_add_f32 v178, 1.0, v178
  v_rcp_f32 v175, v175
  v_rcp_f32 v176, v176
  v_rcp_f32 v177, v177
  v_rcp_f32 v178, v178
  v_mul_f32 v171, v171, v175
  v_mul_f32 v172, v172, v176
  v_mul_f32 v173, v173, v177
  v_mul_f32 v174, v174, v178
  v_cvt_pk_bf16_f32 v179, v171, v172
  v_cvt_pk_bf16_f32 v180, v173, v174
  v_dot2_f32_bf16 v162, v179, v138, v162
  v_dot2_f32_bf16 v162, v180, v139, v162
  v_mul_f32 v171, s65, v144
  v_mul_f32 v172, s65, v145
  v_mul_f32 v173, s65, v146
  v_mul_f32 v174, s65, v147
  v_cvt_pk_bf16_f32 v179, v171, v172
  v_lshlrev_b32 v171, 16, v179
  v_and_b32 v172, s87, v179
  v_cvt_pk_bf16_f32 v180, v173, v174
  v_lshlrev_b32 v173, 16, v180
  v_and_b32 v174, s87, v180
  v_add_f32 v171, v171, v153
  v_add_f32 v172, v172, v154
  v_add_f32 v173, v173, v155
  v_add_f32 v174, v174, v156
  v_cvt_pk_bf16_f32 v179, v171, v172
  v_lshlrev_b32 v171, 16, v179
  v_and_b32 v172, s87, v179
  v_cvt_pk_bf16_f32 v180, v173, v174
  v_lshlrev_b32 v173, 16, v180
  v_and_b32 v174, s87, v180
  v_mul_f32 v175, v171, v171
  v_mul_f32 v176, v172, v172
  v_mul_f32 v177, v173, v173
  v_mul_f32 v178, v174, v174
  v_fmaak_f32 v175, v175, v143, 0x40135761
  v_fmaak_f32 v176, v176, v143, 0x40135761
  v_fmaak_f32 v177, v177, v143, 0x40135761
  v_fmaak_f32 v178, v178, v143, 0x40135761
  v_mul_f32 v175, v175, v171
  v_mul_f32 v176, v176, v172
  v_mul_f32 v177, v177, v173
  v_mul_f32 v178, v178, v174
  v_exp_f32 v175, -v175
  v_exp_f32 v176, -v176
  v_exp_f32 v177, -v177
  v_exp_f32 v178, -v178
  v_add_f32 v175, 1.0, v175
  v_add_f32 v176, 1.0, v176
  v_add_f32 v177, 1.0, v177
  v_add_f32 v178, 1.0, v178
  v_rcp_f32 v175, v175
  v_rcp_f32 v176, v176
  v_rcp_f32 v177, v177
  v_rcp_f32 v178, v178
  v_mul_f32 v171, v171, v175
  v_mul_f32 v172, v172, v176
  v_mul_f32 v173, v173, v177
  v_mul_f32 v174, v174, v178
  v_cvt_pk_bf16_f32 v179, v171, v172
  v_cvt_pk_bf16_f32 v180, v173, v174
  v_dot2_f32_bf16 v163, v179, v136, 0
  v_dot2_f32_bf16 v163, v180, v137, v163
  v_mul_f32 v171, s65, v148
  v_mul_f32 v172, s65, v149
  v_mul_f32 v173, s65, v150
  v_mul_f32 v174, s65, v151
  v_cvt_pk_bf16_f32 v179, v171, v172
  v_lshlrev_b32 v171, 16, v179
  v_and_b32 v172, s87, v179
  v_cvt_pk_bf16_f32 v180, v173, v174
  v_lshlrev_b32 v173, 16, v180
  v_and_b32 v174, s87, v180
  v_add_f32 v171, v171, v157
  v_add_f32 v172, v172, v158
  v_add_f32 v173, v173, v159
  v_add_f32 v174, v174, v160
  v_cvt_pk_bf16_f32 v179, v171, v172
  v_lshlrev_b32 v171, 16, v179
  v_and_b32 v172, s87, v179
  v_cvt_pk_bf16_f32 v180, v173, v174
  v_lshlrev_b32 v173, 16, v180
  v_and_b32 v174, s87, v180
  v_mul_f32 v175, v171, v171
  v_mul_f32 v176, v172, v172
  v_mul_f32 v177, v173, v173
  v_mul_f32 v178, v174, v174
  v_fmaak_f32 v175, v175, v143, 0x40135761
  v_fmaak_f32 v176, v176, v143, 0x40135761
  v_fmaak_f32 v177, v177, v143, 0x40135761
  v_fmaak_f32 v178, v178, v143, 0x40135761
  v_mul_f32 v175, v175, v171
  v_mul_f32 v176, v176, v172
  v_mul_f32 v177, v177, v173
  v_mul_f32 v178, v178, v174
  v_exp_f32 v175, -v175
  v_exp_f32 v176, -v176
  v_exp_f32 v177, -v177
  v_exp_f32 v178, -v178
  v_add_f32 v175, 1.0, v175
  v_add_f32 v176, 1.0, v176
  v_add_f32 v177, 1.0, v177
  v_add_f32 v178, 1.0, v178
  v_rcp_f32 v175, v175
  v_rcp_f32 v176, v176
  v_rcp_f32 v177, v177
  v_rcp_f32 v178, v178
  v_mul_f32 v171, v171, v175
  v_mul_f32 v172, v172, v176
  v_mul_f32 v173, v173, v177
  v_mul_f32 v174, v174, v178
  v_cvt_pk_bf16_f32 v179, v171, v172
  v_cvt_pk_bf16_f32 v180, v173, v174
  v_dot2_f32_bf16 v163, v179, v138, v163
  v_dot2_f32_bf16 v163, v180, v139, v163
  s_lshl_b32 s84, s82, 14
  s_add_u32 s84, s84, 16384
  v_lshlrev_b32 v7, 4, v1
  v_add_u32 v7, s84, v7
  ds_read_b128 v[48:51], v7 offset:0
  ds_read_b128 v[52:55], v7 offset:1024
  ds_read_b128 v[56:59], v7 offset:2048
  ds_read_b128 v[60:63], v7 offset:3072
  ds_read_b128 v[64:67], v7 offset:4096
  ds_read_b128 v[68:71], v7 offset:5120
  ds_read_b128 v[72:75], v7 offset:6144
  ds_read_b128 v[76:79], v7 offset:7168
  s_waitcnt lgkmcnt(4)
  v_dot2_f32_bf16 v32, v48, v8, 0
  v_dot2_f32_bf16 v36, v48, v12, 0
  v_dot2_f32_bf16 v33, v52, v8, 0
  v_dot2_f32_bf16 v37, v52, v12, 0
  v_dot2_f32_bf16 v34, v56, v8, 0
  v_dot2_f32_bf16 v38, v56, v12, 0
  v_dot2_f32_bf16 v35, v60, v8, 0
  v_dot2_f32_bf16 v39, v60, v12, 0
  v_dot2_f32_bf16 v32, v49, v9, v32
  v_dot2_f32_bf16 v36, v49, v13, v36
  v_dot2_f32_bf16 v33, v53, v9, v33
  v_dot2_f32_bf16 v37, v53, v13, v37
  v_dot2_f32_bf16 v34, v57, v9, v34
  v_dot2_f32_bf16 v38, v57, v13, v38
  v_dot2_f32_bf16 v35, v61, v9, v35
  v_dot2_f32_bf16 v39, v61, v13, v39
  v_dot2_f32_bf16 v32, v50, v10, v32
  v_dot2_f32_bf16 v36, v50, v14, v36
  v_dot2_f32_bf16 v33, v54, v10, v33
  v_dot2_f32_bf16 v37, v54, v14, v37
  v_dot2_f32_bf16 v34, v58, v10, v34
  v_dot2_f32_bf16 v38, v58, v14, v38
  v_dot2_f32_bf16 v35, v62, v10, v35
  v_dot2_f32_bf16 v39, v62, v14, v39
  v_dot2_f32_bf16 v32, v51, v11, v32
  v_dot2_f32_bf16 v36, v51, v15, v36
  v_dot2_f32_bf16 v33, v55, v11, v33
  v_dot2_f32_bf16 v37, v55, v15, v37
  v_dot2_f32_bf16 v34, v59, v11, v34
  v_dot2_f32_bf16 v38, v59, v15, v38
  v_dot2_f32_bf16 v35, v63, v11, v35
  v_dot2_f32_bf16 v39, v63, v15, v39
  v_add_f32_dpp v32, v32, v32 row_ror:8 row_mask:0xf bank_mask:0x3
  v_add_f32_dpp v33, v33, v33 row_ror:8 row_mask:0xf bank_mask:0x3
  v_add_f32_dpp v36, v36, v36 row_ror:8 row_mask:0xf bank_mask:0x3
  v_add_f32_dpp v37, v37, v37 row_ror:8 row_mask:0xf bank_mask:0x3
  v_add_f32_dpp v32, v34, v34 row_ror:8 row_mask:0xf bank_mask:0xc
  v_add_f32_dpp v33, v35, v35 row_ror:8 row_mask:0xf bank_mask:0xc
  v_add_f32_dpp v36, v38, v38 row_ror:8 row_mask:0xf bank_mask:0xc
  v_add_f32_dpp v37, v39, v39 row_ror:8 row_mask:0xf bank_mask:0xc
  v_add_f32_dpp v32, v32, v32 row_shl:4 row_mask:0xf bank_mask:0x5
  v_add_f32_dpp v33, v33, v33 row_shl:4 row_mask:0xf bank_mask:0x5
  s_nop 0
  v_add_f32_dpp v32, v36, v36 row_shr:4 row_mask:0xf bank_mask:0xa
  v_add_f32_dpp v33, v37, v37 row_shr:4 row_mask:0xf bank_mask:0xa
  s_nop 0
  v_add_f32_dpp v32, v32, v32 quad_perm:[1,0,3,2] row_mask:0xf bank_mask:0xf
  v_add_f32_dpp v33, v33, v33 quad_perm:[1,0,3,2] row_mask:0xf bank_mask:0xf
  s_nop 0
  v_add_f32_dpp v32, v32, v32 quad_perm:[2,3,0,1] row_mask:0xf bank_mask:0xf
  v_add_f32_dpp v33, v33, v33 quad_perm:[2,3,0,1] row_mask:0xf bank_mask:0xf
  v_cvt_pk_bf16_f32 v34, v32, v33
  v_lshlrev_b32 v32, 16, v34
  v_and_b32 v33, s87, v34
  v_mul_f32 v32, s88, v32
  v_mul_f32 v33, s88, v33
  v_cvt_pk_bf16_f32 v34, v32, v33
  v_lshlrev_b32 v32, 16, v34
  v_and_b32 v33, s87, v34
  v_fma_f32 v32, v32, s89, -v3
  v_fma_f32 v33, v33, s89, -v3
  v_max_f32 v35, v32, v33
  v_cmp_lt_f32 vcc, 0x41000000, v35
  v_exp_f32 v37, v32
  v_exp_f32 v38, v33
  s_cmp_eq_u64 vcc, 0
  s_cbranch_scc1 K1_LZ2B
  v_max_f32_dpp v35, v35, v35 row_ror:8 row_mask:0xf bank_mask:0xf
  v_max_f32 v35, 0, v35
  v_exp_f32 v36, -v35
  v_add_f32 v3, v3, v35
  v_sub_f32 v32, v32, v35
  v_sub_f32 v33, v33, v35
  v_exp_f32 v37, v32
  v_exp_f32 v38, v33
  v_mul_f32 v4, v4, v36
  v_mul_f32_dpp v16, v36, v16 row_newbcast:0 row_mask:0xf bank_mask:0xf
  v_mul_f32_dpp v17, v36, v17 row_newbcast:0 row_mask:0xf bank_mask:0xf
  v_mul_f32_dpp v18, v36, v18 row_newbcast:0 row_mask:0xf bank_mask:0xf
  v_mul_f32_dpp v19, v36, v19 row_newbcast:0 row_mask:0xf bank_mask:0xf
  v_mul_f32_dpp v20, v36, v20 row_newbcast:0 row_mask:0xf bank_mask:0xf
  v_mul_f32_dpp v21, v36, v21 row_newbcast:0 row_mask:0xf bank_mask:0xf
  v_mul_f32_dpp v22, v36, v22 row_newbcast:0 row_mask:0xf bank_mask:0xf
  v_mul_f32_dpp v23, v36, v23 row_newbcast:0 row_mask:0xf bank_mask:0xf
  v_mul_f32_dpp v24, v36, v24 row_newbcast:4 row_mask:0xf bank_mask:0xf
  v_mul_f32_dpp v25, v36, v25 row_newbcast:4 row_mask:0xf bank_mask:0xf
  v_mul_f32_dpp v26, v36, v26 row_newbcast:4 row_mask:0xf bank_mask:0xf
  v_mul_f32_dpp v27, v36, v27 row_newbcast:4 row_mask:0xf bank_mask:0xf
  v_mul_f32_dpp v28, v36, v28 row_newbcast:4 row_mask:0xf bank_mask:0xf
  v_mul_f32_dpp v29, v36, v29 row_newbcast:4 row_mask:0xf bank_mask:0xf
  v_mul_f32_dpp v30, v36, v30 row_newbcast:4 row_mask:0xf bank_mask:0xf
  v_mul_f32_dpp v31, v36, v31 row_newbcast:4 row_mask:0xf bank_mask:0xf
K1_LZ2B:
  s_nop 1
  v_add_f32 v4, v4, v37
  v_cvt_pk_bf16_f32 v44, v37, v38
  v_add_f32 v4, v4, v38
  s_waitcnt lgkmcnt(0)
  v_perm_b32 v40, v68, v64, s85
  v_perm_b32 v41, v68, v64, s86
  v_perm_b32 v42, v69, v65, s85
  v_perm_b32 v43, v69, v65, s86
  v_dot2c_f32_bf16_dpp v16, v44, v40 row_newbcast:0 row_mask:0xf bank_mask:0xf
  v_dot2c_f32_bf16_dpp v17, v44, v41 row_newbcast:0 row_mask:0xf bank_mask:0xf
  v_dot2c_f32_bf16_dpp v18, v44, v42 row_newbcast:0 row_mask:0xf bank_mask:0xf
  v_dot2c_f32_bf16_dpp v19, v44, v43 row_newbcast:0 row_mask:0xf bank_mask:0xf
  v_dot2c_f32_bf16_dpp v24, v44, v40 row_newbcast:4 row_mask:0xf bank_mask:0xf
  v_dot2c_f32_bf16_dpp v25, v44, v41 row_newbcast:4 row_mask:0xf bank_mask:0xf
  v_dot2c_f32_bf16_dpp v26, v44, v42 row_newbcast:4 row_mask:0xf bank_mask:0xf
  v_dot2c_f32_bf16_dpp v27, v44, v43 row_newbcast:4 row_mask:0xf bank_mask:0xf
  v_perm_b32 v40, v70, v66, s85
  v_perm_b32 v41, v70, v66, s86
  v_perm_b32 v42, v71, v67, s85
  v_perm_b32 v43, v71, v67, s86
  v_dot2c_f32_bf16_dpp v20, v44, v40 row_newbcast:0 row_mask:0xf bank_mask:0xf
  v_dot2c_f32_bf16_dpp v21, v44, v41 row_newbcast:0 row_mask:0xf bank_mask:0xf
  v_dot2c_f32_bf16_dpp v22, v44, v42 row_newbcast:0 row_mask:0xf bank_mask:0xf
  v_dot2c_f32_bf16_dpp v23, v44, v43 row_newbcast:0 row_mask:0xf bank_mask:0xf
  v_dot2c_f32_bf16_dpp v28, v44, v40 row_newbcast:4 row_mask:0xf bank_mask:0xf
  v_dot2c_f32_bf16_dpp v29, v44, v41 row_newbcast:4 row_mask:0xf bank_mask:0xf
  v_dot2c_f32_bf16_dpp v30, v44, v42 row_newbcast:4 row_mask:0xf bank_mask:0xf
  v_dot2c_f32_bf16_dpp v31, v44, v43 row_newbcast:4 row_mask:0xf bank_mask:0xf
  v_perm_b32 v40, v76, v72, s85
  v_perm_b32 v41, v76, v72, s86
  v_perm_b32 v42, v77, v73, s85
  v_perm_b32 v43, v77, v73, s86
  v_dot2c_f32_bf16_dpp v16, v44, v40 row_newbcast:8 row_mask:0xf bank_mask:0xf
  v_dot2c_f32_bf16_dpp v17, v44, v41 row_newbcast:8 row_mask:0xf bank_mask:0xf
  v_dot2c_f32_bf16_dpp v18, v44, v42 row_newbcast:8 row_mask:0xf bank_mask:0xf
  v_dot2c_f32_bf16_dpp v19, v44, v43 row_newbcast:8 row_mask:0xf bank_mask:0xf
  v_dot2c_f32_bf16_dpp v24, v44, v40 row_newbcast:12 row_mask:0xf bank_mask:0xf
  v_dot2c_f32_bf16_dpp v25, v44, v41 row_newbcast:12 row_mask:0xf bank_mask:0xf
  v_dot2c_f32_bf16_dpp v26, v44, v42 row_newbcast:12 row_mask:0xf bank_mask:0xf
  v_dot2c_f32_bf16_dpp v27, v44, v43 row_newbcast:12 row_mask:0xf bank_mask:0xf
  v_perm_b32 v40, v78, v74, s85
  v_perm_b32 v41, v78, v74, s86
  v_perm_b32 v42, v79, v75, s85
  v_perm_b32 v43, v79, v75, s86
  v_dot2c_f32_bf16_dpp v20, v44, v40 row_newbcast:8 row_mask:0xf bank_mask:0xf
  v_dot2c_f32_bf16_dpp v21, v44, v41 row_newbcast:8 row_mask:0xf bank_mask:0xf
  v_dot2c_f32_bf16_dpp v22, v44, v42 row_newbcast:8 row_mask:0xf bank_mask:0xf
  v_dot2c_f32_bf16_dpp v23, v44, v43 row_newbcast:8 row_mask:0xf bank_mask:0xf
  v_dot2c_f32_bf16_dpp v28, v44, v40 row_newbcast:12 row_mask:0xf bank_mask:0xf
  v_dot2c_f32_bf16_dpp v29, v44, v41 row_newbcast:12 row_mask:0xf bank_mask:0xf
  v_dot2c_f32_bf16_dpp v30, v44, v42 row_newbcast:12 row_mask:0xf bank_mask:0xf
  v_dot2c_f32_bf16_dpp v31, v44, v43 row_newbcast:12 row_mask:0xf bank_mask:0xf
  v_mul_f32 v171, s66, v144
  v_mul_f32 v172, s66, v145
  v_mul_f32 v173, s66, v146
  v_mul_f32 v174, s66, v147
  v_cvt_pk_bf16_f32 v179, v171, v172
  v_lshlrev_b32 v171, 16, v179
  v_and_b32 v172, s87, v179
  v_cvt_pk_bf16_f32 v180, v173, v174
  v_lshlrev_b32 v173, 16, v180
  v_and_b32 v174, s87, v180
  v_add_f32 v171, v171, v153
  v_add_f32 v172, v172, v154
  v_add_f32 v173, v173, v155
  v_add_f32 v174, v174, v156
  v_cvt_pk_bf16_f32 v179, v171, v172
  v_lshlrev_b32 v171, 16, v179
  v_and_b32 v172, s87, v179
  v_cvt_pk_bf16_f32 v180, v173, v174
  v_lshlrev_b32 v173, 16, v180
  v_and_b32 v174, s87, v180
  v_mul_f32 v175, v171, v171
  v_mul_f32 v176, v172, v172
  v_mul_f32 v177, v173, v173
  v_mul_f32 v178, v174, v174
  v_fmaak_f32 v175, v175, v143, 0x40135761
  v_fmaak_f32 v176, v176, v143, 0x40135761
  v_fmaak_f32 v177, v177, v143, 0x40135761
  v_fmaak_f32 v178, v178, v143, 0x40135761
  v_mul_f32 v175, v175, v171
  v_mul_f32 v176, v176, v172
  v_mul_f32 v177, v177, v173
  v_mul_f32 v178, v178, v174
  v_exp_f32 v175, -v175
  v_exp_f32 v176, -v176
  v_exp_f32 v177, -v177
  v_exp_f32 v178, -v178
  v_add_f32 v175, 1.0, v175
  v_add_f32 v176, 1.0, v176
  v_add_f32 v177, 1.0, v177
  v_add_f32 v178, 1.0, v178
  v_rcp_f32 v175, v175
  v_rcp_f32 v176, v176
  v_rcp_f32 v177, v177
  v_rcp_f32 v178, v178
  v_mul_f32 v171, v171, v175
  v_mul_f32 v172, v172, v176
  v_mul_f32 v173, v173, v177
  v_mul_f32 v174, v174, v178
  v_cvt_pk_bf16_f32 v179, v171, v172
  v_cvt_pk_bf16_f32 v180, v173, v174
  v_dot2_f32_bf16 v164, v179, v136, 0
  v_dot2_f32_bf16 v164, v180, v137, v164
  v_mul_f32 v171, s66, v148
  v_mul_f32 v172, s66, v149
  v_mul_f32 v173, s66, v150
  v_mul_f32 v174, s66, v151
  v_cvt_pk_bf16_f32 v179, v171, v172
  v_lshlrev_b32 v171, 16, v179
  v_and_b32 v172, s87, v179
  v_cvt_pk_bf16_f32 v180, v173, v174
  v_lshlrev_b32 v173, 16, v180
  v_and_b32 v174, s87, v180
  v_add_f32 v171, v171, v157
  v_add_f32 v172, v172, v158
  v_add_f32 v173, v173, v159
  v_add_f32 v174, v174, v160
  v_cvt_pk_bf16_f32 v179, v171, v172
  v_lshlrev_b32 v171, 16, v179
  v_and_b32 v172, s87, v179
  v_cvt_pk_bf16_f32 v180, v173, v174
  v_lshlrev_b32 v173, 16, v180
  v_and_b32 v174, s87, v180
  v_mul_f32 v175, v171, v171
  v_mul_f32 v176, v172, v172
  v_mul_f32 v177, v173, v173
  v_mul_f32 v178, v174, v174
  v_fmaak_f32 v175, v175, v143, 0x40135761
  v_fmaak_f32 v176, v176, v143, 0x40135761
  v_fmaak_f32 v177, v177, v143, 0x40135761
  v_fmaak_f32 v178, v178, v143, 0x40135761
  v_mul_f32 v175, v175, v171
  v_mul_f32 v176, v176, v172
  v_mul_f32 v177, v177, v173
  v_mul_f32 v178, v178, v174
  v_exp_f32 v175, -v175
  v_exp_f32 v176, -v176
  v_exp_f32 v177, -v177
  v_exp_f32 v178, -v178
  v_add_f32 v175, 1.0, v175
  v_add_f32 v176, 1.0, v176
  v_add_f32 v177, 1.0, v177
  v_add_f32 v178, 1.0, v178
  v_rcp_f32 v175, v175
  v_rcp_f32 v176, v176
  v_rcp_f32 v177, v177
  v_rcp_f32 v178, v178
  v_mul_f32 v171, v171, v175
  v_mul_f32 v172, v172, v176
  v_mul_f32 v173, v173, v177
  v_mul_f32 v174, v174, v178
  v_cvt_pk_bf16_f32 v179, v171, v172
  v_cvt_pk_bf16_f32 v180, v173, v174
  v_dot2_f32_bf16 v164, v179, v138, v164
  v_dot2_f32_bf16 v164, v180, v139, v164
  v_mul_f32 v171, s67, v144
  v_mul_f32 v172, s67, v145
  v_mul_f32 v173, s67, v146
  v_mul_f32 v174, s67, v147
  v_cvt_pk_bf16_f32 v179, v171, v172
  v_lshlrev_b32 v171, 16, v179
  v_and_b32 v172, s87, v179
  v_cvt_pk_bf16_f32 v180, v173, v174
  v_lshlrev_b32 v173, 16, v180
  v_and_b32 v174, s87, v180
  v_add_f32 v171, v171, v153
  v_add_f32 v172, v172, v154
  v_add_f32 v173, v173, v155
  v_add_f32 v174, v174, v156
  v_cvt_pk_bf16_f32 v179, v171, v172
  v_lshlrev_b32 v171, 16, v179
  v_and_b32 v172, s87, v179
  v_cvt_pk_bf16_f32 v180, v173, v174
  v_lshlrev_b32 v173, 16, v180
  v_and_b32 v174, s87, v180
  v_mul_f32 v175, v171, v171
  v_mul_f32 v176, v172, v172
  v_mul_f32 v177, v173, v173
  v_mul_f32 v178, v174, v174
  v_fmaak_f32 v175, v175, v143, 0x40135761
  v_fmaak_f32 v176, v176, v143, 0x40135761
  v_fmaak_f32 v177, v177, v143, 0x40135761
  v_fmaak_f32 v178, v178, v143, 0x40135761
  v_mul_f32 v175, v175, v171
  v_mul_f32 v176, v176, v172
  v_mul_f32 v177, v177, v173
  v_mul_f32 v178, v178, v174
  v_exp_f32 v175, -v175
  v_exp_f32 v176, -v176
  v_exp_f32 v177, -v177
  v_exp_f32 v178, -v178
  v_add_f32 v175, 1.0, v175
  v_add_f32 v176, 1.0, v176
  v_add_f32 v177, 1.0, v177
  v_add_f32 v178, 1.0, v178
  v_rcp_f32 v175, v175
  v_rcp_f32 v176, v176
  v_rcp_f32 v177, v177
  v_rcp_f32 v178, v178
  v_mul_f32 v171, v171, v175
  v_mul_f32 v172, v172, v176
  v_mul_f32 v173, v173, v177
  v_mul_f32 v174, v174, v178
  v_cvt_pk_bf16_f32 v179, v171, v172
  v_cvt_pk_bf16_f32 v180, v173, v174
  v_dot2_f32_bf16 v165, v179, v136, 0
  v_dot2_f32_bf16 v165, v180, v137, v165
  v_mul_f32 v171, s67, v148
  v_mul_f32 v172, s67, v149
  v_mul_f32 v173, s67, v150
  v_mul_f32 v174, s67, v151
  v_cvt_pk_bf16_f32 v179, v171, v172
  v_lshlrev_b32 v171, 16, v179
  v_and_b32 v172, s87, v179
  v_cvt_pk_bf16_f32 v180, v173, v174
  v_lshlrev_b32 v173, 16, v180
  v_and_b32 v174, s87, v180
  v_add_f32 v171, v171, v157
  v_add_f32 v172, v172, v158
  v_add_f32 v173, v173, v159
  v_add_f32 v174, v174, v160
  v_cvt_pk_bf16_f32 v179, v171, v172
  v_lshlrev_b32 v171, 16, v179
  v_and_b32 v172, s87, v179
  v_cvt_pk_bf16_f32 v180, v173, v174
  v_lshlrev_b32 v173, 16, v180
  v_and_b32 v174, s87, v180
  v_mul_f32 v175, v171, v171
  v_mul_f32 v176, v172, v172
  v_mul_f32 v177, v173, v173
  v_mul_f32 v178, v174, v174
  v_fmaak_f32 v175, v175, v143, 0x40135761
  v_fmaak_f32 v176, v176, v143, 0x40135761
  v_fmaak_f32 v177, v177, v143, 0x40135761
  v_fmaak_f32 v178, v178, v143, 0x40135761
  v_mul_f32 v175, v175, v171
  v_mul_f32 v176, v176, v172
  v_mul_f32 v177, v177, v173
  v_mul_f32 v178, v178, v174
  v_exp_f32 v175, -v175
  v_exp_f32 v176, -v176
  v_exp_f32 v177, -v177
  v_exp_f32 v178, -v178
  v_add_f32 v175, 1.0, v175
  v_add_f32 v176, 1.0, v176
  v_add_f32 v177, 1.0, v177
  v_add_f32 v178, 1.0, v178
  v_rcp_f32 v175, v175
  v_rcp_f32 v176, v176
  v_rcp_f32 v177, v177
  v_rcp_f32 v178, v178
  v_mul_f32 v171, v171, v175
  v_mul_f32 v172, v172, v176
  v_mul_f32 v173, v173, v177
  v_mul_f32 v174, v174, v178
  v_cvt_pk_bf16_f32 v179, v171, v172
  v_cvt_pk_bf16_f32 v180, v173, v174
  v_dot2_f32_bf16 v165, v179, v138, v165
  v_dot2_f32_bf16 v165, v180, v139, v165
  s_lshl_b32 s84, s82, 14
  s_add_u32 s84, s84, 16384
  v_lshlrev_b32 v7, 4, v1
  v_add_u32 v7, s84, v7
  ds_read_b128 v[80:83], v7 offset:8192
  ds_read_b128 v[84:87], v7 offset:9216
  ds_read_b128 v[88:91], v7 offset:10240
  ds_read_b128 v[92:95], v7 offset:11264
  ds_read_b128 v[96:99], v7 offset:12288
  ds_read_b128 v[100:103], v7 offset:13312
  ds_read_b128 v[104:107], v7 offset:14336
  ds_read_b128 v[108:111], v7 offset:15360
  s_waitcnt lgkmcnt(4)
  v_dot2_f32_bf16 v32, v80, v8, 0
  v_dot2_f32_bf16 v36, v80, v12, 0
  v_dot2_f32_bf16 v33, v84, v8, 0
  v_dot2_f32_bf16 v37, v84, v12, 0
  v_dot2_f32_bf16 v34, v88, v8, 0
  v_dot2_f32_bf16 v38, v88, v12, 0
  v_dot2_f32_bf16 v35, v92, v8, 0
  v_dot2_f32_bf16 v39, v92, v12, 0
  v_dot2_f32_bf16 v32, v81, v9, v32
  v_dot2_f32_bf16 v36, v81, v13, v36
  v_dot2_f32_bf16 v33, v85, v9, v33
  v_dot2_f32_bf16 v37, v85, v13, v37
  v_dot2_f32_bf16 v34, v89, v9, v34
  v_dot2_f32_bf16 v38, v89, v13, v38
  v_dot2_f32_bf16 v35, v93, v9, v35
  v_dot2_f32_bf16 v39, v93, v13, v39
  v_dot2_f32_bf16 v32, v82, v10, v32
  v_dot2_f32_bf16 v36, v82, v14, v36
  v_dot2_f32_bf16 v33, v86, v10, v33
  v_dot2_f32_bf16 v37, v86, v14, v37
  v_dot2_f32_bf16 v34, v90, v10, v34
  v_dot2_f32_bf16 v38, v90, v14, v38
  v_dot2_f32_bf16 v35, v94, v10, v35
  v_dot2_f32_bf16 v39, v94, v14, v39
  v_dot2_f32_bf16 v32, v83, v11, v32
  v_dot2_f32_bf16 v36, v83, v15, v36
  v_dot2_f32_bf16 v33, v87, v11, v33
  v_dot2_f32_bf16 v37, v87, v15, v37
  v_dot2_f32_bf16 v34, v91, v11, v34
  v_dot2_f32_bf16 v38, v91, v15, v38
  v_dot2_f32_bf16 v35, v95, v11, v35
  v_dot2_f32_bf16 v39, v95, v15, v39
  v_add_f32_dpp v32, v32, v32 row_ror:8 row_mask:0xf bank_mask:0x3
  v_add_f32_dpp v33, v33, v33 row_ror:8 row_mask:0xf bank_mask:0x3
  v_add_f32_dpp v36, v36, v36 row_ror:8 row_mask:0xf bank_mask:0x3
  v_add_f32_dpp v37, v37, v37 row_ror:8 row_mask:0xf bank_mask:0x3
  v_add_f32_dpp v32, v34, v34 row_ror:8 row_mask:0xf bank_mask:0xc
  v_add_f32_dpp v33, v35, v35 row_ror:8 row_mask:0xf bank_mask:0xc
  v_add_f32_dpp v36, v38, v38 row_ror:8 row_mask:0xf bank_mask:0xc
  v_add_f32_dpp v37, v39, v39 row_ror:8 row_mask:0xf bank_mask:0xc
  v_add_f32_dpp v32, v32, v32 row_shl:4 row_mask:0xf bank_mask:0x5
  v_add_f32_dpp v33, v33, v33 row_shl:4 row_mask:0xf bank_mask:0x5
  s_nop 0
  v_add_f32_dpp v32, v36, v36 row_shr:4 row_mask:0xf bank_mask:0xa
  v_add_f32_dpp v33, v37, v37 row_shr:4 row_mask:0xf bank_mask:0xa
  s_nop 0
  v_add_f32_dpp v32, v32, v32 quad_perm:[1,0,3,2] row_mask:0xf bank_mask:0xf
  v_add_f32_dpp v33, v33, v33 quad_perm:[1,0,3,2] row_mask:0xf bank_mask:0xf
  s_nop 0
  v_add_f32_dpp v32, v32, v32 quad_perm:[2,3,0,1] row_mask:0xf bank_mask:0xf
  v_add_f32_dpp v33, v33, v33 quad_perm:[2,3,0,1] row_mask:0xf bank_mask:0xf
  v_cvt_pk_bf16_f32 v34, v32, v33
  v_lshlrev_b32 v32, 16, v34
  v_and_b32 v33, s87, v34
  v_mul_f32 v32, s88, v32
  v_mul_f32 v33, s88, v33
  v_cvt_pk_bf16_f32 v34, v32, v33
  v_lshlrev_b32 v32, 16, v34
  v_and_b32 v33, s87, v34
  v_fma_f32 v32, v32, s89, -v3
  v_fma_f32 v33, v33, s89, -v3
  v_max_f32 v35, v32, v33
  v_cmp_lt_f32 vcc, 0x41000000, v35
  v_exp_f32 v37, v32
  v_exp_f32 v38, v33
  s_cmp_eq_u64 vcc, 0
  s_cbranch_scc1 K1_LZ3B
  v_max_f32_dpp v35, v35, v35 row_ror:8 row_mask:0xf bank_mask:0xf
  v_max_f32 v35, 0, v35
  v_exp_f32 v36, -v35
  v_add_f32 v3, v3, v35
  v_sub_f32 v32, v32, v35
  v_sub_f32 v33, v33, v35
  v_exp_f32 v37, v32
  v_exp_f32 v38, v33
  v_mul_f32 v4, v4, v36
  v_mul_f32_dpp v16, v36, v16 row_newbcast:0 row_mask:0xf bank_mask:0xf
  v_mul_f32_dpp v17, v36, v17 row_newbcast:0 row_mask:0xf bank_mask:0xf
  v_mul_f32_dpp v18, v36, v18 row_newbcast:0 row_mask:0xf bank_mask:0xf
  v_mul_f32_dpp v19, v36, v19 row_newbcast:0 row_mask:0xf bank_mask:0xf
  v_mul_f32_dpp v20, v36, v20 row_newbcast:0 row_mask:0xf bank_mask:0xf
  v_mul_f32_dpp v21, v36, v21 row_newbcast:0 row_mask:0xf bank_mask:0xf
  v_mul_f32_dpp v22, v36, v22 row_newbcast:0 row_mask:0xf bank_mask:0xf
  v_mul_f32_dpp v23, v36, v23 row_newbcast:0 row_mask:0xf bank_mask:0xf
  v_mul_f32_dpp v24, v36, v24 row_newbcast:4 row_mask:0xf bank_mask:0xf
  v_mul_f32_dpp v25, v36, v25 row_newbcast:4 row_mask:0xf bank_mask:0xf
  v_mul_f32_dpp v26, v36, v26 row_newbcast:4 row_mask:0xf bank_mask:0xf
  v_mul_f32_dpp v27, v36, v27 row_newbcast:4 row_mask:0xf bank_mask:0xf
  v_mul_f32_dpp v28, v36, v28 row_newbcast:4 row_mask:0xf bank_mask:0xf
  v_mul_f32_dpp v29, v36, v29 row_newbcast:4 row_mask:0xf bank_mask:0xf
  v_mul_f32_dpp v30, v36, v30 row_newbcast:4 row_mask:0xf bank_mask:0xf
  v_mul_f32_dpp v31, v36, v31 row_newbcast:4 row_mask:0xf bank_mask:0xf
K1_LZ3B:
  s_nop 1
  v_add_f32 v4, v4, v37
  v_cvt_pk_bf16_f32 v44, v37, v38
  v_add_f32 v4, v4, v38
  s_waitcnt lgkmcnt(0)
  v_perm_b32 v40, v100, v96, s85
  v_perm_b32 v41, v100, v96, s86
  v_perm_b32 v42, v101, v97, s85
  v_perm_b32 v43, v101, v97, s86
  v_dot2c_f32_bf16_dpp v16, v44, v40 row_newbcast:0 row_mask:0xf bank_mask:0xf
  v_dot2c_f32_bf16_dpp v17, v44, v41 row_newbcast:0 row_mask:0xf bank_mask:0xf
  v_dot2c_f32_bf16_dpp v18, v44, v42 row_newbcast:0 row_mask:0xf bank_mask:0xf
  v_dot2c_f32_bf16_dpp v19, v44, v43 row_newbcast:0 row_mask:0xf bank_mask:0xf
  v_dot2c_f32_bf16_dpp v24, v44, v40 row_newbcast:4 row_mask:0xf bank_mask:0xf
  v_dot2c_f32_bf16_dpp v25, v44, v41 row_newbcast:4 row_mask:0xf bank_mask:0xf
  v_dot2c_f32_bf16_dpp v26, v44, v42 row_newbcast:4 row_mask:0xf bank_mask:0xf
  v_dot2c_f32_bf16_dpp v27, v44, v43 row_newbcast:4 row_mask:0xf bank_mask:0xf
  v_perm_b32 v40, v102, v98, s85
  v_perm_b32 v41, v102, v98, s86
  v_perm_b32 v42, v103, v99, s85
  v_perm_b32 v43, v103, v99, s86
  v_dot2c_f32_bf16_dpp v20, v44, v40 row_newbcast:0 row_mask:0xf bank_mask:0xf
  v_dot2c_f32_bf16_dpp v21, v44, v41 row_newbcast:0 row_mask:0xf bank_mask:0xf
  v_dot2c_f32_bf16_dpp v22, v44, v42 row_newbcast:0 row_mask:0xf bank_mask:0xf
  v_dot2c_f32_bf16_dpp v23, v44, v43 row_newbcast:0 row_mask:0xf bank_mask:0xf
  v_dot2c_f32_bf16_dpp v28, v44, v40 row_newbcast:4 row_mask:0xf bank_mask:0xf
  v_dot2c_f32_bf16_dpp v29, v44, v41 row_newbcast:4 row_mask:0xf bank_mask:0xf
  v_dot2c_f32_bf16_dpp v30, v44, v42 row_newbcast:4 row_mask:0xf bank_mask:0xf
  v_dot2c_f32_bf16_dpp v31, v44, v43 row_newbcast:4 row_mask:0xf bank_mask:0xf
  v_perm_b32 v40, v108, v104, s85
  v_perm_b32 v41, v108, v104, s86
  v_perm_b32 v42, v109, v105, s85
  v_perm_b32 v43, v109, v105, s86
  v_dot2c_f32_bf16_dpp v16, v44, v40 row_newbcast:8 row_mask:0xf bank_mask:0xf
  v_dot2c_f32_bf16_dpp v17, v44, v41 row_newbcast:8 row_mask:0xf bank_mask:0xf
  v_dot2c_f32_bf16_dpp v18, v44, v42 row_newbcast:8 row_mask:0xf bank_mask:0xf
  v_dot2c_f32_bf16_dpp v19, v44, v43 row_newbcast:8 row_mask:0xf bank_mask:0xf
  v_dot2c_f32_bf16_dpp v24, v44, v40 row_newbcast:12 row_mask:0xf bank_mask:0xf
  v_dot2c_f32_bf16_dpp v25, v44, v41 row_newbcast:12 row_mask:0xf bank_mask:0xf
  v_dot2c_f32_bf16_dpp v26, v44, v42 row_newbcast:12 row_mask:0xf bank_mask:0xf
  v_dot2c_f32_bf16_dpp v27, v44, v43 row_newbcast:12 row_mask:0xf bank_mask:0xf
  v_perm_b32 v40, v110, v106, s85
  v_perm_b32 v41, v110, v106, s86
  v_perm_b32 v42, v111, v107, s85
  v_perm_b32 v43, v111, v107, s86
  v_dot2c_f32_bf16_dpp v20, v44, v40 row_newbcast:8 row_mask:0xf bank_mask:0xf
  v_dot2c_f32_bf16_dpp v21, v44, v41 row_newbcast:8 row_mask:0xf bank_mask:0xf
  v_dot2c_f32_bf16_dpp v22, v44, v42 row_newbcast:8 row_mask:0xf bank_mask:0xf
  v_dot2c_f32_bf16_dpp v23, v44, v43 row_newbcast:8 row_mask:0xf bank_mask:0xf
  v_dot2c_f32_bf16_dpp v28, v44, v40 row_newbcast:12 row_mask:0xf bank_mask:0xf
  v_dot2c_f32_bf16_dpp v29, v44, v41 row_newbcast:12 row_mask:0xf bank_mask:0xf
  v_dot2c_f32_bf16_dpp v30, v44, v42 row_newbcast:12 row_mask:0xf bank_mask:0xf
  v_dot2c_f32_bf16_dpp v31, v44, v43 row_newbcast:12 row_mask:0xf bank_mask:0xf
  v_mul_f32 v171, s68, v144
  v_mul_f32 v172, s68, v145
  v_mul_f32 v173, s68, v146
  v_mul_f32 v174, s68, v147
  v_cvt_pk_bf16_f32 v179, v171, v172
  v_lshlrev_b32 v171, 16, v179
  v_and_b32 v172, s87, v179
  v_cvt_pk_bf16_f32 v180, v173, v174
  v_lshlrev_b32 v173, 16, v180
  v_and_b32 v174, s87, v180
  v_add_f32 v171, v171, v153
  v_add_f32 v172, v172, v154
  v_add_f32 v173, v173, v155
  v_add_f32 v174, v174, v156
  v_cvt_pk_bf16_f32 v179, v171, v172
  v_lshlrev_b32 v171, 16, v179
  v_and_b32 v172, s87, v179
  v_cvt_pk_bf16_f32 v180, v173, v174
  v_lshlrev_b32 v173, 16, v180
  v_and_b32 v174, s87, v180
  v_mul_f32 v175, v171, v171
  v_mul_f32 v176, v172, v172
  v_mul_f32 v177, v173, v173
  v_mul_f32 v178, v174, v174
  v_fmaak_f32 v175, v175, v143, 0x40135761
  v_fmaak_f32 v176, v176, v143, 0x40135761
  v_fmaak_f32 v177, v177, v143, 0x40135761
  v_fmaak_f32 v178, v178, v143, 0x40135761
  v_mul_f32 v175, v175, v171
  v_mul_f32 v176, v176, v172
  v_mul_f32 v177, v177, v173
  v_mul_f32 v178, v178, v174
  v_exp_f32 v175, -v175
  v_exp_f32 v176, -v176
  v_exp_f32 v177, -v177
  v_exp_f32 v178, -v178
  v_add_f32 v175, 1.0, v175
  v_add_f32 v176, 1.0, v176
  v_add_f32 v177, 1.0, v177
  v_add_f32 v178, 1.0, v178
  v_rcp_f32 v175, v175
  v_rcp_f32 v176, v176
  v_rcp_f32 v177, v177
  v_rcp_f32 v178, v178
  v_mul_f32 v171, v171, v175
  v_mul_f32 v172, v172, v176
  v_mul_f32 v173, v173, v177
  v_mul_f32 v174, v174, v178
  v_cvt_pk_bf16_f32 v179, v171, v172
  v_cvt_pk_bf16_f32 v180, v173, v174
  v_dot2_f32_bf16 v166, v179, v136, 0
  v_dot2_f32_bf16 v166, v180, v137, v166
  v_mul_f32 v171, s68, v148
  v_mul_f32 v172, s68, v149
  v_mul_f32 v173, s68, v150
  v_mul_f32 v174, s68, v151
  v_cvt_pk_bf16_f32 v179, v171, v172
  v_lshlrev_b32 v171, 16, v179
  v_and_b32 v172, s87, v179
  v_cvt_pk_bf16_f32 v180, v173, v174
  v_lshlrev_b32 v173, 16, v180
  v_and_b32 v174, s87, v180
  v_add_f32 v171, v171, v157
  v_add_f32 v172, v172, v158
  v_add_f32 v173, v173, v159
  v_add_f32 v174, v174, v160
  v_cvt_pk_bf16_f32 v179, v171, v172
  v_lshlrev_b32 v171, 16, v179
  v_and_b32 v172, s87, v179
  v_cvt_pk_bf16_f32 v180, v173, v174
  v_lshlrev_b32 v173, 16, v180
  v_and_b32 v174, s87, v180
  v_mul_f32 v175, v171, v171
  v_mul_f32 v176, v172, v172
  v_mul_f32 v177, v173, v173
  v_mul_f32 v178, v174, v174
  v_fmaak_f32 v175, v175, v143, 0x40135761
  v_fmaak_f32 v176, v176, v143, 0x40135761
  v_fmaak_f32 v177, v177, v143, 0x40135761
  v_fmaak_f32 v178, v178, v143, 0x40135761
  v_mul_f32 v175, v175, v171
  v_mul_f32 v176, v176, v172
  v_mul_f32 v177, v177, v173
  v_mul_f32 v178, v178, v174
  v_exp_f32 v175, -v175
  v_exp_f32 v176, -v176
  v_exp_f32 v177, -v177
  v_exp_f32 v178, -v178
  v_add_f32 v175, 1.0, v175
  v_add_f32 v176, 1.0, v176
  v_add_f32 v177, 1.0, v177
  v_add_f32 v178, 1.0, v178
  v_rcp_f32 v175, v175
  v_rcp_f32 v176, v176
  v_rcp_f32 v177, v177
  v_rcp_f32 v178, v178
  v_mul_f32 v171, v171, v175
  v_mul_f32 v172, v172, v176
  v_mul_f32 v173, v173, v177
  v_mul_f32 v174, v174, v178
  v_cvt_pk_bf16_f32 v179, v171, v172
  v_cvt_pk_bf16_f32 v180, v173, v174
  v_dot2_f32_bf16 v166, v179, v138, v166
  v_dot2_f32_bf16 v166, v180, v139, v166
  v_mul_f32 v171, s69, v144
  v_mul_f32 v172, s69, v145
  v_mul_f32 v173, s69, v146
  v_mul_f32 v174, s69, v147
  v_cvt_pk_bf16_f32 v179, v171, v172
  v_lshlrev_b32 v171, 16, v179
  v_and_b32 v172, s87, v179
  v_cvt_pk_bf16_f32 v180, v173, v174
  v_lshlrev_b32 v173, 16, v180
  v_and_b32 v174, s87, v180
  v_add_f32 v171, v171, v153
  v_add_f32 v172, v172, v154
  v_add_f32 v173, v173, v155
  v_add_f32 v174, v174, v156
  v_cvt_pk_bf16_f32 v179, v171, v172
  v_lshlrev_b32 v171, 16, v179
  v_and_b32 v172, s87, v179
  v_cvt_pk_bf16_f32 v180, v173, v174
  v_lshlrev_b32 v173, 16, v180
  v_and_b32 v174, s87, v180
  v_mul_f32 v175, v171, v171
  v_mul_f32 v176, v172, v172
  v_mul_f32 v177, v173, v173
  v_mul_f32 v178, v174, v174
  v_fmaak_f32 v175, v175, v143, 0x40135761
  v_fmaak_f32 v176, v176, v143, 0x40135761
  v_fmaak_f32 v177, v177, v143, 0x40135761
  v_fmaak_f32 v178, v178, v143, 0x40135761
  v_mul_f32 v175, v175, v171
  v_mul_f32 v176, v176, v172
  v_mul_f32 v177, v177, v173
  v_mul_f32 v178, v178, v174
  v_exp_f32 v175, -v175
  v_exp_f32 v176, -v176
  v_exp_f32 v177, -v177
  v_exp_f32 v178, -v178
  v_add_f32 v175, 1.0, v175
  v_add_f32 v176, 1.0, v176
  v_add_f32 v177, 1.0, v177
  v_add_f32 v178, 1.0, v178
  v_rcp_f32 v175, v175
  v_rcp_f32 v176, v176
  v_rcp_f32 v177, v177
  v_rcp_f32 v178, v178
  v_mul_f32 v171, v171, v175
  v_mul_f32 v172, v172, v176
  v_mul_f32 v173, v173, v177
  v_mul_f32 v174, v174, v178
  v_cvt_pk_bf16_f32 v179, v171, v172
  v_cvt_pk_bf16_f32 v180, v173, v174
  v_dot2_f32_bf16 v167, v179, v136, 0
  v_dot2_f32_bf16 v167, v180, v137, v167
  v_mul_f32 v171, s69, v148
  v_mul_f32 v172, s69, v149
  v_mul_f32 v173, s69, v150
  v_mul_f32 v174, s69, v151
  v_cvt_pk_bf16_f32 v179, v171, v172
  v_lshlrev_b32 v171, 16, v179
  v_and_b32 v172, s87, v179
  v_cvt_pk_bf16_f32 v180, v173, v174
  v_lshlrev_b32 v173, 16, v180
  v_and_b32 v174, s87, v180
  v_add_f32 v171, v171, v157
  v_add_f32 v172, v172, v158
  v_add_f32 v173, v173, v159
  v_add_f32 v174, v174, v160
  v_cvt_pk_bf16_f32 v179, v171, v172
  v_lshlrev_b32 v171, 16, v179
  v_and_b32 v172, s87, v179
  v_cvt_pk_bf16_f32 v180, v173, v174
  v_lshlrev_b32 v173, 16, v180
  v_and_b32 v174, s87, v180
  v_mul_f32 v175, v171, v171
  v_mul_f32 v176, v172, v172
  v_mul_f32 v177, v173, v173
  v_mul_f32 v178, v174, v174
  v_fmaak_f32 v175, v175, v143, 0x40135761
  v_fmaak_f32 v176, v176, v143, 0x40135761
  v_fmaak_f32 v177, v177, v143, 0x40135761
  v_fmaak_f32 v178, v178, v143, 0x40135761
  v_mul_f32 v175, v175, v171
  v_mul_f32 v176, v176, v172
  v_mul_f32 v177, v177, v173
  v_mul_f32 v178, v178, v174
  v_exp_f32 v175, -v175
  v_exp_f32 v176, -v176
  v_exp_f32 v177, -v177
  v_exp_f32 v178, -v178
  v_add_f32 v175, 1.0, v175
  v_add_f32 v176, 1.0, v176
  v_add_f32 v177, 1.0, v177
  v_add_f32 v178, 1.0, v178
  v_rcp_f32 v175, v175
  v_rcp_f32 v176, v176
  v_rcp_f32 v177, v177
  v_rcp_f32 v178, v178
  v_mul_f32 v171, v171, v175
  v_mul_f32 v172, v172, v176
  v_mul_f32 v173, v173, v177
  v_mul_f32 v174, v174, v178
  v_cvt_pk_bf16_f32 v179, v171, v172
  v_cvt_pk_bf16_f32 v180, v173, v174
  v_dot2_f32_bf16 v167, v179, v138, v167
  v_dot2_f32_bf16 v167, v180, v139, v167
  s_waitcnt vmcnt(12)
  v_dot2_f32_bf16 v32, v192, v8, 0
  v_dot2_f32_bf16 v36, v192, v12, 0
  v_dot2_f32_bf16 v33, v196, v8, 0
  v_dot2_f32_bf16 v37, v196, v12, 0
  v_dot2_f32_bf16 v34, v200, v8, 0
  v_dot2_f32_bf16 v38, v200, v12, 0
  v_dot2_f32_bf16 v35, v204, v8, 0
  v_dot2_f32_bf16 v39, v204, v12, 0
  v_dot2_f32_bf16 v32, v193, v9, v32
  v_dot2_f32_bf16 v36, v193, v13, v36
  v_dot2_f32_bf16 v33, v197, v9, v33
  v_dot2_f32_bf16 v37, v197, v13, v37
  v_dot2_f32_bf16 v34, v201, v9, v34
  v_dot2_f32_bf16 v38, v201, v13, v38
  v_dot2_f32_bf16 v35, v205, v9, v35
  v_dot2_f32_bf16 v39, v205, v13, v39
  v_dot2_f32_bf16 v32, v194, v10, v32
  v_dot2_f32_bf16 v36, v194, v14, v36
  v_dot2_f32_bf16 v33, v198, v10, v33
  v_dot2_f32_bf16 v37, v198, v14, v37
  v_dot2_f32_bf16 v34, v202, v10, v34
  v_dot2_f32_bf16 v38, v202, v14, v38
  v_dot2_f32_bf16 v35, v206, v10, v35
  v_dot2_f32_bf16 v39, v206, v14, v39
  v_dot2_f32_bf16 v32, v195, v11, v32
  v_dot2_f32_bf16 v36, v195, v15, v36
  v_dot2_f32_bf16 v33, v199, v11, v33
  v_dot2_f32_bf16 v37, v199, v15, v37
  v_dot2_f32_bf16 v34, v203, v11, v34
  v_dot2_f32_bf16 v38, v203, v15, v38
  v_dot2_f32_bf16 v35, v207, v11, v35
  v_dot2_f32_bf16 v39, v207, v15, v39
  s_mov_b32 s83, 196608
  buffer_load_dwordx4 v[192:195], v2, s[4:7], s83 offen offset:0 nt
  buffer_load_dwordx4 v[196:199], v2, s[4:7], s83 offen offset:1024 nt
  buffer_load_dwordx4 v[200:203], v2, s[4:7], s83 offen offset:2048 nt
  buffer_load_dwordx4 v[204:207], v2, s[4:7], s83 offen offset:3072 nt
  v_add_f32_dpp v32, v32, v32 row_ror:8 row_mask:0xf bank_mask:0x3
  v_add_f32_dpp v33, v33, v33 row_ror:8 row_mask:0xf bank_mask:0x3
  v_add_f32_dpp v36, v36, v36 row_ror:8 row_mask:0xf bank_mask:0x3
  v_add_f32_dpp v37, v37, v37 row_ror:8 row_mask:0xf bank_mask:0x3
  v_add_f32_dpp v32, v34, v34 row_ror:8 row_mask:0xf bank_mask:0xc
  v_add_f32_dpp v33, v35, v35 row_ror:8 row_mask:0xf bank_mask:0xc
  v_add_f32_dpp v36, v38, v38 row_ror:8 row_mask:0xf bank_mask:0xc
  v_add_f32_dpp v37, v39, v39 row_ror:8 row_mask:0xf bank_mask:0xc
  v_add_f32_dpp v32, v32, v32 row_shl:4 row_mask:0xf bank_mask:0x5
  v_add_f32_dpp v33, v33, v33 row_shl:4 row_mask:0xf bank_mask:0x5
  s_nop 0
  v_add_f32_dpp v32, v36, v36 row_shr:4 row_mask:0xf bank_mask:0xa
  v_add_f32_dpp v33, v37, v37 row_shr:4 row_mask:0xf bank_mask:0xa
  s_nop 0
  v_add_f32_dpp v32, v32, v32 quad_perm:[1,0,3,2] row_mask:0xf bank_mask:0xf
  v_add_f32_dpp v33, v33, v33 quad_perm:[1,0,3,2] row_mask:0xf bank_mask:0xf
  s_nop 0
  v_add_f32_dpp v32, v32, v32 quad_perm:[2,3,0,1] row_mask:0xf bank_mask:0xf
  v_add_f32_dpp v33, v33, v33 quad_perm:[2,3,0,1] row_mask:0xf bank_mask:0xf
  v_cvt_pk_bf16_f32 v34, v32, v33
  v_lshlrev_b32 v32, 16, v34
  v_and_b32 v33, s87, v34
  v_mul_f32 v32, s88, v32
  v_mul_f32 v33, s88, v33
  v_cvt_pk_bf16_f32 v34, v32, v33
  v_lshlrev_b32 v32, 16, v34
  v_and_b32 v33, s87, v34
  v_fma_f32 v32, v32, s89, -v3
  v_fma_f32 v33, v33, s89, -v3
  v_max_f32 v35, v32, v33
  v_cmp_lt_f32 vcc, 0x41000000, v35
  v_exp_f32 v37, v32
  v_exp_f32 v38, v33
  s_cmp_eq_u64 vcc, 0
  s_cbranch_scc1 K1_LZ4B
  v_max_f32_dpp v35, v35, v35 row_ror:8 row_mask:0xf bank_mask:0xf
  v_max_f32 v35, 0, v35
  v_exp_f32 v36, -v35
  v_add_f32 v3, v3, v35
  v_sub_f32 v32, v32, v35
  v_sub_f32 v33, v33, v35
  v_exp_f32 v37, v32
  v_exp_f32 v38, v33
  v_mul_f32 v4, v4, v36
  v_mul_f32_dpp v16, v36, v16 row_newbcast:0 row_mask:0xf bank_mask:0xf
  v_mul_f32_dpp v17, v36, v17 row_newbcast:0 row_mask:0xf bank_mask:0xf
  v_mul_f32_dpp v18, v36, v18 row_newbcast:0 row_mask:0xf bank_mask:0xf
  v_mul_f32_dpp v19, v36, v19 row_newbcast:0 row_mask:0xf bank_mask:0xf
  v_mul_f32_dpp v20, v36, v20 row_newbcast:0 row_mask:0xf bank_mask:0xf
  v_mul_f32_dpp v21, v36, v21 row_newbcast:0 row_mask:0xf bank_mask:0xf
  v_mul_f32_dpp v22, v36, v22 row_newbcast:0 row_mask:0xf bank_mask:0xf
  v_mul_f32_dpp v23, v36, v23 row_newbcast:0 row_mask:0xf bank_mask:0xf
  v_mul_f32_dpp v24, v36, v24 row_newbcast:4 row_mask:0xf bank_mask:0xf
  v_mul_f32_dpp v25, v36, v25 row_newbcast:4 row_mask:0xf bank_mask:0xf
  v_mul_f32_dpp v26, v36, v26 row_newbcast:4 row_mask:0xf bank_mask:0xf
  v_mul_f32_dpp v27, v36, v27 row_newbcast:4 row_mask:0xf bank_mask:0xf
  v_mul_f32_dpp v28, v36, v28 row_newbcast:4 row_mask:0xf bank_mask:0xf
  v_mul_f32_dpp v29, v36, v29 row_newbcast:4 row_mask:0xf bank_mask:0xf
  v_mul_f32_dpp v30, v36, v30 row_newbcast:4 row_mask:0xf bank_mask:0xf
  v_mul_f32_dpp v31, v36, v31 row_newbcast:4 row_mask:0xf bank_mask:0xf
K1_LZ4B:
  s_nop 1
  v_add_f32 v4, v4, v37
  v_cvt_pk_bf16_f32 v44, v37, v38
  v_add_f32 v4, v4, v38
  s_waitcnt vmcnt(12)
  v_perm_b32 v40, v212, v208, s85
  v_perm_b32 v41, v212, v208, s86
  v_perm_b32 v42, v213, v209, s85
  v_perm_b32 v43, v213, v209, s86
  v_dot2c_f32_bf16_dpp v16, v44, v40 row_newbcast:0 row_mask:0xf bank_mask:0xf
  v_dot2c_f32_bf16_dpp v17, v44, v41 row_newbcast:0 row_mask:0xf bank_mask:0xf
  v_dot2c_f32_bf16_dpp v18, v44, v42 row_newbcast:0 row_mask:0xf bank_mask:0xf
  v_dot2c_f32_bf16_dpp v19, v44, v43 row_newbcast:0 row_mask:0xf bank_mask:0xf
  v_dot2c_f32_bf16_dpp v24, v44, v40 row_newbcast:4 row_mask:0xf bank_mask:0xf
  v_dot2c_f32_bf16_dpp v25, v44, v41 row_newbcast:4 row_mask:0xf bank_mask:0xf
  v_dot2c_f32_bf16_dpp v26, v44, v42 row_newbcast:4 row_mask:0xf bank_mask:0xf
  v_dot2c_f32_bf16_dpp v27, v44, v43 row_newbcast:4 row_mask:0xf bank_mask:0xf
  v_perm_b32 v40, v214, v210, s85
  v_perm_b32 v41, v214, v210, s86
  v_perm_b32 v42, v215, v211, s85
  v_perm_b32 v43, v215, v211, s86
  v_dot2c_f32_bf16_dpp v20, v44, v40 row_newbcast:0 row_mask:0xf bank_mask:0xf
  v_dot2c_f32_bf16_dpp v21, v44, v41 row_newbcast:0 row_mask:0xf bank_mask:0xf
  v_dot2c_f32_bf16_dpp v22, v44, v42 row_newbcast:0 row_mask:0xf bank_mask:0xf
  v_dot2c_f32_bf16_dpp v23, v44, v43 row_newbcast:0 row_mask:0xf bank_mask:0xf
  v_dot2c_f32_bf16_dpp v28, v44, v40 row_newbcast:4 row_mask:0xf bank_mask:0xf
  v_dot2c_f32_bf16_dpp v29, v44, v41 row_newbcast:4 row_mask:0xf bank_mask:0xf
  v_dot2c_f32_bf16_dpp v30, v44, v42 row_newbcast:4 row_mask:0xf bank_mask:0xf
  v_dot2c_f32_bf16_dpp v31, v44, v43 row_newbcast:4 row_mask:0xf bank_mask:0xf
  v_perm_b32 v40, v220, v216, s85
  v_perm_b32 v41, v220, v216, s86
  v_perm_b32 v42, v221, v217, s85
  v_perm_b32 v43, v221, v217, s86
  v_dot2c_f32_bf16_dpp v16, v44, v40 row_newbcast:8 row_mask:0xf bank_mask:0xf
  v_dot2c_f32_bf16_dpp v17, v44, v41 row_newbcast:8 row_mask:0xf bank_mask:0xf
  v_dot2c_f32_bf16_dpp v18, v44, v42 row_newbcast:8 row_mask:0xf bank_mask:0xf
  v_dot2c_f32_bf16_dpp v19, v44, v43 row_newbcast:8 row_mask:0xf bank_mask:0xf
  v_dot2c_f32_bf16_dpp v24, v44, v40 row_newbcast:12 row_mask:0xf bank_mask:0xf
  v_dot2c_f32_bf16_dpp v25, v44, v41 row_newbcast:12 row_mask:0xf bank_mask:0xf
  v_dot2c_f32_bf16_dpp v26, v44, v42 row_newbcast:12 row_mask:0xf bank_mask:0xf
  v_dot2c_f32_bf16_dpp v27, v44, v43 row_newbcast:12 row_mask:0xf bank_mask:0xf
  v_perm_b32 v40, v222, v218, s85
  v_perm_b32 v41, v222, v218, s86
  v_perm_b32 v42, v223, v219, s85
  v_perm_b32 v43, v223, v219, s86
  v_dot2c_f32_bf16_dpp v20, v44, v40 row_newbcast:8 row_mask:0xf bank_mask:0xf
  v_dot2c_f32_bf16_dpp v21, v44, v41 row_newbcast:8 row_mask:0xf bank_mask:0xf
  v_dot2c_f32_bf16_dpp v22, v44, v42 row_newbcast:8 row_mask:0xf bank_mask:0xf
  v_dot2c_f32_bf16_dpp v23, v44, v43 row_newbcast:8 row_mask:0xf bank_mask:0xf
  v_dot2c_f32_bf16_dpp v28, v44, v40 row_newbcast:12 row_mask:0xf bank_mask:0xf
  v_dot2c_f32_bf16_dpp v29, v44, v41 row_newbcast:12 row_mask:0xf bank_mask:0xf
  v_dot2c_f32_bf16_dpp v30, v44, v42 row_newbcast:12 row_mask:0xf bank_mask:0xf
  v_dot2c_f32_bf16_dpp v31, v44, v43 row_newbcast:12 row_mask:0xf bank_mask:0xf
  s_mov_b32 s83, 196608
  buffer_load_dwordx4 v[208:211], v2, s[8:11], s83 offen offset:0 nt
  buffer_load_dwordx4 v[212:215], v2, s[8:11], s83 offen offset:1024 nt
  buffer_load_dwordx4 v[216:219], v2, s[8:11], s83 offen offset:2048 nt
  buffer_load_dwordx4 v[220:223], v2, s[8:11], s83 offen offset:3072 nt
  v_mul_f32 v171, s70, v144
  v_mul_f32 v172, s70, v145
  v_mul_f32 v173, s70, v146
  v_mul_f32 v174, s70, v147
  v_cvt_pk_bf16_f32 v179, v171, v172
  v_lshlrev_b32 v171, 16, v179
  v_and_b32 v172, s87, v179
  v_cvt_pk_bf16_f32 v180, v173, v174
  v_lshlrev_b32 v173, 16, v180
  v_and_b32 v174, s87, v180
  v_add_f32 v171, v171, v153
  v_add_f32 v172, v172, v154
  v_add_f32 v173, v173, v155
  v_add_f32 v174, v174, v156
  v_cvt_pk_bf16_f32 v179, v171, v172
  v_lshlrev_b32 v171, 16, v179
  v_and_b32 v172, s87, v179
  v_cvt_pk_bf16_f32 v180, v173, v174
  v_lshlrev_b32 v173, 16, v180
  v_and_b32 v174, s87, v180
  v_mul_f32 v175, v171, v171
  v_mul_f32 v176, v172, v172
  v_mul_f32 v177, v173, v173
  v_mul_f32 v178, v174, v174
  v_fmaak_f32 v175, v175, v143, 0x40135761
  v_fmaak_f32 v176, v176, v143, 0x40135761
  v_fmaak_f32 v177, v177, v143, 0x40135761
  v_fmaak_f32 v178, v178, v143, 0x40135761
  v_mul_f32 v175, v175, v171
  v_mul_f32 v176, v176, v172
  v_mul_f32 v177, v177, v173
  v_mul_f32 v178, v178, v174
  v_exp_f32 v175, -v175
  v_exp_f32 v176, -v176
  v_exp_f32 v177, -v177
  v_exp_f32 v178, -v178
  v_add_f32 v175, 1.0, v175
  v_add_f32 v176, 1.0, v176
  v_add_f32 v177, 1.0, v177
  v_add_f32 v178, 1.0, v178
  v_rcp_f32 v175, v175
  v_rcp_f32 v176, v176
  v_rcp_f32 v177, v177
  v_rcp_f32 v178, v178
  v_mul_f32 v171, v171, v175
  v_mul_f32 v172, v172, v176
  v_mul_f32 v173, v173, v177
  v_mul_f32 v174, v174, v178
  v_cvt_pk_bf16_f32 v179, v171, v172
  v_cvt_pk_bf16_f32 v180, v173, v174
  v_dot2_f32_bf16 v168, v179, v136, 0
  v_dot2_f32_bf16 v168, v180, v137, v168
  v_mul_f32 v171, s70, v148
  v_mul_f32 v172, s70, v149
  v_mul_f32 v173, s70, v150
  v_mul_f32 v174, s70, v151
  v_cvt_pk_bf16_f32 v179, v171, v172
  v_lshlrev_b32 v171, 16, v179
  v_and_b32 v172, s87, v179
  v_cvt_pk_bf16_f32 v180, v173, v174
  v_lshlrev_b32 v173, 16, v180
  v_and_b32 v174, s87, v180
  v_add_f32 v171, v171, v157
  v_add_f32 v172, v172, v158
  v_add_f32 v173, v173, v159
  v_add_f32 v174, v174, v160
  v_cvt_pk_bf16_f32 v179, v171, v172
  v_lshlrev_b32 v171, 16, v179
  v_and_b32 v172, s87, v179
  v_cvt_pk_bf16_f32 v180, v173, v174
  v_lshlrev_b32 v173, 16, v180
  v_and_b32 v174, s87, v180
  v_mul_f32 v175, v171, v171
  v_mul_f32 v176, v172, v172
  v_mul_f32 v177, v173, v173
  v_mul_f32 v178, v174, v174
  v_fmaak_f32 v175, v175, v143, 0x40135761
  v_fmaak_f32 v176, v176, v143, 0x40135761
  v_fmaak_f32 v177, v177, v143, 0x40135761
  v_fmaak_f32 v178, v178, v143, 0x40135761
  v_mul_f32 v175, v175, v171
  v_mul_f32 v176, v176, v172
  v_mul_f32 v177, v177, v173
  v_mul_f32 v178, v178, v174
  v_exp_f32 v175, -v175
  v_exp_f32 v176, -v176
  v_exp_f32 v177, -v177
  v_exp_f32 v178, -v178
  v_add_f32 v175, 1.0, v175
  v_add_f32 v176, 1.0, v176
  v_add_f32 v177, 1.0, v177
  v_add_f32 v178, 1.0, v178
  v_rcp_f32 v175, v175
  v_rcp_f32 v176, v176
  v_rcp_f32 v177, v177
  v_rcp_f32 v178, v178
  v_mul_f32 v171, v171, v175
  v_mul_f32 v172, v172, v176
  v_mul_f32 v173, v173, v177
  v_mul_f32 v174, v174, v178
  v_cvt_pk_bf16_f32 v179, v171, v172
  v_cvt_pk_bf16_f32 v180, v173, v174
  v_dot2_f32_bf16 v168, v179, v138, v168
  v_dot2_f32_bf16 v168, v180, v139, v168
  v_mul_f32 v171, s71, v144
  v_mul_f32 v172, s71, v145
  v_mul_f32 v173, s71, v146
  v_mul_f32 v174, s71, v147
  v_cvt_pk_bf16_f32 v179, v171, v172
  v_lshlrev_b32 v171, 16, v179
  v_and_b32 v172, s87, v179
  v_cvt_pk_bf16_f32 v180, v173, v174
  v_lshlrev_b32 v173, 16, v180
  v_and_b32 v174, s87, v180
  v_add_f32 v171, v171, v153
  v_add_f32 v172, v172, v154
  v_add_f32 v173, v173, v155
  v_add_f32 v174, v174, v156
  v_cvt_pk_bf16_f32 v179, v171, v172
  v_lshlrev_b32 v171, 16, v179
  v_and_b32 v172, s87, v179
  v_cvt_pk_bf16_f32 v180, v173, v174
  v_lshlrev_b32 v173, 16, v180
  v_and_b32 v174, s87, v180
  v_mul_f32 v175, v171, v171
  v_mul_f32 v176, v172, v172
  v_mul_f32 v177, v173, v173
  v_mul_f32 v178, v174, v174
  v_fmaak_f32 v175, v175, v143, 0x40135761
  v_fmaak_f32 v176, v176, v143, 0x40135761
  v_fmaak_f32 v177, v177, v143, 0x40135761
  v_fmaak_f32 v178, v178, v143, 0x40135761
  v_mul_f32 v175, v175, v171
  v_mul_f32 v176, v176, v172
  v_mul_f32 v177, v177, v173
  v_mul_f32 v178, v178, v174
  v_exp_f32 v175, -v175
  v_exp_f32 v176, -v176
  v_exp_f32 v177, -v177
  v_exp_f32 v178, -v178
  v_add_f32 v175, 1.0, v175
  v_add_f32 v176, 1.0, v176
  v_add_f32 v177, 1.0, v177
  v_add_f32 v178, 1.0, v178
  v_rcp_f32 v175, v175
  v_rcp_f32 v176, v176
  v_rcp_f32 v177, v177
  v_rcp_f32 v178, v178
  v_mul_f32 v171, v171, v175
  v_mul_f32 v172, v172, v176
  v_mul_f32 v173, v173, v177
  v_mul_f32 v174, v174, v178
  v_cvt_pk_bf16_f32 v179, v171, v172
  v_cvt_pk_bf16_f32 v180, v173, v174
  v_dot2_f32_bf16 v169, v179, v136, 0
  v_dot2_f32_bf16 v169, v180, v137, v169
  v_mul_f32 v171, s71, v148
  v_mul_f32 v172, s71, v149
  v_mul_f32 v173, s71, v150
  v_mul_f32 v174, s71, v151
  v_cvt_pk_bf16_f32 v179, v171, v172
  v_lshlrev_b32 v171, 16, v179
  v_and_b32 v172, s87, v179
  v_cvt_pk_bf16_f32 v180, v173, v174
  v_lshlrev_b32 v173, 16, v180
  v_and_b32 v174, s87, v180
  v_add_f32 v171, v171, v157
  v_add_f32 v172, v172, v158
  v_add_f32 v173, v173, v159
  v_add_f32 v174, v174, v160
  v_cvt_pk_bf16_f32 v179, v171, v172
  v_lshlrev_b32 v171, 16, v179
  v_and_b32 v172, s87, v179
  v_cvt_pk_bf16_f32 v180, v173, v174
  v_lshlrev_b32 v173, 16, v180
  v_and_b32 v174, s87, v180
  v_mul_f32 v175, v171, v171
  v_mul_f32 v176, v172, v172
  v_mul_f32 v177, v173, v173
  v_mul_f32 v178, v174, v174
  v_fmaak_f32 v175, v175, v143, 0x40135761
  v_fmaak_f32 v176, v176, v143, 0x40135761
  v_fmaak_f32 v177, v177, v143, 0x40135761
  v_fmaak_f32 v178, v178, v143, 0x40135761
  v_mul_f32 v175, v175, v171
  v_mul_f32 v176, v176, v172
  v_mul_f32 v177, v177, v173
  v_mul_f32 v178, v178, v174
  v_exp_f32 v175, -v175
  v_exp_f32 v176, -v176
  v_exp_f32 v177, -v177
  v_exp_f32 v178, -v178
  v_add_f32 v175, 1.0, v175
  v_add_f32 v176, 1.0, v176
  v_add_f32 v177, 1.0, v177
  v_add_f32 v178, 1.0, v178
  v_rcp_f32 v175, v175
  v_rcp_f32 v176, v176
  v_rcp_f32 v177, v177
  v_rcp_f32 v178, v178
  v_mul_f32 v171, v171, v175
  v_mul_f32 v172, v172, v176
  v_mul_f32 v173, v173, v177
  v_mul_f32 v174, v174, v178
  v_cvt_pk_bf16_f32 v179, v171, v172
  v_cvt_pk_bf16_f32 v180, v173, v174
  v_dot2_f32_bf16 v169, v179, v138, v169
  v_dot2_f32_bf16 v169, v180, v139, v169
  s_mov_b32 s84, 0
  buffer_load_dwordx4 v[48:51], v46, s[16:19], s84 offen offset:0
  s_mov_b32 s84, 0
  buffer_load_dwordx4 v[52:55], v46, s[16:19], s84 offen offset:1152
  s_mov_b32 s84, 0
  buffer_load_dwordx4 v[56:59], v46, s[16:19], s84 offen offset:2304
  s_mov_b32 s84, 3456
  buffer_load_dwordx4 v[60:63], v46, s[16:19], s84 offen offset:0
  s_waitcnt vmcnt(16)
  v_dot2_f32_bf16 v32, v224, v8, 0
  v_dot2_f32_bf16 v36, v224, v12, 0
  v_dot2_f32_bf16 v33, v228, v8, 0
  v_dot2_f32_bf16 v37, v228, v12, 0
  v_dot2_f32_bf16 v34, v232, v8, 0
  v_dot2_f32_bf16 v38, v232, v12, 0
  v_dot2_f32_bf16 v35, v236, v8, 0
  v_dot2_f32_bf16 v39, v236, v12, 0
  v_dot2_f32_bf16 v32, v225, v9, v32
  v_dot2_f32_bf16 v36, v225, v13, v36
  v_dot2_f32_bf16 v33, v229, v9, v33
  v_dot2_f32_bf16 v37, v229, v13, v37
  v_dot2_f32_bf16 v34, v233, v9, v34
  v_dot2_f32_bf16 v38, v233, v13, v38
  v_dot2_f32_bf16 v35, v237, v9, v35
  v_dot2_f32_bf16 v39, v237, v13, v39
  v_dot2_f32_bf16 v32, v226, v10, v32
  v_dot2_f32_bf16 v36, v226, v14, v36
  v_dot2_f32_bf16 v33, v230, v10, v33
  v_dot2_f32_bf16 v37, v230, v14, v37
  v_dot2_f32_bf16 v34, v234, v10, v34
  v_dot2_f32_bf16 v38, v234, v14, v38
  v_dot2_f32_bf16 v35, v238, v10, v35
  v_dot2_f32_bf16 v39, v238, v14, v39
  v_dot2_f32_bf16 v32, v227, v11, v32
  v_dot2_f32_bf16 v36, v227, v15, v36
  v_dot2_f32_bf16 v33, v231, v11, v33
  v_dot2_f32_bf16 v37, v231, v15, v37
  v_dot2_f32_bf16 v34, v235, v11, v34
  v_dot2_f32_bf16 v38, v235, v15, v38
  v_dot2_f32_bf16 v35, v239, v11, v35
  v_dot2_f32_bf16 v39, v239, v15, v39
  s_mov_b32 s83, 229376
  buffer_load_dwordx4 v[224:227], v2, s[4:7], s83 offen offset:0 nt
  buffer_load_dwordx4 v[228:231], v2, s[4:7], s83 offen offset:1024 nt
  buffer_load_dwordx4 v[232:235], v2, s[4:7], s83 offen offset:2048 nt
  buffer_load_dwordx4 v[236:239], v2, s[4:7], s83 offen offset:3072 nt
  v_add_f32_dpp v32, v32, v32 row_ror:8 row_mask:0xf bank_mask:0x3
  v_add_f32_dpp v33, v33, v33 row_ror:8 row_mask:0xf bank_mask:0x3
  v_add_f32_dpp v36, v36, v36 row_ror:8 row_mask:0xf bank_mask:0x3
  v_add_f32_dpp v37, v37, v37 row_ror:8 row_mask:0xf bank_mask:0x3
  v_add_f32_dpp v32, v34, v34 row_ror:8 row_mask:0xf bank_mask:0xc
  v_add_f32_dpp v33, v35, v35 row_ror:8 row_mask:0xf bank_mask:0xc
  v_add_f32_dpp v36, v38, v38 row_ror:8 row_mask:0xf bank_mask:0xc
  v_add_f32_dpp v37, v39, v39 row_ror:8 row_mask:0xf bank_mask:0xc
  v_add_f32_dpp v32, v32, v32 row_shl:4 row_mask:0xf bank_mask:0x5
  v_add_f32_dpp v33, v33, v33 row_shl:4 row_mask:0xf bank_mask:0x5
  s_nop 0
  v_add_f32_dpp v32, v36, v36 row_shr:4 row_mask:0xf bank_mask:0xa
  v_add_f32_dpp v33, v37, v37 row_shr:4 row_mask:0xf bank_mask:0xa
  s_nop 0
  v_add_f32_dpp v32, v32, v32 quad_perm:[1,0,3,2] row_mask:0xf bank_mask:0xf
  v_add_f32_dpp v33, v33, v33 quad_perm:[1,0,3,2] row_mask:0xf bank_mask:0xf
  s_nop 0
  v_add_f32_dpp v32, v32, v32 quad_perm:[2,3,0,1] row_mask:0xf bank_mask:0xf
  v_add_f32_dpp v33, v33, v33 quad_perm:[2,3,0,1] row_mask:0xf bank_mask:0xf
  v_cvt_pk_bf16_f32 v34, v32, v33
  v_lshlrev_b32 v32, 16, v34
  v_and_b32 v33, s87, v34
  v_mul_f32 v32, s88, v32
  v_mul_f32 v33, s88, v33
  v_cvt_pk_bf16_f32 v34, v32, v33
  v_lshlrev_b32 v32, 16, v34
  v_and_b32 v33, s87, v34
  v_fma_f32 v32, v32, s89, -v3
  v_fma_f32 v33, v33, s89, -v3
  v_max_f32 v35, v32, v33
  v_cmp_lt_f32 vcc, 0x41000000, v35
  v_exp_f32 v37, v32
  v_exp_f32 v38, v33
  s_cmp_eq_u64 vcc, 0
  s_cbranch_scc1 K1_LZ5B
  v_max_f32_dpp v35, v35, v35 row_ror:8 row_mask:0xf bank_mask:0xf
  v_max_f32 v35, 0, v35
  v_exp_f32 v36, -v35
  v_add_f32 v3, v3, v35
  v_sub_f32 v32, v32, v35
  v_sub_f32 v33, v33, v35
  v_exp_f32 v37, v32
  v_exp_f32 v38, v33
  v_mul_f32 v4, v4, v36
  v_mul_f32_dpp v16, v36, v16 row_newbcast:0 row_mask:0xf bank_mask:0xf
  v_mul_f32_dpp v17, v36, v17 row_newbcast:0 row_mask:0xf bank_mask:0xf
  v_mul_f32_dpp v18, v36, v18 row_newbcast:0 row_mask:0xf bank_mask:0xf
  v_mul_f32_dpp v19, v36, v19 row_newbcast:0 row_mask:0xf bank_mask:0xf
  v_mul_f32_dpp v20, v36, v20 row_newbcast:0 row_mask:0xf bank_mask:0xf
  v_mul_f32_dpp v21, v36, v21 row_newbcast:0 row_mask:0xf bank_mask:0xf
  v_mul_f32_dpp v22, v36, v22 row_newbcast:0 row_mask:0xf bank_mask:0xf
  v_mul_f32_dpp v23, v36, v23 row_newbcast:0 row_mask:0xf bank_mask:0xf
  v_mul_f32_dpp v24, v36, v24 row_newbcast:4 row_mask:0xf bank_mask:0xf
  v_mul_f32_dpp v25, v36, v25 row_newbcast:4 row_mask:0xf bank_mask:0xf
  v_mul_f32_dpp v26, v36, v26 row_newbcast:4 row_mask:0xf bank_mask:0xf
  v_mul_f32_dpp v27, v36, v27 row_newbcast:4 row_mask:0xf bank_mask:0xf
  v_mul_f32_dpp v28, v36, v28 row_newbcast:4 row_mask:0xf bank_mask:0xf
  v_mul_f32_dpp v29, v36, v29 row_newbcast:4 row_mask:0xf bank_mask:0xf
  v_mul_f32_dpp v30, v36, v30 row_newbcast:4 row_mask:0xf bank_mask:0xf
  v_mul_f32_dpp v31, v36, v31 row_newbcast:4 row_mask:0xf bank_mask:0xf
K1_LZ5B:
  s_nop 1
  v_add_f32 v4, v4, v37
  v_cvt_pk_bf16_f32 v44, v37, v38
  v_add_f32 v4, v4, v38
  s_waitcnt vmcnt(16)
  v_perm_b32 v40, v244, v240, s85
  v_perm_b32 v41, v244, v240, s86
  v_perm_b32 v42, v245, v241, s85
  v_perm_b32 v43, v245, v241, s86
  v_dot2c_f32_bf16_dpp v16, v44, v40 row_newbcast:0 row_mask:0xf bank_mask:0xf
  v_dot2c_f32_bf16_dpp v17, v44, v41 row_newbcast:0 row_mask:0xf bank_mask:0xf
  v_dot2c_f32_bf16_dpp v18, v44, v42 row_newbcast:0 row_mask:0xf bank_mask:0xf
  v_dot2c_f32_bf16_dpp v19, v44, v43 row_newbcast:0 row_mask:0xf bank_mask:0xf
  v_dot2c_f32_bf16_dpp v24, v44, v40 row_newbcast:4 row_mask:0xf bank_mask:0xf
  v_dot2c_f32_bf16_dpp v25, v44, v41 row_newbcast:4 row_mask:0xf bank_mask:0xf
  v_dot2c_f32_bf16_dpp v26, v44, v42 row_newbcast:4 row_mask:0xf bank_mask:0xf
  v_dot2c_f32_bf16_dpp v27, v44, v43 row_newbcast:4 row_mask:0xf bank_mask:0xf
  v_perm_b32 v40, v246, v242, s85
  v_perm_b32 v41, v246, v242, s86
  v_perm_b32 v42, v247, v243, s85
  v_perm_b32 v43, v247, v243, s86
  v_dot2c_f32_bf16_dpp v20, v44, v40 row_newbcast:0 row_mask:0xf bank_mask:0xf
  v_dot2c_f32_bf16_dpp v21, v44, v41 row_newbcast:0 row_mask:0xf bank_mask:0xf
  v_dot2c_f32_bf16_dpp v22, v44, v42 row_newbcast:0 row_mask:0xf bank_mask:0xf
  v_dot2c_f32_bf16_dpp v23, v44, v43 row_newbcast:0 row_mask:0xf bank_mask:0xf
  v_dot2c_f32_bf16_dpp v28, v44, v40 row_newbcast:4 row_mask:0xf bank_mask:0xf
  v_dot2c_f32_bf16_dpp v29, v44, v41 row_newbcast:4 row_mask:0xf bank_mask:0xf
  v_dot2c_f32_bf16_dpp v30, v44, v42 row_newbcast:4 row_mask:0xf bank_mask:0xf
  v_dot2c_f32_bf16_dpp v31, v44, v43 row_newbcast:4 row_mask:0xf bank_mask:0xf
  v_perm_b32 v40, v252, v248, s85
  v_perm_b32 v41, v252, v248, s86
  v_perm_b32 v42, v253, v249, s85
  v_perm_b32 v43, v253, v249, s86
  v_dot2c_f32_bf16_dpp v16, v44, v40 row_newbcast:8 row_mask:0xf bank_mask:0xf
  v_dot2c_f32_bf16_dpp v17, v44, v41 row_newbcast:8 row_mask:0xf bank_mask:0xf
  v_dot2c_f32_bf16_dpp v18, v44, v42 row_newbcast:8 row_mask:0xf bank_mask:0xf
  v_dot2c_f32_bf16_dpp v19, v44, v43 row_newbcast:8 row_mask:0xf bank_mask:0xf
  v_dot2c_f32_bf16_dpp v24, v44, v40 row_newbcast:12 row_mask:0xf bank_mask:0xf
  v_dot2c_f32_bf16_dpp v25, v44, v41 row_newbcast:12 row_mask:0xf bank_mask:0xf
  v_dot2c_f32_bf16_dpp v26, v44, v42 row_newbcast:12 row_mask:0xf bank_mask:0xf
  v_dot2c_f32_bf16_dpp v27, v44, v43 row_newbcast:12 row_mask:0xf bank_mask:0xf
  v_perm_b32 v40, v254, v250, s85
  v_perm_b32 v41, v254, v250, s86
  v_perm_b32 v42, v255, v251, s85
  v_perm_b32 v43, v255, v251, s86
  v_dot2c_f32_bf16_dpp v20, v44, v40 row_newbcast:8 row_mask:0xf bank_mask:0xf
  v_dot2c_f32_bf16_dpp v21, v44, v41 row_newbcast:8 row_mask:0xf bank_mask:0xf
  v_dot2c_f32_bf16_dpp v22, v44, v42 row_newbcast:8 row_mask:0xf bank_mask:0xf
  v_dot2c_f32_bf16_dpp v23, v44, v43 row_newbcast:8 row_mask:0xf bank_mask:0xf
  v_dot2c_f32_bf16_dpp v28, v44, v40 row_newbcast:12 row_mask:0xf bank_mask:0xf
  v_dot2c_f32_bf16_dpp v29, v44, v41 row_newbcast:12 row_mask:0xf bank_mask:0xf
  v_dot2c_f32_bf16_dpp v30, v44, v42 row_newbcast:12 row_mask:0xf bank_mask:0xf
  v_dot2c_f32_bf16_dpp v31, v44, v43 row_newbcast:12 row_mask:0xf bank_mask:0xf
  s_mov_b32 s83, 229376
  buffer_load_dwordx4 v[240:243], v2, s[8:11], s83 offen offset:0 nt
  buffer_load_dwordx4 v[244:247], v2, s[8:11], s83 offen offset:1024 nt
  buffer_load_dwordx4 v[248:251], v2, s[8:11], s83 offen offset:2048 nt
  buffer_load_dwordx4 v[252:255], v2, s[8:11], s83 offen offset:3072 nt
  v_mul_f32 v171, s72, v144
  v_mul_f32 v172, s72, v145
  v_mul_f32 v173, s72, v146
  v_mul_f32 v174, s72, v147
  v_cvt_pk_bf16_f32 v179, v171, v172
  v_lshlrev_b32 v171, 16, v179
  v_and_b32 v172, s87, v179
  v_cvt_pk_bf16_f32 v180, v173, v174
  v_lshlrev_b32 v173, 16, v180
  v_and_b32 v174, s87, v180
  v_add_f32 v171, v171, v153
  v_add_f32 v172, v172, v154
  v_add_f32 v173, v173, v155
  v_add_f32 v174, v174, v156
  v_cvt_pk_bf16_f32 v179, v171, v172
  v_lshlrev_b32 v171, 16, v179
  v_and_b32 v172, s87, v179
  v_cvt_pk_bf16_f32 v180, v173, v174
  v_lshlrev_b32 v173, 16, v180
  v_and_b32 v174, s87, v180
  v_mul_f32 v175, v171, v171
  v_mul_f32 v176, v172, v172
  v_mul_f32 v177, v173, v173
  v_mul_f32 v178, v174, v174
  v_fmaak_f32 v175, v175, v143, 0x40135761
  v_fmaak_f32 v176, v176, v143, 0x40135761
  v_fmaak_f32 v177, v177, v143, 0x40135761
  v_fmaak_f32 v178, v178, v143, 0x40135761
  v_mul_f32 v175, v175, v171
  v_mul_f32 v176, v176, v172
  v_mul_f32 v177, v177, v173
  v_mul_f32 v178, v178, v174
  v_exp_f32 v175, -v175
  v_exp_f32 v176, -v176
  v_exp_f32 v177, -v177
  v_exp_f32 v178, -v178
  v_add_f32 v175, 1.0, v175
  v_add_f32 v176, 1.0, v176
  v_add_f32 v177, 1.0, v177
  v_add_f32 v178, 1.0, v178
  v_rcp_f32 v175, v175
  v_rcp_f32 v176, v176
  v_rcp_f32 v177, v177
  v_rcp_f32 v178, v178
  v_mul_f32 v171, v171, v175
  v_mul_f32 v172, v172, v176
  v_mul_f32 v173, v173, v177
  v_mul_f32 v174, v174, v178
  v_cvt_pk_bf16_f32 v179, v171, v172
  v_cvt_pk_bf16_f32 v180, v173, v174
  v_dot2_f32_bf16 v170, v179, v136, 0
  v_dot2_f32_bf16 v170, v180, v137, v170
  v_mul_f32 v171, s72, v148
  v_mul_f32 v172, s72, v149
  v_mul_f32 v173, s72, v150
  v_mul_f32 v174, s72, v151
  v_cvt_pk_bf16_f32 v179, v171, v172
  v_lshlrev_b32 v171, 16, v179
  v_and_b32 v172, s87, v179
  v_cvt_pk_bf16_f32 v180, v173, v174
  v_lshlrev_b32 v173, 16, v180
  v_and_b32 v174, s87, v180
  v_add_f32 v171, v171, v157
  v_add_f32 v172, v172, v158
  v_add_f32 v173, v173, v159
  v_add_f32 v174, v174, v160
  v_cvt_pk_bf16_f32 v179, v171, v172
  v_lshlrev_b32 v171, 16, v179
  v_and_b32 v172, s87, v179
  v_cvt_pk_bf16_f32 v180, v173, v174
  v_lshlrev_b32 v173, 16, v180
  v_and_b32 v174, s87, v180
  v_mul_f32 v175, v171, v171
  v_mul_f32 v176, v172, v172
  v_mul_f32 v177, v173, v173
  v_mul_f32 v178, v174, v174
  v_fmaak_f32 v175, v175, v143, 0x40135761
  v_fmaak_f32 v176, v176, v143, 0x40135761
  v_fmaak_f32 v177, v177, v143, 0x40135761
  v_fmaak_f32 v178, v178, v143, 0x40135761
  v_mul_f32 v175, v175, v171
  v_mul_f32 v176, v176, v172
  v_mul_f32 v177, v177, v173
  v_mul_f32 v178, v178, v174
  v_exp_f32 v175, -v175
  v_exp_f32 v176, -v176
  v_exp_f32 v177, -v177
  v_exp_f32 v178, -v178
  v_add_f32 v175, 1.0, v175
  v_add_f32 v176, 1.0, v176
  v_add_f32 v177, 1.0, v177
  v_add_f32 v178, 1.0, v178
  v_rcp_f32 v175, v175
  v_rcp_f32 v176, v176
  v_rcp_f32 v177, v177
  v_rcp_f32 v178, v178
  v_mul_f32 v171, v171, v175
  v_mul_f32 v172, v172, v176
  v_mul_f32 v173, v173, v177
  v_mul_f32 v174, v174, v178
  v_cvt_pk_bf16_f32 v179, v171, v172
  v_cvt_pk_bf16_f32 v180, v173, v174
  v_dot2_f32_bf16 v170, v179, v138, v170
  v_dot2_f32_bf16 v170, v180, v139, v170
  v_mul_f32 v171, s64, v152
  v_mul_f32 v172, s65, v152
  v_mul_f32 v173, s66, v152
  v_mul_f32 v174, s67, v152
  v_cvt_pk_bf16_f32 v179, v171, v172
  v_lshlrev_b32 v171, 16, v179
  v_and_b32 v172, s87, v179
  v_cvt_pk_bf16_f32 v180, v173, v174
  v_lshlrev_b32 v173, 16, v180
  v_and_b32 v174, s87, v180
  v_add_f32 v171, v171, v161
  v_add_f32 v172, v172, v161
  v_add_f32 v173, v173, v161
  v_add_f32 v174, v174, v161
  v_cvt_pk_bf16_f32 v179, v171, v172
  v_lshlrev_b32 v171, 16, v179
  v_and_b32 v172, s87, v179
  v_cvt_pk_bf16_f32 v180, v173, v174
  v_lshlrev_b32 v173, 16, v180
  v_and_b32 v174, s87, v180
  v_mul_f32 v175, v171, v171
  v_mul_f32 v176, v172, v172
  v_mul_f32 v177, v173, v173
  v_mul_f32 v178, v174, v174
  v_fmaak_f32 v175, v175, v143, 0x40135761
  v_fmaak_f32 v176, v176, v143, 0x40135761
  v_fmaak_f32 v177, v177, v143, 0x40135761
  v_fmaak_f32 v178, v178, v143, 0x40135761
  v_mul_f32 v175, v175, v171
  v_mul_f32 v176, v176, v172
  v_mul_f32 v177, v177, v173
  v_mul_f32 v178, v178, v174
  v_exp_f32 v175, -v175
  v_exp_f32 v176, -v176
  v_exp_f32 v177, -v177
  v_exp_f32 v178, -v178
  v_add_f32 v175, 1.0, v175
  v_add_f32 v176, 1.0, v176
  v_add_f32 v177, 1.0, v177
  v_add_f32 v178, 1.0, v178
  v_rcp_f32 v175, v175
  v_rcp_f32 v176, v176
  v_rcp_f32 v177, v177
  v_rcp_f32 v178, v178
  v_mul_f32 v171, v171, v175
  v_mul_f32 v172, v172, v176
  v_mul_f32 v173, v173, v177
  v_mul_f32 v174, v174, v178
  v_cvt_pk_bf16_f32 v179, v171, v172
  v_lshlrev_b32 v171, 16, v179
  v_and_b32 v172, s87, v179
  v_cvt_pk_bf16_f32 v180, v173, v174
  v_lshlrev_b32 v173, 16, v180
  v_and_b32 v174, s87, v180
  v_fmac_f32 v162, v171, v142
  v_fmac_f32 v163, v172, v142
  v_fmac_f32 v164, v173, v142
  v_fmac_f32 v165, v174, v142
  v_mul_f32 v171, s68, v152
  v_mul_f32 v172, s69, v152
  v_mul_f32 v173, s70, v152
  v_mul_f32 v174, s71, v152
  v_cvt_pk_bf16_f32 v179, v171, v172
  v_lshlrev_b32 v171, 16, v179
  v_and_b32 v172, s87, v179
  v_cvt_pk_bf16_f32 v180, v173, v174
  v_lshlrev_b32 v173, 16, v180
  v_and_b32 v174, s87, v180
  v_add_f32 v171, v171, v161
  v_add_f32 v172, v172, v161
  v_add_f32 v173, v173, v161
  v_add_f32 v174, v174, v161
  v_cvt_pk_bf16_f32 v179, v171, v172
  v_lshlrev_b32 v171, 16, v179
  v_and_b32 v172, s87, v179
  v_cvt_pk_bf16_f32 v180, v173, v174
  v_lshlrev_b32 v173, 16, v180
  v_and_b32 v174, s87, v180
  v_mul_f32 v175, v171, v171
  v_mul_f32 v176, v172, v172
  v_mul_f32 v177, v173, v173
  v_mul_f32 v178, v174, v174
  v_fmaak_f32 v175, v175, v143, 0x40135761
  v_fmaak_f32 v176, v176, v143, 0x40135761
  v_fmaak_f32 v177, v177, v143, 0x40135761
  v_fmaak_f32 v178, v178, v143, 0x40135761
  v_mul_f32 v175, v175, v171
  v_mul_f32 v176, v176, v172
  v_mul_f32 v177, v177, v173
  v_mul_f32 v178, v178, v174
  v_exp_f32 v175, -v175
  v_exp_f32 v176, -v176
  v_exp_f32 v177, -v177
  v_exp_f32 v178, -v178
  v_add_f32 v175, 1.0, v175
  v_add_f32 v176, 1.0, v176
  v_add_f32 v177, 1.0, v177
  v_add_f32 v178, 1.0, v178
  v_rcp_f32 v175, v175
  v_rcp_f32 v176, v176
  v_rcp_f32 v177, v177
  v_rcp_f32 v178, v178
  v_mul_f32 v171, v171, v175
  v_mul_f32 v172, v172, v176
  v_mul_f32 v173, v173, v177
  v_mul_f32 v174, v174, v178
  v_cvt_pk_bf16_f32 v179, v171, v172
  v_lshlrev_b32 v171, 16, v179
  v_and_b32 v172, s87, v179
  v_cvt_pk_bf16_f32 v180, v173, v174
  v_lshlrev_b32 v173, 16, v180
  v_and_b32 v174, s87, v180
  v_fmac_f32 v166, v171, v142
  v_fmac_f32 v167, v172, v142
  v_fmac_f32 v168, v173, v142
  v_fmac_f32 v169, v174, v142
  v_mul_f32 v171, s72, v152
  v_cvt_pk_bf16_f32 v171, v171, v171
  v_and_b32 v171, s87, v171
  v_add_f32 v171, v171, v161
  v_cvt_pk_bf16_f32 v171, v171, v171
  v_and_b32 v171, s87, v171
  v_mul_f32 v175, v171, v171
  v_fmaak_f32 v175, v175, v143, 0x40135761
  v_mul_f32 v175, v175, v171
  v_exp_f32 v175, -v175
  s_nop 0
  v_add_f32 v175, 1.0, v175
  v_rcp_f32 v175, v175
  s_nop 0
  v_mul_f32 v171, v171, v175
  v_cvt_pk_bf16_f32 v171, v171, v171
  v_and_b32 v171, s87, v171
  v_fmac_f32 v170, v171, v142
  v_add_f32_dpp v162, v162, v162 row_ror:8 row_mask:0xf bank_mask:0xf
  v_add_f32_dpp v163, v163, v163 row_ror:8 row_mask:0xf bank_mask:0xf
  v_add_f32_dpp v164, v164, v164 row_ror:8 row_mask:0xf bank_mask:0xf
  v_add_f32_dpp v165, v165, v165 row_ror:8 row_mask:0xf bank_mask:0xf
  v_add_f32_dpp v166, v166, v166 row_ror:8 row_mask:0xf bank_mask:0xf
  v_add_f32_dpp v167, v167, v167 row_ror:8 row_mask:0xf bank_mask:0xf
  v_add_f32_dpp v168, v168, v168 row_ror:8 row_mask:0xf bank_mask:0xf
  v_add_f32_dpp v169, v169, v169 row_ror:8 row_mask:0xf bank_mask:0xf
  v_add_f32_dpp v170, v170, v170 row_ror:8 row_mask:0xf bank_mask:0xf
  v_add_f32_dpp v162, v162, v162 row_ror:4 row_mask:0xf bank_mask:0xf
  v_add_f32_dpp v163, v163, v163 row_ror:4 row_mask:0xf bank_mask:0xf
  v_add_f32_dpp v164, v164, v164 row_ror:4 row_mask:0xf bank_mask:0xf
  v_add_f32_dpp v165, v165, v165 row_ror:4 row_mask:0xf bank_mask:0xf
  v_add_f32_dpp v166, v166, v166 row_ror:4 row_mask:0xf bank_mask:0xf
  v_add_f32_dpp v167, v167, v167 row_ror:4 row_mask:0xf bank_mask:0xf
  v_add_f32_dpp v168, v168, v168 row_ror:4 row_mask:0xf bank_mask:0xf
  v_add_f32_dpp v169, v169, v169 row_ror:4 row_mask:0xf bank_mask:0xf
  v_add_f32_dpp v170, v170, v170 row_ror:4 row_mask:0xf bank_mask:0xf
  v_add_f32_dpp v162, v162, v162 row_ror:2 row_mask:0xf bank_mask:0xf
  v_add_f32_dpp v163, v163, v163 row_ror:2 row_mask:0xf bank_mask:0xf
  v_add_f32_dpp v164, v164, v164 row_ror:2 row_mask:0xf bank_mask:0xf
  v_add_f32_dpp v165, v165, v165 row_ror:2 row_mask:0xf bank_mask:0xf
  v_add_f32_dpp v166, v166, v166 row_ror:2 row_mask:0xf bank_mask:0xf
  v_add_f32_dpp v167, v167, v167 row_ror:2 row_mask:0xf bank_mask:0xf
  v_add_f32_dpp v168, v168, v168 row_ror:2 row_mask:0xf bank_mask:0xf
  v_add_f32_dpp v169, v169, v169 row_ror:2 row_mask:0xf bank_mask:0xf
  v_add_f32_dpp v170, v170, v170 row_ror:2 row_mask:0xf bank_mask:0xf
  v_add_f32_dpp v162, v162, v162 row_ror:1 row_mask:0xf bank_mask:0xf
  v_add_f32_dpp v163, v163, v163 row_ror:1 row_mask:0xf bank_mask:0xf
  v_add_f32_dpp v164, v164, v164 row_ror:1 row_mask:0xf bank_mask:0xf
  v_add_f32_dpp v165, v165, v165 row_ror:1 row_mask:0xf bank_mask:0xf
  v_add_f32_dpp v166, v166, v166 row_ror:1 row_mask:0xf bank_mask:0xf
  v_add_f32_dpp v167, v167, v167 row_ror:1 row_mask:0xf bank_mask:0xf
  v_add_f32_dpp v168, v168, v168 row_ror:1 row_mask:0xf bank_mask:0xf
  v_add_f32_dpp v169, v169, v169 row_ror:1 row_mask:0xf bank_mask:0xf
  v_add_f32_dpp v170, v170, v170 row_ror:1 row_mask:0xf bank_mask:0xf
  v_mov_b32 v171, v162
  v_mov_b32 v172, v163
  v_mov_b32 v173, v164
  v_mov_b32 v174, v165
  v_mov_b32 v175, v166
  v_mov_b32 v176, v167
  v_mov_b32 v177, v168
  v_mov_b32 v178, v169
  v_mov_b32 v179, v170
  v_permlane16_swap_b32 v162, v171
  v_permlane16_swap_b32 v163, v172
  v_permlane16_swap_b32 v164, v173
  v_permlane16_swap_b32 v165, v174
  v_permlane16_swap_b32 v166, v175
  v_permlane16_swap_b32 v167, v176
  v_permlane16_swap_b32 v168, v177
  v_permlane16_swap_b32 v169, v178
  v_permlane16_swap_b32 v170, v179
  v_add_f32 v162, v162, v171
  v_add_f32 v163, v163, v172
  v_add_f32 v164, v164, v173
  v_add_f32 v165, v165, v174
  v_add_f32 v166, v166, v175
  v_add_f32 v167, v167, v176
  v_add_f32 v168, v168, v177
  v_add_f32 v169, v169, v178
  v_add_f32 v170, v170, v179
  v_mov_b32 v171, v162
  v_mov_b32 v172, v163
  v_mov_b32 v173, v164
  v_mov_b32 v174, v165
  v_mov_b32 v175, v166
  v_mov_b32 v176, v167
  v_mov_b32 v177, v168
  v_mov_b32 v178, v169
  v_mov_b32 v179, v170
  v_permlane32_swap_b32 v162, v171
  v_permlane32_swap_b32 v163, v172
  v_permlane32_swap_b32 v164, v173
  v_permlane32_swap_b32 v165, v174
  v_permlane32_swap_b32 v166, v175
  v_permlane32_swap_b32 v167, v176
  v_permlane32_swap_b32 v168, v177
  v_permlane32_swap_b32 v169, v178
  v_permlane32_swap_b32 v170, v179
  v_add_f32 v162, v162, v171
  v_add_f32 v163, v163, v172
  v_add_f32 v164, v164, v173
  v_add_f32 v165, v165, v174
  v_add_f32 v166, v166, v175
  v_add_f32 v167, v167, v176
  v_add_f32 v168, v168, v177
  v_add_f32 v169, v169, v178
  v_add_f32 v170, v170, v179
  s_lshl_b32 s83, s82, 6
  v_mov_b32 v171, s83
  ds_write_b32 v171, v162 offset:8704
  ds_write_b32 v171, v163 offset:8708
  ds_write_b32 v171, v164 offset:8712
  ds_write_b32 v171, v165 offset:8716
  ds_write_b32 v171, v166 offset:8720
  ds_write_b32 v171, v167 offset:8724
  ds_write_b32 v171, v168 offset:8728
  ds_write_b32 v171, v169 offset:8732
  ds_write_b32 v171, v170 offset:8736
  s_mov_b32 s84, 3456
  buffer_load_dwordx4 v[64:67], v46, s[16:19], s84 offen offset:1152
  s_mov_b32 s84, 3456
  buffer_load_dwordx4 v[68:71], v46, s[16:19], s84 offen offset:2304
  s_mov_b32 s84, 6912
  buffer_load_dwordx4 v[72:75], v46, s[16:19], s84 offen offset:0
  s_mov_b32 s84, 6912
  buffer_load_dwordx4 v[76:79], v46, s[16:19], s84 offen offset:1152
  s_waitcnt vmcnt(20)
  v_dot2_f32_bf16 v32, v192, v8, 0
  v_dot2_f32_bf16 v36, v192, v12, 0
  v_dot2_f32_bf16 v33, v196, v8, 0
  v_dot2_f32_bf16 v37, v196, v12, 0
  v_dot2_f32_bf16 v34, v200, v8, 0
  v_dot2_f32_bf16 v38, v200, v12, 0
  v_dot2_f32_bf16 v35, v204, v8, 0
  v_dot2_f32_bf16 v39, v204, v12, 0
  v_dot2_f32_bf16 v32, v193, v9, v32
  v_dot2_f32_bf16 v36, v193, v13, v36
  v_dot2_f32_bf16 v33, v197, v9, v33
  v_dot2_f32_bf16 v37, v197, v13, v37
  v_dot2_f32_bf16 v34, v201, v9, v34
  v_dot2_f32_bf16 v38, v201, v13, v38
  v_dot2_f32_bf16 v35, v205, v9, v35
  v_dot2_f32_bf16 v39, v205, v13, v39
  v_dot2_f32_bf16 v32, v194, v10, v32
  v_dot2_f32_bf16 v36, v194, v14, v36
  v_dot2_f32_bf16 v33, v198, v10, v33
  v_dot2_f32_bf16 v37, v198, v14, v37
  v_dot2_f32_bf16 v34, v202, v10, v34
  v_dot2_f32_bf16 v38, v202, v14, v38
  v_dot2_f32_bf16 v35, v206, v10, v35
  v_dot2_f32_bf16 v39, v206, v14, v39
  v_dot2_f32_bf16 v32, v195, v11, v32
  v_dot2_f32_bf16 v36, v195, v15, v36
  v_dot2_f32_bf16 v33, v199, v11, v33
  v_dot2_f32_bf16 v37, v199, v15, v37
  v_dot2_f32_bf16 v34, v203, v11, v34
  v_dot2_f32_bf16 v38, v203, v15, v38
  v_dot2_f32_bf16 v35, v207, v11, v35
  v_dot2_f32_bf16 v39, v207, v15, v39
  s_mov_b32 s83, 262144
  buffer_load_dwordx4 v[192:195], v2, s[4:7], s83 offen offset:0 nt
  buffer_load_dwordx4 v[196:199], v2, s[4:7], s83 offen offset:1024 nt
  buffer_load_dwordx4 v[200:203], v2, s[4:7], s83 offen offset:2048 nt
  buffer_load_dwordx4 v[204:207], v2, s[4:7], s83 offen offset:3072 nt
  v_add_f32_dpp v32, v32, v32 row_ror:8 row_mask:0xf bank_mask:0x3
  v_add_f32_dpp v33, v33, v33 row_ror:8 row_mask:0xf bank_mask:0x3
  v_add_f32_dpp v36, v36, v36 row_ror:8 row_mask:0xf bank_mask:0x3
  v_add_f32_dpp v37, v37, v37 row_ror:8 row_mask:0xf bank_mask:0x3
  v_add_f32_dpp v32, v34, v34 row_ror:8 row_mask:0xf bank_mask:0xc
  v_add_f32_dpp v33, v35, v35 row_ror:8 row_mask:0xf bank_mask:0xc
  v_add_f32_dpp v36, v38, v38 row_ror:8 row_mask:0xf bank_mask:0xc
  v_add_f32_dpp v37, v39, v39 row_ror:8 row_mask:0xf bank_mask:0xc
  v_add_f32_dpp v32, v32, v32 row_shl:4 row_mask:0xf bank_mask:0x5
  v_add_f32_dpp v33, v33, v33 row_shl:4 row_mask:0xf bank_mask:0x5
  s_nop 0
  v_add_f32_dpp v32, v36, v36 row_shr:4 row_mask:0xf bank_mask:0xa
  v_add_f32_dpp v33, v37, v37 row_shr:4 row_mask:0xf bank_mask:0xa
  s_nop 0
  v_add_f32_dpp v32, v32, v32 quad_perm:[1,0,3,2] row_mask:0xf bank_mask:0xf
  v_add_f32_dpp v33, v33, v33 quad_perm:[1,0,3,2] row_mask:0xf bank_mask:0xf
  s_nop 0
  v_add_f32_dpp v32, v32, v32 quad_perm:[2,3,0,1] row_mask:0xf bank_mask:0xf
  v_add_f32_dpp v33, v33, v33 quad_perm:[2,3,0,1] row_mask:0xf bank_mask:0xf
  v_cvt_pk_bf16_f32 v34, v32, v33
  v_lshlrev_b32 v32, 16, v34
  v_and_b32 v33, s87, v34
  v_mul_f32 v32, s88, v32
  v_mul_f32 v33, s88, v33
  v_cvt_pk_bf16_f32 v34, v32, v33
  v_lshlrev_b32 v32, 16, v34
  v_and_b32 v33, s87, v34
  v_fma_f32 v32, v32, s89, -v3
  v_fma_f32 v33, v33, s89, -v3
  v_max_f32 v35, v32, v33
  v_cmp_lt_f32 vcc, 0x41000000, v35
  v_exp_f32 v37, v32
  v_exp_f32 v38, v33
  s_cmp_eq_u64 vcc, 0
  s_cbranch_scc1 K1_LZ6B
  v_max_f32_dpp v35, v35, v35 row_ror:8 row_mask:0xf bank_mask:0xf
  v_max_f32 v35, 0, v35
  v_exp_f32 v36, -v35
  v_add_f32 v3, v3, v35
  v_sub_f32 v32, v32, v35
  v_sub_f32 v33, v33, v35
  v_exp_f32 v37, v32
  v_exp_f32 v38, v33
  v_mul_f32 v4, v4, v36
  v_mul_f32_dpp v16, v36, v16 row_newbcast:0 row_mask:0xf bank_mask:0xf
  v_mul_f32_dpp v17, v36, v17 row_newbcast:0 row_mask:0xf bank_mask:0xf
  v_mul_f32_dpp v18, v36, v18 row_newbcast:0 row_mask:0xf bank_mask:0xf
  v_mul_f32_dpp v19, v36, v19 row_newbcast:0 row_mask:0xf bank_mask:0xf
  v_mul_f32_dpp v20, v36, v20 row_newbcast:0 row_mask:0xf bank_mask:0xf
  v_mul_f32_dpp v21, v36, v21 row_newbcast:0 row_mask:0xf bank_mask:0xf
  v_mul_f32_dpp v22, v36, v22 row_newbcast:0 row_mask:0xf bank_mask:0xf
  v_mul_f32_dpp v23, v36, v23 row_newbcast:0 row_mask:0xf bank_mask:0xf
  v_mul_f32_dpp v24, v36, v24 row_newbcast:4 row_mask:0xf bank_mask:0xf
  v_mul_f32_dpp v25, v36, v25 row_newbcast:4 row_mask:0xf bank_mask:0xf
  v_mul_f32_dpp v26, v36, v26 row_newbcast:4 row_mask:0xf bank_mask:0xf
  v_mul_f32_dpp v27, v36, v27 row_newbcast:4 row_mask:0xf bank_mask:0xf
  v_mul_f32_dpp v28, v36, v28 row_newbcast:4 row_mask:0xf bank_mask:0xf
  v_mul_f32_dpp v29, v36, v29 row_newbcast:4 row_mask:0xf bank_mask:0xf
  v_mul_f32_dpp v30, v36, v30 row_newbcast:4 row_mask:0xf bank_mask:0xf
  v_mul_f32_dpp v31, v36, v31 row_newbcast:4 row_mask:0xf bank_mask:0xf
K1_LZ6B:
  s_nop 1
  v_add_f32 v4, v4, v37
  v_cvt_pk_bf16_f32 v44, v37, v38
  v_add_f32 v4, v4, v38
  s_waitcnt vmcnt(20)
  v_perm_b32 v40, v212, v208, s85
  v_perm_b32 v41, v212, v208, s86
  v_perm_b32 v42, v213, v209, s85
  v_perm_b32 v43, v213, v209, s86
  v_dot2c_f32_bf16_dpp v16, v44, v40 row_newbcast:0 row_mask:0xf bank_mask:0xf
  v_dot2c_f32_bf16_dpp v17, v44, v41 row_newbcast:0 row_mask:0xf bank_mask:0xf
  v_dot2c_f32_bf16_dpp v18, v44, v42 row_newbcast:0 row_mask:0xf bank_mask:0xf
  v_dot2c_f32_bf16_dpp v19, v44, v43 row_newbcast:0 row_mask:0xf bank_mask:0xf
  v_dot2c_f32_bf16_dpp v24, v44, v40 row_newbcast:4 row_mask:0xf bank_mask:0xf
  v_dot2c_f32_bf16_dpp v25, v44, v41 row_newbcast:4 row_mask:0xf bank_mask:0xf
  v_dot2c_f32_bf16_dpp v26, v44, v42 row_newbcast:4 row_mask:0xf bank_mask:0xf
  v_dot2c_f32_bf16_dpp v27, v44, v43 row_newbcast:4 row_mask:0xf bank_mask:0xf
  v_perm_b32 v40, v214, v210, s85
  v_perm_b32 v41, v214, v210, s86
  v_perm_b32 v42, v215, v211, s85
  v_perm_b32 v43, v215, v211, s86
  v_dot2c_f32_bf16_dpp v20, v44, v40 row_newbcast:0 row_mask:0xf bank_mask:0xf
  v_dot2c_f32_bf16_dpp v21, v44, v41 row_newbcast:0 row_mask:0xf bank_mask:0xf
  v_dot2c_f32_bf16_dpp v22, v44, v42 row_newbcast:0 row_mask:0xf bank_mask:0xf
  v_dot2c_f32_bf16_dpp v23, v44, v43 row_newbcast:0 row_mask:0xf bank_mask:0xf
  v_dot2c_f32_bf16_dpp v28, v44, v40 row_newbcast:4 row_mask:0xf bank_mask:0xf
  v_dot2c_f32_bf16_dpp v29, v44, v41 row_newbcast:4 row_mask:0xf bank_mask:0xf
  v_dot2c_f32_bf16_dpp v30, v44, v42 row_newbcast:4 row_mask:0xf bank_mask:0xf
  v_dot2c_f32_bf16_dpp v31, v44, v43 row_newbcast:4 row_mask:0xf bank_mask:0xf
  v_perm_b32 v40, v220, v216, s85
  v_perm_b32 v41, v220, v216, s86
  v_perm_b32 v42, v221, v217, s85
  v_perm_b32 v43, v221, v217, s86
  v_dot2c_f32_bf16_dpp v16, v44, v40 row_newbcast:8 row_mask:0xf bank_mask:0xf
  v_dot2c_f32_bf16_dpp v17, v44, v41 row_newbcast:8 row_mask:0xf bank_mask:0xf
  v_dot2c_f32_bf16_dpp v18, v44, v42 row_newbcast:8 row_mask:0xf bank_mask:0xf
  v_dot2c_f32_bf16_dpp v19, v44, v43 row_newbcast:8 row_mask:0xf bank_mask:0xf
  v_dot2c_f32_bf16_dpp v24, v44, v40 row_newbcast:12 row_mask:0xf bank_mask:0xf
  v_dot2c_f32_bf16_dpp v25, v44, v41 row_newbcast:12 row_mask:0xf bank_mask:0xf
  v_dot2c_f32_bf16_dpp v26, v44, v42 row_newbcast:12 row_mask:0xf bank_mask:0xf
  v_dot2c_f32_bf16_dpp v27, v44, v43 row_newbcast:12 row_mask:0xf bank_mask:0xf
  v_perm_b32 v40, v222, v218, s85
  v_perm_b32 v41, v222, v218, s86
  v_perm_b32 v42, v223, v219, s85
  v_perm_b32 v43, v223, v219, s86
  v_dot2c_f32_bf16_dpp v20, v44, v40 row_newbcast:8 row_mask:0xf bank_mask:0xf
  v_dot2c_f32_bf16_dpp v21, v44, v41 row_newbcast:8 row_mask:0xf bank_mask:0xf
  v_dot2c_f32_bf16_dpp v22, v44, v42 row_newbcast:8 row_mask:0xf bank_mask:0xf
  v_dot2c_f32_bf16_dpp v23, v44, v43 row_newbcast:8 row_mask:0xf bank_mask:0xf
  v_dot2c_f32_bf16_dpp v28, v44, v40 row_newbcast:12 row_mask:0xf bank_mask:0xf
  v_dot2c_f32_bf16_dpp v29, v44, v41 row_newbcast:12 row_mask:0xf bank_mask:0xf
  v_dot2c_f32_bf16_dpp v30, v44, v42 row_newbcast:12 row_mask:0xf bank_mask:0xf
  v_dot2c_f32_bf16_dpp v31, v44, v43 row_newbcast:12 row_mask:0xf bank_mask:0xf
  s_mov_b32 s83, 262144
  buffer_load_dwordx4 v[208:211], v2, s[8:11], s83 offen offset:0 nt
  buffer_load_dwordx4 v[212:215], v2, s[8:11], s83 offen offset:1024 nt
  buffer_load_dwordx4 v[216:219], v2, s[8:11], s83 offen offset:2048 nt
  buffer_load_dwordx4 v[220:223], v2, s[8:11], s83 offen offset:3072 nt
  s_waitcnt vmcnt(22)
  v_perm_b32 v45, v52, v48, s85
  v_perm_b32 v52, v52, v48, s86
  v_perm_b32 v48, v53, v49, s85
  v_perm_b32 v53, v53, v49, s86
  v_perm_b32 v49, v54, v50, s85
  v_perm_b32 v54, v54, v50, s86
  v_perm_b32 v50, v55, v51, s85
  v_perm_b32 v55, v55, v51, s86
  s_waitcnt vmcnt(20)
  v_perm_b32 v51, v60, v56, s85
  v_perm_b32 v60, v60, v56, s86
  v_perm_b32 v56, v61, v57, s85
  v_perm_b32 v61, v61, v57, s86
  v_perm_b32 v57, v62, v58, s85
  v_perm_b32 v62, v62, v58, s86
  v_perm_b32 v58, v63, v59, s85
  v_perm_b32 v63, v63, v59, s86
  s_mov_b32 s84, 6912
  buffer_load_dwordx4 v[80:83], v46, s[16:19], s84 offen offset:2304
  s_mov_b32 s84, 10368
  buffer_load_dwordx4 v[84:87], v46, s[16:19], s84 offen offset:0
  s_mov_b32 s84, 10368
  buffer_load_dwordx4 v[88:91], v46, s[16:19], s84 offen offset:1152
  s_mov_b32 s84, 10368
  buffer_load_dwordx4 v[92:95], v46, s[16:19], s84 offen offset:2304
  s_waitcnt vmcnt(20)
  v_dot2_f32_bf16 v32, v224, v8, 0
  v_dot2_f32_bf16 v36, v224, v12, 0
  v_dot2_f32_bf16 v33, v228, v8, 0
  v_dot2_f32_bf16 v37, v228, v12, 0
  v_dot2_f32_bf16 v34, v232, v8, 0
  v_dot2_f32_bf16 v38, v232, v12, 0
  v_dot2_f32_bf16 v35, v236, v8, 0
  v_dot2_f32_bf16 v39, v236, v12, 0
  v_dot2_f32_bf16 v32, v225, v9, v32
  v_dot2_f32_bf16 v36, v225, v13, v36
  v_dot2_f32_bf16 v33, v229, v9, v33
  v_dot2_f32_bf16 v37, v229, v13, v37
  v_dot2_f32_bf16 v34, v233, v9, v34
  v_dot2_f32_bf16 v38, v233, v13, v38
  v_dot2_f32_bf16 v35, v237, v9, v35
  v_dot2_f32_bf16 v39, v237, v13, v39
  v_dot2_f32_bf16 v32, v226, v10, v32
  v_dot2_f32_bf16 v36, v226, v14, v36
  v_dot2_f32_bf16 v33, v230, v10, v33
  v_dot2_f32_bf16 v37, v230, v14, v37
  v_dot2_f32_bf16 v34, v234, v10, v34
  v_dot2_f32_bf16 v38, v234, v14, v38
  v_dot2_f32_bf16 v35, v238, v10, v35
  v_dot2_f32_bf16 v39, v238, v14, v39
  v_dot2_f32_bf16 v32, v227, v11, v32
  v_dot2_f32_bf16 v36, v227, v15, v36
  v_dot2_f32_bf16 v33, v231, v11, v33
  v_dot2_f32_bf16 v37, v231, v15, v37
  v_dot2_f32_bf16 v34, v235, v11, v34
  v_dot2_f32_bf16 v38, v235, v15, v38
  v_dot2_f32_bf16 v35, v239, v11, v35
  v_dot2_f32_bf16 v39, v239, v15, v39
  s_mov_b32 s83, 294912
  buffer_load_dwordx4 v[224:227], v2, s[4:7], s83 offen offset:0 nt
  buffer_load_dwordx4 v[228:231], v2, s[4:7], s83 offen offset:1024 nt
  buffer_load_dwordx4 v[232:235], v2, s[4:7], s83 offen offset:2048 nt
  buffer_load_dwordx4 v[236:239], v2, s[4:7], s83 offen offset:3072 nt
  v_add_f32_dpp v32, v32, v32 row_ror:8 row_mask:0xf bank_mask:0x3
  v_add_f32_dpp v33, v33, v33 row_ror:8 row_mask:0xf bank_mask:0x3
  v_add_f32_dpp v36, v36, v36 row_ror:8 row_mask:0xf bank_mask:0x3
  v_add_f32_dpp v37, v37, v37 row_ror:8 row_mask:0xf bank_mask:0x3
  v_add_f32_dpp v32, v34, v34 row_ror:8 row_mask:0xf bank_mask:0xc
  v_add_f32_dpp v33, v35, v35 row_ror:8 row_mask:0xf bank_mask:0xc
  v_add_f32_dpp v36, v38, v38 row_ror:8 row_mask:0xf bank_mask:0xc
  v_add_f32_dpp v37, v39, v39 row_ror:8 row_mask:0xf bank_mask:0xc
  v_add_f32_dpp v32, v32, v32 row_shl:4 row_mask:0xf bank_mask:0x5
  v_add_f32_dpp v33, v33, v33 row_shl:4 row_mask:0xf bank_mask:0x5
  s_nop 0
  v_add_f32_dpp v32, v36, v36 row_shr:4 row_mask:0xf bank_mask:0xa
  v_add_f32_dpp v33, v37, v37 row_shr:4 row_mask:0xf bank_mask:0xa
  s_nop 0
  v_add_f32_dpp v32, v32, v32 quad_perm:[1,0,3,2] row_mask:0xf bank_mask:0xf
  v_add_f32_dpp v33, v33, v33 quad_perm:[1,0,3,2] row_mask:0xf bank_mask:0xf
  s_nop 0
  v_add_f32_dpp v32, v32, v32 quad_perm:[2,3,0,1] row_mask:0xf bank_mask:0xf
  v_add_f32_dpp v33, v33, v33 quad_perm:[2,3,0,1] row_mask:0xf bank_mask:0xf
  v_cvt_pk_bf16_f32 v34, v32, v33
  v_lshlrev_b32 v32, 16, v34
  v_and_b32 v33, s87, v34
  v_mul_f32 v32, s88, v32
  v_mul_f32 v33, s88, v33
  v_cvt_pk_bf16_f32 v34, v32, v33
  v_lshlrev_b32 v32, 16, v34
  v_and_b32 v33, s87, v34
  v_fma_f32 v32, v32, s89, -v3
  v_fma_f32 v33, v33, s89, -v3
  v_max_f32 v35, v32, v33
  v_cmp_lt_f32 vcc, 0x41000000, v35
  v_exp_f32 v37, v32
  v_exp_f32 v38, v33
  s_cmp_eq_u64 vcc, 0
  s_cbranch_scc1 K1_LZ7B
  v_max_f32_dpp v35, v35, v35 row_ror:8 row_mask:0xf bank_mask:0xf
  v_max_f32 v35, 0, v35
  v_exp_f32 v36, -v35
  v_add_f32 v3, v3, v35
  v_sub_f32 v32, v32, v35
  v_sub_f32 v33, v33, v35
  v_exp_f32 v37, v32
  v_exp_f32 v38, v33
  v_mul_f32 v4, v4, v36
  v_mul_f32_dpp v16, v36, v16 row_newbcast:0 row_mask:0xf bank_mask:0xf
  v_mul_f32_dpp v17, v36, v17 row_newbcast:0 row_mask:0xf bank_mask:0xf
  v_mul_f32_dpp v18, v36, v18 row_newbcast:0 row_mask:0xf bank_mask:0xf
  v_mul_f32_dpp v19, v36, v19 row_newbcast:0 row_mask:0xf bank_mask:0xf
  v_mul_f32_dpp v20, v36, v20 row_newbcast:0 row_mask:0xf bank_mask:0xf
  v_mul_f32_dpp v21, v36, v21 row_newbcast:0 row_mask:0xf bank_mask:0xf
  v_mul_f32_dpp v22, v36, v22 row_newbcast:0 row_mask:0xf bank_mask:0xf
  v_mul_f32_dpp v23, v36, v23 row_newbcast:0 row_mask:0xf bank_mask:0xf
  v_mul_f32_dpp v24, v36, v24 row_newbcast:4 row_mask:0xf bank_mask:0xf
  v_mul_f32_dpp v25, v36, v25 row_newbcast:4 row_mask:0xf bank_mask:0xf
  v_mul_f32_dpp v26, v36, v26 row_newbcast:4 row_mask:0xf bank_mask:0xf
  v_mul_f32_dpp v27, v36, v27 row_newbcast:4 row_mask:0xf bank_mask:0xf
  v_mul_f32_dpp v28, v36, v28 row_newbcast:4 row_mask:0xf bank_mask:0xf
  v_mul_f32_dpp v29, v36, v29 row_newbcast:4 row_mask:0xf bank_mask:0xf
  v_mul_f32_dpp v30, v36, v30 row_newbcast:4 row_mask:0xf bank_mask:0xf
  v_mul_f32_dpp v31, v36, v31 row_newbcast:4 row_mask:0xf bank_mask:0xf
K1_LZ7B:
  s_nop 1
  v_add_f32 v4, v4, v37
  v_cvt_pk_bf16_f32 v44, v37, v38
  v_add_f32 v4, v4, v38
  s_waitcnt vmcnt(20)
  v_perm_b32 v40, v244, v240, s85
  v_perm_b32 v41, v244, v240, s86
  v_perm_b32 v42, v245, v241, s85
  v_perm_b32 v43, v245, v241, s86
  v_dot2c_f32_bf16_dpp v16, v44, v40 row_newbcast:0 row_mask:0xf bank_mask:0xf
  v_dot2c_f32_bf16_dpp v17, v44, v41 row_newbcast:0 row_mask:0xf bank_mask:0xf
  v_dot2c_f32_bf16_dpp v18, v44, v42 row_newbcast:0 row_mask:0xf bank_mask:0xf
  v_dot2c_f32_bf16_dpp v19, v44, v43 row_newbcast:0 row_mask:0xf bank_mask:0xf
  v_dot2c_f32_bf16_dpp v24, v44, v40 row_newbcast:4 row_mask:0xf bank_mask:0xf
  v_dot2c_f32_bf16_dpp v25, v44, v41 row_newbcast:4 row_mask:0xf bank_mask:0xf
  v_dot2c_f32_bf16_dpp v26, v44, v42 row_newbcast:4 row_mask:0xf bank_mask:0xf
  v_dot2c_f32_bf16_dpp v27, v44, v43 row_newbcast:4 row_mask:0xf bank_mask:0xf
  v_perm_b32 v40, v246, v242, s85
  v_perm_b32 v41, v246, v242, s86
  v_perm_b32 v42, v247, v243, s85
  v_perm_b32 v43, v247, v243, s86
  v_dot2c_f32_bf16_dpp v20, v44, v40 row_newbcast:0 row_mask:0xf bank_mask:0xf
  v_dot2c_f32_bf16_dpp v21, v44, v41 row_newbcast:0 row_mask:0xf bank_mask:0xf
  v_dot2c_f32_bf16_dpp v22, v44, v42 row_newbcast:0 row_mask:0xf bank_mask:0xf
  v_dot2c_f32_bf16_dpp v23, v44, v43 row_newbcast:0 row_mask:0xf bank_mask:0xf
  v_dot2c_f32_bf16_dpp v28, v44, v40 row_newbcast:4 row_mask:0xf bank_mask:0xf
  v_dot2c_f32_bf16_dpp v29, v44, v41 row_newbcast:4 row_mask:0xf bank_mask:0xf
  v_dot2c_f32_bf16_dpp v30, v44, v42 row_newbcast:4 row_mask:0xf bank_mask:0xf
  v_dot2c_f32_bf16_dpp v31, v44, v43 row_newbcast:4 row_mask:0xf bank_mask:0xf
  v_perm_b32 v40, v252, v248, s85
  v_perm_b32 v41, v252, v248, s86
  v_perm_b32 v42, v253, v249, s85
  v_perm_b32 v43, v253, v249, s86
  v_dot2c_f32_bf16_dpp v16, v44, v40 row_newbcast:8 row_mask:0xf bank_mask:0xf
  v_dot2c_f32_bf16_dpp v17, v44, v41 row_newbcast:8 row_mask:0xf bank_mask:0xf
  v_dot2c_f32_bf16_dpp v18, v44, v42 row_newbcast:8 row_mask:0xf bank_mask:0xf
  v_dot2c_f32_bf16_dpp v19, v44, v43 row_newbcast:8 row_mask:0xf bank_mask:0xf
  v_dot2c_f32_bf16_dpp v24, v44, v40 row_newbcast:12 row_mask:0xf bank_mask:0xf
  v_dot2c_f32_bf16_dpp v25, v44, v41 row_newbcast:12 row_mask:0xf bank_mask:0xf
  v_dot2c_f32_bf16_dpp v26, v44, v42 row_newbcast:12 row_mask:0xf bank_mask:0xf
  v_dot2c_f32_bf16_dpp v27, v44, v43 row_newbcast:12 row_mask:0xf bank_mask:0xf
  v_perm_b32 v40, v254, v250, s85
  v_perm_b32 v41, v254, v250, s86
  v_perm_b32 v42, v255, v251, s85
  v_perm_b32 v43, v255, v251, s86
  v_dot2c_f32_bf16_dpp v20, v44, v40 row_newbcast:8 row_mask:0xf bank_mask:0xf
  v_dot2c_f32_bf16_dpp v21, v44, v41 row_newbcast:8 row_mask:0xf bank_mask:0xf
  v_dot2c_f32_bf16_dpp v22, v44, v42 row_newbcast:8 row_mask:0xf bank_mask:0xf
  v_dot2c_f32_bf16_dpp v23, v44, v43 row_newbcast:8 row_mask:0xf bank_mask:0xf
  v_dot2c_f32_bf16_dpp v28, v44, v40 row_newbcast:12 row_mask:0xf bank_mask:0xf
  v_dot2c_f32_bf16_dpp v29, v44, v41 row_newbcast:12 row_mask:0xf bank_mask:0xf
  v_dot2c_f32_bf16_dpp v30, v44, v42 row_newbcast:12 row_mask:0xf bank_mask:0xf
  v_dot2c_f32_bf16_dpp v31, v44, v43 row_newbcast:12 row_mask:0xf bank_mask:0xf
  s_mov_b32 s83, 294912
  buffer_load_dwordx4 v[240:243], v2, s[8:11], s83 offen offset:0 nt
  buffer_load_dwordx4 v[244:247], v2, s[8:11], s83 offen offset:1024 nt
  buffer_load_dwordx4 v[248:251], v2, s[8:11], s83 offen offset:2048 nt
  buffer_load_dwordx4 v[252:255], v2, s[8:11], s83 offen offset:3072 nt
  s_waitcnt vmcnt(22)
  v_perm_b32 v59, v68, v64, s85
  v_perm_b32 v68, v68, v64, s86
  v_perm_b32 v64, v69, v65, s85
  v_perm_b32 v69, v69, v65, s86
  v_perm_b32 v65, v70, v66, s85
  v_perm_b32 v70, v70, v66, s86
  v_perm_b32 v66, v71, v67, s85
  v_perm_b32 v71, v71, v67, s86
  s_waitcnt vmcnt(20)
  v_perm_b32 v67, v76, v72, s85
  v_perm_b32 v76, v76, v72, s86
  v_perm_b32 v72, v77, v73, s85
  v_perm_b32 v77, v77, v73, s86
  v_perm_b32 v73, v78, v74, s85
  v_perm_b32 v78, v78, v74, s86
  v_perm_b32 v74, v79, v75, s85
  v_perm_b32 v79, v79, v75, s86
  s_mov_b32 s84, 13824
  buffer_load_dwordx4 v[96:99], v46, s[16:19], s84 offen offset:0
  s_mov_b32 s84, 13824
  buffer_load_dwordx4 v[100:103], v46, s[16:19], s84 offen offset:1152
  s_mov_b32 s84, 13824
  buffer_load_dwordx4 v[104:107], v46, s[16:19], s84 offen offset:2304
  s_mov_b32 s84, 17280
  buffer_load_dwordx4 v[108:111], v46, s[16:19], s84 offen offset:0
  s_waitcnt vmcnt(20)
  v_dot2_f32_bf16 v32, v192, v8, 0
  v_dot2_f32_bf16 v36, v192, v12, 0
  v_dot2_f32_bf16 v33, v196, v8, 0
  v_dot2_f32_bf16 v37, v196, v12, 0
  v_dot2_f32_bf16 v34, v200, v8, 0
  v_dot2_f32_bf16 v38, v200, v12, 0
  v_dot2_f32_bf16 v35, v204, v8, 0
  v_dot2_f32_bf16 v39, v204, v12, 0
  v_dot2_f32_bf16 v32, v193, v9, v32
  v_dot2_f32_bf16 v36, v193, v13, v36
  v_dot2_f32_bf16 v33, v197, v9, v33
  v_dot2_f32_bf16 v37, v197, v13, v37
  v_dot2_f32_bf16 v34, v201, v9, v34
  v_dot2_f32_bf16 v38, v201, v13, v38
  v_dot2_f32_bf16 v35, v205, v9, v35
  v_dot2_f32_bf16 v39, v205, v13, v39
  v_dot2_f32_bf16 v32, v194, v10, v32
  v_dot2_f32_bf16 v36, v194, v14, v36
  v_dot2_f32_bf16 v33, v198, v10, v33
  v_dot2_f32_bf16 v37, v198, v14, v37
  v_dot2_f32_bf16 v34, v202, v10, v34
  v_dot2_f32_bf16 v38, v202, v14, v38
  v_dot2_f32_bf16 v35, v206, v10, v35
  v_dot2_f32_bf16 v39, v206, v14, v39
  v_dot2_f32_bf16 v32, v195, v11, v32
  v_dot2_f32_bf16 v36, v195, v15, v36
  v_dot2_f32_bf16 v33, v199, v11, v33
  v_dot2_f32_bf16 v37, v199, v15, v37
  v_dot2_f32_bf16 v34, v203, v11, v34
  v_dot2_f32_bf16 v38, v203, v15, v38
  v_dot2_f32_bf16 v35, v207, v11, v35
  v_dot2_f32_bf16 v39, v207, v15, v39
  s_mov_b32 s83, 327680
  buffer_load_dwordx4 v[192:195], v2, s[4:7], s83 offen offset:0 nt
  buffer_load_dwordx4 v[196:199], v2, s[4:7], s83 offen offset:1024 nt
  buffer_load_dwordx4 v[200:203], v2, s[4:7], s83 offen offset:2048 nt
  buffer_load_dwordx4 v[204:207], v2, s[4:7], s83 offen offset:3072 nt
  v_add_f32_dpp v32, v32, v32 row_ror:8 row_mask:0xf bank_mask:0x3
  v_add_f32_dpp v33, v33, v33 row_ror:8 row_mask:0xf bank_mask:0x3
  v_add_f32_dpp v36, v36, v36 row_ror:8 row_mask:0xf bank_mask:0x3
  v_add_f32_dpp v37, v37, v37 row_ror:8 row_mask:0xf bank_mask:0x3
  v_add_f32_dpp v32, v34, v34 row_ror:8 row_mask:0xf bank_mask:0xc
  v_add_f32_dpp v33, v35, v35 row_ror:8 row_mask:0xf bank_mask:0xc
  v_add_f32_dpp v36, v38, v38 row_ror:8 row_mask:0xf bank_mask:0xc
  v_add_f32_dpp v37, v39, v39 row_ror:8 row_mask:0xf bank_mask:0xc
  v_add_f32_dpp v32, v32, v32 row_shl:4 row_mask:0xf bank_mask:0x5
  v_add_f32_dpp v33, v33, v33 row_shl:4 row_mask:0xf bank_mask:0x5
  s_nop 0
  v_add_f32_dpp v32, v36, v36 row_shr:4 row_mask:0xf bank_mask:0xa
  v_add_f32_dpp v33, v37, v37 row_shr:4 row_mask:0xf bank_mask:0xa
  s_nop 0
  v_add_f32_dpp v32, v32, v32 quad_perm:[1,0,3,2] row_mask:0xf bank_mask:0xf
  v_add_f32_dpp v33, v33, v33 quad_perm:[1,0,3,2] row_mask:0xf bank_mask:0xf
  s_nop 0
  v_add_f32_dpp v32, v32, v32 quad_perm:[2,3,0,1] row_mask:0xf bank_mask:0xf
  v_add_f32_dpp v33, v33, v33 quad_perm:[2,3,0,1] row_mask:0xf bank_mask:0xf
  v_cvt_pk_bf16_f32 v34, v32, v33
  v_lshlrev_b32 v32, 16, v34
  v_and_b32 v33, s87, v34
  v_mul_f32 v32, s88, v32
  v_mul_f32 v33, s88, v33
  v_cvt_pk_bf16_f32 v34, v32, v33
  v_lshlrev_b32 v32, 16, v34
  v_and_b32 v33, s87, v34
  v_fma_f32 v32, v32, s89, -v3
  v_fma_f32 v33, v33, s89, -v3
  v_max_f32 v35, v32, v33
  v_cmp_lt_f32 vcc, 0x41000000, v35
  v_exp_f32 v37, v32
  v_exp_f32 v38, v33
  s_cmp_eq_u64 vcc, 0
  s_cbranch_scc1 K1_LZ8B
  v_max_f32_dpp v35, v35, v35 row_ror:8 row_mask:0xf bank_mask:0xf
  v_max_f32 v35, 0, v35
  v_exp_f32 v36, -v35
  v_add_f32 v3, v3, v35
  v_sub_f32 v32, v32, v35
  v_sub_f32 v33, v33, v35
  v_exp_f32 v37, v32
  v_exp_f32 v38, v33
  v_mul_f32 v4, v4, v36
  v_mul_f32_dpp v16, v36, v16 row_newbcast:0 row_mask:0xf bank_mask:0xf
  v_mul_f32_dpp v17, v36, v17 row_newbcast:0 row_mask:0xf bank_mask:0xf
  v_mul_f32_dpp v18, v36, v18 row_newbcast:0 row_mask:0xf bank_mask:0xf
  v_mul_f32_dpp v19, v36, v19 row_newbcast:0 row_mask:0xf bank_mask:0xf
  v_mul_f32_dpp v20, v36, v20 row_newbcast:0 row_mask:0xf bank_mask:0xf
  v_mul_f32_dpp v21, v36, v21 row_newbcast:0 row_mask:0xf bank_mask:0xf
  v_mul_f32_dpp v22, v36, v22 row_newbcast:0 row_mask:0xf bank_mask:0xf
  v_mul_f32_dpp v23, v36, v23 row_newbcast:0 row_mask:0xf bank_mask:0xf
  v_mul_f32_dpp v24, v36, v24 row_newbcast:4 row_mask:0xf bank_mask:0xf
  v_mul_f32_dpp v25, v36, v25 row_newbcast:4 row_mask:0xf bank_mask:0xf
  v_mul_f32_dpp v26, v36, v26 row_newbcast:4 row_mask:0xf bank_mask:0xf
  v_mul_f32_dpp v27, v36, v27 row_newbcast:4 row_mask:0xf bank_mask:0xf
  v_mul_f32_dpp v28, v36, v28 row_newbcast:4 row_mask:0xf bank_mask:0xf
  v_mul_f32_dpp v29, v36, v29 row_newbcast:4 row_mask:0xf bank_mask:0xf
  v_mul_f32_dpp v30, v36, v30 row_newbcast:4 row_mask:0xf bank_mask:0xf
  v_mul_f32_dpp v31, v36, v31 row_newbcast:4 row_mask:0xf bank_mask:0xf
K1_LZ8B:
  s_nop 1
  v_add_f32 v4, v4, v37
  v_cvt_pk_bf16_f32 v44, v37, v38
  v_add_f32 v4, v4, v38
  s_waitcnt vmcnt(20)
  v_perm_b32 v40, v212, v208, s85
  v_perm_b32 v41, v212, v208, s86
  v_perm_b32 v42, v213, v209, s85
  v_perm_b32 v43, v213, v209, s86
  v_dot2c_f32_bf16_dpp v16, v44, v40 row_newbcast:0 row_mask:0xf bank_mask:0xf
  v_dot2c_f32_bf16_dpp v17, v44, v41 row_newbcast:0 row_mask:0xf bank_mask:0xf
  v_dot2c_f32_bf16_dpp v18, v44, v42 row_newbcast:0 row_mask:0xf bank_mask:0xf
  v_dot2c_f32_bf16_dpp v19, v44, v43 row_newbcast:0 row_mask:0xf bank_mask:0xf
  v_dot2c_f32_bf16_dpp v24, v44, v40 row_newbcast:4 row_mask:0xf bank_mask:0xf
  v_dot2c_f32_bf16_dpp v25, v44, v41 row_newbcast:4 row_mask:0xf bank_mask:0xf
  v_dot2c_f32_bf16_dpp v26, v44, v42 row_newbcast:4 row_mask:0xf bank_mask:0xf
  v_dot2c_f32_bf16_dpp v27, v44, v43 row_newbcast:4 row_mask:0xf bank_mask:0xf
  v_perm_b32 v40, v214, v210, s85
  v_perm_b32 v41, v214, v210, s86
  v_perm_b32 v42, v215, v211, s85
  v_perm_b32 v43, v215, v211, s86
  v_dot2c_f32_bf16_dpp v20, v44, v40 row_newbcast:0 row_mask:0xf bank_mask:0xf
  v_dot2c_f32_bf16_dpp v21, v44, v41 row_newbcast:0 row_mask:0xf bank_mask:0xf
  v_dot2c_f32_bf16_dpp v22, v44, v42 row_newbcast:0 row_mask:0xf bank_mask:0xf
  v_dot2c_f32_bf16_dpp v23, v44, v43 row_newbcast:0 row_mask:0xf bank_mask:0xf
  v_dot2c_f32_bf16_dpp v28, v44, v40 row_newbcast:4 row_mask:0xf bank_mask:0xf
  v_dot2c_f32_bf16_dpp v29, v44, v41 row_newbcast:4 row_mask:0xf bank_mask:0xf
  v_dot2c_f32_bf16_dpp v30, v44, v42 row_newbcast:4 row_mask:0xf bank_mask:0xf
  v_dot2c_f32_bf16_dpp v31, v44, v43 row_newbcast:4 row_mask:0xf bank_mask:0xf
  v_perm_b32 v40, v220, v216, s85
  v_perm_b32 v41, v220, v216, s86
  v_perm_b32 v42, v221, v217, s85
  v_perm_b32 v43, v221, v217, s86
  v_dot2c_f32_bf16_dpp v16, v44, v40 row_newbcast:8 row_mask:0xf bank_mask:0xf
  v_dot2c_f32_bf16_dpp v17, v44, v41 row_newbcast:8 row_mask:0xf bank_mask:0xf
  v_dot2c_f32_bf16_dpp v18, v44, v42 row_newbcast:8 row_mask:0xf bank_mask:0xf
  v_dot2c_f32_bf16_dpp v19, v44, v43 row_newbcast:8 row_mask:0xf bank_mask:0xf
  v_dot2c_f32_bf16_dpp v24, v44, v40 row_newbcast:12 row_mask:0xf bank_mask:0xf
  v_dot2c_f32_bf16_dpp v25, v44, v41 row_newbcast:12 row_mask:0xf bank_mask:0xf
  v_dot2c_f32_bf16_dpp v26, v44, v42 row_newbcast:12 row_mask:0xf bank_mask:0xf
  v_dot2c_f32_bf16_dpp v27, v44, v43 row_newbcast:12 row_mask:0xf bank_mask:0xf
  v_perm_b32 v40, v222, v218, s85
  v_perm_b32 v41, v222, v218, s86
  v_perm_b32 v42, v223, v219, s85
  v_perm_b32 v43, v223, v219, s86
  v_dot2c_f32_bf16_dpp v20, v44, v40 row_newbcast:8 row_mask:0xf bank_mask:0xf
  v_dot2c_f32_bf16_dpp v21, v44, v41 row_newbcast:8 row_mask:0xf bank_mask:0xf
  v_dot2c_f32_bf16_dpp v22, v44, v42 row_newbcast:8 row_mask:0xf bank_mask:0xf
  v_dot2c_f32_bf16_dpp v23, v44, v43 row_newbcast:8 row_mask:0xf bank_mask:0xf
  v_dot2c_f32_bf16_dpp v28, v44, v40 row_newbcast:12 row_mask:0xf bank_mask:0xf
  v_dot2c_f32_bf16_dpp v29, v44, v41 row_newbcast:12 row_mask:0xf bank_mask:0xf
  v_dot2c_f32_bf16_dpp v30, v44, v42 row_newbcast:12 row_mask:0xf bank_mask:0xf
  v_dot2c_f32_bf16_dpp v31, v44, v43 row_newbcast:12 row_mask:0xf bank_mask:0xf
  s_mov_b32 s83, 327680
  buffer_load_dwordx4 v[208:211], v2, s[8:11], s83 offen offset:0 nt
  buffer_load_dwordx4 v[212:215], v2, s[8:11], s83 offen offset:1024 nt
  buffer_load_dwordx4 v[216:219], v2, s[8:11], s83 offen offset:2048 nt
  buffer_load_dwordx4 v[220:223], v2, s[8:11], s83 offen offset:3072 nt
  s_waitcnt vmcnt(22)
  v_perm_b32 v75, v84, v80, s85
  v_perm_b32 v84, v84, v80, s86
  v_perm_b32 v80, v85, v81, s85
  v_perm_b32 v85, v85, v81, s86
  v_perm_b32 v81, v86, v82, s85
  v_perm_b32 v86, v86, v82, s86
  v_perm_b32 v82, v87, v83, s85
  v_perm_b32 v87, v87, v83, s86
  s_waitcnt vmcnt(20)
  v_perm_b32 v83, v92, v88, s85
  v_perm_b32 v92, v92, v88, s86
  v_perm_b32 v88, v93, v89, s85
  v_perm_b32 v93, v93, v89, s86
  v_perm_b32 v89, v94, v90, s85
  v_perm_b32 v94, v94, v90, s86
  v_perm_b32 v90, v95, v91, s85
  v_perm_b32 v95, v95, v91, s86
  s_mov_b32 s84, 17280
  buffer_load_dwordx4 v[112:115], v46, s[16:19], s84 offen offset:1152
  s_mov_b32 s84, 17280
  buffer_load_dwordx4 v[116:119], v46, s[16:19], s84 offen offset:2304
  s_mov_b32 s84, 20736
  buffer_load_dwordx4 v[120:123], v46, s[16:19], s84 offen offset:0
  s_mov_b32 s84, 20736
  buffer_load_dwordx4 v[124:127], v46, s[16:19], s84 offen offset:1152
  s_waitcnt vmcnt(20)
  v_dot2_f32_bf16 v32, v224, v8, 0
  v_dot2_f32_bf16 v36, v224, v12, 0
  v_dot2_f32_bf16 v33, v228, v8, 0
  v_dot2_f32_bf16 v37, v228, v12, 0
  v_dot2_f32_bf16 v34, v232, v8, 0
  v_dot2_f32_bf16 v38, v232, v12, 0
  v_dot2_f32_bf16 v35, v236, v8, 0
  v_dot2_f32_bf16 v39, v236, v12, 0
  v_dot2_f32_bf16 v32, v225, v9, v32
  v_dot2_f32_bf16 v36, v225, v13, v36
  v_dot2_f32_bf16 v33, v229, v9, v33
  v_dot2_f32_bf16 v37, v229, v13, v37
  v_dot2_f32_bf16 v34, v233, v9, v34
  v_dot2_f32_bf16 v38, v233, v13, v38
  v_dot2_f32_bf16 v35, v237, v9, v35
  v_dot2_f32_bf16 v39, v237, v13, v39
  v_dot2_f32_bf16 v32, v226, v10, v32
  v_dot2_f32_bf16 v36, v226, v14, v36
  v_dot2_f32_bf16 v33, v230, v10, v33
  v_dot2_f32_bf16 v37, v230, v14, v37
  v_dot2_f32_bf16 v34, v234, v10, v34
  v_dot2_f32_bf16 v38, v234, v14, v38
  v_dot2_f32_bf16 v35, v238, v10, v35
  v_dot2_f32_bf16 v39, v238, v14, v39
  v_dot2_f32_bf16 v32, v227, v11, v32
  v_dot2_f32_bf16 v36, v227, v15, v36
  v_dot2_f32_bf16 v33, v231, v11, v33
  v_dot2_f32_bf16 v37, v231, v15, v37
  v_dot2_f32_bf16 v34, v235, v11, v34
  v_dot2_f32_bf16 v38, v235, v15, v38
  v_dot2_f32_bf16 v35, v239, v11, v35
  v_dot2_f32_bf16 v39, v239, v15, v39
  s_mov_b32 s83, 360448
  buffer_load_dwordx4 v[224:227], v2, s[4:7], s83 offen offset:0 nt
  buffer_load_dwordx4 v[228:231], v2, s[4:7], s83 offen offset:1024 nt
  buffer_load_dwordx4 v[232:235], v2, s[4:7], s83 offen offset:2048 nt
  buffer_load_dwordx4 v[236:239], v2, s[4:7], s83 offen offset:3072 nt
  v_add_f32_dpp v32, v32, v32 row_ror:8 row_mask:0xf bank_mask:0x3
  v_add_f32_dpp v33, v33, v33 row_ror:8 row_mask:0xf bank_mask:0x3
  v_add_f32_dpp v36, v36, v36 row_ror:8 row_mask:0xf bank_mask:0x3
  v_add_f32_dpp v37, v37, v37 row_ror:8 row_mask:0xf bank_mask:0x3
  v_add_f32_dpp v32, v34, v34 row_ror:8 row_mask:0xf bank_mask:0xc
  v_add_f32_dpp v33, v35, v35 row_ror:8 row_mask:0xf bank_mask:0xc
  v_add_f32_dpp v36, v38, v38 row_ror:8 row_mask:0xf bank_mask:0xc
  v_add_f32_dpp v37, v39, v39 row_ror:8 row_mask:0xf bank_mask:0xc
  v_add_f32_dpp v32, v32, v32 row_shl:4 row_mask:0xf bank_mask:0x5
  v_add_f32_dpp v33, v33, v33 row_shl:4 row_mask:0xf bank_mask:0x5
  s_nop 0
  v_add_f32_dpp v32, v36, v36 row_shr:4 row_mask:0xf bank_mask:0xa
  v_add_f32_dpp v33, v37, v37 row_shr:4 row_mask:0xf bank_mask:0xa
  s_nop 0
  v_add_f32_dpp v32, v32, v32 quad_perm:[1,0,3,2] row_mask:0xf bank_mask:0xf
  v_add_f32_dpp v33, v33, v33 quad_perm:[1,0,3,2] row_mask:0xf bank_mask:0xf
  s_nop 0
  v_add_f32_dpp v32, v32, v32 quad_perm:[2,3,0,1] row_mask:0xf bank_mask:0xf
  v_add_f32_dpp v33, v33, v33 quad_perm:[2,3,0,1] row_mask:0xf bank_mask:0xf
  v_cvt_pk_bf16_f32 v34, v32, v33
  v_lshlrev_b32 v32, 16, v34
  v_and_b32 v33, s87, v34
  v_mul_f32 v32, s88, v32
  v_mul_f32 v33, s88, v33
  v_cvt_pk_bf16_f32 v34, v32, v33
  v_lshlrev_b32 v32, 16, v34
  v_and_b32 v33, s87, v34
  v_fma_f32 v32, v32, s89, -v3
  v_fma_f32 v33, v33, s89, -v3
  v_max_f32 v35, v32, v33
  v_cmp_lt_f32 vcc, 0x41000000, v35
  v_exp_f32 v37, v32
  v_exp_f32 v38, v33
  s_cmp_eq_u64 vcc, 0
  s_cbranch_scc1 K1_LZ9B
  v_max_f32_dpp v35, v35, v35 row_ror:8 row_mask:0xf bank_mask:0xf
  v_max_f32 v35, 0, v35
  v_exp_f32 v36, -v35
  v_add_f32 v3, v3, v35
  v_sub_f32 v32, v32, v35
  v_sub_f32 v33, v33, v35
  v_exp_f32 v37, v32
  v_exp_f32 v38, v33
  v_mul_f32 v4, v4, v36
  v_mul_f32_dpp v16, v36, v16 row_newbcast:0 row_mask:0xf bank_mask:0xf
  v_mul_f32_dpp v17, v36, v17 row_newbcast:0 row_mask:0xf bank_mask:0xf
  v_mul_f32_dpp v18, v36, v18 row_newbcast:0 row_mask:0xf bank_mask:0xf
  v_mul_f32_dpp v19, v36, v19 row_newbcast:0 row_mask:0xf bank_mask:0xf
  v_mul_f32_dpp v20, v36, v20 row_newbcast:0 row_mask:0xf bank_mask:0xf
  v_mul_f32_dpp v21, v36, v21 row_newbcast:0 row_mask:0xf bank_mask:0xf
  v_mul_f32_dpp v22, v36, v22 row_newbcast:0 row_mask:0xf bank_mask:0xf
  v_mul_f32_dpp v23, v36, v23 row_newbcast:0 row_mask:0xf bank_mask:0xf
  v_mul_f32_dpp v24, v36, v24 row_newbcast:4 row_mask:0xf bank_mask:0xf
  v_mul_f32_dpp v25, v36, v25 row_newbcast:4 row_mask:0xf bank_mask:0xf
  v_mul_f32_dpp v26, v36, v26 row_newbcast:4 row_mask:0xf bank_mask:0xf
  v_mul_f32_dpp v27, v36, v27 row_newbcast:4 row_mask:0xf bank_mask:0xf
  v_mul_f32_dpp v28, v36, v28 row_newbcast:4 row_mask:0xf bank_mask:0xf
  v_mul_f32_dpp v29, v36, v29 row_newbcast:4 row_mask:0xf bank_mask:0xf
  v_mul_f32_dpp v30, v36, v30 row_newbcast:4 row_mask:0xf bank_mask:0xf
  v_mul_f32_dpp v31, v36, v31 row_newbcast:4 row_mask:0xf bank_mask:0xf
K1_LZ9B:
  s_nop 1
  v_add_f32 v4, v4, v37
  v_cvt_pk_bf16_f32 v44, v37, v38
  v_add_f32 v4, v4, v38
  s_waitcnt vmcnt(20)
  v_perm_b32 v40, v244, v240, s85
  v_perm_b32 v41, v244, v240, s86
  v_perm_b32 v42, v245, v241, s85
  v_perm_b32 v43, v245, v241, s86
  v_dot2c_f32_bf16_dpp v16, v44, v40 row_newbcast:0 row_mask:0xf bank_mask:0xf
  v_dot2c_f32_bf16_dpp v17, v44, v41 row_newbcast:0 row_mask:0xf bank_mask:0xf
  v_dot2c_f32_bf16_dpp v18, v44, v42 row_newbcast:0 row_mask:0xf bank_mask:0xf
  v_dot2c_f32_bf16_dpp v19, v44, v43 row_newbcast:0 row_mask:0xf bank_mask:0xf
  v_dot2c_f32_bf16_dpp v24, v44, v40 row_newbcast:4 row_mask:0xf bank_mask:0xf
  v_dot2c_f32_bf16_dpp v25, v44, v41 row_newbcast:4 row_mask:0xf bank_mask:0xf
  v_dot2c_f32_bf16_dpp v26, v44, v42 row_newbcast:4 row_mask:0xf bank_mask:0xf
  v_dot2c_f32_bf16_dpp v27, v44, v43 row_newbcast:4 row_mask:0xf bank_mask:0xf
  v_perm_b32 v40, v246, v242, s85
  v_perm_b32 v41, v246, v242, s86
  v_perm_b32 v42, v247, v243, s85
  v_perm_b32 v43, v247, v243, s86
  v_dot2c_f32_bf16_dpp v20, v44, v40 row_newbcast:0 row_mask:0xf bank_mask:0xf
  v_dot2c_f32_bf16_dpp v21, v44, v41 row_newbcast:0 row_mask:0xf bank_mask:0xf
  v_dot2c_f32_bf16_dpp v22, v44, v42 row_newbcast:0 row_mask:0xf bank_mask:0xf
  v_dot2c_f32_bf16_dpp v23, v44, v43 row_newbcast:0 row_mask:0xf bank_mask:0xf
  v_dot2c_f32_bf16_dpp v28, v44, v40 row_newbcast:4 row_mask:0xf bank_mask:0xf
  v_dot2c_f32_bf16_dpp v29, v44, v41 row_newbcast:4 row_mask:0xf bank_mask:0xf
  v_dot2c_f32_bf16_dpp v30, v44, v42 row_newbcast:4 row_mask:0xf bank_mask:0xf
  v_dot2c_f32_bf16_dpp v31, v44, v43 row_newbcast:4 row_mask:0xf bank_mask:0xf
  v_perm_b32 v40, v252, v248, s85
  v_perm_b32 v41, v252, v248, s86
  v_perm_b32 v42, v253, v249, s85
  v_perm_b32 v43, v253, v249, s86
  v_dot2c_f32_bf16_dpp v16, v44, v40 row_newbcast:8 row_mask:0xf bank_mask:0xf
  v_dot2c_f32_bf16_dpp v17, v44, v41 row_newbcast:8 row_mask:0xf bank_mask:0xf
  v_dot2c_f32_bf16_dpp v18, v44, v42 row_newbcast:8 row_mask:0xf bank_mask:0xf
  v_dot2c_f32_bf16_dpp v19, v44, v43 row_newbcast:8 row_mask:0xf bank_mask:0xf
  v_dot2c_f32_bf16_dpp v24, v44, v40 row_newbcast:12 row_mask:0xf bank_mask:0xf
  v_dot2c_f32_bf16_dpp v25, v44, v41 row_newbcast:12 row_mask:0xf bank_mask:0xf
  v_dot2c_f32_bf16_dpp v26, v44, v42 row_newbcast:12 row_mask:0xf bank_mask:0xf
  v_dot2c_f32_bf16_dpp v27, v44, v43 row_newbcast:12 row_mask:0xf bank_mask:0xf
  v_perm_b32 v40, v254, v250, s85
  v_perm_b32 v41, v254, v250, s86
  v_perm_b32 v42, v255, v251, s85
  v_perm_b32 v43, v255, v251, s86
  v_dot2c_f32_bf16_dpp v20, v44, v40 row_newbcast:8 row_mask:0xf bank_mask:0xf
  v_dot2c_f32_bf16_dpp v21, v44, v41 row_newbcast:8 row_mask:0xf bank_mask:0xf
  v_dot2c_f32_bf16_dpp v22, v44, v42 row_newbcast:8 row_mask:0xf bank_mask:0xf
  v_dot2c_f32_bf16_dpp v23, v44, v43 row_newbcast:8 row_mask:0xf bank_mask:0xf
  v_dot2c_f32_bf16_dpp v28, v44, v40 row_newbcast:12 row_mask:0xf bank_mask:0xf
  v_dot2c_f32_bf16_dpp v29, v44, v41 row_newbcast:12 row_mask:0xf bank_mask:0xf
  v_dot2c_f32_bf16_dpp v30, v44, v42 row_newbcast:12 row_mask:0xf bank_mask:0xf
  v_dot2c_f32_bf16_dpp v31, v44, v43 row_newbcast:12 row_mask:0xf bank_mask:0xf
  s_mov_b32 s83, 360448
  buffer_load_dwordx4 v[240:243], v2, s[8:11], s83 offen offset:0 nt
  buffer_load_dwordx4 v[244:247], v2, s[8:11], s83 offen offset:1024 nt
  buffer_load_dwordx4 v[248:251], v2, s[8:11], s83 offen offset:2048 nt
  buffer_load_dwordx4 v[252:255], v2, s[8:11], s83 offen offset:3072 nt
  s_waitcnt vmcnt(22)
  v_perm_b32 v91, v100, v96, s85
  v_perm_b32 v100, v100, v96, s86
  v_perm_b32 v96, v101, v97, s85
  v_perm_b32 v101, v101, v97, s86
  v_perm_b32 v97, v102, v98, s85
  v_perm_b32 v102, v102, v98, s86
  v_perm_b32 v98, v103, v99, s85
  v_perm_b32 v103, v103, v99, s86
  s_waitcnt vmcnt(20)
  v_perm_b32 v99, v108, v104, s85
  v_perm_b32 v108, v108, v104, s86
  v_perm_b32 v104, v109, v105, s85
  v_perm_b32 v109, v109, v105, s86
  v_perm_b32 v105, v110, v106, s85
  v_perm_b32 v110, v110, v106, s86
  v_perm_b32 v106, v111, v107, s85
  v_perm_b32 v111, v111, v107, s86
  s_mov_b32 s84, 20736
  buffer_load_dwordx4 v[128:131], v46, s[16:19], s84 offen offset:2304
  s_mov_b32 s84, 24192
  buffer_load_dwordx4 v[132:135], v46, s[16:19], s84 offen offset:0
  s_mov_b32 s84, 24192
  buffer_load_dwordx4 v[136:139], v46, s[16:19], s84 offen offset:1152
  s_mov_b32 s84, 24192
  buffer_load_dwordx4 v[140:143], v46, s[16:19], s84 offen offset:2304
  s_waitcnt vmcnt(20)
  v_dot2_f32_bf16 v32, v192, v8, 0
  v_dot2_f32_bf16 v36, v192, v12, 0
  v_dot2_f32_bf16 v33, v196, v8, 0
  v_dot2_f32_bf16 v37, v196, v12, 0
  v_dot2_f32_bf16 v34, v200, v8, 0
  v_dot2_f32_bf16 v38, v200, v12, 0
  v_dot2_f32_bf16 v35, v204, v8, 0
  v_dot2_f32_bf16 v39, v204, v12, 0
  v_dot2_f32_bf16 v32, v193, v9, v32
  v_dot2_f32_bf16 v36, v193, v13, v36
  v_dot2_f32_bf16 v33, v197, v9, v33
  v_dot2_f32_bf16 v37, v197, v13, v37
  v_dot2_f32_bf16 v34, v201, v9, v34
  v_dot2_f32_bf16 v38, v201, v13, v38
  v_dot2_f32_bf16 v35, v205, v9, v35
  v_dot2_f32_bf16 v39, v205, v13, v39
  v_dot2_f32_bf16 v32, v194, v10, v32
  v_dot2_f32_bf16 v36, v194, v14, v36
  v_dot2_f32_bf16 v33, v198, v10, v33
  v_dot2_f32_bf16 v37, v198, v14, v37
  v_dot2_f32_bf16 v34, v202, v10, v34
  v_dot2_f32_bf16 v38, v202, v14, v38
  v_dot2_f32_bf16 v35, v206, v10, v35
  v_dot2_f32_bf16 v39, v206, v14, v39
  v_dot2_f32_bf16 v32, v195, v11, v32
  v_dot2_f32_bf16 v36, v195, v15, v36
  v_dot2_f32_bf16 v33, v199, v11, v33
  v_dot2_f32_bf16 v37, v199, v15, v37
  v_dot2_f32_bf16 v34, v203, v11, v34
  v_dot2_f32_bf16 v38, v203, v15, v38
  v_dot2_f32_bf16 v35, v207, v11, v35
  v_dot2_f32_bf16 v39, v207, v15, v39
  s_mov_b32 s83, 393216
  buffer_load_dwordx4 v[192:195], v2, s[4:7], s83 offen offset:0 nt
  buffer_load_dwordx4 v[196:199], v2, s[4:7], s83 offen offset:1024 nt
  buffer_load_dwordx4 v[200:203], v2, s[4:7], s83 offen offset:2048 nt
  buffer_load_dwordx4 v[204:207], v2, s[4:7], s83 offen offset:3072 nt
  v_add_f32_dpp v32, v32, v32 row_ror:8 row_mask:0xf bank_mask:0x3
  v_add_f32_dpp v33, v33, v33 row_ror:8 row_mask:0xf bank_mask:0x3
  v_add_f32_dpp v36, v36, v36 row_ror:8 row_mask:0xf bank_mask:0x3
  v_add_f32_dpp v37, v37, v37 row_ror:8 row_mask:0xf bank_mask:0x3
  v_add_f32_dpp v32, v34, v34 row_ror:8 row_mask:0xf bank_mask:0xc
  v_add_f32_dpp v33, v35, v35 row_ror:8 row_mask:0xf bank_mask:0xc
  v_add_f32_dpp v36, v38, v38 row_ror:8 row_mask:0xf bank_mask:0xc
  v_add_f32_dpp v37, v39, v39 row_ror:8 row_mask:0xf bank_mask:0xc
  v_add_f32_dpp v32, v32, v32 row_shl:4 row_mask:0xf bank_mask:0x5
  v_add_f32_dpp v33, v33, v33 row_shl:4 row_mask:0xf bank_mask:0x5
  s_nop 0
  v_add_f32_dpp v32, v36, v36 row_shr:4 row_mask:0xf bank_mask:0xa
  v_add_f32_dpp v33, v37, v37 row_shr:4 row_mask:0xf bank_mask:0xa
  s_nop 0
  v_add_f32_dpp v32, v32, v32 quad_perm:[1,0,3,2] row_mask:0xf bank_mask:0xf
  v_add_f32_dpp v33, v33, v33 quad_perm:[1,0,3,2] row_mask:0xf bank_mask:0xf
  s_nop 0
  v_add_f32_dpp v32, v32, v32 quad_perm:[2,3,0,1] row_mask:0xf bank_mask:0xf
  v_add_f32_dpp v33, v33, v33 quad_perm:[2,3,0,1] row_mask:0xf bank_mask:0xf
  v_cvt_pk_bf16_f32 v34, v32, v33
  v_lshlrev_b32 v32, 16, v34
  v_and_b32 v33, s87, v34
  v_mul_f32 v32, s88, v32
  v_mul_f32 v33, s88, v33
  v_cvt_pk_bf16_f32 v34, v32, v33
  v_lshlrev_b32 v32, 16, v34
  v_and_b32 v33, s87, v34
  v_fma_f32 v32, v32, s89, -v3
  v_fma_f32 v33, v33, s89, -v3
  v_max_f32 v35, v32, v33
  v_cmp_lt_f32 vcc, 0x41000000, v35
  v_exp_f32 v37, v32
  v_exp_f32 v38, v33
  s_cmp_eq_u64 vcc, 0
  s_cbranch_scc1 K1_LZ10B
  v_max_f32_dpp v35, v35, v35 row_ror:8 row_mask:0xf bank_mask:0xf
  v_max_f32 v35, 0, v35
  v_exp_f32 v36, -v35
  v_add_f32 v3, v3, v35
  v_sub_f32 v32, v32, v35
  v_sub_f32 v33, v33, v35
  v_exp_f32 v37, v32
  v_exp_f32 v38, v33
  v_mul_f32 v4, v4, v36
  v_mul_f32_dpp v16, v36, v16 row_newbcast:0 row_mask:0xf bank_mask:0xf
  v_mul_f32_dpp v17, v36, v17 row_newbcast:0 row_mask:0xf bank_mask:0xf
  v_mul_f32_dpp v18, v36, v18 row_newbcast:0 row_mask:0xf bank_mask:0xf
  v_mul_f32_dpp v19, v36, v19 row_newbcast:0 row_mask:0xf bank_mask:0xf
  v_mul_f32_dpp v20, v36, v20 row_newbcast:0 row_mask:0xf bank_mask:0xf
  v_mul_f32_dpp v21, v36, v21 row_newbcast:0 row_mask:0xf bank_mask:0xf
  v_mul_f32_dpp v22, v36, v22 row_newbcast:0 row_mask:0xf bank_mask:0xf
  v_mul_f32_dpp v23, v36, v23 row_newbcast:0 row_mask:0xf bank_mask:0xf
  v_mul_f32_dpp v24, v36, v24 row_newbcast:4 row_mask:0xf bank_mask:0xf
  v_mul_f32_dpp v25, v36, v25 row_newbcast:4 row_mask:0xf bank_mask:0xf
  v_mul_f32_dpp v26, v36, v26 row_newbcast:4 row_mask:0xf bank_mask:0xf
  v_mul_f32_dpp v27, v36, v27 row_newbcast:4 row_mask:0xf bank_mask:0xf
  v_mul_f32_dpp v28, v36, v28 row_newbcast:4 row_mask:0xf bank_mask:0xf
  v_mul_f32_dpp v29, v36, v29 row_newbcast:4 row_mask:0xf bank_mask:0xf
  v_mul_f32_dpp v30, v36, v30 row_newbcast:4 row_mask:0xf bank_mask:0xf
  v_mul_f32_dpp v31, v36, v31 row_newbcast:4 row_mask:0xf bank_mask:0xf
K1_LZ10B:
  s_nop 1
  v_add_f32 v4, v4, v37
  v_cvt_pk_bf16_f32 v44, v37, v38
  v_add_f32 v4, v4, v38
  s_waitcnt vmcnt(20)
  v_perm_b32 v40, v212, v208, s85
  v_perm_b32 v41, v212, v208, s86
  v_perm_b32 v42, v213, v209, s85
  v_perm_b32 v43, v213, v209, s86
  v_dot2c_f32_bf16_dpp v16, v44, v40 row_newbcast:0 row_mask:0xf bank_mask:0xf
  v_dot2c_f32_bf16_dpp v17, v44, v41 row_newbcast:0 row_mask:0xf bank_mask:0xf
  v_dot2c_f32_bf16_dpp v18, v44, v42 row_newbcast:0 row_mask:0xf bank_mask:0xf
  v_dot2c_f32_bf16_dpp v19, v44, v43 row_newbcast:0 row_mask:0xf bank_mask:0xf
  v_dot2c_f32_bf16_dpp v24, v44, v40 row_newbcast:4 row_mask:0xf bank_mask:0xf
  v_dot2c_f32_bf16_dpp v25, v44, v41 row_newbcast:4 row_mask:0xf bank_mask:0xf
  v_dot2c_f32_bf16_dpp v26, v44, v42 row_newbcast:4 row_mask:0xf bank_mask:0xf
  v_dot2c_f32_bf16_dpp v27, v44, v43 row_newbcast:4 row_mask:0xf bank_mask:0xf
  v_perm_b32 v40, v214, v210, s85
  v_perm_b32 v41, v214, v210, s86
  v_perm_b32 v42, v215, v211, s85
  v_perm_b32 v43, v215, v211, s86
  v_dot2c_f32_bf16_dpp v20, v44, v40 row_newbcast:0 row_mask:0xf bank_mask:0xf
  v_dot2c_f32_bf16_dpp v21, v44, v41 row_newbcast:0 row_mask:0xf bank_mask:0xf
  v_dot2c_f32_bf16_dpp v22, v44, v42 row_newbcast:0 row_mask:0xf bank_mask:0xf
  v_dot2c_f32_bf16_dpp v23, v44, v43 row_newbcast:0 row_mask:0xf bank_mask:0xf
  v_dot2c_f32_bf16_dpp v28, v44, v40 row_newbcast:4 row_mask:0xf bank_mask:0xf
  v_dot2c_f32_bf16_dpp v29, v44, v41 row_newbcast:4 row_mask:0xf bank_mask:0xf
  v_dot2c_f32_bf16_dpp v30, v44, v42 row_newbcast:4 row_mask:0xf bank_mask:0xf
  v_dot2c_f32_bf16_dpp v31, v44, v43 row_newbcast:4 row_mask:0xf bank_mask:0xf
  v_perm_b32 v40, v220, v216, s85
  v_perm_b32 v41, v220, v216, s86
  v_perm_b32 v42, v221, v217, s85
  v_perm_b32 v43, v221, v217, s86
  v_dot2c_f32_bf16_dpp v16, v44, v40 row_newbcast:8 row_mask:0xf bank_mask:0xf
  v_dot2c_f32_bf16_dpp v17, v44, v41 row_newbcast:8 row_mask:0xf bank_mask:0xf
  v_dot2c_f32_bf16_dpp v18, v44, v42 row_newbcast:8 row_mask:0xf bank_mask:0xf
  v_dot2c_f32_bf16_dpp v19, v44, v43 row_newbcast:8 row_mask:0xf bank_mask:0xf
  v_dot2c_f32_bf16_dpp v24, v44, v40 row_newbcast:12 row_mask:0xf bank_mask:0xf
  v_dot2c_f32_bf16_dpp v25, v44, v41 row_newbcast:12 row_mask:0xf bank_mask:0xf
  v_dot2c_f32_bf16_dpp v26, v44, v42 row_newbcast:12 row_mask:0xf bank_mask:0xf
  v_dot2c_f32_bf16_dpp v27, v44, v43 row_newbcast:12 row_mask:0xf bank_mask:0xf
  v_perm_b32 v40, v222, v218, s85
  v_perm_b32 v41, v222, v218, s86
  v_perm_b32 v42, v223, v219, s85
  v_perm_b32 v43, v223, v219, s86
  v_dot2c_f32_bf16_dpp v20, v44, v40 row_newbcast:8 row_mask:0xf bank_mask:0xf
  v_dot2c_f32_bf16_dpp v21, v44, v41 row_newbcast:8 row_mask:0xf bank_mask:0xf
  v_dot2c_f32_bf16_dpp v22, v44, v42 row_newbcast:8 row_mask:0xf bank_mask:0xf
  v_dot2c_f32_bf16_dpp v23, v44, v43 row_newbcast:8 row_mask:0xf bank_mask:0xf
  v_dot2c_f32_bf16_dpp v28, v44, v40 row_newbcast:12 row_mask:0xf bank_mask:0xf
  v_dot2c_f32_bf16_dpp v29, v44, v41 row_newbcast:12 row_mask:0xf bank_mask:0xf
  v_dot2c_f32_bf16_dpp v30, v44, v42 row_newbcast:12 row_mask:0xf bank_mask:0xf
  v_dot2c_f32_bf16_dpp v31, v44, v43 row_newbcast:12 row_mask:0xf bank_mask:0xf
  s_mov_b32 s83, 393216
  buffer_load_dwordx4 v[208:211], v2, s[8:11], s83 offen offset:0 nt
  buffer_load_dwordx4 v[212:215], v2, s[8:11], s83 offen offset:1024 nt
  buffer_load_dwordx4 v[216:219], v2, s[8:11], s83 offen offset:2048 nt
  buffer_load_dwordx4 v[220:223], v2, s[8:11], s83 offen offset:3072 nt
  s_waitcnt vmcnt(22)
  v_perm_b32 v107, v116, v112, s85
  v_perm_b32 v116, v116, v112, s86
  v_perm_b32 v112, v117, v113, s85
  v_perm_b32 v117, v117, v113, s86
  v_perm_b32 v113, v118, v114, s85
  v_perm_b32 v118, v118, v114, s86
  v_perm_b32 v114, v119, v115, s85
  v_perm_b32 v119, v119, v115, s86
  s_waitcnt vmcnt(20)
  v_perm_b32 v115, v124, v120, s85
  v_perm_b32 v124, v124, v120, s86
  v_perm_b32 v120, v125, v121, s85
  v_perm_b32 v125, v125, v121, s86
  v_perm_b32 v121, v126, v122, s85
  v_perm_b32 v126, v126, v122, s86
  v_perm_b32 v122, v127, v123, s85
  v_perm_b32 v127, v127, v123, s86
  s_mov_b32 s84, 27648
  buffer_load_dwordx4 v[144:147], v46, s[16:19], s84 offen offset:0
  s_mov_b32 s84, 27648
  buffer_load_dwordx4 v[148:151], v46, s[16:19], s84 offen offset:1152
  s_mov_b32 s84, 27648
  buffer_load_dwordx4 v[152:155], v46, s[16:19], s84 offen offset:2304
  s_mov_b32 s84, 31104
  buffer_load_dwordx4 v[156:159], v46, s[16:19], s84 offen offset:0
  s_waitcnt vmcnt(20)
  v_dot2_f32_bf16 v32, v224, v8, 0
  v_dot2_f32_bf16 v36, v224, v12, 0
  v_dot2_f32_bf16 v33, v228, v8, 0
  v_dot2_f32_bf16 v37, v228, v12, 0
  v_dot2_f32_bf16 v34, v232, v8, 0
  v_dot2_f32_bf16 v38, v232, v12, 0
  v_dot2_f32_bf16 v35, v236, v8, 0
  v_dot2_f32_bf16 v39, v236, v12, 0
  v_dot2_f32_bf16 v32, v225, v9, v32
  v_dot2_f32_bf16 v36, v225, v13, v36
  v_dot2_f32_bf16 v33, v229, v9, v33
  v_dot2_f32_bf16 v37, v229, v13, v37
  v_dot2_f32_bf16 v34, v233, v9, v34
  v_dot2_f32_bf16 v38, v233, v13, v38
  v_dot2_f32_bf16 v35, v237, v9, v35
  v_dot2_f32_bf16 v39, v237, v13, v39
  v_dot2_f32_bf16 v32, v226, v10, v32
  v_dot2_f32_bf16 v36, v226, v14, v36
  v_dot2_f32_bf16 v33, v230, v10, v33
  v_dot2_f32_bf16 v37, v230, v14, v37
  v_dot2_f32_bf16 v34, v234, v10, v34
  v_dot2_f32_bf16 v38, v234, v14, v38
  v_dot2_f32_bf16 v35, v238, v10, v35
  v_dot2_f32_bf16 v39, v238, v14, v39
  v_dot2_f32_bf16 v32, v227, v11, v32
  v_dot2_f32_bf16 v36, v227, v15, v36
  v_dot2_f32_bf16 v33, v231, v11, v33
  v_dot2_f32_bf16 v37, v231, v15, v37
  v_dot2_f32_bf16 v34, v235, v11, v34
  v_dot2_f32_bf16 v38, v235, v15, v38
  v_dot2_f32_bf16 v35, v239, v11, v35
  v_dot2_f32_bf16 v39, v239, v15, v39
  s_mov_b32 s83, 425984
  buffer_load_dwordx4 v[224:227], v2, s[4:7], s83 offen offset:0 nt
  buffer_load_dwordx4 v[228:231], v2, s[4:7], s83 offen offset:1024 nt
  buffer_load_dwordx4 v[232:235], v2, s[4:7], s83 offen offset:2048 nt
  buffer_load_dwordx4 v[236:239], v2, s[4:7], s83 offen offset:3072 nt
  v_add_f32_dpp v32, v32, v32 row_ror:8 row_mask:0xf bank_mask:0x3
  v_add_f32_dpp v33, v33, v33 row_ror:8 row_mask:0xf bank_mask:0x3
  v_add_f32_dpp v36, v36, v36 row_ror:8 row_mask:0xf bank_mask:0x3
  v_add_f32_dpp v37, v37, v37 row_ror:8 row_mask:0xf bank_mask:0x3
  v_add_f32_dpp v32, v34, v34 row_ror:8 row_mask:0xf bank_mask:0xc
  v_add_f32_dpp v33, v35, v35 row_ror:8 row_mask:0xf bank_mask:0xc
  v_add_f32_dpp v36, v38, v38 row_ror:8 row_mask:0xf bank_mask:0xc
  v_add_f32_dpp v37, v39, v39 row_ror:8 row_mask:0xf bank_mask:0xc
  v_add_f32_dpp v32, v32, v32 row_shl:4 row_mask:0xf bank_mask:0x5
  v_add_f32_dpp v33, v33, v33 row_shl:4 row_mask:0xf bank_mask:0x5
  s_nop 0
  v_add_f32_dpp v32, v36, v36 row_shr:4 row_mask:0xf bank_mask:0xa
  v_add_f32_dpp v33, v37, v37 row_shr:4 row_mask:0xf bank_mask:0xa
  s_nop 0
  v_add_f32_dpp v32, v32, v32 quad_perm:[1,0,3,2] row_mask:0xf bank_mask:0xf
  v_add_f32_dpp v33, v33, v33 quad_perm:[1,0,3,2] row_mask:0xf bank_mask:0xf
  s_nop 0
  v_add_f32_dpp v32, v32, v32 quad_perm:[2,3,0,1] row_mask:0xf bank_mask:0xf
  v_add_f32_dpp v33, v33, v33 quad_perm:[2,3,0,1] row_mask:0xf bank_mask:0xf
  v_cvt_pk_bf16_f32 v34, v32, v33
  v_lshlrev_b32 v32, 16, v34
  v_and_b32 v33, s87, v34
  v_mul_f32 v32, s88, v32
  v_mul_f32 v33, s88, v33
  v_cvt_pk_bf16_f32 v34, v32, v33
  v_lshlrev_b32 v32, 16, v34
  v_and_b32 v33, s87, v34
  v_fma_f32 v32, v32, s89, -v3
  v_fma_f32 v33, v33, s89, -v3
  v_max_f32 v35, v32, v33
  v_cmp_lt_f32 vcc, 0x41000000, v35
  v_exp_f32 v37, v32
  v_exp_f32 v38, v33
  s_cmp_eq_u64 vcc, 0
  s_cbranch_scc1 K1_LZ11B
  v_max_f32_dpp v35, v35, v35 row_ror:8 row_mask:0xf bank_mask:0xf
  v_max_f32 v35, 0, v35
  v_exp_f32 v36, -v35
  v_add_f32 v3, v3, v35
  v_sub_f32 v32, v32, v35
  v_sub_f32 v33, v33, v35
  v_exp_f32 v37, v32
  v_exp_f32 v38, v33
  v_mul_f32 v4, v4, v36
  v_mul_f32_dpp v16, v36, v16 row_newbcast:0 row_mask:0xf bank_mask:0xf
  v_mul_f32_dpp v17, v36, v17 row_newbcast:0 row_mask:0xf bank_mask:0xf
  v_mul_f32_dpp v18, v36, v18 row_newbcast:0 row_mask:0xf bank_mask:0xf
  v_mul_f32_dpp v19, v36, v19 row_newbcast:0 row_mask:0xf bank_mask:0xf
  v_mul_f32_dpp v20, v36, v20 row_newbcast:0 row_mask:0xf bank_mask:0xf
  v_mul_f32_dpp v21, v36, v21 row_newbcast:0 row_mask:0xf bank_mask:0xf
  v_mul_f32_dpp v22, v36, v22 row_newbcast:0 row_mask:0xf bank_mask:0xf
  v_mul_f32_dpp v23, v36, v23 row_newbcast:0 row_mask:0xf bank_mask:0xf
  v_mul_f32_dpp v24, v36, v24 row_newbcast:4 row_mask:0xf bank_mask:0xf
  v_mul_f32_dpp v25, v36, v25 row_newbcast:4 row_mask:0xf bank_mask:0xf
  v_mul_f32_dpp v26, v36, v26 row_newbcast:4 row_mask:0xf bank_mask:0xf
  v_mul_f32_dpp v27, v36, v27 row_newbcast:4 row_mask:0xf bank_mask:0xf
  v_mul_f32_dpp v28, v36, v28 row_newbcast:4 row_mask:0xf bank_mask:0xf
  v_mul_f32_dpp v29, v36, v29 row_newbcast:4 row_mask:0xf bank_mask:0xf
  v_mul_f32_dpp v30, v36, v30 row_newbcast:4 row_mask:0xf bank_mask:0xf
  v_mul_f32_dpp v31, v36, v31 row_newbcast:4 row_mask:0xf bank_mask:0xf
K1_LZ11B:
  s_nop 1
  v_add_f32 v4, v4, v37
  v_cvt_pk_bf16_f32 v44, v37, v38
  v_add_f32 v4, v4, v38
  s_waitcnt vmcnt(20)
  v_perm_b32 v40, v244, v240, s85
  v_perm_b32 v41, v244, v240, s86
  v_perm_b32 v42, v245, v241, s85
  v_perm_b32 v43, v245, v241, s86
  v_dot2c_f32_bf16_dpp v16, v44, v40 row_newbcast:0 row_mask:0xf bank_mask:0xf
  v_dot2c_f32_bf16_dpp v17, v44, v41 row_newbcast:0 row_mask:0xf bank_mask:0xf
  v_dot2c_f32_bf16_dpp v18, v44, v42 row_newbcast:0 row_mask:0xf bank_mask:0xf
  v_dot2c_f32_bf16_dpp v19, v44, v43 row_newbcast:0 row_mask:0xf bank_mask:0xf
  v_dot2c_f32_bf16_dpp v24, v44, v40 row_newbcast:4 row_mask:0xf bank_mask:0xf
  v_dot2c_f32_bf16_dpp v25, v44, v41 row_newbcast:4 row_mask:0xf bank_mask:0xf
  v_dot2c_f32_bf16_dpp v26, v44, v42 row_newbcast:4 row_mask:0xf bank_mask:0xf
  v_dot2c_f32_bf16_dpp v27, v44, v43 row_newbcast:4 row_mask:0xf bank_mask:0xf
  v_perm_b32 v40, v246, v242, s85
  v_perm_b32 v41, v246, v242, s86
  v_perm_b32 v42, v247, v243, s85
  v_perm_b32 v43, v247, v243, s86
  v_dot2c_f32_bf16_dpp v20, v44, v40 row_newbcast:0 row_mask:0xf bank_mask:0xf
  v_dot2c_f32_bf16_dpp v21, v44, v41 row_newbcast:0 row_mask:0xf bank_mask:0xf
  v_dot2c_f32_bf16_dpp v22, v44, v42 row_newbcast:0 row_mask:0xf bank_mask:0xf
  v_dot2c_f32_bf16_dpp v23, v44, v43 row_newbcast:0 row_mask:0xf bank_mask:0xf
  v_dot2c_f32_bf16_dpp v28, v44, v40 row_newbcast:4 row_mask:0xf bank_mask:0xf
  v_dot2c_f32_bf16_dpp v29, v44, v41 row_newbcast:4 row_mask:0xf bank_mask:0xf
  v_dot2c_f32_bf16_dpp v30, v44, v42 row_newbcast:4 row_mask:0xf bank_mask:0xf
  v_dot2c_f32_bf16_dpp v31, v44, v43 row_newbcast:4 row_mask:0xf bank_mask:0xf
  v_perm_b32 v40, v252, v248, s85
  v_perm_b32 v41, v252, v248, s86
  v_perm_b32 v42, v253, v249, s85
  v_perm_b32 v43, v253, v249, s86
  v_dot2c_f32_bf16_dpp v16, v44, v40 row_newbcast:8 row_mask:0xf bank_mask:0xf
  v_dot2c_f32_bf16_dpp v17, v44, v41 row_newbcast:8 row_mask:0xf bank_mask:0xf
  v_dot2c_f32_bf16_dpp v18, v44, v42 row_newbcast:8 row_mask:0xf bank_mask:0xf
  v_dot2c_f32_bf16_dpp v19, v44, v43 row_newbcast:8 row_mask:0xf bank_mask:0xf
  v_dot2c_f32_bf16_dpp v24, v44, v40 row_newbcast:12 row_mask:0xf bank_mask:0xf
  v_dot2c_f32_bf16_dpp v25, v44, v41 row_newbcast:12 row_mask:0xf bank_mask:0xf
  v_dot2c_f32_bf16_dpp v26, v44, v42 row_newbcast:12 row_mask:0xf bank_mask:0xf
  v_dot2c_f32_bf16_dpp v27, v44, v43 row_newbcast:12 row_mask:0xf bank_mask:0xf
  v_perm_b32 v40, v254, v250, s85
  v_perm_b32 v41, v254, v250, s86
  v_perm_b32 v42, v255, v251, s85
  v_perm_b32 v43, v255, v251, s86
  v_dot2c_f32_bf16_dpp v20, v44, v40 row_newbcast:8 row_mask:0xf bank_mask:0xf
  v_dot2c_f32_bf16_dpp v21, v44, v41 row_newbcast:8 row_mask:0xf bank_mask:0xf
  v_dot2c_f32_bf16_dpp v22, v44, v42 row_newbcast:8 row_mask:0xf bank_mask:0xf
  v_dot2c_f32_bf16_dpp v23, v44, v43 row_newbcast:8 row_mask:0xf bank_mask:0xf
  v_dot2c_f32_bf16_dpp v28, v44, v40 row_newbcast:12 row_mask:0xf bank_mask:0xf
  v_dot2c_f32_bf16_dpp v29, v44, v41 row_newbcast:12 row_mask:0xf bank_mask:0xf
  v_dot2c_f32_bf16_dpp v30, v44, v42 row_newbcast:12 row_mask:0xf bank_mask:0xf
  v_dot2c_f32_bf16_dpp v31, v44, v43 row_newbcast:12 row_mask:0xf bank_mask:0xf
  s_mov_b32 s83, 425984
  buffer_load_dwordx4 v[240:243], v2, s[8:11], s83 offen offset:0 nt
  buffer_load_dwordx4 v[244:247], v2, s[8:11], s83 offen offset:1024 nt
  buffer_load_dwordx4 v[248:251], v2, s[8:11], s83 offen offset:2048 nt
  buffer_load_dwordx4 v[252:255], v2, s[8:11], s83 offen offset:3072 nt
  s_waitcnt vmcnt(22)
  v_perm_b32 v123, v132, v128, s85
  v_perm_b32 v132, v132, v128, s86
  v_perm_b32 v128, v133, v129, s85
  v_perm_b32 v133, v133, v129, s86
  v_perm_b32 v129, v134, v130, s85
  v_perm_b32 v134, v134, v130, s86
  v_perm_b32 v130, v135, v131, s85
  v_perm_b32 v135, v135, v131, s86
  s_waitcnt vmcnt(20)
  v_perm_b32 v131, v140, v136, s85
  v_perm_b32 v140, v140, v136, s86
  v_perm_b32 v136, v141, v137, s85
  v_perm_b32 v141, v141, v137, s86
  v_perm_b32 v137, v142, v138, s85
  v_perm_b32 v142, v142, v138, s86
  v_perm_b32 v138, v143, v139, s85
  v_perm_b32 v143, v143, v139, s86
  s_mov_b32 s84, 31104
  buffer_load_dwordx4 v[160:163], v46, s[16:19], s84 offen offset:1152
  s_mov_b32 s84, 31104
  buffer_load_dwordx4 v[164:167], v46, s[16:19], s84 offen offset:2304
  s_mov_b32 s84, 34560
  buffer_load_dwordx4 v[168:171], v46, s[16:19], s84 offen offset:0
  s_mov_b32 s84, 34560
  buffer_load_dwordx4 v[172:175], v46, s[16:19], s84 offen offset:1152
  s_waitcnt vmcnt(20)
  v_dot2_f32_bf16 v32, v192, v8, 0
  v_dot2_f32_bf16 v36, v192, v12, 0
  v_dot2_f32_bf16 v33, v196, v8, 0
  v_dot2_f32_bf16 v37, v196, v12, 0
  v_dot2_f32_bf16 v34, v200, v8, 0
  v_dot2_f32_bf16 v38, v200, v12, 0
  v_dot2_f32_bf16 v35, v204, v8, 0
  v_dot2_f32_bf16 v39, v204, v12, 0
  v_dot2_f32_bf16 v32, v193, v9, v32
  v_dot2_f32_bf16 v36, v193, v13, v36
  v_dot2_f32_bf16 v33, v197, v9, v33
  v_dot2_f32_bf16 v37, v197, v13, v37
  v_dot2_f32_bf16 v34, v201, v9, v34
  v_dot2_f32_bf16 v38, v201, v13, v38
  v_dot2_f32_bf16 v35, v205, v9, v35
  v_dot2_f32_bf16 v39, v205, v13, v39
  v_dot2_f32_bf16 v32, v194, v10, v32
  v_dot2_f32_bf16 v36, v194, v14, v36
  v_dot2_f32_bf16 v33, v198, v10, v33
  v_dot2_f32_bf16 v37, v198, v14, v37
  v_dot2_f32_bf16 v34, v202, v10, v34
  v_dot2_f32_bf16 v38, v202, v14, v38
  v_dot2_f32_bf16 v35, v206, v10, v35
  v_dot2_f32_bf16 v39, v206, v14, v39
  v_dot2_f32_bf16 v32, v195, v11, v32
  v_dot2_f32_bf16 v36, v195, v15, v36
  v_dot2_f32_bf16 v33, v199, v11, v33
  v_dot2_f32_bf16 v37, v199, v15, v37
  v_dot2_f32_bf16 v34, v203, v11, v34
  v_dot2_f32_bf16 v38, v203, v15, v38
  v_dot2_f32_bf16 v35, v207, v11, v35
  v_dot2_f32_bf16 v39, v207, v15, v39
  s_mov_b32 s83, 458752
  buffer_load_dwordx4 v[192:195], v2, s[4:7], s83 offen offset:0 nt
  buffer_load_dwordx4 v[196:199], v2, s[4:7], s83 offen offset:1024 nt
  buffer_load_dwordx4 v[200:203], v2, s[4:7], s83 offen offset:2048 nt
  buffer_load_dwordx4 v[204:207], v2, s[4:7], s83 offen offset:3072 nt
  v_add_f32_dpp v32, v32, v32 row_ror:8 row_mask:0xf bank_mask:0x3
  v_add_f32_dpp v33, v33, v33 row_ror:8 row_mask:0xf bank_mask:0x3
  v_add_f32_dpp v36, v36, v36 row_ror:8 row_mask:0xf bank_mask:0x3
  v_add_f32_dpp v37, v37, v37 row_ror:8 row_mask:0xf bank_mask:0x3
  v_add_f32_dpp v32, v34, v34 row_ror:8 row_mask:0xf bank_mask:0xc
  v_add_f32_dpp v33, v35, v35 row_ror:8 row_mask:0xf bank_mask:0xc
  v_add_f32_dpp v36, v38, v38 row_ror:8 row_mask:0xf bank_mask:0xc
  v_add_f32_dpp v37, v39, v39 row_ror:8 row_mask:0xf bank_mask:0xc
  v_add_f32_dpp v32, v32, v32 row_shl:4 row_mask:0xf bank_mask:0x5
  v_add_f32_dpp v33, v33, v33 row_shl:4 row_mask:0xf bank_mask:0x5
  s_nop 0
  v_add_f32_dpp v32, v36, v36 row_shr:4 row_mask:0xf bank_mask:0xa
  v_add_f32_dpp v33, v37, v37 row_shr:4 row_mask:0xf bank_mask:0xa
  s_nop 0
  v_add_f32_dpp v32, v32, v32 quad_perm:[1,0,3,2] row_mask:0xf bank_mask:0xf
  v_add_f32_dpp v33, v33, v33 quad_perm:[1,0,3,2] row_mask:0xf bank_mask:0xf
  s_nop 0
  v_add_f32_dpp v32, v32, v32 quad_perm:[2,3,0,1] row_mask:0xf bank_mask:0xf
  v_add_f32_dpp v33, v33, v33 quad_perm:[2,3,0,1] row_mask:0xf bank_mask:0xf
  v_cvt_pk_bf16_f32 v34, v32, v33
  v_lshlrev_b32 v32, 16, v34
  v_and_b32 v33, s87, v34
  v_mul_f32 v32, s88, v32
  v_mul_f32 v33, s88, v33
  v_cvt_pk_bf16_f32 v34, v32, v33
  v_lshlrev_b32 v32, 16, v34
  v_and_b32 v33, s87, v34
  v_fma_f32 v32, v32, s89, -v3
  v_fma_f32 v33, v33, s89, -v3
  v_max_f32 v35, v32, v33
  v_cmp_lt_f32 vcc, 0x41000000, v35
  v_exp_f32 v37, v32
  v_exp_f32 v38, v33
  s_cmp_eq_u64 vcc, 0
  s_cbranch_scc1 K1_LZ12B
  v_max_f32_dpp v35, v35, v35 row_ror:8 row_mask:0xf bank_mask:0xf
  v_max_f32 v35, 0, v35
  v_exp_f32 v36, -v35
  v_add_f32 v3, v3, v35
  v_sub_f32 v32, v32, v35
  v_sub_f32 v33, v33, v35
  v_exp_f32 v37, v32
  v_exp_f32 v38, v33
  v_mul_f32 v4, v4, v36
  v_mul_f32_dpp v16, v36, v16 row_newbcast:0 row_mask:0xf bank_mask:0xf
  v_mul_f32_dpp v17, v36, v17 row_newbcast:0 row_mask:0xf bank_mask:0xf
  v_mul_f32_dpp v18, v36, v18 row_newbcast:0 row_mask:0xf bank_mask:0xf
  v_mul_f32_dpp v19, v36, v19 row_newbcast:0 row_mask:0xf bank_mask:0xf
  v_mul_f32_dpp v20, v36, v20 row_newbcast:0 row_mask:0xf bank_mask:0xf
  v_mul_f32_dpp v21, v36, v21 row_newbcast:0 row_mask:0xf bank_mask:0xf
  v_mul_f32_dpp v22, v36, v22 row_newbcast:0 row_mask:0xf bank_mask:0xf
  v_mul_f32_dpp v23, v36, v23 row_newbcast:0 row_mask:0xf bank_mask:0xf
  v_mul_f32_dpp v24, v36, v24 row_newbcast:4 row_mask:0xf bank_mask:0xf
  v_mul_f32_dpp v25, v36, v25 row_newbcast:4 row_mask:0xf bank_mask:0xf
  v_mul_f32_dpp v26, v36, v26 row_newbcast:4 row_mask:0xf bank_mask:0xf
  v_mul_f32_dpp v27, v36, v27 row_newbcast:4 row_mask:0xf bank_mask:0xf
  v_mul_f32_dpp v28, v36, v28 row_newbcast:4 row_mask:0xf bank_mask:0xf
  v_mul_f32_dpp v29, v36, v29 row_newbcast:4 row_mask:0xf bank_mask:0xf
  v_mul_f32_dpp v30, v36, v30 row_newbcast:4 row_mask:0xf bank_mask:0xf
  v_mul_f32_dpp v31, v36, v31 row_newbcast:4 row_mask:0xf bank_mask:0xf
K1_LZ12B:
  s_nop 1
  v_add_f32 v4, v4, v37
  v_cvt_pk_bf16_f32 v44, v37, v38
  v_add_f32 v4, v4, v38
  s_waitcnt vmcnt(20)
  v_perm_b32 v40, v212, v208, s85
  v_perm_b32 v41, v212, v208, s86
  v_perm_b32 v42, v213, v209, s85
  v_perm_b32 v43, v213, v209, s86
  v_dot2c_f32_bf16_dpp v16, v44, v40 row_newbcast:0 row_mask:0xf bank_mask:0xf
  v_dot2c_f32_bf16_dpp v17, v44, v41 row_newbcast:0 row_mask:0xf bank_mask:0xf
  v_dot2c_f32_bf16_dpp v18, v44, v42 row_newbcast:0 row_mask:0xf bank_mask:0xf
  v_dot2c_f32_bf16_dpp v19, v44, v43 row_newbcast:0 row_mask:0xf bank_mask:0xf
  v_dot2c_f32_bf16_dpp v24, v44, v40 row_newbcast:4 row_mask:0xf bank_mask:0xf
  v_dot2c_f32_bf16_dpp v25, v44, v41 row_newbcast:4 row_mask:0xf bank_mask:0xf
  v_dot2c_f32_bf16_dpp v26, v44, v42 row_newbcast:4 row_mask:0xf bank_mask:0xf
  v_dot2c_f32_bf16_dpp v27, v44, v43 row_newbcast:4 row_mask:0xf bank_mask:0xf
  v_perm_b32 v40, v214, v210, s85
  v_perm_b32 v41, v214, v210, s86
  v_perm_b32 v42, v215, v211, s85
  v_perm_b32 v43, v215, v211, s86
  v_dot2c_f32_bf16_dpp v20, v44, v40 row_newbcast:0 row_mask:0xf bank_mask:0xf
  v_dot2c_f32_bf16_dpp v21, v44, v41 row_newbcast:0 row_mask:0xf bank_mask:0xf
  v_dot2c_f32_bf16_dpp v22, v44, v42 row_newbcast:0 row_mask:0xf bank_mask:0xf
  v_dot2c_f32_bf16_dpp v23, v44, v43 row_newbcast:0 row_mask:0xf bank_mask:0xf
  v_dot2c_f32_bf16_dpp v28, v44, v40 row_newbcast:4 row_mask:0xf bank_mask:0xf
  v_dot2c_f32_bf16_dpp v29, v44, v41 row_newbcast:4 row_mask:0xf bank_mask:0xf
  v_dot2c_f32_bf16_dpp v30, v44, v42 row_newbcast:4 row_mask:0xf bank_mask:0xf
  v_dot2c_f32_bf16_dpp v31, v44, v43 row_newbcast:4 row_mask:0xf bank_mask:0xf
  v_perm_b32 v40, v220, v216, s85
  v_perm_b32 v41, v220, v216, s86
  v_perm_b32 v42, v221, v217, s85
  v_perm_b32 v43, v221, v217, s86
  v_dot2c_f32_bf16_dpp v16, v44, v40 row_newbcast:8 row_mask:0xf bank_mask:0xf
  v_dot2c_f32_bf16_dpp v17, v44, v41 row_newbcast:8 row_mask:0xf bank_mask:0xf
  v_dot2c_f32_bf16_dpp v18, v44, v42 row_newbcast:8 row_mask:0xf bank_mask:0xf
  v_dot2c_f32_bf16_dpp v19, v44, v43 row_newbcast:8 row_mask:0xf bank_mask:0xf
  v_dot2c_f32_bf16_dpp v24, v44, v40 row_newbcast:12 row_mask:0xf bank_mask:0xf
  v_dot2c_f32_bf16_dpp v25, v44, v41 row_newbcast:12 row_mask:0xf bank_mask:0xf
  v_dot2c_f32_bf16_dpp v26, v44, v42 row_newbcast:12 row_mask:0xf bank_mask:0xf
  v_dot2c_f32_bf16_dpp v27, v44, v43 row_newbcast:12 row_mask:0xf bank_mask:0xf
  v_perm_b32 v40, v222, v218, s85
  v_perm_b32 v41, v222, v218, s86
  v_perm_b32 v42, v223, v219, s85
  v_perm_b32 v43, v223, v219, s86
  v_dot2c_f32_bf16_dpp v20, v44, v40 row_newbcast:8 row_mask:0xf bank_mask:0xf
  v_dot2c_f32_bf16_dpp v21, v44, v41 row_newbcast:8 row_mask:0xf bank_mask:0xf
  v_dot2c_f32_bf16_dpp v22, v44, v42 row_newbcast:8 row_mask:0xf bank_mask:0xf
  v_dot2c_f32_bf16_dpp v23, v44, v43 row_newbcast:8 row_mask:0xf bank_mask:0xf
  v_dot2c_f32_bf16_dpp v28, v44, v40 row_newbcast:12 row_mask:0xf bank_mask:0xf
  v_dot2c_f32_bf16_dpp v29, v44, v41 row_newbcast:12 row_mask:0xf bank_mask:0xf
  v_dot2c_f32_bf16_dpp v30, v44, v42 row_newbcast:12 row_mask:0xf bank_mask:0xf
  v_dot2c_f32_bf16_dpp v31, v44, v43 row_newbcast:12 row_mask:0xf bank_mask:0xf
  s_mov_b32 s83, 458752
  buffer_load_dwordx4 v[208:211], v2, s[8:11], s83 offen offset:0 nt
  buffer_load_dwordx4 v[212:215], v2, s[8:11], s83 offen offset:1024 nt
  buffer_load_dwordx4 v[216:219], v2, s[8:11], s83 offen offset:2048 nt
  buffer_load_dwordx4 v[220:223], v2, s[8:11], s83 offen offset:3072 nt
  s_waitcnt vmcnt(22)
  v_perm_b32 v139, v148, v144, s85
  v_perm_b32 v148, v148, v144, s86
  v_perm_b32 v144, v149, v145, s85
  v_perm_b32 v149, v149, v145, s86
  v_perm_b32 v145, v150, v146, s85
  v_perm_b32 v150, v150, v146, s86
  v_perm_b32 v146, v151, v147, s85
  v_perm_b32 v151, v151, v147, s86
  s_waitcnt vmcnt(20)
  v_perm_b32 v147, v156, v152, s85
  v_perm_b32 v156, v156, v152, s86
  v_perm_b32 v152, v157, v153, s85
  v_perm_b32 v157, v157, v153, s86
  v_perm_b32 v153, v158, v154, s85
  v_perm_b32 v158, v158, v154, s86
  v_perm_b32 v154, v159, v155, s85
  v_perm_b32 v159, v159, v155, s86
  buffer_load_dwordx4 v[176:179], v47, s[16:19], 0 offen offset:0
  buffer_load_dwordx4 v[180:183], v47, s[16:19], 0 offen offset:1152
  buffer_load_dwordx4 v[184:187], v47, s[16:19], 0 offen offset:2304
  buffer_load_dwordx4 v[188:191], v47, s[16:19], 0 offen offset:3456
  s_waitcnt vmcnt(20)
  v_dot2_f32_bf16 v32, v224, v8, 0
  v_dot2_f32_bf16 v36, v224, v12, 0
  v_dot2_f32_bf16 v33, v228, v8, 0
  v_dot2_f32_bf16 v37, v228, v12, 0
  v_dot2_f32_bf16 v34, v232, v8, 0
  v_dot2_f32_bf16 v38, v232, v12, 0
  v_dot2_f32_bf16 v35, v236, v8, 0
  v_dot2_f32_bf16 v39, v236, v12, 0
  v_dot2_f32_bf16 v32, v225, v9, v32
  v_dot2_f32_bf16 v36, v225, v13, v36
  v_dot2_f32_bf16 v33, v229, v9, v33
  v_dot2_f32_bf16 v37, v229, v13, v37
  v_dot2_f32_bf16 v34, v233, v9, v34
  v_dot2_f32_bf16 v38, v233, v13, v38
  v_dot2_f32_bf16 v35, v237, v9, v35
  v_dot2_f32_bf16 v39, v237, v13, v39
  v_dot2_f32_bf16 v32, v226, v10, v32
  v_dot2_f32_bf16 v36, v226, v14, v36
  v_dot2_f32_bf16 v33, v230, v10, v33
  v_dot2_f32_bf16 v37, v230, v14, v37
  v_dot2_f32_bf16 v34, v234, v10, v34
  v_dot2_f32_bf16 v38, v234, v14, v38
  v_dot2_f32_bf16 v35, v238, v10, v35
  v_dot2_f32_bf16 v39, v238, v14, v39
  v_dot2_f32_bf16 v32, v227, v11, v32
  v_dot2_f32_bf16 v36, v227, v15, v36
  v_dot2_f32_bf16 v33, v231, v11, v33
  v_dot2_f32_bf16 v37, v231, v15, v37
  v_dot2_f32_bf16 v34, v235, v11, v34
  v_dot2_f32_bf16 v38, v235, v15, v38
  v_dot2_f32_bf16 v35, v239, v11, v35
  v_dot2_f32_bf16 v39, v239, v15, v39
  s_mov_b32 s83, 491520
  buffer_load_dwordx4 v[224:227], v2, s[4:7], s83 offen offset:0 nt
  buffer_load_dwordx4 v[228:231], v2, s[4:7], s83 offen offset:1024 nt
  buffer_load_dwordx4 v[232:235], v2, s[4:7], s83 offen offset:2048 nt
  buffer_load_dwordx4 v[236:239], v2, s[4:7], s83 offen offset:3072 nt
  v_add_f32_dpp v32, v32, v32 row_ror:8 row_mask:0xf bank_mask:0x3
  v_add_f32_dpp v33, v33, v33 row_ror:8 row_mask:0xf bank_mask:0x3
  v_add_f32_dpp v36, v36, v36 row_ror:8 row_mask:0xf bank_mask:0x3
  v_add_f32_dpp v37, v37, v37 row_ror:8 row_mask:0xf bank_mask:0x3
  v_add_f32_dpp v32, v34, v34 row_ror:8 row_mask:0xf bank_mask:0xc
  v_add_f32_dpp v33, v35, v35 row_ror:8 row_mask:0xf bank_mask:0xc
  v_add_f32_dpp v36, v38, v38 row_ror:8 row_mask:0xf bank_mask:0xc
  v_add_f32_dpp v37, v39, v39 row_ror:8 row_mask:0xf bank_mask:0xc
  v_add_f32_dpp v32, v32, v32 row_shl:4 row_mask:0xf bank_mask:0x5
  v_add_f32_dpp v33, v33, v33 row_shl:4 row_mask:0xf bank_mask:0x5
  s_nop 0
  v_add_f32_dpp v32, v36, v36 row_shr:4 row_mask:0xf bank_mask:0xa
  v_add_f32_dpp v33, v37, v37 row_shr:4 row_mask:0xf bank_mask:0xa
  s_nop 0
  v_add_f32_dpp v32, v32, v32 quad_perm:[1,0,3,2] row_mask:0xf bank_mask:0xf
  v_add_f32_dpp v33, v33, v33 quad_perm:[1,0,3,2] row_mask:0xf bank_mask:0xf
  s_nop 0
  v_add_f32_dpp v32, v32, v32 quad_perm:[2,3,0,1] row_mask:0xf bank_mask:0xf
  v_add_f32_dpp v33, v33, v33 quad_perm:[2,3,0,1] row_mask:0xf bank_mask:0xf
  v_cvt_pk_bf16_f32 v34, v32, v33
  v_lshlrev_b32 v32, 16, v34
  v_and_b32 v33, s87, v34
  v_mul_f32 v32, s88, v32
  v_mul_f32 v33, s88, v33
  v_cvt_pk_bf16_f32 v34, v32, v33
  v_lshlrev_b32 v32, 16, v34
  v_and_b32 v33, s87, v34
  v_fma_f32 v32, v32, s89, -v3
  v_fma_f32 v33, v33, s89, -v3
  v_max_f32 v35, v32, v33
  v_cmp_lt_f32 vcc, 0x41000000, v35
  v_exp_f32 v37, v32
  v_exp_f32 v38, v33
  s_cmp_eq_u64 vcc, 0
  s_cbranch_scc1 K1_LZ13B
  v_max_f32_dpp v35, v35, v35 row_ror:8 row_mask:0xf bank_mask:0xf
  v_max_f32 v35, 0, v35
  v_exp_f32 v36, -v35
  v_add_f32 v3, v3, v35
  v_sub_f32 v32, v32, v35
  v_sub_f32 v33, v33, v35
  v_exp_f32 v37, v32
  v_exp_f32 v38, v33
  v_mul_f32 v4, v4, v36
  v_mul_f32_dpp v16, v36, v16 row_newbcast:0 row_mask:0xf bank_mask:0xf
  v_mul_f32_dpp v17, v36, v17 row_newbcast:0 row_mask:0xf bank_mask:0xf
  v_mul_f32_dpp v18, v36, v18 row_newbcast:0 row_mask:0xf bank_mask:0xf
  v_mul_f32_dpp v19, v36, v19 row_newbcast:0 row_mask:0xf bank_mask:0xf
  v_mul_f32_dpp v20, v36, v20 row_newbcast:0 row_mask:0xf bank_mask:0xf
  v_mul_f32_dpp v21, v36, v21 row_newbcast:0 row_mask:0xf bank_mask:0xf
  v_mul_f32_dpp v22, v36, v22 row_newbcast:0 row_mask:0xf bank_mask:0xf
  v_mul_f32_dpp v23, v36, v23 row_newbcast:0 row_mask:0xf bank_mask:0xf
  v_mul_f32_dpp v24, v36, v24 row_newbcast:4 row_mask:0xf bank_mask:0xf
  v_mul_f32_dpp v25, v36, v25 row_newbcast:4 row_mask:0xf bank_mask:0xf
  v_mul_f32_dpp v26, v36, v26 row_newbcast:4 row_mask:0xf bank_mask:0xf
  v_mul_f32_dpp v27, v36, v27 row_newbcast:4 row_mask:0xf bank_mask:0xf
  v_mul_f32_dpp v28, v36, v28 row_newbcast:4 row_mask:0xf bank_mask:0xf
  v_mul_f32_dpp v29, v36, v29 row_newbcast:4 row_mask:0xf bank_mask:0xf
  v_mul_f32_dpp v30, v36, v30 row_newbcast:4 row_mask:0xf bank_mask:0xf
  v_mul_f32_dpp v31, v36, v31 row_newbcast:4 row_mask:0xf bank_mask:0xf
K1_LZ13B:
  s_nop 1
  v_add_f32 v4, v4, v37
  v_cvt_pk_bf16_f32 v44, v37, v38
  v_add_f32 v4, v4, v38
  s_waitcnt vmcnt(20)
  v_perm_b32 v40, v244, v240, s85
  v_perm_b32 v41, v244, v240, s86
  v_perm_b32 v42, v245, v241, s85
  v_perm_b32 v43, v245, v241, s86
  v_dot2c_f32_bf16_dpp v16, v44, v40 row_newbcast:0 row_mask:0xf bank_mask:0xf
  v_dot2c_f32_bf16_dpp v17, v44, v41 row_newbcast:0 row_mask:0xf bank_mask:0xf
  v_dot2c_f32_bf16_dpp v18, v44, v42 row_newbcast:0 row_mask:0xf bank_mask:0xf
  v_dot2c_f32_bf16_dpp v19, v44, v43 row_newbcast:0 row_mask:0xf bank_mask:0xf
  v_dot2c_f32_bf16_dpp v24, v44, v40 row_newbcast:4 row_mask:0xf bank_mask:0xf
  v_dot2c_f32_bf16_dpp v25, v44, v41 row_newbcast:4 row_mask:0xf bank_mask:0xf
  v_dot2c_f32_bf16_dpp v26, v44, v42 row_newbcast:4 row_mask:0xf bank_mask:0xf
  v_dot2c_f32_bf16_dpp v27, v44, v43 row_newbcast:4 row_mask:0xf bank_mask:0xf
  v_perm_b32 v40, v246, v242, s85
  v_perm_b32 v41, v246, v242, s86
  v_perm_b32 v42, v247, v243, s85
  v_perm_b32 v43, v247, v243, s86
  v_dot2c_f32_bf16_dpp v20, v44, v40 row_newbcast:0 row_mask:0xf bank_mask:0xf
  v_dot2c_f32_bf16_dpp v21, v44, v41 row_newbcast:0 row_mask:0xf bank_mask:0xf
  v_dot2c_f32_bf16_dpp v22, v44, v42 row_newbcast:0 row_mask:0xf bank_mask:0xf
  v_dot2c_f32_bf16_dpp v23, v44, v43 row_newbcast:0 row_mask:0xf bank_mask:0xf
  v_dot2c_f32_bf16_dpp v28, v44, v40 row_newbcast:4 row_mask:0xf bank_mask:0xf
  v_dot2c_f32_bf16_dpp v29, v44, v41 row_newbcast:4 row_mask:0xf bank_mask:0xf
  v_dot2c_f32_bf16_dpp v30, v44, v42 row_newbcast:4 row_mask:0xf bank_mask:0xf
  v_dot2c_f32_bf16_dpp v31, v44, v43 row_newbcast:4 row_mask:0xf bank_mask:0xf
  v_perm_b32 v40, v252, v248, s85
  v_perm_b32 v41, v252, v248, s86
  v_perm_b32 v42, v253, v249, s85
  v_perm_b32 v43, v253, v249, s86
  v_dot2c_f32_bf16_dpp v16, v44, v40 row_newbcast:8 row_mask:0xf bank_mask:0xf
  v_dot2c_f32_bf16_dpp v17, v44, v41 row_newbcast:8 row_mask:0xf bank_mask:0xf
  v_dot2c_f32_bf16_dpp v18, v44, v42 row_newbcast:8 row_mask:0xf bank_mask:0xf
  v_dot2c_f32_bf16_dpp v19, v44, v43 row_newbcast:8 row_mask:0xf bank_mask:0xf
  v_dot2c_f32_bf16_dpp v24, v44, v40 row_newbcast:12 row_mask:0xf bank_mask:0xf
  v_dot2c_f32_bf16_dpp v25, v44, v41 row_newbcast:12 row_mask:0xf bank_mask:0xf
  v_dot2c_f32_bf16_dpp v26, v44, v42 row_newbcast:12 row_mask:0xf bank_mask:0xf
  v_dot2c_f32_bf16_dpp v27, v44, v43 row_newbcast:12 row_mask:0xf bank_mask:0xf
  v_perm_b32 v40, v254, v250, s85
  v_perm_b32 v41, v254, v250, s86
  v_perm_b32 v42, v255, v251, s85
  v_perm_b32 v43, v255, v251, s86
  v_dot2c_f32_bf16_dpp v20, v44, v40 row_newbcast:8 row_mask:0xf bank_mask:0xf
  v_dot2c_f32_bf16_dpp v21, v44, v41 row_newbcast:8 row_mask:0xf bank_mask:0xf
  v_dot2c_f32_bf16_dpp v22, v44, v42 row_newbcast:8 row_mask:0xf bank_mask:0xf
  v_dot2c_f32_bf16_dpp v23, v44, v43 row_newbcast:8 row_mask:0xf bank_mask:0xf
  v_dot2c_f32_bf16_dpp v28, v44, v40 row_newbcast:12 row_mask:0xf bank_mask:0xf
  v_dot2c_f32_bf16_dpp v29, v44, v41 row_newbcast:12 row_mask:0xf bank_mask:0xf
  v_dot2c_f32_bf16_dpp v30, v44, v42 row_newbcast:12 row_mask:0xf bank_mask:0xf
  v_dot2c_f32_bf16_dpp v31, v44, v43 row_newbcast:12 row_mask:0xf bank_mask:0xf
  s_mov_b32 s83, 491520
  buffer_load_dwordx4 v[240:243], v2, s[8:11], s83 offen offset:0 nt
  buffer_load_dwordx4 v[244:247], v2, s[8:11], s83 offen offset:1024 nt
  buffer_load_dwordx4 v[248:251], v2, s[8:11], s83 offen offset:2048 nt
  buffer_load_dwordx4 v[252:255], v2, s[8:11], s83 offen offset:3072 nt
  s_waitcnt vmcnt(22)
  v_perm_b32 v155, v164, v160, s85
  v_perm_b32 v164, v164, v160, s86
  v_perm_b32 v160, v165, v161, s85
  v_perm_b32 v165, v165, v161, s86
  v_perm_b32 v161, v166, v162, s85
  v_perm_b32 v166, v166, v162, s86
  v_perm_b32 v162, v167, v163, s85
  v_perm_b32 v167, v167, v163, s86
  s_waitcnt vmcnt(20)
  v_perm_b32 v163, v172, v168, s85
  v_perm_b32 v172, v172, v168, s86
  v_perm_b32 v168, v173, v169, s85
  v_perm_b32 v173, v173, v169, s86
  v_perm_b32 v169, v174, v170, s85
  v_perm_b32 v174, v174, v170, s86
  v_perm_b32 v170, v175, v171, s85
  v_perm_b32 v175, v175, v171, s86
  s_waitcnt vmcnt(16)
  v_dot2_f32_bf16 v32, v192, v8, 0
  v_dot2_f32_bf16 v36, v192, v12, 0
  v_dot2_f32_bf16 v33, v196, v8, 0
  v_dot2_f32_bf16 v37, v196, v12, 0
  v_dot2_f32_bf16 v34, v200, v8, 0
  v_dot2_f32_bf16 v38, v200, v12, 0
  v_dot2_f32_bf16 v35, v204, v8, 0
  v_dot2_f32_bf16 v39, v204, v12, 0
  v_dot2_f32_bf16 v32, v193, v9, v32
  v_dot2_f32_bf16 v36, v193, v13, v36
  v_dot2_f32_bf16 v33, v197, v9, v33
  v_dot2_f32_bf16 v37, v197, v13, v37
  v_dot2_f32_bf16 v34, v201, v9, v34
  v_dot2_f32_bf16 v38, v201, v13, v38
  v_dot2_f32_bf16 v35, v205, v9, v35
  v_dot2_f32_bf16 v39, v205, v13, v39
  v_dot2_f32_bf16 v32, v194, v10, v32
  v_dot2_f32_bf16 v36, v194, v14, v36
  v_dot2_f32_bf16 v33, v198, v10, v33
  v_dot2_f32_bf16 v37, v198, v14, v37
  v_dot2_f32_bf16 v34, v202, v10, v34
  v_dot2_f32_bf16 v38, v202, v14, v38
  v_dot2_f32_bf16 v35, v206, v10, v35
  v_dot2_f32_bf16 v39, v206, v14, v39
  v_dot2_f32_bf16 v32, v195, v11, v32
  v_dot2_f32_bf16 v36, v195, v15, v36
  v_dot2_f32_bf16 v33, v199, v11, v33
  v_dot2_f32_bf16 v37, v199, v15, v37
  v_dot2_f32_bf16 v34, v203, v11, v34
  v_dot2_f32_bf16 v38, v203, v15, v38
  v_dot2_f32_bf16 v35, v207, v11, v35
  v_dot2_f32_bf16 v39, v207, v15, v39
  v_add_f32_dpp v32, v32, v32 row_ror:8 row_mask:0xf bank_mask:0x3
  v_add_f32_dpp v33, v33, v33 row_ror:8 row_mask:0xf bank_mask:0x3
  v_add_f32_dpp v36, v36, v36 row_ror:8 row_mask:0xf bank_mask:0x3
  v_add_f32_dpp v37, v37, v37 row_ror:8 row_mask:0xf bank_mask:0x3
  v_add_f32_dpp v32, v34, v34 row_ror:8 row_mask:0xf bank_mask:0xc
  v_add_f32_dpp v33, v35, v35 row_ror:8 row_mask:0xf bank_mask:0xc
  v_add_f32_dpp v36, v38, v38 row_ror:8 row_mask:0xf bank_mask:0xc
  v_add_f32_dpp v37, v39, v39 row_ror:8 row_mask:0xf bank_mask:0xc
  v_add_f32_dpp v32, v32, v32 row_shl:4 row_mask:0xf bank_mask:0x5
  v_add_f32_dpp v33, v33, v33 row_shl:4 row_mask:0xf bank_mask:0x5
  s_nop 0
  v_add_f32_dpp v32, v36, v36 row_shr:4 row_mask:0xf bank_mask:0xa
  v_add_f32_dpp v33, v37, v37 row_shr:4 row_mask:0xf bank_mask:0xa
  s_nop 0
  v_add_f32_dpp v32, v32, v32 quad_perm:[1,0,3,2] row_mask:0xf bank_mask:0xf
  v_add_f32_dpp v33, v33, v33 quad_perm:[1,0,3,2] row_mask:0xf bank_mask:0xf
  s_nop 0
  v_add_f32_dpp v32, v32, v32 quad_perm:[2,3,0,1] row_mask:0xf bank_mask:0xf
  v_add_f32_dpp v33, v33, v33 quad_perm:[2,3,0,1] row_mask:0xf bank_mask:0xf
  v_cvt_pk_bf16_f32 v34, v32, v33
  v_lshlrev_b32 v32, 16, v34
  v_and_b32 v33, s87, v34
  v_mul_f32 v32, s88, v32
  v_mul_f32 v33, s88, v33
  v_cvt_pk_bf16_f32 v34, v32, v33
  v_lshlrev_b32 v32, 16, v34
  v_and_b32 v33, s87, v34
  v_fma_f32 v32, v32, s89, -v3
  v_fma_f32 v33, v33, s89, -v3
  v_max_f32 v35, v32, v33
  v_cmp_lt_f32 vcc, 0x41000000, v35
  v_exp_f32 v37, v32
  v_exp_f32 v38, v33
  s_cmp_eq_u64 vcc, 0
  s_cbranch_scc1 K1_LZ14B
  v_max_f32_dpp v35, v35, v35 row_ror:8 row_mask:0xf bank_mask:0xf
  v_max_f32 v35, 0, v35
  v_exp_f32 v36, -v35
  v_add_f32 v3, v3, v35
  v_sub_f32 v32, v32, v35
  v_sub_f32 v33, v33, v35
  v_exp_f32 v37, v32
  v_exp_f32 v38, v33
  v_mul_f32 v4, v4, v36
  v_mul_f32_dpp v16, v36, v16 row_newbcast:0 row_mask:0xf bank_mask:0xf
  v_mul_f32_dpp v17, v36, v17 row_newbcast:0 row_mask:0xf bank_mask:0xf
  v_mul_f32_dpp v18, v36, v18 row_newbcast:0 row_mask:0xf bank_mask:0xf
  v_mul_f32_dpp v19, v36, v19 row_newbcast:0 row_mask:0xf bank_mask:0xf
  v_mul_f32_dpp v20, v36, v20 row_newbcast:0 row_mask:0xf bank_mask:0xf
  v_mul_f32_dpp v21, v36, v21 row_newbcast:0 row_mask:0xf bank_mask:0xf
  v_mul_f32_dpp v22, v36, v22 row_newbcast:0 row_mask:0xf bank_mask:0xf
  v_mul_f32_dpp v23, v36, v23 row_newbcast:0 row_mask:0xf bank_mask:0xf
  v_mul_f32_dpp v24, v36, v24 row_newbcast:4 row_mask:0xf bank_mask:0xf
  v_mul_f32_dpp v25, v36, v25 row_newbcast:4 row_mask:0xf bank_mask:0xf
  v_mul_f32_dpp v26, v36, v26 row_newbcast:4 row_mask:0xf bank_mask:0xf
  v_mul_f32_dpp v27, v36, v27 row_newbcast:4 row_mask:0xf bank_mask:0xf
  v_mul_f32_dpp v28, v36, v28 row_newbcast:4 row_mask:0xf bank_mask:0xf
  v_mul_f32_dpp v29, v36, v29 row_newbcast:4 row_mask:0xf bank_mask:0xf
  v_mul_f32_dpp v30, v36, v30 row_newbcast:4 row_mask:0xf bank_mask:0xf
  v_mul_f32_dpp v31, v36, v31 row_newbcast:4 row_mask:0xf bank_mask:0xf
K1_LZ14B:
  s_nop 1
  v_add_f32 v4, v4, v37
  v_cvt_pk_bf16_f32 v44, v37, v38
  v_add_f32 v4, v4, v38
  s_waitcnt vmcnt(12)
  v_perm_b32 v40, v212, v208, s85
  v_perm_b32 v41, v212, v208, s86
  v_perm_b32 v42, v213, v209, s85
  v_perm_b32 v43, v213, v209, s86
  v_dot2c_f32_bf16_dpp v16, v44, v40 row_newbcast:0 row_mask:0xf bank_mask:0xf
  v_dot2c_f32_bf16_dpp v17, v44, v41 row_newbcast:0 row_mask:0xf bank_mask:0xf
  v_dot2c_f32_bf16_dpp v18, v44, v42 row_newbcast:0 row_mask:0xf bank_mask:0xf
  v_dot2c_f32_bf16_dpp v19, v44, v43 row_newbcast:0 row_mask:0xf bank_mask:0xf
  v_dot2c_f32_bf16_dpp v24, v44, v40 row_newbcast:4 row_mask:0xf bank_mask:0xf
  v_dot2c_f32_bf16_dpp v25, v44, v41 row_newbcast:4 row_mask:0xf bank_mask:0xf
  v_dot2c_f32_bf16_dpp v26, v44, v42 row_newbcast:4 row_mask:0xf bank_mask:0xf
  v_dot2c_f32_bf16_dpp v27, v44, v43 row_newbcast:4 row_mask:0xf bank_mask:0xf
  v_perm_b32 v40, v214, v210, s85
  v_perm_b32 v41, v214, v210, s86
  v_perm_b32 v42, v215, v211, s85
  v_perm_b32 v43, v215, v211, s86
  v_dot2c_f32_bf16_dpp v20, v44, v40 row_newbcast:0 row_mask:0xf bank_mask:0xf
  v_dot2c_f32_bf16_dpp v21, v44, v41 row_newbcast:0 row_mask:0xf bank_mask:0xf
  v_dot2c_f32_bf16_dpp v22, v44, v42 row_newbcast:0 row_mask:0xf bank_mask:0xf
  v_dot2c_f32_bf16_dpp v23, v44, v43 row_newbcast:0 row_mask:0xf bank_mask:0xf
  v_dot2c_f32_bf16_dpp v28, v44, v40 row_newbcast:4 row_mask:0xf bank_mask:0xf
  v_dot2c_f32_bf16_dpp v29, v44, v41 row_newbcast:4 row_mask:0xf bank_mask:0xf
  v_dot2c_f32_bf16_dpp v30, v44, v42 row_newbcast:4 row_mask:0xf bank_mask:0xf
  v_dot2c_f32_bf16_dpp v31, v44, v43 row_newbcast:4 row_mask:0xf bank_mask:0xf
  v_perm_b32 v40, v220, v216, s85
  v_perm_b32 v41, v220, v216, s86
  v_perm_b32 v42, v221, v217, s85
  v_perm_b32 v43, v221, v217, s86
  v_dot2c_f32_bf16_dpp v16, v44, v40 row_newbcast:8 row_mask:0xf bank_mask:0xf
  v_dot2c_f32_bf16_dpp v17, v44, v41 row_newbcast:8 row_mask:0xf bank_mask:0xf
  v_dot2c_f32_bf16_dpp v18, v44, v42 row_newbcast:8 row_mask:0xf bank_mask:0xf
  v_dot2c_f32_bf16_dpp v19, v44, v43 row_newbcast:8 row_mask:0xf bank_mask:0xf
  v_dot2c_f32_bf16_dpp v24, v44, v40 row_newbcast:12 row_mask:0xf bank_mask:0xf
  v_dot2c_f32_bf16_dpp v25, v44, v41 row_newbcast:12 row_mask:0xf bank_mask:0xf
  v_dot2c_f32_bf16_dpp v26, v44, v42 row_newbcast:12 row_mask:0xf bank_mask:0xf
  v_dot2c_f32_bf16_dpp v27, v44, v43 row_newbcast:12 row_mask:0xf bank_mask:0xf
  v_perm_b32 v40, v222, v218, s85
  v_perm_b32 v41, v222, v218, s86
  v_perm_b32 v42, v223, v219, s85
  v_perm_b32 v43, v223, v219, s86
  v_dot2c_f32_bf16_dpp v20, v44, v40 row_newbcast:8 row_mask:0xf bank_mask:0xf
  v_dot2c_f32_bf16_dpp v21, v44, v41 row_newbcast:8 row_mask:0xf bank_mask:0xf
  v_dot2c_f32_bf16_dpp v22, v44, v42 row_newbcast:8 row_mask:0xf bank_mask:0xf
  v_dot2c_f32_bf16_dpp v23, v44, v43 row_newbcast:8 row_mask:0xf bank_mask:0xf
  v_dot2c_f32_bf16_dpp v28, v44, v40 row_newbcast:12 row_mask:0xf bank_mask:0xf
  v_dot2c_f32_bf16_dpp v29, v44, v41 row_newbcast:12 row_mask:0xf bank_mask:0xf
  v_dot2c_f32_bf16_dpp v30, v44, v42 row_newbcast:12 row_mask:0xf bank_mask:0xf
  v_dot2c_f32_bf16_dpp v31, v44, v43 row_newbcast:12 row_mask:0xf bank_mask:0xf
  s_waitcnt vmcnt(10)
  v_perm_b32 v171, v180, v176, s85
  v_perm_b32 v180, v180, v176, s86
  v_perm_b32 v176, v181, v177, s85
  v_perm_b32 v181, v181, v177, s86
  v_perm_b32 v177, v182, v178, s85
  v_perm_b32 v182, v182, v178, s86
  v_perm_b32 v178, v183, v179, s85
  v_perm_b32 v183, v183, v179, s86
  s_waitcnt vmcnt(8)
  v_perm_b32 v179, v188, v184, s85
  v_perm_b32 v188, v188, v184, s86
  v_perm_b32 v184, v189, v185, s85
  v_perm_b32 v189, v189, v185, s86
  v_perm_b32 v185, v190, v186, s85
  v_perm_b32 v190, v190, v186, s86
  v_perm_b32 v186, v191, v187, s85
  v_perm_b32 v191, v191, v187, s86
  v_and_b32 v5, 15, v1
  v_lshlrev_b32 v5, 5, v5
  v_bfe_u32 v6, v1, 4, 1
  v_lshl_add_u32 v5, v6, 4, v5
  v_lshrrev_b32 v6, 5, v1
  v_lshl_add_u32 v5, v6, 9, v5
  s_lshl_b32 s83, s82, 10
  s_add_u32 s83, s83, 147456
  v_add_u32 v207, s83, v5
  v_bfe_u32 v6, v1, 2, 1
  v_lshlrev_b32 v6, 5, v6
  s_lshl_b32 s83, s82, 2
  v_add_u32 v199, s83, v6
  v_lshrrev_b32 v5, 3, v1
  v_and_b32 v6, 7, v1
  s_lshl_b32 s83, s82, 7
  s_add_u32 s83, s83, 147456
  s_lshr_b32 s84, s82, 2
  s_lshl_b32 s84, s84, 5
  v_lshl_add_u32 v201, v6, 2, s84
  v_lshl_add_u32 v200, v5, 4, s83
  v_lshl_add_u32 v200, v6, 10, v200
  s_lshr_b32 s84, s84, 2
  v_mov_b32 v202, s84
  s_mul_i32 s83, s82, 2304
  v_lshlrev_b32 v6, 5, v6
  v_lshl_add_u32 v204, v5, 2, v6
  v_add_u32 v204, s83, v204
  v_lshl_add_u32 v203, v1, 5, s83
  v_lshlrev_b32 v206, 4, v0
  v_cmp_le_u32 vcc, 144, v0
  v_mov_b32 v5, 6912
  s_nop 0
  v_cndmask_b32 v205, 0, v5, vcc
  v_add_u32 v205, v205, v206
  s_waitcnt vmcnt(4)
  s_mov_b32 s24, s54
  s_mov_b32 s25, s55
  s_mov_b32 s26, 2
  s_mov_b32 s27, 0x20000
  v_mov_b32 v7, 0
  buffer_load_ushort v192, v7, s[24:27], 0 offen
  s_mul_i32 s83, s90, 18
  s_add_u32 s20, s36, s83
  s_addc_u32 s21, s37, 0
  s_mov_b32 s22, 18
  s_mov_b32 s23, 0x20000
  v_lshrrev_b32 v196, 2, v1
  v_and_b32 v195, 7, v1
  v_cmp_eq_u32 vcc, 0, v195
  v_mov_b32 v195, 16
  s_nop 0
  v_cndmask_b32 v196, v195, v196, vcc
  buffer_load_ushort v193, v196, s[20:23], 0 offen
  s_mov_b32 s32, s58
  s_mov_b32 s33, s59
  s_mov_b32 s34, 256
  s_mov_b32 s35, 0x20000
  v_lshlrev_b32 v195, 2, v1
  buffer_load_dword v194, v195, s[32:35], 0 offen sc1
  v_dot2_f32_bf16 v32, v224, v8, 0
  v_dot2_f32_bf16 v36, v224, v12, 0
  v_dot2_f32_bf16 v33, v228, v8, 0
  v_dot2_f32_bf16 v37, v228, v12, 0
  v_dot2_f32_bf16 v34, v232, v8, 0
  v_dot2_f32_bf16 v38, v232, v12, 0
  v_dot2_f32_bf16 v35, v236, v8, 0
  v_dot2_f32_bf16 v39, v236, v12, 0
  v_dot2_f32_bf16 v32, v225, v9, v32
  v_dot2_f32_bf16 v36, v225, v13, v36
  v_dot2_f32_bf16 v33, v229, v9, v33
  v_dot2_f32_bf16 v37, v229, v13, v37
  v_dot2_f32_bf16 v34, v233, v9, v34
  v_dot2_f32_bf16 v38, v233, v13, v38
  v_dot2_f32_bf16 v35, v237, v9, v35
  v_dot2_f32_bf16 v39, v237, v13, v39
  v_dot2_f32_bf16 v32, v226, v10, v32
  v_dot2_f32_bf16 v36, v226, v14, v36
  v_dot2_f32_bf16 v33, v230, v10, v33
  v_dot2_f32_bf16 v37, v230, v14, v37
  v_dot2_f32_bf16 v34, v234, v10, v34
  v_dot2_f32_bf16 v38, v234, v14, v38
  v_dot2_f32_bf16 v35, v238, v10, v35
  v_dot2_f32_bf16 v39, v238, v14, v39
  v_dot2_f32_bf16 v32, v227, v11, v32
  v_dot2_f32_bf16 v36, v227, v15, v36
  v_dot2_f32_bf16 v33, v231, v11, v33
  v_dot2_f32_bf16 v37, v231, v15, v37
  v_dot2_f32_bf16 v34, v235, v11, v34
  v_dot2_f32_bf16 v38, v235, v15, v38
  v_dot2_f32_bf16 v35, v239, v11, v35
  v_dot2_f32_bf16 v39, v239, v15, v39
  v_add_f32_dpp v32, v32, v32 row_ror:8 row_mask:0xf bank_mask:0x3
  v_add_f32_dpp v33, v33, v33 row_ror:8 row_mask:0xf bank_mask:0x3
  v_add_f32_dpp v36, v36, v36 row_ror:8 row_mask:0xf bank_mask:0x3
  v_add_f32_dpp v37, v37, v37 row_ror:8 row_mask:0xf bank_mask:0x3
  v_add_f32_dpp v32, v34, v34 row_ror:8 row_mask:0xf bank_mask:0xc
  v_add_f32_dpp v33, v35, v35 row_ror:8 row_mask:0xf bank_mask:0xc
  v_add_f32_dpp v36, v38, v38 row_ror:8 row_mask:0xf bank_mask:0xc
  v_add_f32_dpp v37, v39, v39 row_ror:8 row_mask:0xf bank_mask:0xc
  v_add_f32_dpp v32, v32, v32 row_shl:4 row_mask:0xf bank_mask:0x5
  v_add_f32_dpp v33, v33, v33 row_shl:4 row_mask:0xf bank_mask:0x5
  s_nop 0
  v_add_f32_dpp v32, v36, v36 row_shr:4 row_mask:0xf bank_mask:0xa
  v_add_f32_dpp v33, v37, v37 row_shr:4 row_mask:0xf bank_mask:0xa
  s_nop 0
  v_add_f32_dpp v32, v32, v32 quad_perm:[1,0,3,2] row_mask:0xf bank_mask:0xf
  v_add_f32_dpp v33, v33, v33 quad_perm:[1,0,3,2] row_mask:0xf bank_mask:0xf
  s_nop 0
  v_add_f32_dpp v32, v32, v32 quad_perm:[2,3,0,1] row_mask:0xf bank_mask:0xf
  v_add_f32_dpp v33, v33, v33 quad_perm:[2,3,0,1] row_mask:0xf bank_mask:0xf
  v_cvt_pk_bf16_f32 v34, v32, v33
  v_lshlrev_b32 v32, 16, v34
  v_and_b32 v33, s87, v34
  v_mul_f32 v32, s88, v32
  v_mul_f32 v33, s88, v33
  v_cvt_pk_bf16_f32 v34, v32, v33
  v_lshlrev_b32 v32, 16, v34
  v_and_b32 v33, s87, v34
  v_max_f32 v35, v32, v33
  s_nop 1
  v_max_f32_dpp v35, v35, v35 row_ror:8 row_mask:0xf bank_mask:0xf
  v_mul_f32 v35, s89, v35
  v_max_f32 v35, v35, v3
  v_mov_b32 v37, v35
  s_nop 1
  v_permlane16_swap_b32 v35, v37
  v_max_f32 v35, v35, v37
  v_mov_b32 v37, v35
  s_nop 1
  v_permlane32_swap_b32 v35, v37
  v_max_f32 v35, v35, v37
  v_sub_f32 v36, v3, v35
  v_fma_f32 v32, v32, s89, -v35
  v_fma_f32 v33, v33, s89, -v35
  v_exp_f32 v36, v36
  v_exp_f32 v32, v32
  v_exp_f32 v33, v33
  v_mov_b32 v3, v35
  v_fma_f32 v4, v4, v36, v32
  v_cvt_pk_bf16_f32 v44, v32, v33
  v_add_f32 v4, v4, v33
  v_mul_f32_dpp v16, v36, v16 row_newbcast:0 row_mask:0xf bank_mask:0xf
  v_mul_f32_dpp v17, v36, v17 row_newbcast:0 row_mask:0xf bank_mask:0xf
  v_mul_f32_dpp v18, v36, v18 row_newbcast:0 row_mask:0xf bank_mask:0xf
  v_mul_f32_dpp v19, v36, v19 row_newbcast:0 row_mask:0xf bank_mask:0xf
  v_mul_f32_dpp v20, v36, v20 row_newbcast:0 row_mask:0xf bank_mask:0xf
  v_mul_f32_dpp v21, v36, v21 row_newbcast:0 row_mask:0xf bank_mask:0xf
  v_mul_f32_dpp v22, v36, v22 row_newbcast:0 row_mask:0xf bank_mask:0xf
  v_mul_f32_dpp v23, v36, v23 row_newbcast:0 row_mask:0xf bank_mask:0xf
  v_mul_f32_dpp v24, v36, v24 row_newbcast:4 row_mask:0xf bank_mask:0xf
  v_mul_f32_dpp v25, v36, v25 row_newbcast:4 row_mask:0xf bank_mask:0xf
  v_mul_f32_dpp v26, v36, v26 row_newbcast:4 row_mask:0xf bank_mask:0xf
  v_mul_f32_dpp v27, v36, v27 row_newbcast:4 row_mask:0xf bank_mask:0xf
  v_mul_f32_dpp v28, v36, v28 row_newbcast:4 row_mask:0xf bank_mask:0xf
  v_mul_f32_dpp v29, v36, v29 row_newbcast:4 row_mask:0xf bank_mask:0xf
  v_mul_f32_dpp v30, v36, v30 row_newbcast:4 row_mask:0xf bank_mask:0xf
  v_mul_f32_dpp v31, v36, v31 row_newbcast:4 row_mask:0xf bank_mask:0xf
  ds_write_b32 v199, v3 offset:9216
  v_add_f32_dpp v4, v4, v4 row_ror:8 row_mask:0xf bank_mask:0xf
  v_mov_b32 v37, v4
  s_nop 1
  v_permlane16_swap_b32 v4, v37
  v_add_f32 v4, v4, v37
  v_mov_b32 v37, v4
  s_nop 1
  v_permlane32_swap_b32 v4, v37
  v_add_f32 v4, v4, v37
  ds_write_b32 v199, v4 offset:9280
  s_waitcnt vmcnt(3)
  v_perm_b32 v40, v244, v240, s85
  v_perm_b32 v41, v244, v240, s86
  v_perm_b32 v42, v245, v241, s85
  v_perm_b32 v43, v245, v241, s86
  v_dot2c_f32_bf16_dpp v16, v44, v40 row_newbcast:0 row_mask:0xf bank_mask:0xf
  v_dot2c_f32_bf16_dpp v17, v44, v41 row_newbcast:0 row_mask:0xf bank_mask:0xf
  v_dot2c_f32_bf16_dpp v18, v44, v42 row_newbcast:0 row_mask:0xf bank_mask:0xf
  v_dot2c_f32_bf16_dpp v19, v44, v43 row_newbcast:0 row_mask:0xf bank_mask:0xf
  v_dot2c_f32_bf16_dpp v24, v44, v40 row_newbcast:4 row_mask:0xf bank_mask:0xf
  v_dot2c_f32_bf16_dpp v25, v44, v41 row_newbcast:4 row_mask:0xf bank_mask:0xf
  v_dot2c_f32_bf16_dpp v26, v44, v42 row_newbcast:4 row_mask:0xf bank_mask:0xf
  v_dot2c_f32_bf16_dpp v27, v44, v43 row_newbcast:4 row_mask:0xf bank_mask:0xf
  v_perm_b32 v40, v246, v242, s85
  v_perm_b32 v41, v246, v242, s86
  v_perm_b32 v42, v247, v243, s85
  v_perm_b32 v43, v247, v243, s86
  v_dot2c_f32_bf16_dpp v20, v44, v40 row_newbcast:0 row_mask:0xf bank_mask:0xf
  v_dot2c_f32_bf16_dpp v21, v44, v41 row_newbcast:0 row_mask:0xf bank_mask:0xf
  v_dot2c_f32_bf16_dpp v22, v44, v42 row_newbcast:0 row_mask:0xf bank_mask:0xf
  v_dot2c_f32_bf16_dpp v23, v44, v43 row_newbcast:0 row_mask:0xf bank_mask:0xf
  v_dot2c_f32_bf16_dpp v28, v44, v40 row_newbcast:4 row_mask:0xf bank_mask:0xf
  v_dot2c_f32_bf16_dpp v29, v44, v41 row_newbcast:4 row_mask:0xf bank_mask:0xf
  v_dot2c_f32_bf16_dpp v30, v44, v42 row_newbcast:4 row_mask:0xf bank_mask:0xf
  v_dot2c_f32_bf16_dpp v31, v44, v43 row_newbcast:4 row_mask:0xf bank_mask:0xf
  v_perm_b32 v40, v252, v248, s85
  v_perm_b32 v41, v252, v248, s86
  v_perm_b32 v42, v253, v249, s85
  v_perm_b32 v43, v253, v249, s86
  v_dot2c_f32_bf16_dpp v16, v44, v40 row_newbcast:8 row_mask:0xf bank_mask:0xf
  v_dot2c_f32_bf16_dpp v17, v44, v41 row_newbcast:8 row_mask:0xf bank_mask:0xf
  v_dot2c_f32_bf16_dpp v18, v44, v42 row_newbcast:8 row_mask:0xf bank_mask:0xf
  v_dot2c_f32_bf16_dpp v19, v44, v43 row_newbcast:8 row_mask:0xf bank_mask:0xf
  v_dot2c_f32_bf16_dpp v24, v44, v40 row_newbcast:12 row_mask:0xf bank_mask:0xf
  v_dot2c_f32_bf16_dpp v25, v44, v41 row_newbcast:12 row_mask:0xf bank_mask:0xf
  v_dot2c_f32_bf16_dpp v26, v44, v42 row_newbcast:12 row_mask:0xf bank_mask:0xf
  v_dot2c_f32_bf16_dpp v27, v44, v43 row_newbcast:12 row_mask:0xf bank_mask:0xf
  v_perm_b32 v40, v254, v250, s85
  v_perm_b32 v41, v254, v250, s86
  v_perm_b32 v42, v255, v251, s85
  v_perm_b32 v43, v255, v251, s86
  v_dot2c_f32_bf16_dpp v20, v44, v40 row_newbcast:8 row_mask:0xf bank_mask:0xf
  v_dot2c_f32_bf16_dpp v21, v44, v41 row_newbcast:8 row_mask:0xf bank_mask:0xf
  v_dot2c_f32_bf16_dpp v22, v44, v42 row_newbcast:8 row_mask:0xf bank_mask:0xf
  v_dot2c_f32_bf16_dpp v23, v44, v43 row_newbcast:8 row_mask:0xf bank_mask:0xf
  v_dot2c_f32_bf16_dpp v28, v44, v40 row_newbcast:12 row_mask:0xf bank_mask:0xf
  v_dot2c_f32_bf16_dpp v29, v44, v41 row_newbcast:12 row_mask:0xf bank_mask:0xf
  v_dot2c_f32_bf16_dpp v30, v44, v42 row_newbcast:12 row_mask:0xf bank_mask:0xf
  v_dot2c_f32_bf16_dpp v31, v44, v43 row_newbcast:12 row_mask:0xf bank_mask:0xf
  v_permlane32_swap_b32 v16, v24
  v_permlane32_swap_b32 v17, v25
  v_permlane32_swap_b32 v18, v26
  v_permlane32_swap_b32 v19, v27
  v_permlane32_swap_b32 v20, v28
  v_permlane32_swap_b32 v21, v29
  v_permlane32_swap_b32 v22, v30
  v_permlane32_swap_b32 v23, v31
  v_add_f32 v16, v16, v24
  v_add_f32 v17, v17, v25
  v_add_f32 v18, v18, v26
  v_add_f32 v19, v19, v27
  v_add_f32 v20, v20, v28
  v_add_f32 v21, v21, v29
  v_add_f32 v22, v22, v30
  v_add_f32 v23, v23, v31
  v_permlane16_swap_b32 v16, v20
  v_permlane16_swap_b32 v17, v21
  v_permlane16_swap_b32 v18, v22
  v_permlane16_swap_b32 v19, v23
  v_add_f32 v16, v16, v20
  v_add_f32 v17, v17, v21
  v_add_f32 v18, v18, v22
  v_add_f32 v19, v19, v23
  ds_write_b128 v207, v[16:19]
  s_waitcnt lgkmcnt(0)
  s_barrier
  ds_read_b32 v240, v201 offset:9216
  ds_read_b32 v248, v201 offset:9280
  ds_read_b128 v[208:211], v200
  s_waitcnt lgkmcnt(2)
  v_max_f32_dpp v32, v240, v240 quad_perm:[1,0,3,2] row_mask:0xf bank_mask:0xf
  s_nop 1
  v_max_f32_dpp v32, v32, v32 quad_perm:[2,3,0,1] row_mask:0xf bank_mask:0xf
  s_nop 1
  v_max_f32_dpp v32, v32, v32 row_half_mirror row_mask:0xf bank_mask:0xf
  v_sub_f32 v240, v240, v32
  v_exp_f32 v240, v240
  s_waitcnt lgkmcnt(0)
  v_mul_f32 v33, v240, v248
  v_mul_f32 v34, v240, v208
  v_mul_f32 v35, v240, v209
  v_mul_f32 v36, v240, v210
  v_mul_f32 v37, v240, v211
  v_add_f32_dpp v34, v34, v34 quad_perm:[1,0,3,2] row_mask:0xf bank_mask:0xf
  v_add_f32_dpp v35, v35, v35 quad_perm:[1,0,3,2] row_mask:0xf bank_mask:0xf
  v_add_f32_dpp v36, v36, v36 quad_perm:[1,0,3,2] row_mask:0xf bank_mask:0xf
  v_add_f32_dpp v37, v37, v37 quad_perm:[1,0,3,2] row_mask:0xf bank_mask:0xf
  v_add_f32_dpp v33, v33, v33 quad_perm:[1,0,3,2] row_mask:0xf bank_mask:0xf
  v_add_f32_dpp v34, v34, v34 quad_perm:[2,3,0,1] row_mask:0xf bank_mask:0xf
  v_add_f32_dpp v35, v35, v35 quad_perm:[2,3,0,1] row_mask:0xf bank_mask:0xf
  v_add_f32_dpp v36, v36, v36 quad_perm:[2,3,0,1] row_mask:0xf bank_mask:0xf
  v_add_f32_dpp v37, v37, v37 quad_perm:[2,3,0,1] row_mask:0xf bank_mask:0xf
  v_add_f32_dpp v33, v33, v33 quad_perm:[2,3,0,1] row_mask:0xf bank_mask:0xf
  v_add_f32_dpp v34, v34, v34 row_half_mirror row_mask:0xf bank_mask:0xf
  v_add_f32_dpp v35, v35, v35 row_half_mirror row_mask:0xf bank_mask:0xf
  v_add_f32_dpp v36, v36, v36 row_half_mirror row_mask:0xf bank_mask:0xf
  v_add_f32_dpp v37, v37, v37 row_half_mirror row_mask:0xf bank_mask:0xf
  v_add_f32_dpp v33, v33, v33 row_half_mirror row_mask:0xf bank_mask:0xf
  v_cvt_pk_bf16_f32 v38, v34, v35
  v_cvt_pk_bf16_f32 v39, v36, v37
  v_readlane_b32 s64, v38, 0
  v_readlane_b32 s65, v39, 0
  v_readlane_b32 s66, v38, 8
  v_readlane_b32 s67, v39, 8
  v_readlane_b32 s68, v38, 16
  v_readlane_b32 s69, v39, 16
  v_readlane_b32 s70, v38, 24
  v_readlane_b32 s71, v39, 24
  v_readlane_b32 s72, v38, 32
  v_readlane_b32 s73, v39, 32
  v_readlane_b32 s74, v38, 40
  v_readlane_b32 s75, v39, 40
  v_readlane_b32 s76, v38, 48
  v_readlane_b32 s77, v39, 48
  v_readlane_b32 s78, v38, 56
  v_readlane_b32 s79, v39, 56
  ds_write_b64 v202, v[32:33] offset:9344
  v_dot2_f32_bf16 v24, v171, v38, 0
  v_dot2_f32_bf16 v25, v180, v38, 0
  v_dot2_f32_bf16 v26, v176, v38, 0
  v_dot2_f32_bf16 v27, v181, v38, 0
  v_dot2_f32_bf16 v28, v177, v38, 0
  v_dot2_f32_bf16 v29, v182, v38, 0
  v_dot2_f32_bf16 v30, v178, v38, 0
  v_dot2_f32_bf16 v31, v183, v38, 0
  v_dot2_f32_bf16 v24, v179, v39, v24
  v_dot2_f32_bf16 v25, v188, v39, v25
  v_dot2_f32_bf16 v26, v184, v39, v26
  v_dot2_f32_bf16 v27, v189, v39, v27
  v_dot2_f32_bf16 v28, v185, v39, v28
  v_dot2_f32_bf16 v29, v190, v39, v29
  v_dot2_f32_bf16 v30, v186, v39, v30
  v_dot2_f32_bf16 v31, v191, v39, v31
  v_dot2_f32_bf16 v16, v45, s64, 0
  v_dot2_f32_bf16 v17, v52, s64, 0
  v_dot2_f32_bf16 v18, v48, s64, 0
  v_dot2_f32_bf16 v19, v53, s64, 0
  v_dot2_f32_bf16 v20, v49, s64, 0
  v_dot2_f32_bf16 v21, v54, s64, 0
  v_dot2_f32_bf16 v22, v50, s64, 0
  v_dot2_f32_bf16 v23, v55, s64, 0
  v_dot2_f32_bf16 v16, v51, s65, v16
  v_dot2_f32_bf16 v17, v60, s65, v17
  v_dot2_f32_bf16 v18, v56, s65, v18
  v_dot2_f32_bf16 v19, v61, s65, v19
  v_dot2_f32_bf16 v20, v57, s65, v20
  v_dot2_f32_bf16 v21, v62, s65, v21
  v_dot2_f32_bf16 v22, v58, s65, v22
  v_dot2_f32_bf16 v23, v63, s65, v23
  v_dot2_f32_bf16 v16, v59, s66, v16
  v_dot2_f32_bf16 v17, v68, s66, v17
  v_dot2_f32_bf16 v18, v64, s66, v18
  v_dot2_f32_bf16 v19, v69, s66, v19
  v_dot2_f32_bf16 v20, v65, s66, v20
  v_dot2_f32_bf16 v21, v70, s66, v21
  v_dot2_f32_bf16 v22, v66, s66, v22
  v_dot2_f32_bf16 v23, v71, s66, v23
  v_dot2_f32_bf16 v16, v67, s67, v16
  v_dot2_f32_bf16 v17, v76, s67, v17
  v_dot2_f32_bf16 v18, v72, s67, v18
  v_dot2_f32_bf16 v19, v77, s67, v19
  v_dot2_f32_bf16 v20, v73, s67, v20
  v_dot2_f32_bf16 v21, v78, s67, v21
  v_dot2_f32_bf16 v22, v74, s67, v22
  v_dot2_f32_bf16 v23, v79, s67, v23
  v_dot2_f32_bf16 v16, v75, s68, v16
  v_dot2_f32_bf16 v17, v84, s68, v17
  v_dot2_f32_bf16 v18, v80, s68, v18
  v_dot2_f32_bf16 v19, v85, s68, v19
  v_dot2_f32_bf16 v20, v81, s68, v20
  v_dot2_f32_bf16 v21, v86, s68, v21
  v_dot2_f32_bf16 v22, v82, s68, v22
  v_dot2_f32_bf16 v23, v87, s68, v23
  v_dot2_f32_bf16 v16, v83, s69, v16
  v_dot2_f32_bf16 v17, v92, s69, v17
  v_dot2_f32_bf16 v18, v88, s69, v18
  v_dot2_f32_bf16 v19, v93, s69, v19
  v_dot2_f32_bf16 v20, v89, s69, v20
  v_dot2_f32_bf16 v21, v94, s69, v21
  v_dot2_f32_bf16 v22, v90, s69, v22
  v_dot2_f32_bf16 v23, v95, s69, v23
  v_dot2_f32_bf16 v16, v91, s70, v16
  v_dot2_f32_bf16 v17, v100, s70, v17
  v_dot2_f32_bf16 v18, v96, s70, v18
  v_dot2_f32_bf16 v19, v101, s70, v19
  v_dot2_f32_bf16 v20, v97, s70, v20
  v_dot2_f32_bf16 v21, v102, s70, v21
  v_dot2_f32_bf16 v22, v98, s70, v22
  v_dot2_f32_bf16 v23, v103, s70, v23
  v_dot2_f32_bf16 v16, v99, s71, v16
  v_dot2_f32_bf16 v17, v108, s71, v17
  v_dot2_f32_bf16 v18, v104, s71, v18
  v_dot2_f32_bf16 v19, v109, s71, v19
  v_dot2_f32_bf16 v20, v105, s71, v20
  v_dot2_f32_bf16 v21, v110, s71, v21
  v_dot2_f32_bf16 v22, v106, s71, v22
  v_dot2_f32_bf16 v23, v111, s71, v23
  v_dot2_f32_bf16 v16, v107, s72, v16
  v_dot2_f32_bf16 v17, v116, s72, v17
  v_dot2_f32_bf16 v18, v112, s72, v18
  v_dot2_f32_bf16 v19, v117, s72, v19
  v_dot2_f32_bf16 v20, v113, s72, v20
  v_dot2_f32_bf16 v21, v118, s72, v21
  v_dot2_f32_bf16 v22, v114, s72, v22
  v_dot2_f32_bf16 v23, v119, s72, v23
  v_dot2_f32_bf16 v16, v115, s73, v16
  v_dot2_f32_bf16 v17, v124, s73, v17
  v_dot2_f32_bf16 v18, v120, s73, v18
  v_dot2_f32_bf16 v19, v125, s73, v19
  v_dot2_f32_bf16 v20, v121, s73, v20
  v_dot2_f32_bf16 v21, v126, s73, v21
  v_dot2_f32_bf16 v22, v122, s73, v22
  v_dot2_f32_bf16 v23, v127, s73, v23
  v_dot2_f32_bf16 v16, v123, s74, v16
  v_dot2_f32_bf16 v17, v132, s74, v17
  v_dot2_f32_bf16 v18, v128, s74, v18
  v_dot2_f32_bf16 v19, v133, s74, v19
  v_dot2_f32_bf16 v20, v129, s74, v20
  v_dot2_f32_bf16 v21, v134, s74, v21
  v_dot2_f32_bf16 v22, v130, s74, v22
  v_dot2_f32_bf16 v23, v135, s74, v23
  v_dot2_f32_bf16 v16, v131, s75, v16
  v_dot2_f32_bf16 v17, v140, s75, v17
  v_dot2_f32_bf16 v18, v136, s75, v18
  v_dot2_f32_bf16 v19, v141, s75, v19
  v_dot2_f32_bf16 v20, v137, s75, v20
  v_dot2_f32_bf16 v21, v142, s75, v21
  v_dot2_f32_bf16 v22, v138, s75, v22
  v_dot2_f32_bf16 v23, v143, s75, v23
  v_dot2_f32_bf16 v16, v139, s76, v16
  v_dot2_f32_bf16 v17, v148, s76, v17
  v_dot2_f32_bf16 v18, v144, s76, v18
  v_dot2_f32_bf16 v19, v149, s76, v19
  v_dot2_f32_bf16 v20, v145, s76, v20
  v_dot2_f32_bf16 v21, v150, s76, v21
  v_dot2_f32_bf16 v22, v146, s76, v22
  v_dot2_f32_bf16 v23, v151, s76, v23
  v_dot2_f32_bf16 v16, v147, s77, v16
  v_dot2_f32_bf16 v17, v156, s77, v17
  v_dot2_f32_bf16 v18, v152, s77, v18
  v_dot2_f32_bf16 v19, v157, s77, v19
  v_dot2_f32_bf16 v20, v153, s77, v20
  v_dot2_f32_bf16 v21, v158, s77, v21
  v_dot2_f32_bf16 v22, v154, s77, v22
  v_dot2_f32_bf16 v23, v159, s77, v23
  v_dot2_f32_bf16 v16, v155, s78, v16
  v_dot2_f32_bf16 v17, v164, s78, v17
  v_dot2_f32_bf16 v18, v160, s78, v18
  v_dot2_f32_bf16 v19, v165, s78, v19
  v_dot2_f32_bf16 v20, v161, s78, v20
  v_dot2_f32_bf16 v21, v166, s78, v21
  v_dot2_f32_bf16 v22, v162, s78, v22
  v_dot2_f32_bf16 v23, v167, s78, v23
  v_dot2_f32_bf16 v16, v163, s79, v16
  v_dot2_f32_bf16 v17, v172, s79, v17
  v_dot2_f32_bf16 v18, v168, s79, v18
  v_dot2_f32_bf16 v19, v173, s79, v19
  v_dot2_f32_bf16 v20, v169, s79, v20
  v_dot2_f32_bf16 v21, v174, s79, v21
  v_dot2_f32_bf16 v22, v170, s79, v22
  v_dot2_f32_bf16 v23, v175, s79, v23
  v_permlane32_swap_b32 v24, v28
  v_permlane32_swap_b32 v25, v29
  v_permlane32_swap_b32 v26, v30
  v_permlane32_swap_b32 v27, v31
  v_add_f32 v24, v24, v28
  v_add_f32 v25, v25, v29
  v_add_f32 v26, v26, v30
  v_add_f32 v27, v27, v31
  s_nop 0
  v_permlane16_swap_b32 v24, v26
  v_permlane16_swap_b32 v25, v27
  v_add_f32 v24, v24, v26
  v_add_f32 v25, v25, v27
  s_nop 0
  v_add_f32_dpp v24, v24, v24 row_ror:8 row_mask:0xf bank_mask:0x3
  s_nop 1
  v_add_f32_dpp v24, v25, v25 row_ror:8 row_mask:0xf bank_mask:0xc
  ds_write_b128 v203, v[16:19] offset:16384
  ds_write_b128 v203, v[20:23] offset:16400
  ds_write_b32 v204, v24 offset:18432
  s_waitcnt lgkmcnt(0)
  s_barrier
  s_cmp_ge_u32 s82, 5
  s_cbranch_scc1 K1_W5B
  v_cmp_gt_u32 vcc, 288, v0
  s_nop 0
  s_and_saveexec_b64 s[96:97], vcc
  ds_read_b128 v[208:211], v205 offset:16384
  ds_read_b128 v[212:215], v205 offset:18688
  ds_read_b128 v[216:219], v205 offset:20992
  ds_read_b128 v[220:223], v205 offset:23296
  s_waitcnt lgkmcnt(0)
  v_add_f32 v208, v208, v212
  v_add_f32 v216, v216, v220
  v_add_f32 v209, v209, v213
  v_add_f32 v217, v217, v221
  v_add_f32 v210, v210, v214
  v_add_f32 v218, v218, v222
  v_add_f32 v211, v211, v215
  v_add_f32 v219, v219, v223
  v_add_f32 v208, v208, v216
  v_add_f32 v209, v209, v217
  v_add_f32 v210, v210, v218
  v_add_f32 v211, v211, v219
  buffer_store_dwordx4 v[208:211], v206, s[28:31], 0 offen sc1
  s_branch K1_FINB
K1_W5B:
  s_nop 4
  s_cmp_lg_u32 s82, 5
  s_cbranch_scc1 K1_W6B
  s_mov_b64 exec, 1
  v_mov_b32 v5, 0
  ds_read_b128 v[208:211], v5 offset:9344
  s_waitcnt lgkmcnt(0)
  s_movk_i32 s83, 4608
  buffer_store_dwordx4 v[208:211], v5, s[28:31], s83 offen sc1
  s_branch K1_FINB
K1_W6B:
  s_nop 4
  s_cmp_lg_u32 s82, 6
  s_cbranch_scc1 K1_FINB
  v_lshlrev_b32 v5, 1, v196
  ds_read_b32 v208, v5 offset:8704
  ds_read_b32 v209, v5 offset:8768
  ds_read_b32 v210, v5 offset:8832
  ds_read_b32 v211, v5 offset:8896
  ds_read_b32 v212, v5 offset:8960
  ds_read_b32 v213, v5 offset:9024
  ds_read_b32 v214, v5 offset:9088
  ds_read_b32 v215, v5 offset:9152
  s_waitcnt lgkmcnt(0)
  v_add_f32 v208, v208, v212
  v_add_f32 v209, v209, v213
  v_add_f32 v210, v210, v214
  v_add_f32 v211, v211, v215
  v_add_f32 v208, v208, v210
  v_add_f32 v209, v209, v211
  v_add_f32 v208, v208, v209
  v_cvt_pk_bf16_f32 v208, v208, v208
  v_and_b32 v208, s87, v208
  s_waitcnt vmcnt(0)
  v_lshlrev_b32 v216, 16, v192
  v_add_f32 v208, v208, v216
  v_cvt_pk_bf16_f32 v208, v208, v208
  v_and_b32 v208, s87, v208
  v_mul_f32 v209, s89, v208
  v_exp_f32 v209, -v209
  s_nop 0
  v_add_f32 v209, 1.0, v209
  v_rcp_f32 v210, v209
  s_nop 0
  v_mul_f32 v211, v208, v210
  v_fma_f32 v212, -v211, v209, v208
  v_fma_f32 v211, v212, v210, v211
  v_cvt_pk_bf16_f32 v211, v211, v211
  v_and_b32 v211, s87, v211
  v_mov_b32 v197, v211
  s_mov_b64 exec, -1
  v_mul_u32_u24 v5, 5120, v1
  s_mul_i32 s84, s81, 36
  v_add_u32 v6, s84, v5
  s_mul_i32 s83, s80, 327680
  s_add_u32 s28, s60, s83
  s_addc_u32 s29, s61, 0
  s_mov_b32 s30, 327680
  s_mov_b32 s31, 0x20000
  s_mul_i32 s83, s90, 18
  s_add_u32 s24, s56, s83
  s_addc_u32 s25, s57, 0
  s_mov_b32 s26, 18
  s_mov_b32 s27, 0x20000
  v_and_b32 v7, 7, v1
  v_cmp_eq_u32 s[96:97], 2, v7
  s_mov_b32 s91, 0
K1_STB:
  s_nop 4
  v_cndmask_b32 v198, 0, v194, s[96:97]
  s_nop 1
  v_add_u32_dpp v198, v198, v198 row_ror:8 row_mask:0xf bank_mask:0xf
  s_nop 1
  v_add_u32_dpp v198, v198, v198 row_ror:4 row_mask:0xf bank_mask:0xf
  s_nop 1
  v_add_u32_dpp v198, v198, v198 row_ror:2 row_mask:0xf bank_mask:0xf
  s_nop 1
  v_add_u32_dpp v198, v198, v198 row_ror:1 row_mask:0xf bank_mask:0xf
  v_mov_b32 v199, v198
  s_nop 1
  v_permlane16_swap_b32 v198, v199
  v_add_u32 v198, v198, v199
  v_mov_b32 v199, v198
  s_nop 1
  v_permlane32_swap_b32 v198, v199
  v_add_u32 v198, v198, v199
  s_nop 0
  v_readfirstlane_b32 s83, v198
  s_nop 1
  s_cmp_eq_u32 s83, 256
  s_cbranch_scc1 K1_STOKB
  s_add_u32 s91, s91, 1
  s_cmp_gt_u32 s91, 20000
  s_cbranch_scc1 K1_STOKB
  s_sleep 16
  buffer_load_dword v194, v195, s[32:35], 0 offen sc1
  s_waitcnt vmcnt(0)
  s_branch K1_STB
K1_STOKB:
  s_nop 4
  s_mov_b64 s[96:97], -1
  s_movk_i32 s84, 4608
K1_PLB:
  s_nop 4
  s_mov_b64 exec, s[96:97]
  buffer_load_dwordx4 v[232:235], v5, s[28:31], s84 offen sc1
  buffer_load_dwordx4 v[208:211], v6, s[28:31], 0 offen sc1
  buffer_load_dwordx4 v[212:215], v6, s[28:31], 0 offen offset:16 sc1
  buffer_load_dword v216, v6, s[28:31], 0 offen offset:32 sc1
  buffer_load_dwordx4 v[220:223], v6, s[28:31], 0 offen offset:2304 sc1
  buffer_load_dwordx4 v[224:227], v6, s[28:31], 0 offen offset:2320 sc1
  buffer_load_dword v228, v6, s[28:31], 0 offen offset:2336 sc1
  s_waitcnt vmcnt(0)
  v_max3_u32 v198, v208, v209, v210
  v_max3_u32 v199, v211, v212, v213
  v_max3_u32 v198, v198, v214, v215
  v_max3_u32 v199, v199, v216, v220
  v_max3_u32 v198, v198, v221, v222
  v_max3_u32 v199, v199, v223, v224
  v_max3_u32 v198, v198, v225, v226
  v_max3_u32 v199, v199, v227, v228
  v_max3_u32 v198, v198, v232, v233
  v_max3_u32 v199, v199, v234, v235
  v_max_u32 v198, v198, v199
  v_cmp_eq_u32 s[96:97], -1, v198
  s_nop 1
  s_cmp_eq_u64 s[96:97], 0
  s_cbranch_scc1 K1_PDB
  s_add_u32 s91, s91, 1
  s_cmp_gt_u32 s91, 20000
  s_cbranch_scc1 K1_PDB
  s_bcnt1_i32_b64 s83, s[96:97]
  s_cmp_le_u32 s83, 8
  s_cbranch_scc1 K1_PSB
  s_sleep 24
K1_PSB:
  s_nop 4
  s_sleep 4
  s_branch K1_PLB
K1_PDB:
  s_nop 4
  s_mov_b64 exec, -1
  v_max_f32_dpp v242, v232, v232 quad_perm:[1,0,3,2] row_mask:0xf bank_mask:0xf
  s_nop 1
  v_max_f32_dpp v242, v242, v242 quad_perm:[2,3,0,1] row_mask:0xf bank_mask:0xf
  v_sub_f32 v242, v232, v242
  v_exp_f32 v240, v242
  s_nop 0
  v_mul_f32 v242, v240, v233
  s_nop 1
  v_add_f32_dpp v242, v242, v242 quad_perm:[1,0,3,2] row_mask:0xf bank_mask:0xf
  s_nop 1
  v_add_f32_dpp v242, v242, v242 quad_perm:[2,3,0,1] row_mask:0xf bank_mask:0xf
  v_rcp_f32 v242, v242
  s_nop 0
  v_mul_f32 v240, v240, v242
  v_max_f32_dpp v242, v234, v234 quad_perm:[1,0,3,2] row_mask:0xf bank_mask:0xf
  s_nop 1
  v_max_f32_dpp v242, v242, v242 quad_perm:[2,3,0,1] row_mask:0xf bank_mask:0xf
  v_sub_f32 v242, v234, v242
  v_exp_f32 v241, v242
  s_nop 0
  v_mul_f32 v242, v241, v235
  s_nop 1
  v_add_f32_dpp v242, v242, v242 quad_perm:[1,0,3,2] row_mask:0xf bank_mask:0xf
  s_nop 1
  v_add_f32_dpp v242, v242, v242 quad_perm:[2,3,0,1] row_mask:0xf bank_mask:0xf
  v_rcp_f32 v242, v242
  s_nop 0
  v_mul_f32 v241, v241, v242
  v_mul_f32 v208, v240, v208
  v_mul_f32 v209, v240, v209
  v_mul_f32 v210, v240, v210
  v_mul_f32 v211, v240, v211
  v_mul_f32 v212, v240, v212
  v_mul_f32 v213, v240, v213
  v_mul_f32 v214, v240, v214
  v_mul_f32 v215, v240, v215
  v_mul_f32 v216, v240, v216
  v_fmac_f32 v208, v241, v220
  v_fmac_f32 v209, v241, v221
  v_fmac_f32 v210, v241, v222
  v_fmac_f32 v211, v241, v223
  v_fmac_f32 v212, v241, v224
  v_fmac_f32 v213, v241, v225
  v_fmac_f32 v214, v241, v226
  v_fmac_f32 v215, v241, v227
  v_fmac_f32 v216, v241, v228
  v_mov_b32 v220, v216
  v_permlane32_swap_b32 v208, v212
  v_permlane32_swap_b32 v209, v213
  v_permlane32_swap_b32 v210, v214
  v_permlane32_swap_b32 v211, v215
  v_permlane32_swap_b32 v216, v220
  v_add_f32 v208, v208, v212
  v_add_f32 v209, v209, v213
  v_add_f32 v210, v210, v214
  v_add_f32 v211, v211, v215
  v_add_f32 v216, v216, v220
  v_mov_b32 v220, v216
  v_permlane16_swap_b32 v208, v210
  v_permlane16_swap_b32 v209, v211
  v_permlane16_swap_b32 v216, v220
  v_add_f32 v208, v208, v210
  v_add_f32 v209, v209, v211
  v_add_f32 v216, v216, v220
  v_and_b32 v242, 7, v1
  v_cmp_eq_u32 vcc, 0, v242
  v_add_f32_dpp v208, v208, v208 row_ror:8 row_mask:0xf bank_mask:0x3
  v_add_f32_dpp v216, v216, v216 row_ror:8 row_mask:0xf bank_mask:0xf
  s_nop 0
  v_add_f32_dpp v208, v209, v209 row_ror:8 row_mask:0xf bank_mask:0xc
  v_add_f32_dpp v216, v216, v216 quad_perm:[1,0,3,2] row_mask:0xf bank_mask:0xf
  s_nop 0
  v_add_f32_dpp v208, v208, v208 quad_perm:[1,0,3,2] row_mask:0xf bank_mask:0xf
  v_add_f32_dpp v216, v216, v216 quad_perm:[2,3,0,1] row_mask:0xf bank_mask:0xf
  s_nop 0
  v_add_f32_dpp v208, v208, v208 quad_perm:[2,3,0,1] row_mask:0xf bank_mask:0xf
  v_add_f32_dpp v216, v216, v216 row_half_mirror row_mask:0xf bank_mask:0xf
  s_nop 0
  v_add_f32_dpp v208, v208, v208 row_half_mirror row_mask:0xf bank_mask:0xf
  v_cndmask_b32 v208, v216, v208, vcc
  v_cvt_pk_bf16_f32 v208, v208, v208
  v_and_b32 v208, s87, v208
  v_mul_f32 v208, v208, v197
  v_cvt_pk_bf16_f32 v208, v208, v208
  v_and_b32 v208, s87, v208
  v_lshlrev_b32 v193, 16, v193
  v_add_f32 v208, v208, v193
  v_cvt_pk_bf16_f32 v208, v208, v208
  s_mov_b32 exec_lo, 0x01010103
  s_mov_b32 exec_hi, 0x01010101
  buffer_store_short v208, v196, s[24:27], 0 offen
K1_FINB:
  s_nop 4
  s_endpgm
K1_TK:
  s_nop 4
  s_mov_b32 s32, s58
  s_mov_b32 s33, s59
  s_mov_b32 s34, 256
  s_mov_b32 s35, 0x20000
  s_mov_b64 exec, 1
  s_mov_b32 s91, 0
K1_TKL:
  s_nop 4
  s_lshr_b32 s83, s62, 1
  s_lshl_b32 s83, s83, 5
  s_and_b32 s84, s62, 1
  s_lshl_b32 s84, s84, 2
  s_add_u32 s83, s83, s84
  v_mov_b32 v41, s83
  v_mov_b32 v40, 1
  buffer_atomic_add v40, v41, s[32:35], 0 offen sc0
  s_waitcnt vmcnt(0)
  v_readfirstlane_b32 s83, v40
  s_nop 1
  s_cmp_lt_u32 s83, 16
  s_cbranch_scc1 K1_TKOK
  s_add_u32 s62, s62, 1
  s_and_b32 s62, s62, 15
  s_add_u32 s91, s91, 1
  s_cmp_lt_u32 s91, 64
  s_cbranch_scc1 K1_TKL
  s_and_b32 s83, s83, 15
K1_TKOK:
  s_nop 4
  s_lshl_b32 s101, s62, 4
  s_or_b32 s101, s101, s83
  v_mov_b32 v40, s101
  v_mov_b32 v41, 0
  ds_write_b32 v41, v40 offset:9408
  s_mov_b64 exec, -1
  s_waitcnt lgkmcnt(0)
  s_barrier
  s_lshr_b32 s62, s101, 4
  s_and_b32 s62, s62, 15
  s_and_b32 s63, s101, 3
  s_bfe_u32 s80, s101, 131074
  s_lshl_b32 s81, s62, 2
  s_or_b32 s81, s81, s63
  s_lshl_b32 s90, s80, 6
  s_or_b32 s90, s90, s81
  s_lshl_b32 s83, s90, 19
  s_add_u32 s4, s38, s83
  s_addc_u32 s5, s39, 0
  s_mov_b32 s6, 524288
  s_mov_b32 s7, 0x20000
  s_add_u32 s8, s40, s83
  s_addc_u32 s9, s41, 0
  s_mov_b32 s10, 524288
  s_mov_b32 s11, 0x20000
  s_mul_i32 s83, s90, 5120
  s_add_u32 s28, s60, s83
  s_addc_u32 s29, s61, 0
  s_mov_b32 s30, 5120
  s_mov_b32 s31, 0x20000
  v_mov_b32 v40, -1
  v_mov_b32 v41, -1
  v_mov_b32 v42, -1
  v_mov_b32 v43, -1
  v_lshlrev_b32 v5, 4, v1
  buffer_store_dwordx4 v[40:43], v5, s[28:31], 0 offen offset:0 sc1
  buffer_store_dwordx4 v[40:43], v5, s[28:31], 0 offen offset:1024 sc1
  buffer_store_dwordx4 v[40:43], v5, s[28:31], 0 offen offset:2048 sc1
  buffer_store_dwordx4 v[40:43], v5, s[28:31], 0 offen offset:3072 sc1
  s_movk_i32 s83, 4096
  buffer_store_dwordx4 v[40:43], v5, s[28:31], s83 offen sc1
  s_lshl_b32 s83, s100, 5
  s_add_u32 s83, s83, 8
  v_mov_b32 v45, s83
  v_mov_b32 v44, 1
  s_waitcnt vmcnt(0)
  s_mov_b64 exec, 1
  buffer_atomic_add v44, v45, s[32:35], 0 offen
  s_mov_b64 exec, -1
  s_bitcmp1_b32 s2, 7
  s_cbranch_scc1 K1_RQ2B
  s_branch K1_RQ2A
K1_END:
  s_nop 4
  s_endpgm
.section .rodata,"a"
.p2align 6
.amdhsa_kernel recurrent_scan__gqa_block_cached__mixer_token_mlp__decode_kernel
  .amdhsa_next_free_vgpr 256
  .amdhsa_next_free_sgpr 102
  .amdhsa_accum_offset 256
  .amdhsa_group_segment_fixed_size 0
  .amdhsa_kernarg_size 104
  .amdhsa_user_sgpr_count 2
  .amdhsa_user_sgpr_kernarg_segment_ptr 1
  .amdhsa_system_sgpr_workgroup_id_x 1
.end_amdhsa_kernel
```
